```python
import torch

def _softmax(x, axis=-1):
    return torch.softmax(x, dim=axis)
def _gelu(x):
    return torch.nn.functional.gelu(x, approximate="tanh")
def _silu(x):
    return torch.nn.functional.silu(x)
def _sigmoid(x):
    return torch.sigmoid(x)
def _layernorm(x, axis=-1, eps=1e-5):
    m = x.mean(dim=axis, keepdim=True)
    v = x.var(dim=axis, keepdim=True, unbiased=False)
    return (x - m) / torch.sqrt(v + eps)
def _scatter_add(tgt, idx, src, axis=0):
    return tgt.clone().index_add_(axis, idx, src)
def _segment_sum(src, seg, n):
    out = torch.zeros((n,) + src.shape[1:], dtype=src.dtype)
    return out.index_add_(0, seg, src)
def _pad(x, pw):
    flat = tuple(v for pair in reversed(pw) for v in pair)
    return torch.nn.functional.pad(x, flat)

kernel_name = 'gated_mix__spectral_gfnet__swiglu_ffn__prompt'

def setup_inputs():

    _w = (lambda a: (lambda t: t.to(torch.bfloat16) if t.is_floating_point() else t)(torch.as_tensor(a)))
    def _A_setup():
        B, S, D = 1, 2048, 1024
        Df = D // 2 + 1
        return {
            "x": _w((lambda *s: torch.randn(*s, dtype=torch.bfloat16) * 0.05)(B, S, D)),
            "w_r": _w((lambda *s: torch.randn(*s, dtype=torch.bfloat16) * 1.6)(S, Df) * 0.02),
            "w_i": _w((lambda *s: torch.randn(*s, dtype=torch.bfloat16) * 1.6)(S, Df) * 0.02),
        }
    _A_in = _A_setup()

    def _B_setup():
        B, S, D, F = 1, 2048, 1024, 3584
        return {
            "x": _w((lambda *s: torch.randn(*s, dtype=torch.bfloat16) * 0.05)(B, S, D)),
            "w_gate": _w((lambda *s: torch.randn(*s, dtype=torch.bfloat16) * 0.05)(D, F)),
            "w_up": _w((lambda *s: torch.randn(*s, dtype=torch.bfloat16) * 0.05)(D, F)),
            "w_down": _w((lambda *s: torch.randn(*s, dtype=torch.bfloat16) * 0.05)(F, D)),
        }
    _B_in = _B_setup()

    return {
        "A_x": _A_in["x"],
        "A_w_r": _A_in["w_r"],
        "A_w_i": _A_in["w_i"],
        "B_x": _B_in["x"],
        "B_w_gate": _B_in["w_gate"],
        "B_w_up": _B_in["w_up"],
        "B_w_down": _B_in["w_down"],
        "gate_w": _w((lambda *s: torch.randn(*s, dtype=torch.bfloat16) * 0.05)(1024) * 16.0),
    }

def reference(A_x, A_w_r, A_w_i, B_x, B_w_gate, B_w_up, B_w_down, gate_w):
    def _A_ref(x, w_r, w_i):
        B, S, D = x.shape
        X = (lambda x, axes=(-2,-1): torch.fft.rfft2(x.float(), dim=axes))(x, axes=(-2, -1))
        W = w_r + 1j * w_i
        X = X * W
        y = (lambda x, s, axes=(-2,-1): torch.fft.irfft2(x, s=s, dim=axes).to(torch.bfloat16))(X, (S, D), axes=(-2, -1))
        return y

    def _B_ref(x, w_gate, w_up, w_down):
        g = _silu(x @ w_gate)
        u = x @ w_up
        return (g * u) @ w_down

    x = A_x
    g = _sigmoid((x * gate_w).sum(-1, keepdims=True))
    a = _A_ref(x, A_w_r, A_w_i)
    b = _B_ref(x, B_w_gate, B_w_up, B_w_down)
    return g * a + (1 - g) * b
```

```asm
; @launch grid=(256,1,1) block=(256,1,1) lds=163840
.amdgcn_target "amdgcn-amd-amdhsa--gfx950"
.text
.globl gated_mix__spectral_gfnet__swiglu_ffn__prompt_kernel
.p2align 8
.type gated_mix__spectral_gfnet__swiglu_ffn__prompt_kernel,@function
gated_mix__spectral_gfnet__swiglu_ffn__prompt_kernel:
    s_cmp_ge_u32 s2, 256
    s_cbranch_scc1 Lend0
    s_cmp_ge_u32 s2, 32
    s_cbranch_scc1 Lg1
    s_load_dwordx2 s[4:5], s[0:1], 0
    s_load_dwordx4 s[52:55], s[0:1], 8
    s_load_dwordx2 s[56:57], s[0:1], 56
    s_load_dwordx4 s[40:43], s[0:1], 72
    v_lshrrev_b32 v2, 6, v0
    v_and_b32 v1, 63, v0
    v_readfirstlane_b32 s32, v2
    v_lshlrev_b32 v2, 4, v1
    s_mov_b32 s33, s2
    s_waitcnt lgkmcnt(0)
    s_mov_b32 s6, s42
    s_mov_b32 s7, s43
    s_mov_b32 s8, s4
    s_mov_b32 s9, s5
    s_mov_b32 s10, 0x400000
    s_mov_b32 s11, 0x20000
    s_mov_b32 s24, s56
    s_mov_b32 s25, s57
    s_mov_b32 s26, 0x800
    s_mov_b32 s27, 0x20000
    s_lshl_b32 s84, s2, 14
    s_lshl_b32 s85, s32, 12
    s_add_u32 s84, s84, s85
    s_mul_i32 s85, s32, 4128
    s_add_u32 m0, s85, 65536
    s_nop 0
    buffer_load_dwordx4 v2, s[8:11], s84 offen lds
    s_add_u32 m0, s85, 66560
    s_add_u32 s84, s84, 1024
    buffer_load_dwordx4 v2, s[8:11], s84 offen lds
    s_add_u32 m0, s85, 67600
    s_add_u32 s84, s84, 1024
    buffer_load_dwordx4 v2, s[8:11], s84 offen lds
    s_add_u32 m0, s85, 68624
    s_add_u32 s84, s84, 1024
    buffer_load_dwordx4 v2, s[8:11], s84 offen lds
    v_lshrrev_b32 v224, 5, v1
    v_lshl_add_u32 v224, v224, 12, v2
    s_lshl_b32 s84, s32, 9
    s_lshl_b32 s85, s32, 10
    s_add_u32 m0, s85, 86144
    s_nop 0
    buffer_load_dwordx4 v224, s[24:27], s84 offen lds
    s_mov_b32 s20, s6
    s_mov_b32 s21, s7
    s_mov_b32 s22, 0x3000000
    s_mov_b32 s23, 0x20000
    s_mov_b32 s28, s40
    s_mov_b32 s29, s41
    s_mov_b32 s30, 0x100
    s_mov_b32 s31, 0x20000
    v_readfirstlane_b32 s34, v0
    s_nop 3
    s_or_b32 s34, s34, s2
    s_cbranch_scc1 Lpub_1
    s_mov_b32 s34, 47251456
    buffer_load_dword v12, off, s[20:23], s34 sc1
    s_waitcnt vmcnt(0)
    v_add_u32 v12, 8, v12
    v_mov_b32 v13, 1
    s_mov_b64 exec, 1
    buffer_store_dwordx2 v[12:13], off, s[28:31], 0 sc1
    s_mov_b64 exec, -1
Lpub_1:
    s_mov_b32 s12, s52
    s_mov_b32 s13, s53
    s_mov_b32 s14, 0x201000
    s_mov_b32 s15, 0x20000
    s_mov_b32 s16, s54
    s_mov_b32 s17, s55
    s_mov_b32 s18, 0x201000
    s_mov_b32 s19, 0x20000
    s_getpc_b64 s[44:45]
Lpc_2:
    s_lshr_b32 s46, s2, 3
    s_lshl_b32 s46, s46, 12
    v_lshl_add_u32 v14, v0, 4, s46
    v_min_u32 v14, Lcode_end-gated_mix__spectral_gfnet__swiglu_ffn__prompt_kernel-4, v14
    s_sub_u32 s44, s44, Lpc_2-gated_mix__spectral_gfnet__swiglu_ffn__prompt_kernel
    s_subb_u32 s45, s45, 0
    v_mov_b32 v15, s45
    v_add_co_u32 v14, vcc, s44, v14
    s_nop 1
    v_addc_co_u32 v15, vcc, 0, v15, vcc
    global_load_dword v3, v[14:15], off
    v_bfe_u32 v232, v1, 4, 1
    v_bfe_u32 v233, v1, 2, 1
    v_lshlrev_b32 v232, 3, v232
    v_lshl_add_u32 v232, v233, 2, v232
    v_bfe_u32 v233, v1, 3, 1
    s_mov_b32 s87, 0xbd000000
    s_cmp_eq_u32 s32, 1
    v_lshl_add_u32 v232, v233, 1, v232
    s_cselect_b64 vcc, -1, 0
    s_cselect_b32 s86, 0x3e800000, 0
    s_cselect_b32 s87, 0x3d000000, s87
    v_bfe_u32 v233, v1, 1, 1
    s_cmp_eq_u32 s32, 2
    v_and_b32 v228, 31, v1
    v_add_u32 v232, v232, v233
    s_cselect_b32 s87, 0xba800000, s87
    v_cvt_f32_u32 v228, v228
    v_cvt_f32_u32 v232, v232
    s_cmp_eq_u32 s32, 3
    v_and_b32 v233, 1, v1
    s_cselect_b32 s87, 0x3d000000, s87
    v_cndmask_b32 v228, v228, v232, vcc
    v_cvt_f32_u32 v233, v233
    v_mul_f32 v226, s87, v228
    s_cmp_eq_u32 s32, 3
    v_lshrrev_b32 v229, 5, v1
    v_mul_f32 v233, s86, v233
    s_cselect_b32 s87, -69504, 0
    v_lshlrev_b32 v229, 2, v229
    s_lshl_b32 s86, s32, 12
    v_cvt_f32_u32 v229, v229
    s_add_u32 s86, s86, s87
    v_fma_f32 v227, v226, v229, v233
    s_add_u32 s86, s86, 147456
    v_add_f32 v231, 0x3e800000, v227
    v_add_u32 v232, s86, v2
    s_nop 1
    s_cmp_lg_u32 s32, 3
    s_cbranch_scc1 Lcb_3
    v_fmamk_f32 v82, v226, 0x3f800000, v227
    v_fmamk_f32 v83, v226, 0x3f800000, v231
    v_fmamk_f32 v84, v226, 0x40000000, v227
    v_fmamk_f32 v85, v226, 0x40000000, v231
    v_fmamk_f32 v86, v226, 0x40400000, v227
    v_fmamk_f32 v87, v226, 0x40400000, v231
    v_fmamk_f32 v88, v226, 0x41000000, v227
    v_fmamk_f32 v89, v226, 0x41000000, v231
    v_fmamk_f32 v90, v226, 0x41100000, v227
    v_fmamk_f32 v91, v226, 0x41100000, v231
    v_fmamk_f32 v92, v226, 0x41200000, v227
    v_fmamk_f32 v93, v226, 0x41200000, v231
    v_fmamk_f32 v94, v226, 0x41300000, v227
    v_fmamk_f32 v95, v226, 0x41300000, v231
    v_cos_f32 v66, v82
    v_cos_f32 v67, v83
    v_cos_f32 v68, v84
    v_cos_f32 v69, v85
    v_cos_f32 v70, v86
    v_cos_f32 v71, v87
    v_cos_f32 v72, v88
    v_cos_f32 v73, v89
    v_cos_f32 v74, v90
    v_cos_f32 v75, v91
    v_cos_f32 v76, v92
    v_cos_f32 v77, v93
    v_cos_f32 v78, v94
    v_cos_f32 v79, v95
    v_cos_f32 v64, v227
    v_sin_f32 v80, v227
    v_cos_f32 v65, v231
    v_sin_f32 v81, v231
    v_sin_f32 v82, v82
    v_sin_f32 v83, v83
    v_sin_f32 v84, v84
    v_sin_f32 v85, v85
    v_sin_f32 v86, v86
    v_sin_f32 v87, v87
    v_sin_f32 v88, v88
    v_sin_f32 v89, v89
    v_sin_f32 v90, v90
    v_sin_f32 v91, v91
    v_sin_f32 v92, v92
    v_sin_f32 v93, v93
    v_sin_f32 v94, v94
    v_sin_f32 v95, v95
    s_nop 1
    s_branch Lcp_6
Lcb_3:
    v_fmamk_f32 v81, v226, 0x3f800000, v227
    v_fmamk_f32 v82, v226, 0x40000000, v227
    v_fmamk_f32 v83, v226, 0x40400000, v227
    v_fmamk_f32 v84, v226, 0x41000000, v227
    v_fmamk_f32 v85, v226, 0x41100000, v227
    v_fmamk_f32 v86, v226, 0x41200000, v227
    v_fmamk_f32 v87, v226, 0x41300000, v227
    v_fmamk_f32 v88, v226, 0x41800000, v227
    v_fmamk_f32 v89, v226, 0x41880000, v227
    v_fmamk_f32 v90, v226, 0x41900000, v227
    v_fmamk_f32 v91, v226, 0x41980000, v227
    v_fmamk_f32 v92, v226, 0x41c00000, v227
    v_fmamk_f32 v93, v226, 0x41c80000, v227
    v_fmamk_f32 v94, v226, 0x41d00000, v227
    v_fmamk_f32 v95, v226, 0x41d80000, v227
    v_cos_f32 v65, v81
    v_cos_f32 v66, v82
    v_cos_f32 v67, v83
    v_cos_f32 v68, v84
    v_cos_f32 v69, v85
    v_cos_f32 v70, v86
    v_cos_f32 v71, v87
    v_cos_f32 v72, v88
    v_cos_f32 v73, v89
    v_cos_f32 v74, v90
    v_cos_f32 v75, v91
    v_cos_f32 v76, v92
    v_cos_f32 v77, v93
    v_cos_f32 v78, v94
    v_cos_f32 v79, v95
    v_cos_f32 v64, v227
    v_sin_f32 v80, v227
    v_sin_f32 v81, v81
    v_sin_f32 v82, v82
    v_sin_f32 v83, v83
    v_sin_f32 v84, v84
    v_sin_f32 v85, v85
    v_sin_f32 v86, v86
    v_sin_f32 v87, v87
    v_sin_f32 v88, v88
    v_sin_f32 v89, v89
    v_sin_f32 v90, v90
    v_sin_f32 v91, v91
    v_sin_f32 v92, v92
    v_sin_f32 v93, v93
    v_sin_f32 v94, v94
    v_sin_f32 v95, v95
    s_nop 1
    s_cmp_eq_u32 s32, 2
    s_cbranch_scc1 Lcw_4
Lcp_6:
    v_cvt_pk_bf16_f32 v96, v64, v65
    v_cvt_pk_bf16_f32 v97, v66, v67
    v_cvt_pk_bf16_f32 v98, v68, v69
    v_cvt_pk_bf16_f32 v99, v70, v71
    v_cvt_pk_bf16_f32 v100, v72, v73
    v_cvt_pk_bf16_f32 v101, v74, v75
    v_cvt_pk_bf16_f32 v102, v76, v77
    v_cvt_pk_bf16_f32 v103, v78, v79
    v_cvt_pk_bf16_f32 v104, v80, v81
    v_cvt_pk_bf16_f32 v105, v82, v83
    v_cvt_pk_bf16_f32 v106, v84, v85
    v_cvt_pk_bf16_f32 v107, v86, v87
    v_cvt_pk_bf16_f32 v108, v88, v89
    v_cvt_pk_bf16_f32 v109, v90, v91
    v_cvt_pk_bf16_f32 v110, v92, v93
    v_cvt_pk_bf16_f32 v111, v94, v95
    ds_write_b128 v232, v[96:99] offset:0
    ds_write_b128 v232, v[100:103] offset:1024
    ds_write_b128 v232, v[104:107] offset:2048
    ds_write_b128 v232, v[108:111] offset:3072
    s_branch Lcd_5
Lcw_4:
    ds_write_b128 v232, v[64:67] offset:0
    ds_write_b128 v232, v[68:71] offset:1024
    ds_write_b128 v232, v[72:75] offset:2048
    ds_write_b128 v232, v[76:79] offset:3072
    ds_write_b128 v232, v[80:83] offset:4096
    ds_write_b128 v232, v[84:87] offset:5120
    ds_write_b128 v232, v[88:91] offset:6144
    ds_write_b128 v232, v[92:95] offset:7168
Lcd_5:
    v_and_b32 v179, 7, v1
    v_mul_u32_u24 v179, 2064, v179
    v_lshrrev_b32 v180, 4, v1
    s_mul_i32 s85, s32, 4128
    v_bfe_u32 v176, v1, 2, 2
    v_lshrrev_b32 v177, 5, v1
    v_lshl_add_u32 v34, v180, 4, v179
    s_add_u32 s85, s85, 65536
    v_lshl_add_u32 v176, v177, 2, v176
    v_and_b32 v179, 15, v1
    s_lshl_b32 s86, s32, 9
    v_bfe_u32 v178, v1, 4, 1
    v_lshlrev_b32 v176, 6, v176
    v_cmp_eq_u32 vcc, 1, v179
    s_add_u32 s86, s86, 65536
    v_lshl_add_u32 v176, v178, 5, v176
    v_min_u32 v179, 1, v179
    s_mov_b32 s84, 147456
    s_lshl_b32 s87, s32, 10
    v_and_b32 v178, 3, v1
    v_mov_b32 v181, 0xbf803f80
    v_lshlrev_b32 v179, 9, v179
    v_add_u32 v32, s84, v2
    s_add_u32 s88, s87, 86144
    v_lshl_add_u32 v176, v178, 3, v176
    v_lshl_add_u32 v179, v180, 4, v179
    s_mov_b32 s84, 90240
    v_cndmask_b32 v40, 0, v181, vcc
    s_add_u32 s87, s87, 82048
    v_add_u32 v39, s84, v2
    v_add_u32 v33, s85, v176
    v_add_u32 v34, s86, v34
    v_mov_b32 v41, v40
    v_mov_b32 v42, v40
    v_mov_b32 v43, v40
    v_add_u32 v35, s88, v179
    v_add_u32 v38, s87, v2
    s_nop 1
    s_waitcnt vmcnt(1) lgkmcnt(0)
    s_barrier
    ds_read_b64_tr_b16 a[224:225], v33 offset:0
    ds_read_b64_tr_b16 a[226:227], v33 offset:512
    ds_read_b64_tr_b16 a[232:233], v33 offset:2064
    ds_read_b64_tr_b16 a[234:235], v33 offset:2576
    ds_read_b64_tr_b16 a[228:229], v33 offset:1024
    ds_read_b64_tr_b16 a[230:231], v33 offset:1536
    ds_read_b64_tr_b16 a[236:237], v33 offset:3088
    ds_read_b64_tr_b16 a[238:239], v33 offset:3600
    ds_read_b128 a[192:195], v32 offset:0
    ds_read_b128 a[200:203], v32 offset:2048
    ds_read_b128 a[196:199], v32 offset:1024
    ds_read_b128 a[204:207], v32 offset:3072
    ds_read_b128 v[160:163], v34 offset:0
    ds_read_b128 v[224:227], v35 offset:0
    ds_read_b128 v[164:167], v34 offset:64
    ds_read_b128 v[228:231], v35 offset:64
    s_lshr_b32 s89, s2, 3
    s_lshl_b32 s89, s89, 12
    s_and_b32 s90, s2, 7
    ds_read_b128 v[168:171], v34 offset:128
    ds_read_b128 v[232:235], v35 offset:128
    s_lshl_b32 s90, s90, 7
    s_add_u32 s89, s89, s90
    s_mul_i32 s90, s32, 1051648
    s_add_u32 s89, s89, s90
    ds_read_b128 v[172:175], v34 offset:192
    ds_read_b128 v[236:239], v35 offset:192
    s_add_u32 s89, s89, 33554432
    s_mov_b32 s36, s33
    s_lshr_b32 s39, s36, 2
    s_lshl_b32 s39, s39, 5
    s_and_b32 s40, s36, 3
    s_waitcnt lgkmcnt(11)
    v_mfma_f32_32x32x16_bf16 v[96:111], a[224:227], a[192:195], 0
    ds_read_b128 v[176:179], v34 offset:256
    ds_read_b128 v[240:243], v35 offset:256
    s_lshl_b32 s40, s40, 9
    s_mov_b32 s38, 0
    s_add_u32 s39, s39, s40
    s_waitcnt lgkmcnt(8)
    v_mfma_f32_16x16x32_bf16 a[128:131], v[160:163], v[224:227], 0
    v_bfe_u32 v15, v1, 2, 1
    v_mfma_f32_16x16x32_bf16 a[132:135], v[160:163], v[40:43], 0
    s_mul_i32 s39, s39, 1026
    s_lshl_b32 s40, s38, 10
    s_waitcnt lgkmcnt(6)
    v_mfma_f32_16x16x32_bf16 a[128:131], v[164:167], v[228:231], a[128:131]
    v_and_b32 v14, 3, v1
    s_mov_b32 s37, 8
    v_mfma_f32_16x16x32_bf16 a[132:135], v[164:167], v[40:43], a[132:135]
    s_add_u32 s39, s39, s40
    v_lshl_add_u32 v14, v15, 5, v14
    s_waitcnt lgkmcnt(4)
    v_mfma_f32_16x16x32_bf16 a[128:131], v[168:171], v[232:235], a[128:131]
    ds_read_b128 v[180:183], v34 offset:320
    v_mfma_f32_16x16x32_bf16 a[132:135], v[168:171], v[40:43], a[132:135]
    ds_read_b128 v[244:247], v35 offset:320
    s_waitcnt lgkmcnt(4)
    v_mfma_f32_16x16x32_bf16 a[128:131], v[172:175], v[236:239], a[128:131]
    s_lshl_b32 s40, s37, 7
    v_mul_u32_u24 v52, 8208, v14
    v_mfma_f32_16x16x32_bf16 a[132:135], v[172:175], v[40:43], a[132:135]
    v_lshrrev_b32 v15, 3, v1
    s_mov_b32 s41, 0
    s_waitcnt lgkmcnt(2)
    v_mfma_f32_16x16x32_bf16 a[128:131], v[176:179], v[240:243], a[128:131]
    s_add_u32 s39, s39, s40
    v_lshl_add_u32 v52, v15, 10, v52
    v_mfma_f32_16x16x32_bf16 a[132:135], v[176:179], v[40:43], a[132:135]
    s_add_u32 s39, s39, s41
    v_add_u32 v52, s39, v52
    v_mfma_f32_32x32x16_bf16 v[112:127], a[224:227], a[200:203], 0
    ds_read_b128 v[184:187], v34 offset:384
    ds_read_b128 v[248:251], v35 offset:384
    s_mul_i32 s39, s37, 548864
    s_mul_i32 s40, s38, 8448
    s_sub_u32 s39, s39, s40
    s_waitcnt lgkmcnt(3)
    v_mfma_f32_16x16x32_bf16 a[132:135], v[180:183], v[40:43], a[132:135]
    s_lshl_b32 s40, s36, 10
    s_add_u32 s39, s39, s40
    s_waitcnt lgkmcnt(2)
    v_mfma_f32_16x16x32_bf16 a[128:131], v[180:183], v[244:247], a[128:131]
    ds_read_b128 v[188:191], v34 offset:448
    v_mfma_f32_32x32x16_bf16 v[128:143], a[232:235], a[192:195], 0
    ds_read_b128 v[252:255], v35 offset:448
    s_add_u32 s39, s39, 42142720
    s_add_u32 s39, s39, s41
    s_lshl_b32 s36, s2, 1
    s_and_b32 s37, s32, 1
    v_mfma_f32_32x32x16_bf16 v[144:159], a[232:235], a[200:203], 0
    s_add_u32 s36, s36, s37
    s_cmp_lt_u32 s32, 2
    s_cselect_b32 s41, 0x40000000, 0
    v_and_b32 v53, 7, v1
    s_and_b32 s37, s36, 7
    v_mul_u32_u24 v15, 8448, v15
    s_waitcnt lgkmcnt(2)
    v_mfma_f32_16x16x32_bf16 a[128:131], v[184:187], v[248:251], a[128:131]
    v_lshlrev_b32 v53, 4, v53
    s_lshr_b32 s36, s36, 3
    v_mfma_f32_16x16x32_bf16 a[132:135], v[184:187], v[40:43], a[132:135]
    v_sub_u32 v53, v53, v15
    s_and_b32 s38, s36, 7
    v_mfma_f32_32x32x16_bf16 v[96:111], a[228:231], a[196:199], v[96:111]
    v_add_u32 v53, s39, v53
    s_lshr_b32 s36, s36, 3
    s_lshr_b32 s39, s36, 2
    s_lshl_b32 s39, s39, 5
    s_and_b32 s40, s36, 3
    s_lshl_b32 s40, s40, 9
    s_waitcnt lgkmcnt(0)
    v_mfma_f32_16x16x32_bf16 a[128:131], v[188:191], v[252:255], a[128:131]
    s_add_u32 s39, s39, s40
    v_bfe_u32 v214, v1, 2, 2
    v_mfma_f32_16x16x32_bf16 a[132:135], v[188:191], v[40:43], a[132:135]
    v_bfe_u32 v15, v1, 2, 1
    v_mfma_f32_32x32x16_bf16 v[112:127], a[228:231], a[204:207], v[112:127]
    s_mul_i32 s39, s39, 1026
    s_lshl_b32 s40, s38, 10
    v_and_b32 v14, 3, v1
    s_add_u32 s39, s39, s40
    v_mul_u32_u24 v214, 2064, v214
    v_mfma_f32_32x32x16_bf16 v[128:143], a[236:239], a[196:199], v[128:143]
    v_lshl_add_u32 v14, v15, 5, v14
    v_lshrrev_b32 v209, 5, v1
    s_lshl_b32 s40, s37, 7
    v_lshl_add_u32 v214, v209, 6, v214
    v_mul_u32_u24 v54, 8208, v14
    v_mfma_f32_32x32x16_bf16 v[144:159], a[236:239], a[204:207], v[144:159]
    v_and_b32 v215, 1, v1
    v_lshrrev_b32 v15, 3, v1
    s_add_u32 s39, s39, s40
    v_lshl_add_u32 v214, v215, 3, v214
    v_lshl_add_u32 v54, v15, 4, v54
    s_add_u32 s39, s39, s41
    v_bfe_u32 v215, v1, 4, 1
    v_bfe_u32 v216, v1, 1, 1
    v_add_u32 v54, s39, v54
    v_bfe_u32 v210, v1, 1, 2
    s_mul_i32 s39, s37, 548864
    s_mul_i32 s40, s38, 8448
    v_lshl_add_u32 v215, v215, 1, v216
    v_xor_b32 v210, v210, v209
    s_sub_u32 s39, s39, s40
    v_bfe_u32 v216, v1, 3, 2
    v_and_b32 v208, 31, v1
    v_lshlrev_b32 v210, 4, v210
    s_lshl_b32 s40, s36, 10
    v_mul_u32_u24 v217, 131456, v209
    v_lshl_add_u32 v208, v208, 6, v210
    v_lshlrev_b32 v216, 10, v216
    v_and_b32 v55, 7, v1
    s_add_u32 s39, s39, s40
    v_add_u32 v216, v216, v217
    v_mul_u32_u24 v15, 68608, v15
    v_add_u32 v36, s85, v208
    v_lshlrev_b32 v55, 4, v55
    s_add_u32 s39, s39, 42142720
    v_add_u32 v214, s86, v214
    v_xor_b32 v218, 0, v215
    v_xor_b32 v219, 1, v215
    v_xor_b32 v220, 2, v215
    v_xor_b32 v221, 3, v215
    v_and_b32 v217, 7, v1
    v_xor_b32 v208, 32, v208
    s_mov_b32 s60, 65664
    s_mov_b32 s61, 131328
    s_mov_b32 s62, 196992
    s_mov_b32 s63, 0x05040100
    s_mov_b32 s64, 0x07060302
    s_add_u32 s39, s39, s41
    v_add_u32 v55, v55, v15
    ds_read_b128 v[64:67], v32 offset:8192
    ds_read_b128 v[68:71], v32 offset:9216
    ds_read_b128 v[72:75], v32 offset:10240
    ds_read_b128 v[76:79], v32 offset:11264
    ds_read_b128 v[80:83], v32 offset:12288
    ds_read_b128 v[84:87], v32 offset:13312
    ds_read_b128 v[88:91], v32 offset:14336
    ds_read_b128 v[92:95], v32 offset:15360
    buffer_load_dwordx2 v[4:5], off, s[28:31], 0 sc1
    v_lshl_add_u32 v44, v218, 4, v214
    v_lshl_add_u32 v45, v219, 4, v214
    v_lshl_add_u32 v46, v220, 4, v214
    v_lshl_add_u32 v47, v221, 4, v214
    v_lshl_add_u32 v48, v217, 4, v216
    v_add_u32 v37, s85, v208
    v_add_u32 v55, s39, v55
    s_mov_b32 s60, 65664
    s_mov_b32 s61, 131328
    s_mov_b32 s62, 196992
    s_mov_b32 s63, 0x05040100
    s_mov_b32 s64, 0x07060302
    s_nop 1
    s_waitcnt lgkmcnt(0)
    s_barrier
    ds_read_b128 a[208:211], v32 offset:4096
    ds_read_b128 a[212:215], v32 offset:5120
    ds_read_b128 a[216:219], v32 offset:6144
    ds_read_b128 a[220:223], v32 offset:7168
    v_pk_mul_f32 v[192:193], v[112:113], v[80:81]
    v_pk_mul_f32 v[194:195], v[114:115], v[82:83]
    v_pk_mul_f32 v[196:197], v[116:117], v[84:85]
    v_pk_mul_f32 v[198:199], v[118:119], v[86:87]
    v_pk_mul_f32 v[200:201], v[120:121], v[88:89]
    v_pk_mul_f32 v[202:203], v[122:123], v[90:91]
    v_pk_mul_f32 v[204:205], v[124:125], v[92:93]
    v_pk_mul_f32 v[206:207], v[126:127], v[94:95]
    v_pk_mul_f32 v[208:209], v[144:145], v[80:81]
    v_pk_mul_f32 v[210:211], v[146:147], v[82:83]
    v_pk_mul_f32 v[212:213], v[148:149], v[84:85]
    v_pk_mul_f32 v[214:215], v[150:151], v[86:87]
    v_pk_mul_f32 v[216:217], v[152:153], v[88:89]
    v_pk_mul_f32 v[218:219], v[154:155], v[90:91]
    v_pk_mul_f32 v[220:221], v[156:157], v[92:93]
    v_pk_mul_f32 v[222:223], v[158:159], v[94:95]
    v_pk_mul_f32 v[112:113], v[112:113], v[64:65]
    v_pk_fma_f32 v[192:193], v[96:97], v[64:65], v[192:193] neg_lo:[0,0,1] neg_hi:[0,0,1]
    v_pk_mul_f32 v[114:115], v[114:115], v[66:67]
    v_pk_fma_f32 v[194:195], v[98:99], v[66:67], v[194:195] neg_lo:[0,0,1] neg_hi:[0,0,1]
    v_pk_mul_f32 v[116:117], v[116:117], v[68:69]
    v_pk_fma_f32 v[196:197], v[100:101], v[68:69], v[196:197] neg_lo:[0,0,1] neg_hi:[0,0,1]
    v_pk_mul_f32 v[118:119], v[118:119], v[70:71]
    v_pk_fma_f32 v[198:199], v[102:103], v[70:71], v[198:199] neg_lo:[0,0,1] neg_hi:[0,0,1]
    v_pk_mul_f32 v[120:121], v[120:121], v[72:73]
    v_pk_mul_f32 v[122:123], v[122:123], v[74:75]
    v_pk_mul_f32 v[124:125], v[124:125], v[76:77]
    v_pk_mul_f32 v[126:127], v[126:127], v[78:79]
    v_pk_mul_f32 v[144:145], v[144:145], v[64:65]
    v_pk_fma_f32 v[208:209], v[128:129], v[64:65], v[208:209] neg_lo:[0,0,1] neg_hi:[0,0,1]
    v_pk_mul_f32 v[146:147], v[146:147], v[66:67]
    v_pk_fma_f32 v[210:211], v[130:131], v[66:67], v[210:211] neg_lo:[0,0,1] neg_hi:[0,0,1]
    v_pk_mul_f32 v[148:149], v[148:149], v[68:69]
    v_pk_fma_f32 v[212:213], v[132:133], v[68:69], v[212:213] neg_lo:[0,0,1] neg_hi:[0,0,1]
    v_pk_mul_f32 v[150:151], v[150:151], v[70:71]
    v_pk_fma_f32 v[214:215], v[134:135], v[70:71], v[214:215] neg_lo:[0,0,1] neg_hi:[0,0,1]
    v_pk_mul_f32 v[152:153], v[152:153], v[72:73]
    v_pk_mul_f32 v[154:155], v[154:155], v[74:75]
    v_pk_mul_f32 v[156:157], v[156:157], v[76:77]
    v_pk_mul_f32 v[158:159], v[158:159], v[78:79]
    v_pk_fma_f32 v[112:113], v[96:97], v[80:81], v[112:113]
    v_pk_fma_f32 v[114:115], v[98:99], v[82:83], v[114:115]
    v_pk_fma_f32 v[116:117], v[100:101], v[84:85], v[116:117]
    v_pk_fma_f32 v[118:119], v[102:103], v[86:87], v[118:119]
    v_pk_fma_f32 v[200:201], v[104:105], v[72:73], v[200:201] neg_lo:[0,0,1] neg_hi:[0,0,1]
    v_pk_fma_f32 v[120:121], v[104:105], v[88:89], v[120:121]
    v_pk_fma_f32 v[202:203], v[106:107], v[74:75], v[202:203] neg_lo:[0,0,1] neg_hi:[0,0,1]
    v_pk_fma_f32 v[122:123], v[106:107], v[90:91], v[122:123]
    v_pk_fma_f32 v[204:205], v[108:109], v[76:77], v[204:205] neg_lo:[0,0,1] neg_hi:[0,0,1]
    v_pk_fma_f32 v[124:125], v[108:109], v[92:93], v[124:125]
    v_pk_fma_f32 v[206:207], v[110:111], v[78:79], v[206:207] neg_lo:[0,0,1] neg_hi:[0,0,1]
    v_pk_fma_f32 v[126:127], v[110:111], v[94:95], v[126:127]
    v_pk_fma_f32 v[144:145], v[128:129], v[80:81], v[144:145]
    v_pk_fma_f32 v[146:147], v[130:131], v[82:83], v[146:147]
    v_pk_fma_f32 v[148:149], v[132:133], v[84:85], v[148:149]
    v_pk_fma_f32 v[150:151], v[134:135], v[86:87], v[150:151]
    v_pk_fma_f32 v[216:217], v[136:137], v[72:73], v[216:217] neg_lo:[0,0,1] neg_hi:[0,0,1]
    v_pk_fma_f32 v[152:153], v[136:137], v[88:89], v[152:153]
    v_pk_fma_f32 v[218:219], v[138:139], v[74:75], v[218:219] neg_lo:[0,0,1] neg_hi:[0,0,1]
    v_pk_fma_f32 v[154:155], v[138:139], v[90:91], v[154:155]
    v_pk_fma_f32 v[220:221], v[140:141], v[76:77], v[220:221] neg_lo:[0,0,1] neg_hi:[0,0,1]
    v_pk_fma_f32 v[156:157], v[140:141], v[92:93], v[156:157]
    v_pk_fma_f32 v[222:223], v[142:143], v[78:79], v[222:223] neg_lo:[0,0,1] neg_hi:[0,0,1]
    v_pk_fma_f32 v[158:159], v[142:143], v[94:95], v[158:159]
    v_cvt_pk_bf16_f32 v160, v192, v193
    v_cvt_pk_bf16_f32 v161, v194, v195
    v_cvt_pk_bf16_f32 v162, v196, v197
    v_cvt_pk_bf16_f32 v163, v198, v199
    v_cvt_pk_bf16_f32 v176, v208, v209
    v_cvt_pk_bf16_f32 v177, v210, v211
    s_waitcnt lgkmcnt(3)
    v_mfma_f32_32x32x16_bf16 v[96:111], a[208:211], v[160:163], 0
    v_cvt_pk_bf16_f32 v178, v212, v213
    v_cvt_pk_bf16_f32 v179, v214, v215
    v_cvt_pk_bf16_f32 v164, v200, v201
    v_cvt_pk_bf16_f32 v165, v202, v203
    v_cvt_pk_bf16_f32 v166, v204, v205
    v_mfma_f32_32x32x16_bf16 v[128:143], a[208:211], v[176:179], 0
    v_cvt_pk_bf16_f32 v167, v206, v207
    v_cvt_pk_bf16_f32 v180, v216, v217
    v_cvt_pk_bf16_f32 v181, v218, v219
    v_cvt_pk_bf16_f32 v182, v220, v221
    v_cvt_pk_bf16_f32 v183, v222, v223
    s_waitcnt lgkmcnt(2)
    v_mfma_f32_32x32x16_bf16 v[96:111], a[212:215], v[164:167], v[96:111]
    v_cvt_pk_bf16_f32 v168, v112, v113
    v_cvt_pk_bf16_f32 v169, v114, v115
    v_cvt_pk_bf16_f32 v170, v116, v117
    v_cvt_pk_bf16_f32 v171, v118, v119
    v_cvt_pk_bf16_f32 v184, v144, v145
    v_mfma_f32_32x32x16_bf16 v[128:143], a[212:215], v[180:183], v[128:143]
    v_cvt_pk_bf16_f32 v185, v146, v147
    v_cvt_pk_bf16_f32 v186, v148, v149
    v_cvt_pk_bf16_f32 v187, v150, v151
    v_cvt_pk_bf16_f32 v172, v120, v121
    v_cvt_pk_bf16_f32 v173, v122, v123
    s_waitcnt lgkmcnt(1)
    v_mfma_f32_32x32x16_bf16 v[96:111], a[216:219], v[168:171], v[96:111]
    v_cvt_pk_bf16_f32 v174, v124, v125
    v_cvt_pk_bf16_f32 v175, v126, v127
    v_cvt_pk_bf16_f32 v188, v152, v153
    v_cvt_pk_bf16_f32 v189, v154, v155
    v_cvt_pk_bf16_f32 v190, v156, v157
    v_mfma_f32_32x32x16_bf16 v[128:143], a[216:219], v[184:187], v[128:143]
    v_cvt_pk_bf16_f32 v191, v158, v159
    s_cmp_eq_u32 s32, 0
    s_cselect_b32 s92, 0, 0x40000000
    s_lshl_b32 s93, s2, 4
    s_add_u32 s93, s93, s92
    s_waitcnt lgkmcnt(0)
    v_mfma_f32_32x32x16_bf16 v[96:111], a[220:223], v[172:175], v[96:111]
    s_mov_b32 s84, 82048
    s_add_u32 s93, s93, 47316992
    v_accvgpr_read_b32 v224, a128
    v_accvgpr_read_b32 v228, a132
    v_accvgpr_read_b32 v225, a129
    v_mfma_f32_32x32x16_bf16 v[128:143], a[220:223], v[188:191], v[128:143]
    v_accvgpr_read_b32 v229, a133
    v_accvgpr_read_b32 v226, a130
    v_accvgpr_read_b32 v230, a134
    v_accvgpr_read_b32 v227, a131
    v_accvgpr_read_b32 v231, a135
    v_add_u32 v34, s84, v2
    s_add_u32 s92, s92, 29360128
    v_cvt_pk_bf16_f32 v192, v96, v97
    v_cvt_pk_bf16_f32 v193, v98, v99
    v_cvt_pk_bf16_f32 v194, v100, v101
    v_cvt_pk_bf16_f32 v195, v102, v103
    ds_write_b128 v36, v[192:195] offset:0
    v_cvt_pk_bf16_f32 v196, v104, v105
    v_cvt_pk_bf16_f32 v197, v106, v107
    v_cvt_pk_bf16_f32 v198, v108, v109
    v_cvt_pk_bf16_f32 v199, v110, v111
    ds_write_b128 v37, v[196:199] offset:0
    v_cvt_pk_bf16_f32 v208, v128, v129
    v_cvt_pk_bf16_f32 v209, v130, v131
    v_cvt_pk_bf16_f32 v210, v132, v133
    v_cvt_pk_bf16_f32 v211, v134, v135
    ds_write_b128 v36, v[208:211] offset:2064
    v_cvt_pk_bf16_f32 v212, v136, v137
    v_cvt_pk_bf16_f32 v213, v138, v139
    v_cvt_pk_bf16_f32 v214, v140, v141
    v_cvt_pk_bf16_f32 v215, v142, v143
    ds_write_b128 v37, v[212:215] offset:2064
    v_add_f32 v224, v224, v228
    v_add_f32 v225, v225, v229
    v_add_f32 v226, v226, v230
    v_add_f32 v227, v227, v231
    ds_write_b128 v38, v[224:227]
    s_lshl_b32 s84, s2, 6
    s_add_u32 s92, s92, s84
    s_nop 1
    s_waitcnt lgkmcnt(0)
    s_barrier
    ds_read_b64_tr_b16 v[160:161], v44 offset:0
    ds_read_b64_tr_b16 v[162:163], v44 offset:8256
    ds_read_b64_tr_b16 v[164:165], v45 offset:128
    ds_read_b64_tr_b16 v[166:167], v45 offset:8384
    ds_read_b64_tr_b16 v[168:169], v46 offset:256
    ds_read_b64_tr_b16 v[170:171], v46 offset:8512
    ds_read_b64_tr_b16 v[172:173], v47 offset:384
    ds_read_b64_tr_b16 v[174:175], v47 offset:8640
    ds_read_b128 v[16:19], v34 offset:0
    ds_read_b128 v[20:23], v34 offset:1024
    ds_read_b128 v[24:27], v34 offset:2048
    ds_read_b128 v[28:31], v34 offset:3072
    s_add_u32 s90, s89, 0
    s_waitcnt lgkmcnt(10)
    buffer_store_dwordx4 v[160:163], v48, s[20:23], s90 offen sc1
    s_add_u32 s90, s89, 262912
    s_waitcnt lgkmcnt(8)
    buffer_store_dwordx4 v[164:167], v48, s[20:23], s90 offen sc1
    s_add_u32 s90, s89, 525824
    s_waitcnt lgkmcnt(6)
    buffer_store_dwordx4 v[168:171], v48, s[20:23], s90 offen sc1
    s_add_u32 s90, s89, 788736
    s_waitcnt lgkmcnt(4)
    buffer_store_dwordx4 v[172:175], v48, s[20:23], s90 offen sc1
    ds_read_b128 a[208:211], v32 offset:8192
    ds_read_b128 a[212:215], v32 offset:9216
    ds_read_b128 a[216:219], v32 offset:10240
    ds_read_b128 a[220:223], v32 offset:11264
    ds_read_b128 a[224:227], v32 offset:12288
    ds_read_b128 a[228:231], v32 offset:13312
    ds_read_b128 a[232:235], v32 offset:14336
    ds_read_b128 a[236:239], v32 offset:15360
    ds_read_b128 a[240:243], v39 offset:0
    ds_read_b128 a[244:247], v39 offset:1024
    ds_read_b128 a[248:251], v39 offset:2048
    ds_read_b128 a[252:255], v39 offset:3072
    s_waitcnt lgkmcnt(0)
    v_add_f32 v16, v16, v20
    v_add_f32 v24, v24, v28
    v_add_f32 v17, v17, v21
    v_add_f32 v25, v25, v29
    v_add_f32 v18, v18, v22
    v_add_f32 v26, v26, v30
    v_add_f32 v19, v19, v23
    v_add_f32 v27, v27, v31
    v_add_f32 v16, v16, v24
    v_add_f32 v17, v17, v25
    v_add_f32 v18, v18, v26
    v_add_f32 v19, v19, v27
    v_cvt_pk_bf16_f32 v20, v16, v17
    v_cvt_pk_bf16_f32 v21, v18, v19
    v_and_b32 v58, 0xffff0000, v20
    v_and_b32 v62, 0xffff0000, v21
    v_lshlrev_b32 v56, 16, v20
    v_lshlrev_b32 v60, 16, v21
    v_mul_f32 v56, 0xbfb8aa3b, v56
    v_mul_f32 v58, 0xbfb8aa3b, v58
    v_mul_f32 v60, 0xbfb8aa3b, v60
    v_mul_f32 v62, 0xbfb8aa3b, v62
    v_exp_f32 v56, v56
    v_exp_f32 v58, v58
    v_exp_f32 v60, v60
    v_exp_f32 v62, v62
    v_add_f32 v56, 1.0, v56
    v_add_f32 v58, 1.0, v58
    v_add_f32 v60, 1.0, v60
    v_add_f32 v62, 1.0, v62
    v_rcp_f32 v56, v56
    v_rcp_f32 v58, v58
    v_rcp_f32 v60, v60
    v_rcp_f32 v62, v62
    v_cvt_pk_bf16_f32 v56, v56, v56
    v_cvt_pk_bf16_f32 v58, v58, v58
    v_cvt_pk_bf16_f32 v60, v60, v60
    v_cvt_pk_bf16_f32 v62, v62, v62
    v_and_b32 v14, 47, v1
    v_lshrrev_b32 v15, 4, v1
    v_mov_b32 v23, 0x40000000
    v_lshlrev_b32 v56, 16, v56
    v_lshlrev_b32 v58, 16, v58
    v_lshlrev_b32 v60, 16, v60
    v_lshlrev_b32 v62, 16, v62
    v_cmp_eq_u32 vcc, 1, v14
    v_lshlrev_b32 v22, 3, v15
    v_sub_f32 v57, 1.0, v56
    v_sub_f32 v59, 1.0, v58
    v_sub_f32 v61, 1.0, v60
    v_sub_f32 v63, 1.0, v62
    v_cndmask_b32 v22, v23, v22, vcc
    v_cvt_pk_bf16_f32 v57, v57, v57
    v_cvt_pk_bf16_f32 v59, v59, v59
    v_cvt_pk_bf16_f32 v61, v61, v61
    v_cvt_pk_bf16_f32 v63, v63, v63
    v_cmp_eq_u32 vcc, 0, v14
    v_lshlrev_b32 v15, 5, v15
    v_mul_f32 v56, 0x35800000, v56
    v_mul_f32 v58, 0x35800000, v58
    v_mul_f32 v60, 0x35800000, v60
    v_mul_f32 v62, 0x35800000, v62
    v_lshlrev_b32 v57, 16, v57
    v_lshlrev_b32 v59, 16, v59
    v_lshlrev_b32 v61, 16, v61
    v_lshlrev_b32 v63, 16, v63
    v_cndmask_b32 v15, v23, v15, vcc
    buffer_store_dwordx2 v[20:21], v22, s[20:23], s93 offen sc1
    buffer_store_dwordx4 v[56:59], v15, s[20:23], s92 offen sc1
    buffer_store_dwordx4 v[60:63], v15, s[20:23], s92 offen offset:16 sc1
    s_nop 1
    v_and_b32 v192, 31, v1
    v_lshrrev_b32 v193, 5, v1
    v_cvt_f32_u32 v192, v192
    v_lshlrev_b32 v193, 2, v193
    v_fma_f32 v198, v192, 2.0, 1.0
    v_mul_f32 v196, 0xbd000000, v192
    v_cvt_f32_u32 v193, v193
    v_mul_f32 v194, 0xbd000000, v192
    v_mul_f32 v198, 0xbc800000, v198
    v_mul_f32 v197, v196, v193
    v_mul_f32 v195, v194, v193
    v_fmac_f32 v197, 0.5, v196
    v_mul_f32 v199, v198, v193
    v_fmamk_f32 v65, v194, 0x3f800000, v195
    v_fmamk_f32 v66, v194, 0x40000000, v195
    v_fmamk_f32 v67, v194, 0x40400000, v195
    v_fmamk_f32 v68, v194, 0x41000000, v195
    v_fmamk_f32 v69, v194, 0x41100000, v195
    v_fmamk_f32 v70, v194, 0x41200000, v195
    v_fmamk_f32 v71, v194, 0x41300000, v195
    v_fmamk_f32 v72, v194, 0x41800000, v195
    v_fmamk_f32 v73, v194, 0x41880000, v195
    v_fmamk_f32 v74, v194, 0x41900000, v195
    v_fmamk_f32 v75, v194, 0x41980000, v195
    v_fmamk_f32 v76, v194, 0x41c00000, v195
    v_fmamk_f32 v77, v194, 0x41c80000, v195
    v_fmamk_f32 v78, v194, 0x41d00000, v195
    v_fmamk_f32 v79, v194, 0x41d80000, v195
    v_fmamk_f32 v113, v196, 0x3f800000, v197
    v_fmamk_f32 v114, v196, 0x40000000, v197
    v_fmamk_f32 v115, v196, 0x40400000, v197
    v_fmamk_f32 v116, v196, 0x41000000, v197
    v_fmamk_f32 v117, v196, 0x41100000, v197
    v_fmamk_f32 v118, v196, 0x41200000, v197
    v_fmamk_f32 v119, v196, 0x41300000, v197
    v_fmamk_f32 v120, v196, 0x41800000, v197
    v_fmamk_f32 v121, v196, 0x41880000, v197
    v_fmamk_f32 v122, v196, 0x41900000, v197
    v_fmamk_f32 v123, v196, 0x41980000, v197
    v_fmamk_f32 v124, v196, 0x41c00000, v197
    v_fmamk_f32 v125, v196, 0x41c80000, v197
    v_fmamk_f32 v126, v196, 0x41d00000, v197
    v_fmamk_f32 v127, v196, 0x41d80000, v197
    v_fmamk_f32 v145, v198, 0x3f800000, v199
    v_fmamk_f32 v146, v198, 0x40000000, v199
    v_fmamk_f32 v147, v198, 0x40400000, v199
    v_fmamk_f32 v148, v198, 0x41000000, v199
    v_fmamk_f32 v149, v198, 0x41100000, v199
    v_fmamk_f32 v150, v198, 0x41200000, v199
    v_fmamk_f32 v151, v198, 0x41300000, v199
    v_fmamk_f32 v152, v198, 0x41800000, v199
    v_fmamk_f32 v153, v198, 0x41880000, v199
    v_fmamk_f32 v154, v198, 0x41900000, v199
    v_fmamk_f32 v155, v198, 0x41980000, v199
    v_fmamk_f32 v156, v198, 0x41c00000, v199
    v_fmamk_f32 v157, v198, 0x41c80000, v199
    v_fmamk_f32 v158, v198, 0x41d00000, v199
    v_fmamk_f32 v159, v198, 0x41d80000, v199
    v_cos_f32 v225, v65
    v_cos_f32 v226, v66
    v_cos_f32 v227, v67
    v_cos_f32 v228, v68
    v_cos_f32 v229, v69
    v_cos_f32 v230, v70
    v_cos_f32 v231, v71
    v_cos_f32 v232, v72
    v_cos_f32 v233, v73
    v_cos_f32 v234, v74
    v_cos_f32 v235, v75
    v_cos_f32 v236, v76
    v_cos_f32 v237, v77
    v_cos_f32 v238, v78
    v_cos_f32 v239, v79
    v_cos_f32 v81, v113
    v_cos_f32 v82, v114
    v_cos_f32 v83, v115
    v_cos_f32 v84, v116
    v_cos_f32 v85, v117
    v_cos_f32 v86, v118
    v_cos_f32 v87, v119
    v_cos_f32 v88, v120
    v_cos_f32 v89, v121
    v_cos_f32 v90, v122
    v_cos_f32 v91, v123
    v_cos_f32 v92, v124
    v_cos_f32 v93, v125
    v_cos_f32 v94, v126
    v_cos_f32 v95, v127
    v_cos_f32 v129, v145
    v_cos_f32 v130, v146
    v_cos_f32 v131, v147
    v_cos_f32 v132, v148
    v_cos_f32 v133, v149
    v_cos_f32 v134, v150
    v_cos_f32 v135, v151
    v_cos_f32 v136, v152
    v_cos_f32 v137, v153
    v_cos_f32 v138, v154
    v_cos_f32 v139, v155
    v_cos_f32 v140, v156
    v_cos_f32 v141, v157
    v_cos_f32 v142, v158
    v_cos_f32 v143, v159
    v_mul_f32 v204, 0xba000000, v192
    v_mul_f32 v205, v204, v193
    v_sin_f32 v64, v195
    v_sin_f32 v65, v65
    v_sin_f32 v66, v66
    v_sin_f32 v67, v67
    v_sin_f32 v68, v68
    v_sin_f32 v69, v69
    v_sin_f32 v70, v70
    v_sin_f32 v71, v71
    v_sin_f32 v72, v72
    v_sin_f32 v73, v73
    v_sin_f32 v74, v74
    v_sin_f32 v75, v75
    v_sin_f32 v76, v76
    v_sin_f32 v77, v77
    v_sin_f32 v78, v78
    v_sin_f32 v79, v79
    v_sin_f32 v112, v197
    v_sin_f32 v113, v113
    v_sin_f32 v114, v114
    v_sin_f32 v115, v115
    v_sin_f32 v116, v116
    v_sin_f32 v117, v117
    v_sin_f32 v118, v118
    v_sin_f32 v119, v119
    v_sin_f32 v120, v120
    v_sin_f32 v121, v121
    v_sin_f32 v122, v122
    v_sin_f32 v123, v123
    v_sin_f32 v124, v124
    v_sin_f32 v125, v125
    v_sin_f32 v126, v126
    v_sin_f32 v127, v127
    v_sin_f32 v144, v199
    v_sin_f32 v145, v145
    v_sin_f32 v146, v146
    v_sin_f32 v147, v147
    v_sin_f32 v148, v148
    v_sin_f32 v149, v149
    v_sin_f32 v150, v150
    v_sin_f32 v151, v151
    v_sin_f32 v152, v152
    v_sin_f32 v153, v153
    v_sin_f32 v154, v154
    v_sin_f32 v155, v155
    v_sin_f32 v156, v156
    v_sin_f32 v157, v157
    v_sin_f32 v158, v158
    v_sin_f32 v159, v159
    v_fmamk_f32 v33, v204, 0x3f800000, v205
    v_fmamk_f32 v34, v204, 0x40000000, v205
    v_fmamk_f32 v35, v204, 0x40400000, v205
    v_fmamk_f32 v36, v204, 0x41000000, v205
    v_fmamk_f32 v37, v204, 0x41100000, v205
    v_fmamk_f32 v38, v204, 0x41200000, v205
    v_fmamk_f32 v39, v204, 0x41300000, v205
    v_fmamk_f32 v40, v204, 0x41800000, v205
    v_fmamk_f32 v41, v204, 0x41880000, v205
    v_fmamk_f32 v42, v204, 0x41900000, v205
    v_fmamk_f32 v43, v204, 0x41980000, v205
    v_fmamk_f32 v44, v204, 0x41c00000, v205
    v_fmamk_f32 v45, v204, 0x41c80000, v205
    v_fmamk_f32 v46, v204, 0x41d00000, v205
    v_fmamk_f32 v47, v204, 0x41d80000, v205
    v_cos_f32 v224, v195
    v_cos_f32 v80, v197
    v_cos_f32 v128, v199
    v_cos_f32 v17, v33
    v_cos_f32 v18, v34
    v_cos_f32 v19, v35
    v_cos_f32 v20, v36
    v_cos_f32 v21, v37
    v_cos_f32 v22, v38
    v_cos_f32 v23, v39
    v_cos_f32 v24, v40
    v_cos_f32 v25, v41
    v_cos_f32 v26, v42
    v_cos_f32 v27, v43
    v_cos_f32 v28, v44
    v_cos_f32 v29, v45
    v_cos_f32 v30, v46
    v_cos_f32 v31, v47
    v_cvt_pk_bf16_f32 v64, v64, v65
    v_cvt_pk_bf16_f32 v66, v66, v67
    v_cvt_pk_bf16_f32 v68, v68, v69
    v_cvt_pk_bf16_f32 v70, v70, v71
    v_cvt_pk_bf16_f32 v72, v72, v73
    v_cvt_pk_bf16_f32 v74, v74, v75
    v_cvt_pk_bf16_f32 v76, v76, v77
    v_cvt_pk_bf16_f32 v78, v78, v79
    v_cvt_pk_bf16_f32 v112, v112, v113
    v_cvt_pk_bf16_f32 v114, v114, v115
    v_cvt_pk_bf16_f32 v116, v116, v117
    v_cvt_pk_bf16_f32 v118, v118, v119
    v_cvt_pk_bf16_f32 v120, v120, v121
    v_cvt_pk_bf16_f32 v122, v122, v123
    v_cvt_pk_bf16_f32 v124, v124, v125
    v_cvt_pk_bf16_f32 v126, v126, v127
    v_cvt_pk_bf16_f32 v144, v144, v145
    v_cvt_pk_bf16_f32 v146, v146, v147
    v_cvt_pk_bf16_f32 v148, v148, v149
    v_cvt_pk_bf16_f32 v150, v150, v151
    v_cvt_pk_bf16_f32 v152, v152, v153
    v_cvt_pk_bf16_f32 v154, v154, v155
    v_cvt_pk_bf16_f32 v156, v156, v157
    v_cvt_pk_bf16_f32 v158, v158, v159
    s_mov_b32 s68, 0x80008000
    v_cvt_pk_bf16_f32 v224, v224, v225
    v_cvt_pk_bf16_f32 v226, v226, v227
    v_cvt_pk_bf16_f32 v228, v228, v229
    v_cvt_pk_bf16_f32 v230, v230, v231
    v_cvt_pk_bf16_f32 v232, v232, v233
    v_cvt_pk_bf16_f32 v234, v234, v235
    v_cvt_pk_bf16_f32 v236, v236, v237
    v_cvt_pk_bf16_f32 v238, v238, v239
    v_cvt_pk_bf16_f32 v80, v80, v81
    v_cvt_pk_bf16_f32 v82, v82, v83
    v_cvt_pk_bf16_f32 v84, v84, v85
    v_cvt_pk_bf16_f32 v86, v86, v87
    v_cvt_pk_bf16_f32 v88, v88, v89
    v_cvt_pk_bf16_f32 v90, v90, v91
    v_cvt_pk_bf16_f32 v92, v92, v93
    v_cvt_pk_bf16_f32 v94, v94, v95
    v_cvt_pk_bf16_f32 v128, v128, v129
    v_cvt_pk_bf16_f32 v130, v130, v131
    v_cvt_pk_bf16_f32 v132, v132, v133
    v_cvt_pk_bf16_f32 v134, v134, v135
    v_cvt_pk_bf16_f32 v136, v136, v137
    v_cvt_pk_bf16_f32 v138, v138, v139
    v_cvt_pk_bf16_f32 v140, v140, v141
    v_cvt_pk_bf16_f32 v142, v142, v143
    v_xor_b32 v65, s68, v64
    v_xor_b32 v67, s68, v66
    v_xor_b32 v69, s68, v68
    v_xor_b32 v71, s68, v70
    v_xor_b32 v73, s68, v72
    v_xor_b32 v75, s68, v74
    v_xor_b32 v77, s68, v76
    v_xor_b32 v79, s68, v78
    v_xor_b32 v113, s68, v112
    v_xor_b32 v115, s68, v114
    v_xor_b32 v117, s68, v116
    v_xor_b32 v119, s68, v118
    v_xor_b32 v121, s68, v120
    v_xor_b32 v123, s68, v122
    v_xor_b32 v125, s68, v124
    v_xor_b32 v127, s68, v126
    v_xor_b32 v145, s68, v144
    v_xor_b32 v147, s68, v146
    v_xor_b32 v149, s68, v148
    v_xor_b32 v151, s68, v150
    v_xor_b32 v153, s68, v152
    v_xor_b32 v155, s68, v154
    v_xor_b32 v157, s68, v156
    v_xor_b32 v159, s68, v158
    v_cos_f32 v16, v205
    v_sin_f32 v32, v205
    v_sin_f32 v33, v33
    v_sin_f32 v34, v34
    v_sin_f32 v35, v35
    v_sin_f32 v36, v36
    v_sin_f32 v37, v37
    v_sin_f32 v38, v38
    v_sin_f32 v39, v39
    v_sin_f32 v40, v40
    v_sin_f32 v41, v41
    v_sin_f32 v42, v42
    v_sin_f32 v43, v43
    v_sin_f32 v44, v44
    v_sin_f32 v45, v45
    v_sin_f32 v46, v46
    v_sin_f32 v47, v47
    v_accvgpr_write_b32 a0, v224
    v_accvgpr_write_b32 a1, v226
    v_accvgpr_write_b32 a2, v228
    v_accvgpr_write_b32 a3, v230
    v_accvgpr_write_b32 a4, v232
    v_accvgpr_write_b32 a5, v234
    v_accvgpr_write_b32 a6, v236
    v_accvgpr_write_b32 a7, v238
    v_accvgpr_write_b32 a8, v64
    v_accvgpr_write_b32 a16, v65
    v_accvgpr_write_b32 a9, v66
    v_accvgpr_write_b32 a17, v67
    v_accvgpr_write_b32 a10, v68
    v_accvgpr_write_b32 a18, v69
    v_accvgpr_write_b32 a11, v70
    v_accvgpr_write_b32 a19, v71
    v_accvgpr_write_b32 a12, v72
    v_accvgpr_write_b32 a20, v73
    v_accvgpr_write_b32 a13, v74
    v_accvgpr_write_b32 a21, v75
    v_accvgpr_write_b32 a14, v76
    v_accvgpr_write_b32 a22, v77
    v_accvgpr_write_b32 a15, v78
    v_accvgpr_write_b32 a23, v79
    v_accvgpr_write_b32 a24, v80
    v_accvgpr_write_b32 a25, v82
    v_accvgpr_write_b32 a26, v84
    v_accvgpr_write_b32 a27, v86
    v_accvgpr_write_b32 a28, v88
    v_accvgpr_write_b32 a29, v90
    v_accvgpr_write_b32 a30, v92
    v_accvgpr_write_b32 a31, v94
    v_accvgpr_write_b32 a32, v112
    v_accvgpr_write_b32 a40, v113
    v_accvgpr_write_b32 a33, v114
    v_accvgpr_write_b32 a41, v115
    v_accvgpr_write_b32 a34, v116
    v_accvgpr_write_b32 a42, v117
    v_accvgpr_write_b32 a35, v118
    v_accvgpr_write_b32 a43, v119
    v_accvgpr_write_b32 a36, v120
    v_accvgpr_write_b32 a44, v121
    v_accvgpr_write_b32 a37, v122
    v_accvgpr_write_b32 a45, v123
    v_accvgpr_write_b32 a38, v124
    v_accvgpr_write_b32 a46, v125
    v_accvgpr_write_b32 a39, v126
    v_accvgpr_write_b32 a47, v127
    v_accvgpr_write_b32 a48, v128
    v_accvgpr_write_b32 a49, v130
    v_accvgpr_write_b32 a50, v132
    v_accvgpr_write_b32 a51, v134
    v_accvgpr_write_b32 a52, v136
    v_accvgpr_write_b32 a53, v138
    v_accvgpr_write_b32 a54, v140
    v_accvgpr_write_b32 a55, v142
    v_accvgpr_write_b32 a56, v144
    v_accvgpr_write_b32 a64, v145
    v_accvgpr_write_b32 a57, v146
    v_accvgpr_write_b32 a65, v147
    v_accvgpr_write_b32 a58, v148
    v_accvgpr_write_b32 a66, v149
    v_accvgpr_write_b32 a59, v150
    v_accvgpr_write_b32 a67, v151
    v_accvgpr_write_b32 a60, v152
    v_accvgpr_write_b32 a68, v153
    v_accvgpr_write_b32 a61, v154
    v_accvgpr_write_b32 a69, v155
    v_accvgpr_write_b32 a62, v156
    v_accvgpr_write_b32 a70, v157
    v_accvgpr_write_b32 a63, v158
    v_accvgpr_write_b32 a71, v159
    s_nop 1
    s_waitcnt vmcnt(0)
    s_mov_b32 s34, 100000
Lbg_7:
    v_readfirstlane_b32 s35, v5
    v_readfirstlane_b32 s70, v4
    s_sub_u32 s34, s34, 1
    s_cbranch_scc1 Lbd_8
    s_cmp_eq_u32 s35, 1
    s_cbranch_scc1 Lbd_8
    s_sleep 4
    buffer_load_dwordx2 v[4:5], off, s[28:31], 0 sc1
    s_waitcnt vmcnt(0)
    s_branch Lbg_7
Lbd_8:
    s_nop 0
    s_barrier
    s_cmp_lg_u32 s32, 0
    s_cbranch_scc1 Lsig_9
    s_add_u32 s49, s70, 1
    v_mov_b32 v15, s49
    s_lshl_b32 s49, s2, 6
    s_add_u32 s49, s49, 47251456
    s_mov_b64 exec, 1
    buffer_store_dword v15, off, s[20:23], s49 sc1
    s_mov_b64 exec, -1
Lsig_9:
    s_cmp_lg_u32 s32, 0
    s_cbranch_scc1 Lw2_10
    s_lshl_b32 s37, s33, 6
    v_add_u32 v96, s37, v1
    v_bfe_u32 v97, v96, 5, 3
    v_bfe_u32 v98, v96, 2, 2
    v_lshl_add_u32 v97, v98, 3, v97
    v_lshrrev_b32 v98, 10, v96
    v_lshl_add_u32 v97, v98, 5, v97
    v_and_b32 v98, 3, v96
    v_lshl_add_u32 v97, v98, 6, v97
    v_bfe_u32 v98, v96, 4, 1
    v_lshl_add_u32 v97, v98, 8, v97
    v_bfe_u32 v98, v96, 8, 2
    v_lshl_add_u32 v97, v98, 9, v97
    v_sub_u32 v98, 0, v97
    v_and_b32 v98, 2047, v98
    v_mul_u32_u24 v97, 1026, v97
    v_mul_u32_u24 v98, 1026, v98
    v_lshlrev_b32 v96, 2, v96
    buffer_load_ushort v100, v97, s[12:15], 0 offen offset:0
    buffer_load_ushort v101, v97, s[16:19], 0 offen offset:0
    buffer_load_ushort v102, v98, s[12:15], 0 offen offset:0
    buffer_load_ushort v103, v98, s[16:19], 0 offen offset:0
    buffer_load_ushort v104, v97, s[12:15], 0 offen offset:1024
    buffer_load_ushort v105, v97, s[16:19], 0 offen offset:1024
    buffer_load_ushort v106, v98, s[12:15], 0 offen offset:1024
    buffer_load_ushort v107, v98, s[16:19], 0 offen offset:1024
    s_branch Lw3_11
Lw2_10:
    s_cmp_lg_u32 s32, 1
    s_cbranch_scc1 Lw3_11
    s_cmp_ge_u32 s33, 8
    s_cbranch_scc1 Lw3_11
    buffer_load_dwordx4 v[208:211], v52, s[12:15], 0 offen offset:0
    buffer_load_dwordx4 v[212:215], v52, s[16:19], 0 offen offset:0
    buffer_load_dwordx4 v[216:219], v52, s[12:15], s60 offen offset:0
    buffer_load_dwordx4 v[220:223], v52, s[16:19], s60 offen offset:0
    buffer_load_dwordx4 v[224:227], v52, s[12:15], s61 offen offset:0
    buffer_load_dwordx4 v[228:231], v52, s[16:19], s61 offen offset:0
    buffer_load_dwordx4 v[232:235], v52, s[12:15], s62 offen offset:0
    buffer_load_dwordx4 v[236:239], v52, s[16:19], s62 offen offset:0
Lw3_11:
    buffer_load_dwordx4 v[160:163], v54, s[12:15], 0 offen offset:0
    buffer_load_dwordx4 v[164:167], v54, s[16:19], 0 offen offset:0
    buffer_load_dwordx4 v[168:171], v54, s[12:15], s60 offen offset:0
    buffer_load_dwordx4 v[172:175], v54, s[16:19], s60 offen offset:0
    buffer_load_dwordx4 v[176:179], v54, s[12:15], s61 offen offset:0
    buffer_load_dwordx4 v[180:183], v54, s[16:19], s61 offen offset:0
    buffer_load_dwordx4 v[184:187], v54, s[12:15], s62 offen offset:0
    buffer_load_dwordx4 v[188:191], v54, s[16:19], s62 offen offset:0
    s_lshl_b32 s40, s32, 7
    s_add_u32 s40, s40, s33
    s_cmp_eq_u32 s40, 0
    s_cselect_b32 s41, 1, 0
    s_mul_i32 s40, s40, 8576
    s_add_u32 s40, s40, 42142720
    v_bfe_u32 v144, v1, 2, 2
    v_lshrrev_b32 v145, 5, v1
    v_lshl_add_u32 v144, v145, 2, v144
    v_mul_u32_u24 v144, 4112, v144
    v_bfe_u32 v145, v1, 4, 1
    v_lshl_add_u32 v144, v145, 8, v144
    v_bfe_u32 v145, v1, 1, 1
    v_lshl_add_u32 v144, v145, 7, v144
    v_and_b32 v145, 1, v1
    v_lshl_add_u32 v144, v145, 3, v144
    s_lshl_b32 s35, s32, 10
    v_add_u32 v3, s35, v144
    v_add_u32 v4, 65792, v3
    v_and_b32 v144, 31, v1
    v_mul_u32_u24 v144, 4112, v144
    v_lshrrev_b32 v145, 5, v1
    v_lshl_add_u32 v144, v145, 3, v144
    v_add_u32 v5, s35, v144
    v_lshrrev_b32 v144, 4, v1
    v_lshlrev_b32 v144, 8, v144
    v_bfe_u32 v145, v1, 1, 1
    v_lshl_add_u32 v144, v145, 7, v144
    v_bfe_u32 v145, v1, 2, 2
    v_lshl_add_u32 v144, v145, 4, v144
    v_and_b32 v145, 1, v1
    v_lshl_add_u32 v144, v145, 3, v144
    v_add_u32 v6, s35, v144
    s_mov_b32 s69, 0xffff0000
    v_and_b32 v144, 7, v1
    v_lshlrev_b32 v144, 3, v144
    v_lshrrev_b32 v145, 5, v1
    v_lshl_add_u32 v144, v145, 2, v144
    v_bfe_u32 v145, v1, 3, 2
    v_add_u32 v144, v144, v145
    v_lshlrev_b32 v11, 4, v144
    s_waitcnt vmcnt(0)
    v_perm_b32 v240, v164, v160, s63
    v_perm_b32 v241, v172, v168, s63
    v_perm_b32 v242, v180, v176, s63
    v_perm_b32 v243, v188, v184, s63
    v_perm_b32 v244, v164, v160, s64
    v_perm_b32 v245, v172, v168, s64
    v_perm_b32 v246, v180, v176, s64
    v_perm_b32 v247, v188, v184, s64
    s_mov_b32 s65, 0
    s_mov_b32 s66, 8576
    buffer_store_dwordx4 v[240:243], v55, s[20:23], s65 offen sc1
    buffer_store_dwordx4 v[244:247], v55, s[20:23], s66 offen sc1
    s_nop 0
    v_perm_b32 v240, v165, v161, s63
    v_perm_b32 v241, v173, v169, s63
    v_perm_b32 v242, v181, v177, s63
    v_perm_b32 v243, v189, v185, s63
    v_perm_b32 v244, v165, v161, s64
    v_perm_b32 v245, v173, v169, s64
    v_perm_b32 v246, v181, v177, s64
    v_perm_b32 v247, v189, v185, s64
    s_mov_b32 s65, 17152
    s_mov_b32 s66, 25728
    buffer_store_dwordx4 v[240:243], v55, s[20:23], s65 offen sc1
    buffer_store_dwordx4 v[244:247], v55, s[20:23], s66 offen sc1
    s_nop 0
    v_perm_b32 v240, v166, v162, s63
    v_perm_b32 v241, v174, v170, s63
    v_perm_b32 v242, v182, v178, s63
    v_perm_b32 v243, v190, v186, s63
    v_perm_b32 v244, v166, v162, s64
    v_perm_b32 v245, v174, v170, s64
    v_perm_b32 v246, v182, v178, s64
    v_perm_b32 v247, v190, v186, s64
    s_mov_b32 s65, 34304
    s_mov_b32 s66, 42880
    buffer_store_dwordx4 v[240:243], v55, s[20:23], s65 offen sc1
    buffer_store_dwordx4 v[244:247], v55, s[20:23], s66 offen sc1
    s_nop 0
    v_perm_b32 v240, v167, v163, s63
    v_perm_b32 v241, v175, v171, s63
    v_perm_b32 v242, v183, v179, s63
    v_perm_b32 v243, v191, v187, s63
    v_perm_b32 v244, v167, v163, s64
    v_perm_b32 v245, v175, v171, s64
    v_perm_b32 v246, v183, v179, s64
    v_perm_b32 v247, v191, v187, s64
    s_mov_b32 s65, 51456
    s_mov_b32 s66, 60032
    buffer_store_dwordx4 v[240:243], v55, s[20:23], s65 offen sc1
    buffer_store_dwordx4 v[244:247], v55, s[20:23], s66 offen sc1
    s_nop 1
    s_cmp_lg_u32 s32, 0
    s_cbranch_scc1 Lw2_12
    v_lshlrev_b32 v100, 16, v100
    v_lshlrev_b32 v101, 16, v101
    v_lshlrev_b32 v102, 16, v102
    v_lshlrev_b32 v103, 16, v103
    v_lshlrev_b32 v104, 16, v104
    v_lshlrev_b32 v105, 16, v105
    v_lshlrev_b32 v106, 16, v106
    v_lshlrev_b32 v107, 16, v107
    v_add_f32 v100, v100, v102
    v_sub_f32 v101, v101, v103
    v_add_f32 v104, v104, v106
    v_sub_f32 v105, v105, v107
    v_add_f32 v108, v100, v104
    v_add_f32 v109, v101, v105
    v_sub_f32 v110, v100, v104
    v_sub_f32 v111, v101, v105
    v_mul_f32 v108, 0x3e000000, v108
    v_mul_f32 v109, 0x3e000000, v109
    v_mul_f32 v110, 0x3e000000, v110
    v_mul_f32 v111, 0x3e000000, v111
    v_cvt_pk_bf16_f32 v108, v108, v109
    v_cvt_pk_bf16_f32 v110, v110, v111
    s_mov_b32 s34, 46619392
    s_mov_b32 s36, 46627968
    buffer_store_dword v108, v96, s[20:23], s34 offen sc1
    buffer_store_dword v110, v96, s[20:23], s36 offen sc1
    s_branch Lw3_13
Lw2_12:
    s_cmp_lg_u32 s32, 1
    s_cbranch_scc1 Lw3_13
    s_cmp_ge_u32 s33, 8
    s_cbranch_scc1 Lw3_13
    v_perm_b32 v240, v212, v208, s63
    v_perm_b32 v241, v220, v216, s63
    v_perm_b32 v242, v228, v224, s63
    v_perm_b32 v243, v236, v232, s63
    v_perm_b32 v244, v212, v208, s64
    v_perm_b32 v245, v220, v216, s64
    v_perm_b32 v246, v228, v224, s64
    v_perm_b32 v247, v236, v232, s64
    s_mov_b32 s65, 0
    s_mov_b32 s66, 8576
    buffer_store_dwordx4 v[240:243], v53, s[20:23], s65 offen sc1
    buffer_store_dwordx4 v[244:247], v53, s[20:23], s66 offen sc1
    s_nop 0
    v_perm_b32 v240, v213, v209, s63
    v_perm_b32 v241, v221, v217, s63
    v_perm_b32 v242, v229, v225, s63
    v_perm_b32 v243, v237, v233, s63
    v_perm_b32 v244, v213, v209, s64
    v_perm_b32 v245, v221, v217, s64
    v_perm_b32 v246, v229, v225, s64
    v_perm_b32 v247, v237, v233, s64
    s_mov_b32 s65, 17152
    s_mov_b32 s66, 25728
    buffer_store_dwordx4 v[240:243], v53, s[20:23], s65 offen sc1
    buffer_store_dwordx4 v[244:247], v53, s[20:23], s66 offen sc1
    s_nop 0
    v_perm_b32 v240, v214, v210, s63
    v_perm_b32 v241, v222, v218, s63
    v_perm_b32 v242, v230, v226, s63
    v_perm_b32 v243, v238, v234, s63
    v_perm_b32 v244, v214, v210, s64
    v_perm_b32 v245, v222, v218, s64
    v_perm_b32 v246, v230, v226, s64
    v_perm_b32 v247, v238, v234, s64
    s_mov_b32 s65, 34304
    s_mov_b32 s66, 42880
    buffer_store_dwordx4 v[240:243], v53, s[20:23], s65 offen sc1
    buffer_store_dwordx4 v[244:247], v53, s[20:23], s66 offen sc1
    s_nop 0
    v_perm_b32 v240, v215, v211, s63
    v_perm_b32 v241, v223, v219, s63
    v_perm_b32 v242, v231, v227, s63
    v_perm_b32 v243, v239, v235, s63
    v_perm_b32 v244, v215, v211, s64
    v_perm_b32 v245, v223, v219, s64
    v_perm_b32 v246, v231, v227, s64
    v_perm_b32 v247, v239, v235, s64
    s_mov_b32 s65, 51456
    s_mov_b32 s66, 60032
    buffer_store_dwordx4 v[240:243], v53, s[20:23], s65 offen sc1
    buffer_store_dwordx4 v[244:247], v53, s[20:23], s66 offen sc1
    s_nop 1
Lw3_13:
    s_waitcnt vmcnt(0) lgkmcnt(0)
    s_barrier
    s_cmp_lg_u32 s32, 0
    s_cbranch_scc1 Lsig_14
    s_add_u32 s49, s70, 2
    v_mov_b32 v15, s49
    s_lshl_b32 s49, s2, 6
    s_add_u32 s49, s49, 47251456
    s_mov_b64 exec, 1
    buffer_store_dword v15, off, s[20:23], s49 sc1
    s_mov_b64 exec, -1
Lsig_14:
    s_load_dwordx2 s[54:55], s[0:1], 48
    v_lshlrev_b32 v8, 6, v1
    s_lshl_b32 s38, s33, 2
    s_add_u32 s38, s38, s32
    s_mul_i32 s38, s38, 57344
    s_waitcnt lgkmcnt(0)
    s_mov_b32 s12, s54
    s_mov_b32 s13, s55
    s_mov_b32 s14, 0x700000
    s_mov_b32 s15, 0x20000
    s_cmp_lg_u32 s32, 0
    s_cbranch_scc1 Lpd_16
    s_mov_b32 s49, 100000
    v_and_b32 v7, 63, v1
    v_lshlrev_b32 v7, 6, v7
    s_add_u32 s51, s70, 1
Lpoll_15:
    s_mov_b32 s50, 47251456
    buffer_load_dword v12, v7, s[20:23], s50 offen sc1
    s_mov_b32 s50, 47255552
    buffer_load_dword v13, v7, s[20:23], s50 offen sc1
    s_mov_b32 s50, 47259648
    buffer_load_dword v14, v7, s[20:23], s50 offen sc1
    s_mov_b32 s50, 47263744
    buffer_load_dword v15, v7, s[20:23], s50 offen sc1
    s_waitcnt vmcnt(0)
    v_subrev_u32 v12, s51, v12
    v_subrev_u32 v13, s51, v13
    v_subrev_u32 v14, s51, v14
    v_subrev_u32 v15, s51, v15
    v_max3_u32 v12, v12, v13, v14
    v_max_u32 v12, v12, v15
    v_cmp_lt_u32 vcc, 6, v12
    s_sub_u32 s49, s49, 1
    s_cbranch_scc1 Lpd_16
    s_cbranch_vccz Lpd_16
    s_sleep 8
    s_branch Lpoll_15
Lpd_16:
    s_barrier
    s_mul_i32 s34, s33, 131456
    s_lshl_b32 s35, s32, 10
    s_add_u32 s34, s34, s35
    s_add_u32 s34, s34, 33554432
    s_lshl_b32 s35, s32, 10
    s_add_u32 m0, s35, 0
    s_nop 0
    buffer_load_dwordx4 v2, s[20:23], s34 offen sc1 lds
    s_add_u32 m0, s35, 4112
    s_add_u32 s34, s34, 4096
    buffer_load_dwordx4 v2, s[20:23], s34 offen sc1 lds
    s_add_u32 m0, s35, 8224
    s_add_u32 s34, s34, 4096
    buffer_load_dwordx4 v2, s[20:23], s34 offen sc1 lds
    s_add_u32 m0, s35, 12336
    s_add_u32 s34, s34, 4096
    buffer_load_dwordx4 v2, s[20:23], s34 offen sc1 lds
    s_add_u32 m0, s35, 16448
    s_add_u32 s34, s34, 4096
    buffer_load_dwordx4 v2, s[20:23], s34 offen sc1 lds
    s_add_u32 m0, s35, 20560
    s_add_u32 s34, s34, 4096
    buffer_load_dwordx4 v2, s[20:23], s34 offen sc1 lds
    s_add_u32 m0, s35, 24672
    s_add_u32 s34, s34, 4096
    buffer_load_dwordx4 v2, s[20:23], s34 offen sc1 lds
    s_add_u32 m0, s35, 28784
    s_add_u32 s34, s34, 4096
    buffer_load_dwordx4 v2, s[20:23], s34 offen sc1 lds
    s_add_u32 m0, s35, 32896
    s_add_u32 s34, s34, 4096
    buffer_load_dwordx4 v2, s[20:23], s34 offen sc1 lds
    s_add_u32 m0, s35, 37008
    s_add_u32 s34, s34, 4096
    buffer_load_dwordx4 v2, s[20:23], s34 offen sc1 lds
    s_add_u32 m0, s35, 41120
    s_add_u32 s34, s34, 4096
    buffer_load_dwordx4 v2, s[20:23], s34 offen sc1 lds
    s_add_u32 m0, s35, 45232
    s_add_u32 s34, s34, 4096
    buffer_load_dwordx4 v2, s[20:23], s34 offen sc1 lds
    s_add_u32 m0, s35, 49344
    s_add_u32 s34, s34, 4096
    buffer_load_dwordx4 v2, s[20:23], s34 offen sc1 lds
    s_add_u32 m0, s35, 53456
    s_add_u32 s34, s34, 4096
    buffer_load_dwordx4 v2, s[20:23], s34 offen sc1 lds
    s_add_u32 m0, s35, 57568
    s_add_u32 s34, s34, 4096
    buffer_load_dwordx4 v2, s[20:23], s34 offen sc1 lds
    s_add_u32 m0, s35, 61680
    s_add_u32 s34, s34, 4096
    buffer_load_dwordx4 v2, s[20:23], s34 offen sc1 lds
    s_add_u32 m0, s35, 65792
    s_add_u32 s34, s34, 4096
    buffer_load_dwordx4 v2, s[20:23], s34 offen sc1 lds
    s_add_u32 m0, s35, 69904
    s_add_u32 s34, s34, 4096
    buffer_load_dwordx4 v2, s[20:23], s34 offen sc1 lds
    s_add_u32 m0, s35, 74016
    s_add_u32 s34, s34, 4096
    buffer_load_dwordx4 v2, s[20:23], s34 offen sc1 lds
    s_add_u32 m0, s35, 78128
    s_add_u32 s34, s34, 4096
    buffer_load_dwordx4 v2, s[20:23], s34 offen sc1 lds
    s_add_u32 m0, s35, 82240
    s_add_u32 s34, s34, 4096
    buffer_load_dwordx4 v2, s[20:23], s34 offen sc1 lds
    s_add_u32 m0, s35, 86352
    s_add_u32 s34, s34, 4096
    buffer_load_dwordx4 v2, s[20:23], s34 offen sc1 lds
    s_add_u32 m0, s35, 90464
    s_add_u32 s34, s34, 4096
    buffer_load_dwordx4 v2, s[20:23], s34 offen sc1 lds
    s_add_u32 m0, s35, 94576
    s_add_u32 s34, s34, 4096
    buffer_load_dwordx4 v2, s[20:23], s34 offen sc1 lds
    s_add_u32 m0, s35, 98688
    s_add_u32 s34, s34, 4096
    buffer_load_dwordx4 v2, s[20:23], s34 offen sc1 lds
    s_add_u32 m0, s35, 102800
    s_add_u32 s34, s34, 4096
    buffer_load_dwordx4 v2, s[20:23], s34 offen sc1 lds
    s_add_u32 m0, s35, 106912
    s_add_u32 s34, s34, 4096
    buffer_load_dwordx4 v2, s[20:23], s34 offen sc1 lds
    s_add_u32 m0, s35, 111024
    s_add_u32 s34, s34, 4096
    buffer_load_dwordx4 v2, s[20:23], s34 offen sc1 lds
    s_add_u32 m0, s35, 115136
    s_add_u32 s34, s34, 4096
    buffer_load_dwordx4 v2, s[20:23], s34 offen sc1 lds
    s_add_u32 m0, s35, 119248
    s_add_u32 s34, s34, 4096
    buffer_load_dwordx4 v2, s[20:23], s34 offen sc1 lds
    s_add_u32 m0, s35, 123360
    s_add_u32 s34, s34, 4096
    buffer_load_dwordx4 v2, s[20:23], s34 offen sc1 lds
    s_add_u32 m0, s35, 127472
    s_add_u32 s34, s34, 4096
    buffer_load_dwordx4 v2, s[20:23], s34 offen sc1 lds
    s_cmp_eq_u32 s41, 0
    s_cselect_b32 s34, s40, 46619392
    s_cmp_eq_u32 s41, 0
    s_cbranch_scc1 Lq_17
    s_mov_b32 s36, 47316992
    buffer_load_dwordx4 v[48:51], v2, s[20:23], s36 offen offset:0 sc1
    buffer_load_dwordx4 v[52:55], v2, s[20:23], s36 offen offset:1024 sc1
    buffer_load_dwordx4 v[56:59], v2, s[20:23], s36 offen offset:2048 sc1
    buffer_load_dwordx4 v[60:63], v2, s[20:23], s36 offen offset:3072 sc1
    v_lshrrev_b32 v144, 3, v1
    v_mul_u32_u24 v144, 4112, v144
    v_and_b32 v145, 7, v1
    v_lshl_add_u32 v144, v145, 7, v144
    v_add_u32 v145, 65792, v144
    s_waitcnt vmcnt(0)
    ds_write_b128 v144, v[48:51] offset:16
    ds_write_b128 v144, v[52:55] offset:32912
    ds_write_b128 v145, v[56:59] offset:16
    ds_write_b128 v145, v[60:63] offset:32912
Lq_17:
    s_cmp_lg_u32 s32, 0
    s_cbranch_scc1 Lpd_19
    s_mov_b32 s49, 100000
    v_and_b32 v7, 63, v1
    v_lshlrev_b32 v7, 6, v7
    s_add_u32 s51, s70, 2
Lpoll_18:
    s_mov_b32 s50, 47251456
    buffer_load_dword v12, v7, s[20:23], s50 offen sc1
    s_mov_b32 s50, 47255552
    buffer_load_dword v13, v7, s[20:23], s50 offen sc1
    s_mov_b32 s50, 47259648
    buffer_load_dword v14, v7, s[20:23], s50 offen sc1
    s_mov_b32 s50, 47263744
    buffer_load_dword v15, v7, s[20:23], s50 offen sc1
    s_waitcnt vmcnt(0)
    v_subrev_u32 v12, s51, v12
    v_subrev_u32 v13, s51, v13
    v_subrev_u32 v14, s51, v14
    v_subrev_u32 v15, s51, v15
    v_max3_u32 v12, v12, v13, v14
    v_max_u32 v12, v12, v15
    v_cmp_lt_u32 vcc, 5, v12
    s_sub_u32 s49, s49, 1
    s_cbranch_scc1 Lpd_19
    s_cbranch_vccz Lpd_19
    s_sleep 8
    s_branch Lpoll_18
Lpd_19:
    s_barrier
    s_waitcnt vmcnt(0)
    s_add_u32 s36, s34, 4096
    buffer_load_dwordx4 v[160:163], v11, s[20:23], s34 offen offset:0 sc1
    buffer_load_dwordx4 v[164:167], v11, s[20:23], s34 offen offset:1024 sc1
    buffer_load_dwordx4 v[168:171], v11, s[20:23], s34 offen offset:2048 sc1
    buffer_load_dwordx4 v[172:175], v11, s[20:23], s34 offen offset:3072 sc1
    buffer_load_dwordx4 v[176:179], v11, s[20:23], s36 offen offset:0 sc1
    buffer_load_dwordx4 v[180:183], v11, s[20:23], s36 offen offset:1024 sc1
    buffer_load_dwordx4 v[184:187], v11, s[20:23], s36 offen offset:2048 sc1
    buffer_load_dwordx4 v[188:191], v11, s[20:23], s36 offen offset:3072 sc1
    s_cmp_eq_u32 s41, 0
    s_cbranch_scc1 Lq_20
    s_mov_b32 s34, 46627968
    s_add_u32 s36, s34, 4096
    buffer_load_dwordx4 a[136:139], v11, s[20:23], s34 offen offset:0 sc1
    buffer_load_dwordx4 a[140:143], v11, s[20:23], s34 offen offset:1024 sc1
    buffer_load_dwordx4 a[144:147], v11, s[20:23], s34 offen offset:2048 sc1
    buffer_load_dwordx4 a[148:151], v11, s[20:23], s34 offen offset:3072 sc1
    buffer_load_dwordx4 a[152:155], v11, s[20:23], s36 offen offset:0 sc1
    buffer_load_dwordx4 a[156:159], v11, s[20:23], s36 offen offset:1024 sc1
    buffer_load_dwordx4 a[160:163], v11, s[20:23], s36 offen offset:2048 sc1
    buffer_load_dwordx4 a[164:167], v11, s[20:23], s36 offen offset:3072 sc1
Lq_20:
    buffer_load_dword a170, v8, s[12:15], s38 offen
    s_add_u32 s38, s38, 4096
    buffer_load_dword a171, v8, s[12:15], s38 offen
    s_add_u32 s38, s38, 4096
    buffer_load_dword a172, v8, s[12:15], s38 offen
    s_add_u32 s38, s38, 4096
    buffer_load_dword a173, v8, s[12:15], s38 offen
    s_add_u32 s38, s38, 4096
    ds_read_b64_tr_b16 a[104:105], v3 offset:0
    ds_read_b64_tr_b16 a[106:107], v3 offset:32896
    ds_read_b64_tr_b16 a[120:121], v3 offset:512
    ds_read_b64_tr_b16 a[122:123], v3 offset:33408
    ds_read_b64_tr_b16 a[108:109], v4 offset:0
    ds_read_b64_tr_b16 a[110:111], v4 offset:32896
    ds_read_b64_tr_b16 a[124:125], v4 offset:512
    ds_read_b64_tr_b16 a[126:127], v4 offset:33408
    ds_read_b64_tr_b16 a[112:113], v3 offset:16
    ds_read_b64_tr_b16 a[114:115], v3 offset:32912
    ds_read_b64_tr_b16 a[128:129], v3 offset:528
    ds_read_b64_tr_b16 a[130:131], v3 offset:33424
    ds_read_b64_tr_b16 a[116:117], v4 offset:16
    ds_read_b64_tr_b16 a[118:119], v4 offset:32912
    ds_read_b64_tr_b16 a[132:133], v4 offset:528
    ds_read_b64_tr_b16 a[134:135], v4 offset:33424
    s_waitcnt lgkmcnt(14)
    v_mfma_f32_32x32x16_bf16 v[48:63], a[104:107], a[0:3], 0
    v_mfma_f32_32x32x16_bf16 v[64:79], a[104:107], a[8:11], 0
    s_waitcnt lgkmcnt(12)
    v_mfma_f32_32x32x16_bf16 v[80:95], a[120:123], a[24:27], 0
    v_mfma_f32_32x32x16_bf16 v[96:111], a[120:123], a[32:35], 0
    s_waitcnt lgkmcnt(10)
    v_mfma_f32_32x32x16_bf16 v[48:63], a[108:111], a[4:7], v[48:63]
    v_mfma_f32_32x32x16_bf16 v[64:79], a[108:111], a[12:15], v[64:79]
    s_waitcnt lgkmcnt(8)
    v_mfma_f32_32x32x16_bf16 v[80:95], a[124:127], a[28:31], v[80:95]
    v_mfma_f32_32x32x16_bf16 v[96:111], a[124:127], a[36:39], v[96:111]
    s_waitcnt lgkmcnt(6)
    v_mfma_f32_32x32x16_bf16 v[48:63], a[112:115], a[16:19], v[48:63]
    v_mfma_f32_32x32x16_bf16 v[64:79], a[112:115], a[0:3], v[64:79]
    s_waitcnt lgkmcnt(4)
    v_mfma_f32_32x32x16_bf16 v[80:95], a[128:131], a[40:43], v[80:95]
    v_mfma_f32_32x32x16_bf16 v[96:111], a[128:131], a[24:27], v[96:111]
    s_waitcnt lgkmcnt(2)
    v_mfma_f32_32x32x16_bf16 v[48:63], a[116:119], a[20:23], v[48:63]
    v_mfma_f32_32x32x16_bf16 v[64:79], a[116:119], a[4:7], v[64:79]
    s_waitcnt lgkmcnt(0)
    v_mfma_f32_32x32x16_bf16 v[80:95], a[132:135], a[44:47], v[80:95]
    v_mfma_f32_32x32x16_bf16 v[96:111], a[132:135], a[28:31], v[96:111]
    s_nop 11
    s_mov_b32 s48, 0
Lc_21:
    s_cmp_eq_u32 s41, 0
    s_cbranch_scc0 Lsp_22
Lback_23:
    s_add_u32 s40, s40, 274432
    s_cmp_lt_u32 s48, 3
    s_cselect_b32 s34, s40, 0x7ff00000
    v_pk_add_f32 v[144:145], v[48:49], v[80:81]
    v_pk_add_f32 v[146:147], v[64:65], v[96:97]
    v_pk_add_f32 v[148:149], v[48:49], v[80:81] neg_lo:[0,1] neg_hi:[0,1]
    v_pk_add_f32 v[150:151], v[64:65], v[96:97] neg_lo:[0,1] neg_hi:[0,1]
    v_pk_add_f32 v[152:153], v[50:51], v[82:83]
    v_pk_add_f32 v[154:155], v[66:67], v[98:99]
    v_pk_add_f32 v[156:157], v[50:51], v[82:83] neg_lo:[0,1] neg_hi:[0,1]
    v_pk_add_f32 v[158:159], v[66:67], v[98:99] neg_lo:[0,1] neg_hi:[0,1]
    v_pk_mul_f32 v[48:49], v[146:147], v[32:33]
    v_pk_mul_f32 v[64:65], v[146:147], v[16:17]
    v_pk_mul_f32 v[80:81], v[150:151], v[32:33]
    v_pk_mul_f32 v[96:97], v[150:151], v[16:17]
    v_pk_mul_f32 v[50:51], v[154:155], v[34:35]
    v_pk_mul_f32 v[66:67], v[154:155], v[18:19]
    v_pk_mul_f32 v[82:83], v[158:159], v[34:35]
    v_pk_mul_f32 v[98:99], v[158:159], v[18:19]
    v_pk_fma_f32 v[48:49], v[144:145], v[16:17], v[48:49] neg_lo:[0,0,1] neg_hi:[0,0,1]
    v_pk_fma_f32 v[64:65], v[144:145], v[32:33], v[64:65]
    v_pk_fma_f32 v[80:81], v[148:149], v[16:17], v[80:81] neg_lo:[0,0,1] neg_hi:[0,0,1]
    v_pk_fma_f32 v[96:97], v[148:149], v[32:33], v[96:97]
    v_pk_fma_f32 v[50:51], v[152:153], v[18:19], v[50:51] neg_lo:[0,0,1] neg_hi:[0,0,1]
    v_pk_fma_f32 v[66:67], v[152:153], v[34:35], v[66:67]
    v_pk_fma_f32 v[82:83], v[156:157], v[18:19], v[82:83] neg_lo:[0,0,1] neg_hi:[0,0,1]
    v_pk_fma_f32 v[98:99], v[156:157], v[34:35], v[98:99]
    v_pk_add_f32 v[144:145], v[52:53], v[84:85]
    v_pk_add_f32 v[146:147], v[68:69], v[100:101]
    v_pk_add_f32 v[148:149], v[52:53], v[84:85] neg_lo:[0,1] neg_hi:[0,1]
    v_pk_add_f32 v[152:153], v[54:55], v[86:87]
    v_pk_add_f32 v[154:155], v[70:71], v[102:103]
    v_pk_add_f32 v[156:157], v[54:55], v[86:87] neg_lo:[0,1] neg_hi:[0,1]
    v_pk_add_f32 v[150:151], v[68:69], v[100:101] neg_lo:[0,1] neg_hi:[0,1]
    v_pk_add_f32 v[158:159], v[70:71], v[102:103] neg_lo:[0,1] neg_hi:[0,1]
    v_pk_mul_f32 v[52:53], v[146:147], v[36:37]
    v_pk_mul_f32 v[54:55], v[154:155], v[38:39]
    v_pk_mul_f32 v[68:69], v[146:147], v[20:21]
    v_pk_mul_f32 v[84:85], v[150:151], v[36:37]
    v_pk_mul_f32 v[100:101], v[150:151], v[20:21]
    v_pk_mul_f32 v[70:71], v[154:155], v[22:23]
    v_pk_mul_f32 v[86:87], v[158:159], v[38:39]
    v_pk_mul_f32 v[102:103], v[158:159], v[22:23]
    v_pk_fma_f32 v[52:53], v[144:145], v[20:21], v[52:53] neg_lo:[0,0,1] neg_hi:[0,0,1]
    v_pk_fma_f32 v[54:55], v[152:153], v[22:23], v[54:55] neg_lo:[0,0,1] neg_hi:[0,0,1]
    v_pk_fma_f32 v[68:69], v[144:145], v[36:37], v[68:69]
    v_pk_fma_f32 v[84:85], v[148:149], v[20:21], v[84:85] neg_lo:[0,0,1] neg_hi:[0,0,1]
    v_pk_fma_f32 v[100:101], v[148:149], v[36:37], v[100:101]
    v_pk_fma_f32 v[70:71], v[152:153], v[38:39], v[70:71]
    v_pk_fma_f32 v[86:87], v[156:157], v[22:23], v[86:87] neg_lo:[0,0,1] neg_hi:[0,0,1]
    v_pk_fma_f32 v[102:103], v[156:157], v[38:39], v[102:103]
    v_pk_add_f32 v[144:145], v[56:57], v[88:89]
    v_pk_add_f32 v[146:147], v[72:73], v[104:105]
    v_pk_add_f32 v[148:149], v[56:57], v[88:89] neg_lo:[0,1] neg_hi:[0,1]
    v_pk_add_f32 v[150:151], v[72:73], v[104:105] neg_lo:[0,1] neg_hi:[0,1]
    v_pk_add_f32 v[152:153], v[58:59], v[90:91]
    v_pk_add_f32 v[154:155], v[74:75], v[106:107]
    v_pk_add_f32 v[156:157], v[58:59], v[90:91] neg_lo:[0,1] neg_hi:[0,1]
    v_pk_add_f32 v[158:159], v[74:75], v[106:107] neg_lo:[0,1] neg_hi:[0,1]
    v_pk_mul_f32 v[56:57], v[146:147], v[40:41]
    v_pk_mul_f32 v[72:73], v[146:147], v[24:25]
    v_pk_mul_f32 v[88:89], v[150:151], v[40:41]
    v_pk_mul_f32 v[104:105], v[150:151], v[24:25]
    v_pk_mul_f32 v[58:59], v[154:155], v[42:43]
    v_pk_mul_f32 v[74:75], v[154:155], v[26:27]
    v_pk_mul_f32 v[90:91], v[158:159], v[42:43]
    v_pk_mul_f32 v[106:107], v[158:159], v[26:27]
    v_pk_fma_f32 v[56:57], v[144:145], v[24:25], v[56:57] neg_lo:[0,0,1] neg_hi:[0,0,1]
    v_pk_fma_f32 v[72:73], v[144:145], v[40:41], v[72:73]
    v_pk_fma_f32 v[88:89], v[148:149], v[24:25], v[88:89] neg_lo:[0,0,1] neg_hi:[0,0,1]
    v_pk_fma_f32 v[104:105], v[148:149], v[40:41], v[104:105]
    v_pk_fma_f32 v[58:59], v[152:153], v[26:27], v[58:59] neg_lo:[0,0,1] neg_hi:[0,0,1]
    v_pk_fma_f32 v[74:75], v[152:153], v[42:43], v[74:75]
    v_pk_fma_f32 v[90:91], v[156:157], v[26:27], v[90:91] neg_lo:[0,0,1] neg_hi:[0,0,1]
    v_pk_fma_f32 v[106:107], v[156:157], v[42:43], v[106:107]
    v_pk_add_f32 v[144:145], v[60:61], v[92:93]
    v_pk_add_f32 v[146:147], v[76:77], v[108:109]
    v_pk_add_f32 v[148:149], v[60:61], v[92:93] neg_lo:[0,1] neg_hi:[0,1]
    v_pk_add_f32 v[152:153], v[62:63], v[94:95]
    v_pk_add_f32 v[154:155], v[78:79], v[110:111]
    v_pk_add_f32 v[156:157], v[62:63], v[94:95] neg_lo:[0,1] neg_hi:[0,1]
    v_pk_mul_f32 v[60:61], v[146:147], v[44:45]
    v_pk_mul_f32 v[62:63], v[154:155], v[46:47]
    v_pk_fma_f32 v[60:61], v[144:145], v[28:29], v[60:61] neg_lo:[0,0,1] neg_hi:[0,0,1]
    v_pk_fma_f32 v[62:63], v[152:153], v[30:31], v[62:63] neg_lo:[0,0,1] neg_hi:[0,0,1]
    v_pk_add_f32 v[150:151], v[76:77], v[108:109] neg_lo:[0,1] neg_hi:[0,1]
    v_pk_add_f32 v[158:159], v[78:79], v[110:111] neg_lo:[0,1] neg_hi:[0,1]
    v_pk_mul_f32 v[92:93], v[150:151], v[44:45]
    v_pk_mul_f32 v[94:95], v[158:159], v[46:47]
    v_pk_fma_f32 v[92:93], v[148:149], v[28:29], v[92:93] neg_lo:[0,0,1] neg_hi:[0,0,1]
    v_pk_fma_f32 v[94:95], v[156:157], v[30:31], v[94:95] neg_lo:[0,0,1] neg_hi:[0,0,1]
    v_pk_mul_f32 v[76:77], v[146:147], v[28:29]
    v_pk_mul_f32 v[78:79], v[154:155], v[30:31]
    v_pk_fma_f32 v[76:77], v[144:145], v[44:45], v[76:77]
    v_pk_fma_f32 v[78:79], v[152:153], v[46:47], v[78:79]
    v_pk_mul_f32 v[108:109], v[150:151], v[28:29]
    v_pk_mul_f32 v[110:111], v[158:159], v[30:31]
    v_pk_fma_f32 v[108:109], v[148:149], v[44:45], v[108:109]
    v_pk_fma_f32 v[110:111], v[156:157], v[46:47], v[110:111]
    v_cvt_pk_bf16_f32 v112, v48, v49
    v_cvt_pk_bf16_f32 v113, v50, v51
    v_cvt_pk_bf16_f32 v114, v52, v53
    v_cvt_pk_bf16_f32 v115, v54, v55
    v_cvt_pk_bf16_f32 v128, v80, v81
    v_cvt_pk_bf16_f32 v129, v82, v83
    v_mfma_f32_32x32x16_bf16 v[208:223], a[8:11], v[112:115], 0
    v_cvt_pk_bf16_f32 v130, v84, v85
    v_cvt_pk_bf16_f32 v131, v86, v87
    v_cvt_pk_bf16_f32 v116, v56, v57
    v_cvt_pk_bf16_f32 v117, v58, v59
    v_cvt_pk_bf16_f32 v118, v60, v61
    v_mfma_f32_32x32x16_bf16 v[192:207], a[0:3], v[112:115], 0
    v_cvt_pk_bf16_f32 v119, v62, v63
    v_cvt_pk_bf16_f32 v132, v88, v89
    v_cvt_pk_bf16_f32 v133, v90, v91
    v_cvt_pk_bf16_f32 v134, v92, v93
    v_cvt_pk_bf16_f32 v135, v94, v95
    v_mfma_f32_32x32x16_bf16 v[240:255], a[56:59], v[128:131], 0
    v_cvt_pk_bf16_f32 v120, v64, v65
    v_cvt_pk_bf16_f32 v121, v66, v67
    v_cvt_pk_bf16_f32 v122, v68, v69
    v_cvt_pk_bf16_f32 v123, v70, v71
    v_cvt_pk_bf16_f32 v136, v96, v97
    v_mfma_f32_32x32x16_bf16 v[224:239], a[48:51], v[128:131], 0
    v_cvt_pk_bf16_f32 v137, v98, v99
    v_cvt_pk_bf16_f32 v138, v100, v101
    v_cvt_pk_bf16_f32 v139, v102, v103
    v_cvt_pk_bf16_f32 v124, v72, v73
    v_cvt_pk_bf16_f32 v125, v74, v75
    v_mfma_f32_32x32x16_bf16 v[208:223], a[12:15], v[116:119], v[208:223]
    v_cvt_pk_bf16_f32 v126, v76, v77
    v_cvt_pk_bf16_f32 v127, v78, v79
    v_cvt_pk_bf16_f32 v140, v104, v105
    v_cvt_pk_bf16_f32 v141, v106, v107
    v_cvt_pk_bf16_f32 v142, v108, v109
    v_mfma_f32_32x32x16_bf16 v[192:207], a[4:7], v[116:119], v[192:207]
    v_cvt_pk_bf16_f32 v143, v110, v111
    s_waitcnt vmcnt(11)
    v_and_b32 v64, s69, v160
    v_and_b32 v65, s69, v161
    v_and_b32 v66, s69, v162
    v_and_b32 v67, s69, v163
    v_mfma_f32_32x32x16_bf16 v[240:255], a[60:63], v[132:135], v[240:255]
    s_waitcnt vmcnt(10)
    v_and_b32 v68, s69, v164
    v_and_b32 v69, s69, v165
    v_and_b32 v70, s69, v166
    v_and_b32 v71, s69, v167
    s_waitcnt vmcnt(9)
    v_and_b32 v72, s69, v168
    v_and_b32 v73, s69, v169
    v_mfma_f32_32x32x16_bf16 v[224:239], a[52:55], v[132:135], v[224:239]
    v_and_b32 v74, s69, v170
    v_and_b32 v75, s69, v171
    s_waitcnt vmcnt(8)
    v_and_b32 v76, s69, v172
    v_and_b32 v77, s69, v173
    v_and_b32 v78, s69, v174
    v_and_b32 v79, s69, v175
    v_mfma_f32_32x32x16_bf16 v[208:223], a[0:3], v[120:123], v[208:223]
    v_lshlrev_b32 v48, 16, v160
    v_lshlrev_b32 v49, 16, v161
    v_lshlrev_b32 v50, 16, v162
    v_lshlrev_b32 v51, 16, v163
    buffer_load_dwordx4 v[160:163], v11, s[20:23], s34 offen offset:0 sc1
    v_mfma_f32_32x32x16_bf16 v[192:207], a[16:19], v[120:123], v[192:207]
    v_lshlrev_b32 v52, 16, v164
    v_lshlrev_b32 v53, 16, v165
    v_lshlrev_b32 v54, 16, v166
    v_lshlrev_b32 v55, 16, v167
    buffer_load_dwordx4 v[164:167], v11, s[20:23], s34 offen offset:1024 sc1
    v_mfma_f32_32x32x16_bf16 v[240:255], a[48:51], v[136:139], v[240:255]
    v_lshlrev_b32 v56, 16, v168
    v_lshlrev_b32 v57, 16, v169
    v_lshlrev_b32 v58, 16, v170
    v_lshlrev_b32 v59, 16, v171
    buffer_load_dwordx4 v[168:171], v11, s[20:23], s34 offen offset:2048 sc1
    v_mfma_f32_32x32x16_bf16 v[224:239], a[64:67], v[136:139], v[224:239]
    v_lshlrev_b32 v60, 16, v172
    v_lshlrev_b32 v61, 16, v173
    v_lshlrev_b32 v62, 16, v174
    v_lshlrev_b32 v63, 16, v175
    buffer_load_dwordx4 v[172:175], v11, s[20:23], s34 offen offset:3072 sc1
    v_mfma_f32_32x32x16_bf16 v[208:223], a[4:7], v[124:127], v[208:223]
    s_waitcnt vmcnt(11)
    v_and_b32 v96, s69, v176
    v_and_b32 v97, s69, v177
    v_and_b32 v98, s69, v178
    v_and_b32 v99, s69, v179
    s_waitcnt vmcnt(10)
    v_and_b32 v100, s69, v180
    v_and_b32 v101, s69, v181
    v_mfma_f32_32x32x16_bf16 v[192:207], a[20:23], v[124:127], v[192:207]
    v_and_b32 v102, s69, v182
    v_and_b32 v103, s69, v183
    s_waitcnt vmcnt(9)
    v_and_b32 v104, s69, v184
    v_and_b32 v105, s69, v185
    v_and_b32 v106, s69, v186
    v_and_b32 v107, s69, v187
    v_mfma_f32_32x32x16_bf16 v[240:255], a[52:55], v[140:143], v[240:255]
    s_waitcnt vmcnt(8)
    v_and_b32 v108, s69, v188
    v_and_b32 v109, s69, v189
    v_and_b32 v110, s69, v190
    v_and_b32 v111, s69, v191
    v_lshlrev_b32 v80, 16, v176
    v_lshlrev_b32 v81, 16, v177
    v_mfma_f32_32x32x16_bf16 v[224:239], a[68:71], v[140:143], v[224:239]
    v_lshlrev_b32 v82, 16, v178
    v_lshlrev_b32 v83, 16, v179
    v_lshlrev_b32 v84, 16, v180
    v_lshlrev_b32 v85, 16, v181
    v_lshlrev_b32 v86, 16, v182
    v_lshlrev_b32 v87, 16, v183
    v_lshlrev_b32 v88, 16, v184
    v_lshlrev_b32 v89, 16, v185
    v_lshlrev_b32 v90, 16, v186
    v_pk_mul_f32 v[144:145], v[208:209], v[64:65]
    v_pk_mul_f32 v[146:147], v[210:211], v[66:67]
    v_pk_mul_f32 v[148:149], v[212:213], v[68:69]
    v_pk_mul_f32 v[150:151], v[214:215], v[70:71]
    v_pk_mul_f32 v[152:153], v[216:217], v[72:73]
    v_pk_mul_f32 v[154:155], v[218:219], v[74:75]
    v_pk_mul_f32 v[156:157], v[220:221], v[76:77]
    v_pk_mul_f32 v[158:159], v[222:223], v[78:79]
    v_pk_fma_f32 v[144:145], v[192:193], v[48:49], v[144:145] neg_lo:[0,0,1] neg_hi:[0,0,1]
    v_pk_fma_f32 v[146:147], v[194:195], v[50:51], v[146:147] neg_lo:[0,0,1] neg_hi:[0,0,1]
    v_pk_fma_f32 v[148:149], v[196:197], v[52:53], v[148:149] neg_lo:[0,0,1] neg_hi:[0,0,1]
    v_pk_fma_f32 v[150:151], v[198:199], v[54:55], v[150:151] neg_lo:[0,0,1] neg_hi:[0,0,1]
    v_pk_fma_f32 v[152:153], v[200:201], v[56:57], v[152:153] neg_lo:[0,0,1] neg_hi:[0,0,1]
    v_pk_fma_f32 v[154:155], v[202:203], v[58:59], v[154:155] neg_lo:[0,0,1] neg_hi:[0,0,1]
    v_pk_fma_f32 v[156:157], v[204:205], v[60:61], v[156:157] neg_lo:[0,0,1] neg_hi:[0,0,1]
    v_pk_fma_f32 v[158:159], v[206:207], v[62:63], v[158:159] neg_lo:[0,0,1] neg_hi:[0,0,1]
    v_pk_mul_f32 v[208:209], v[208:209], v[48:49]
    v_pk_mul_f32 v[210:211], v[210:211], v[50:51]
    v_pk_mul_f32 v[212:213], v[212:213], v[52:53]
    v_pk_mul_f32 v[214:215], v[214:215], v[54:55]
    v_pk_mul_f32 v[216:217], v[216:217], v[56:57]
    v_pk_mul_f32 v[218:219], v[218:219], v[58:59]
    v_pk_mul_f32 v[220:221], v[220:221], v[60:61]
    v_pk_mul_f32 v[222:223], v[222:223], v[62:63]
    v_pk_fma_f32 v[208:209], v[192:193], v[64:65], v[208:209]
    v_pk_fma_f32 v[210:211], v[194:195], v[66:67], v[210:211]
    v_pk_fma_f32 v[212:213], v[196:197], v[68:69], v[212:213]
    v_pk_fma_f32 v[214:215], v[198:199], v[70:71], v[214:215]
    v_pk_fma_f32 v[216:217], v[200:201], v[72:73], v[216:217]
    v_pk_fma_f32 v[218:219], v[202:203], v[74:75], v[218:219]
    v_pk_fma_f32 v[220:221], v[204:205], v[76:77], v[220:221]
    v_pk_fma_f32 v[222:223], v[206:207], v[78:79], v[222:223]
    v_cvt_pk_bf16_f32 v112, v144, v145
    v_pk_mul_f32 v[144:145], v[240:241], v[96:97]
    v_pk_mul_f32 v[240:241], v[240:241], v[80:81]
    v_pk_fma_f32 v[144:145], v[224:225], v[80:81], v[144:145] neg_lo:[0,0,1] neg_hi:[0,0,1]
    v_pk_fma_f32 v[240:241], v[224:225], v[96:97], v[240:241]
    v_cvt_pk_bf16_f32 v113, v146, v147
    v_pk_mul_f32 v[146:147], v[242:243], v[98:99]
    v_pk_mul_f32 v[242:243], v[242:243], v[82:83]
    v_pk_fma_f32 v[146:147], v[226:227], v[82:83], v[146:147] neg_lo:[0,0,1] neg_hi:[0,0,1]
    v_pk_fma_f32 v[242:243], v[226:227], v[98:99], v[242:243]
    v_cvt_pk_bf16_f32 v114, v148, v149
    v_pk_mul_f32 v[148:149], v[244:245], v[100:101]
    v_pk_mul_f32 v[244:245], v[244:245], v[84:85]
    v_pk_fma_f32 v[148:149], v[228:229], v[84:85], v[148:149] neg_lo:[0,0,1] neg_hi:[0,0,1]
    v_pk_fma_f32 v[244:245], v[228:229], v[100:101], v[244:245]
    v_cvt_pk_bf16_f32 v115, v150, v151
    v_pk_mul_f32 v[150:151], v[246:247], v[102:103]
    v_pk_mul_f32 v[246:247], v[246:247], v[86:87]
    v_pk_fma_f32 v[150:151], v[230:231], v[86:87], v[150:151] neg_lo:[0,0,1] neg_hi:[0,0,1]
    v_pk_fma_f32 v[246:247], v[230:231], v[102:103], v[246:247]
    v_mfma_f32_32x32x16_bf16 v[48:63], v[112:115], a[0:3], 0
    v_cvt_pk_bf16_f32 v116, v152, v153
    v_cvt_pk_bf16_f32 v117, v154, v155
    v_cvt_pk_bf16_f32 v118, v156, v157
    v_cvt_pk_bf16_f32 v119, v158, v159
    v_lshlrev_b32 v91, 16, v187
    v_mfma_f32_32x32x16_bf16 v[64:79], v[112:115], a[16:19], 0
    v_lshlrev_b32 v92, 16, v188
    v_lshlrev_b32 v93, 16, v189
    v_lshlrev_b32 v94, 16, v190
    v_lshlrev_b32 v95, 16, v191
    v_mul_f32 v154, v250, v106
    v_mul_f32 v155, v251, v107
    v_mfma_f32_32x32x16_bf16 v[48:63], v[116:119], a[4:7], v[48:63]
    v_mul_f32 v156, v252, v108
    v_mul_f32 v157, v253, v109
    v_mul_f32 v158, v254, v110
    v_mul_f32 v159, v255, v111
    v_mul_f32 v250, v250, v90
    v_mul_f32 v251, v251, v91
    v_mfma_f32_32x32x16_bf16 v[64:79], v[116:119], a[20:23], v[64:79]
    v_mul_f32 v252, v252, v92
    v_mul_f32 v253, v253, v93
    v_mul_f32 v254, v254, v94
    v_mul_f32 v255, v255, v95
    v_cvt_pk_bf16_f32 v128, v144, v145
    v_cvt_pk_bf16_f32 v129, v146, v147
    v_cvt_pk_bf16_f32 v130, v148, v149
    v_cvt_pk_bf16_f32 v131, v150, v151
    v_pk_mul_f32 v[152:153], v[248:249], v[104:105]
    v_pk_mul_f32 v[248:249], v[248:249], v[88:89]
    v_pk_fma_f32 v[152:153], v[232:233], v[88:89], v[152:153] neg_lo:[0,0,1] neg_hi:[0,0,1]
    v_pk_fma_f32 v[248:249], v[232:233], v[104:105], v[248:249]
    v_fma_f32 v154, v234, v90, -v154
    v_fma_f32 v155, v235, v91, -v155
    v_fma_f32 v156, v236, v92, -v156
    v_fma_f32 v157, v237, v93, -v157
    v_fma_f32 v158, v238, v94, -v158
    v_fma_f32 v159, v239, v95, -v159
    v_mfma_f32_32x32x16_bf16 v[80:95], v[128:131], a[24:27], 0
    v_fmac_f32 v250, v234, v106
    v_fmac_f32 v251, v235, v107
    v_fmac_f32 v252, v236, v108
    v_fmac_f32 v253, v237, v109
    v_fmac_f32 v254, v238, v110
    v_fmac_f32 v255, v239, v111
    v_mfma_f32_32x32x16_bf16 v[96:111], v[128:131], a[40:43], 0
    v_cvt_pk_bf16_f32 v132, v152, v153
    v_cvt_pk_bf16_f32 v133, v154, v155
    v_cvt_pk_bf16_f32 v134, v156, v157
    v_cvt_pk_bf16_f32 v135, v158, v159
    v_cvt_pk_bf16_f32 v120, v208, v209
    v_cvt_pk_bf16_f32 v121, v210, v211
    v_mfma_f32_32x32x16_bf16 v[80:95], v[132:135], a[28:31], v[80:95]
    v_cvt_pk_bf16_f32 v122, v212, v213
    v_cvt_pk_bf16_f32 v123, v214, v215
    v_cvt_pk_bf16_f32 v136, v240, v241
    v_cvt_pk_bf16_f32 v137, v242, v243
    v_cvt_pk_bf16_f32 v138, v244, v245
    v_mfma_f32_32x32x16_bf16 v[96:111], v[132:135], a[44:47], v[96:111]
    v_cvt_pk_bf16_f32 v139, v246, v247
    v_cvt_pk_bf16_f32 v124, v216, v217
    v_cvt_pk_bf16_f32 v125, v218, v219
    v_cvt_pk_bf16_f32 v126, v220, v221
    v_cvt_pk_bf16_f32 v127, v222, v223
    v_mfma_f32_32x32x16_bf16 v[48:63], v[120:123], a[8:11], v[48:63]
    v_cvt_pk_bf16_f32 v140, v248, v249
    v_cvt_pk_bf16_f32 v141, v250, v251
    v_cvt_pk_bf16_f32 v142, v252, v253
    v_cvt_pk_bf16_f32 v143, v254, v255
    s_cmp_le_u32 s48, 2
    v_mfma_f32_32x32x16_bf16 v[64:79], v[120:123], a[0:3], v[64:79]
    s_cselect_b32 s38, s38, 0x7ff00000
    s_add_u32 s36, s34, 4096
    buffer_load_dwordx4 v[176:179], v11, s[20:23], s36 offen offset:0 sc1
    buffer_load_dwordx4 v[180:183], v11, s[20:23], s36 offen offset:1024 sc1
    buffer_load_dwordx4 v[184:187], v11, s[20:23], s36 offen offset:2048 sc1
    v_mfma_f32_32x32x16_bf16 v[80:95], v[136:139], a[32:35], v[80:95]
    buffer_load_dwordx4 v[188:191], v11, s[20:23], s36 offen offset:3072 sc1
    buffer_load_dword a170, v8, s[12:15], s38 offen
    s_add_u32 s38, s38, 4096
    buffer_load_dword a171, v8, s[12:15], s38 offen
    s_add_u32 s38, s38, 4096
    v_mfma_f32_32x32x16_bf16 v[96:111], v[136:139], a[24:27], v[96:111]
    buffer_load_dword a172, v8, s[12:15], s38 offen
    s_add_u32 s38, s38, 4096
    buffer_load_dword a173, v8, s[12:15], s38 offen
    s_add_u32 s38, s38, 4096
    s_add_u32 s48, s48, 1
    v_mfma_f32_32x32x16_bf16 v[48:63], v[124:127], a[12:15], v[48:63]
    s_mov_b32 s41, 0
    s_cmp_lt_u32 s48, 4
    v_add_u32 v4, 32, v4
    ds_read_b64_tr_b16 a[116:117], v4 offset:16
    ds_read_b64_tr_b16 a[118:119], v4 offset:32912
    v_mfma_f32_32x32x16_bf16 v[64:79], v[124:127], a[4:7], v[64:79]
    ds_read_b64_tr_b16 a[132:133], v4 offset:528
    ds_read_b64_tr_b16 a[134:135], v4 offset:33424
    ds_read_b64_tr_b16 a[108:109], v4 offset:0
    ds_read_b64_tr_b16 a[110:111], v4 offset:32896
    ds_read_b64_tr_b16 a[124:125], v4 offset:512
    v_mfma_f32_32x32x16_bf16 v[80:95], v[140:143], a[36:39], v[80:95]
    ds_read_b64_tr_b16 a[126:127], v4 offset:33408
    v_add_u32 v3, 32, v3
    ds_read_b64_tr_b16 a[112:113], v3 offset:16
    ds_read_b64_tr_b16 a[114:115], v3 offset:32912
    ds_read_b64_tr_b16 a[128:129], v3 offset:528
    v_mfma_f32_32x32x16_bf16 v[96:111], v[140:143], a[28:31], v[96:111]
    ds_read_b64_tr_b16 a[130:131], v3 offset:33424
    ds_read_b64_tr_b16 a[104:105], v3 offset:0
    ds_read_b64_tr_b16 a[106:107], v3 offset:32896
    ds_read_b64_tr_b16 a[120:121], v3 offset:512
    ds_read_b64_tr_b16 a[122:123], v3 offset:33408
    s_nop 0
    v_pk_add_f32 v[144:145], v[48:49], v[80:81]
    v_pk_add_f32 v[148:149], v[48:49], v[80:81] neg_lo:[0,1] neg_hi:[0,1]
    v_pk_add_f32 v[152:153], v[50:51], v[82:83]
    v_pk_add_f32 v[156:157], v[50:51], v[82:83] neg_lo:[0,1] neg_hi:[0,1]
    s_nop 1
    v_pk_add_f32 v[146:147], v[64:65], v[96:97]
    v_pk_add_f32 v[150:151], v[64:65], v[96:97] neg_lo:[0,1] neg_hi:[0,1]
    v_pk_add_f32 v[154:155], v[66:67], v[98:99]
    v_pk_add_f32 v[158:159], v[66:67], v[98:99] neg_lo:[0,1] neg_hi:[0,1]
    v_pk_mul_f32 v[48:49], v[146:147], v[32:33]
    v_pk_mul_f32 v[64:65], v[146:147], v[16:17]
    v_pk_mul_f32 v[80:81], v[150:151], v[32:33]
    v_pk_mul_f32 v[96:97], v[150:151], v[16:17]
    v_pk_mul_f32 v[50:51], v[154:155], v[34:35]
    v_pk_mul_f32 v[66:67], v[154:155], v[18:19]
    v_pk_mul_f32 v[82:83], v[158:159], v[34:35]
    v_pk_mul_f32 v[98:99], v[158:159], v[18:19]
    v_pk_fma_f32 v[48:49], v[144:145], v[16:17], v[48:49]
    v_pk_fma_f32 v[64:65], v[144:145], v[32:33], v[64:65] neg_lo:[0,1,0] neg_hi:[0,1,0]
    v_pk_fma_f32 v[80:81], v[148:149], v[16:17], v[80:81]
    v_pk_fma_f32 v[96:97], v[148:149], v[32:33], v[96:97] neg_lo:[0,1,0] neg_hi:[0,1,0]
    v_pk_fma_f32 v[50:51], v[152:153], v[18:19], v[50:51]
    v_pk_fma_f32 v[66:67], v[152:153], v[34:35], v[66:67] neg_lo:[0,1,0] neg_hi:[0,1,0]
    v_pk_fma_f32 v[82:83], v[156:157], v[18:19], v[82:83]
    v_pk_fma_f32 v[98:99], v[156:157], v[34:35], v[98:99] neg_lo:[0,1,0] neg_hi:[0,1,0]
    v_pk_add_f32 v[144:145], v[52:53], v[84:85]
    v_pk_add_f32 v[146:147], v[68:69], v[100:101]
    v_pk_add_f32 v[148:149], v[52:53], v[84:85] neg_lo:[0,1] neg_hi:[0,1]
    v_pk_add_f32 v[150:151], v[68:69], v[100:101] neg_lo:[0,1] neg_hi:[0,1]
    v_pk_add_f32 v[152:153], v[54:55], v[86:87]
    v_pk_add_f32 v[154:155], v[70:71], v[102:103]
    v_pk_add_f32 v[156:157], v[54:55], v[86:87] neg_lo:[0,1] neg_hi:[0,1]
    v_pk_add_f32 v[158:159], v[70:71], v[102:103] neg_lo:[0,1] neg_hi:[0,1]
    v_pk_mul_f32 v[52:53], v[146:147], v[36:37]
    v_pk_mul_f32 v[84:85], v[150:151], v[36:37]
    v_pk_mul_f32 v[54:55], v[154:155], v[38:39]
    v_pk_mul_f32 v[86:87], v[158:159], v[38:39]
    v_pk_mul_f32 v[68:69], v[146:147], v[20:21]
    v_pk_mul_f32 v[100:101], v[150:151], v[20:21]
    v_pk_fma_f32 v[52:53], v[144:145], v[20:21], v[52:53]
    v_pk_fma_f32 v[84:85], v[148:149], v[20:21], v[84:85]
    v_pk_mul_f32 v[70:71], v[154:155], v[22:23]
    v_pk_fma_f32 v[54:55], v[152:153], v[22:23], v[54:55]
    v_pk_mul_f32 v[102:103], v[158:159], v[22:23]
    v_pk_fma_f32 v[86:87], v[156:157], v[22:23], v[86:87]
    v_pk_fma_f32 v[68:69], v[144:145], v[36:37], v[68:69] neg_lo:[0,1,0] neg_hi:[0,1,0]
    v_pk_fma_f32 v[100:101], v[148:149], v[36:37], v[100:101] neg_lo:[0,1,0] neg_hi:[0,1,0]
    v_pk_fma_f32 v[70:71], v[152:153], v[38:39], v[70:71] neg_lo:[0,1,0] neg_hi:[0,1,0]
    v_pk_fma_f32 v[102:103], v[156:157], v[38:39], v[102:103] neg_lo:[0,1,0] neg_hi:[0,1,0]
    v_pk_add_f32 v[144:145], v[56:57], v[88:89]
    v_pk_add_f32 v[146:147], v[72:73], v[104:105]
    v_pk_add_f32 v[148:149], v[56:57], v[88:89] neg_lo:[0,1] neg_hi:[0,1]
    v_pk_add_f32 v[150:151], v[72:73], v[104:105] neg_lo:[0,1] neg_hi:[0,1]
    v_pk_add_f32 v[152:153], v[58:59], v[90:91]
    v_pk_add_f32 v[154:155], v[74:75], v[106:107]
    v_pk_add_f32 v[156:157], v[58:59], v[90:91] neg_lo:[0,1] neg_hi:[0,1]
    v_pk_add_f32 v[158:159], v[74:75], v[106:107] neg_lo:[0,1] neg_hi:[0,1]
    v_pk_mul_f32 v[56:57], v[146:147], v[40:41]
    v_pk_mul_f32 v[72:73], v[146:147], v[24:25]
    v_pk_mul_f32 v[88:89], v[150:151], v[40:41]
    v_pk_mul_f32 v[104:105], v[150:151], v[24:25]
    v_pk_mul_f32 v[58:59], v[154:155], v[42:43]
    v_pk_mul_f32 v[74:75], v[154:155], v[26:27]
    v_pk_mul_f32 v[90:91], v[158:159], v[42:43]
    v_pk_mul_f32 v[106:107], v[158:159], v[26:27]
    v_pk_fma_f32 v[56:57], v[144:145], v[24:25], v[56:57]
    v_pk_fma_f32 v[72:73], v[144:145], v[40:41], v[72:73] neg_lo:[0,1,0] neg_hi:[0,1,0]
    v_pk_fma_f32 v[88:89], v[148:149], v[24:25], v[88:89]
    v_pk_fma_f32 v[104:105], v[148:149], v[40:41], v[104:105] neg_lo:[0,1,0] neg_hi:[0,1,0]
    v_pk_fma_f32 v[58:59], v[152:153], v[26:27], v[58:59]
    v_pk_fma_f32 v[74:75], v[152:153], v[42:43], v[74:75] neg_lo:[0,1,0] neg_hi:[0,1,0]
    v_pk_fma_f32 v[90:91], v[156:157], v[26:27], v[90:91]
    v_pk_fma_f32 v[106:107], v[156:157], v[42:43], v[106:107] neg_lo:[0,1,0] neg_hi:[0,1,0]
    v_pk_add_f32 v[144:145], v[60:61], v[92:93]
    v_pk_add_f32 v[146:147], v[76:77], v[108:109]
    v_pk_add_f32 v[148:149], v[60:61], v[92:93] neg_lo:[0,1] neg_hi:[0,1]
    v_pk_add_f32 v[150:151], v[76:77], v[108:109] neg_lo:[0,1] neg_hi:[0,1]
    v_pk_mul_f32 v[60:61], v[146:147], v[44:45]
    v_pk_mul_f32 v[92:93], v[150:151], v[44:45]
    v_pk_fma_f32 v[60:61], v[144:145], v[28:29], v[60:61]
    v_pk_fma_f32 v[92:93], v[148:149], v[28:29], v[92:93]
    v_pk_mul_f32 v[76:77], v[146:147], v[28:29]
    v_pk_mul_f32 v[108:109], v[150:151], v[28:29]
    v_pk_fma_f32 v[76:77], v[144:145], v[44:45], v[76:77] neg_lo:[0,1,0] neg_hi:[0,1,0]
    v_pk_fma_f32 v[108:109], v[148:149], v[44:45], v[108:109] neg_lo:[0,1,0] neg_hi:[0,1,0]
    v_cvt_pk_bf16_f32 v112, v48, v49
    v_cvt_pk_bf16_f32 v128, v80, v81
    v_cvt_pk_bf16_f32 v113, v50, v51
    v_cvt_pk_bf16_f32 v129, v82, v83
    v_cvt_pk_bf16_f32 v114, v52, v53
    v_cvt_pk_bf16_f32 v130, v84, v85
    v_cvt_pk_bf16_f32 v115, v54, v55
    v_cvt_pk_bf16_f32 v131, v86, v87
    v_add_f32 v152, v62, v94
    v_mfma_f32_32x32x16_bf16 v[192:207], v[112:115], a[0:3], 0
    v_add_f32 v153, v63, v95
    v_add_f32 v154, v78, v110
    v_add_f32 v155, v79, v111
    v_sub_f32 v156, v62, v94
    v_sub_f32 v157, v63, v95
    v_sub_f32 v158, v78, v110
    v_mfma_f32_32x32x16_bf16 v[208:223], v[112:115], a[16:19], 0
    v_sub_f32 v159, v79, v111
    v_mul_f32 v62, v154, v46
    v_mul_f32 v63, v155, v47
    v_mul_f32 v94, v158, v46
    v_mul_f32 v95, v159, v47
    v_fmac_f32 v62, v152, v30
    v_mfma_f32_32x32x16_bf16 v[224:239], v[128:131], a[48:51], 0
    v_fmac_f32 v63, v153, v31
    v_fmac_f32 v94, v156, v30
    v_fmac_f32 v95, v157, v31
    v_cvt_pk_bf16_f32 v116, v56, v57
    v_cvt_pk_bf16_f32 v132, v88, v89
    v_mfma_f32_32x32x16_bf16 v[240:255], v[128:131], a[64:67], 0
    v_cvt_pk_bf16_f32 v117, v58, v59
    v_cvt_pk_bf16_f32 v133, v90, v91
    v_cvt_pk_bf16_f32 v118, v60, v61
    v_cvt_pk_bf16_f32 v134, v92, v93
    v_cvt_pk_bf16_f32 v119, v62, v63
    s_waitcnt lgkmcnt(2)
    v_mfma_f32_32x32x16_bf16 v[48:63], a[104:107], a[0:3], 0
    v_cvt_pk_bf16_f32 v135, v94, v95
    v_cvt_pk_bf16_f32 v120, v64, v65
    v_cvt_pk_bf16_f32 v136, v96, v97
    v_cvt_pk_bf16_f32 v121, v66, v67
    v_cvt_pk_bf16_f32 v137, v98, v99
    v_mfma_f32_32x32x16_bf16 v[192:207], v[116:119], a[4:7], v[192:207]
    v_cvt_pk_bf16_f32 v122, v68, v69
    v_cvt_pk_bf16_f32 v138, v100, v101
    v_cvt_pk_bf16_f32 v123, v70, v71
    v_cvt_pk_bf16_f32 v139, v102, v103
    v_mul_f32 v78, v154, v30
    v_mfma_f32_32x32x16_bf16 v[208:223], v[116:119], a[20:23], v[208:223]
    v_mul_f32 v79, v155, v31
    v_mul_f32 v110, v158, v30
    v_mul_f32 v111, v159, v31
    v_fma_f32 v78, v152, -v46, v78
    v_fma_f32 v79, v153, -v47, v79
    v_mfma_f32_32x32x16_bf16 v[224:239], v[132:135], a[52:55], v[224:239]
    v_fma_f32 v110, v156, -v46, v110
    v_fma_f32 v111, v157, -v47, v111
    v_cvt_pk_bf16_f32 v124, v72, v73
    v_cvt_pk_bf16_f32 v140, v104, v105
    v_cvt_pk_bf16_f32 v125, v74, v75
    v_mfma_f32_32x32x16_bf16 v[240:255], v[132:135], a[68:71], v[240:255]
    v_cvt_pk_bf16_f32 v141, v106, v107
    v_cvt_pk_bf16_f32 v126, v76, v77
    v_cvt_pk_bf16_f32 v142, v108, v109
    v_cvt_pk_bf16_f32 v127, v78, v79
    v_cvt_pk_bf16_f32 v143, v110, v111
    v_mfma_f32_32x32x16_bf16 v[192:207], v[120:123], a[8:11], v[192:207]
    v_mfma_f32_32x32x16_bf16 v[208:223], v[120:123], a[0:3], v[208:223]
    v_mfma_f32_32x32x16_bf16 v[224:239], v[136:139], a[56:59], v[224:239]
    v_mfma_f32_32x32x16_bf16 v[240:255], v[136:139], a[48:51], v[240:255]
    v_mfma_f32_32x32x16_bf16 v[192:207], v[124:127], a[12:15], v[192:207]
    v_mfma_f32_32x32x16_bf16 v[208:223], v[124:127], a[4:7], v[208:223]
    v_mfma_f32_32x32x16_bf16 v[224:239], v[140:143], a[60:63], v[224:239]
    v_mfma_f32_32x32x16_bf16 v[240:255], v[140:143], a[52:55], v[240:255]
    v_mfma_f32_32x32x16_bf16 v[48:63], a[108:111], a[4:7], v[48:63]
    v_mfma_f32_32x32x16_bf16 v[48:63], a[112:115], a[16:19], v[48:63]
    v_mfma_f32_32x32x16_bf16 v[48:63], a[116:119], a[20:23], v[48:63]
    v_mfma_f32_32x32x16_bf16 v[64:79], a[104:107], a[8:11], 0
    s_nop 4
    v_cvt_pk_bf16_f32 v112, v192, v193
    v_mfma_f32_32x32x16_bf16 v[64:79], a[108:111], a[12:15], v[64:79]
    v_cvt_pk_bf16_f32 v113, v194, v195
    ds_write_b64 v5, v[112:113] offset:0
    v_cvt_pk_bf16_f32 v114, v196, v197
    v_cvt_pk_bf16_f32 v115, v198, v199
    ds_write_b64 v5, v[114:115] offset:128
    v_mfma_f32_32x32x16_bf16 v[64:79], a[112:115], a[0:3], v[64:79]
    v_cvt_pk_bf16_f32 v116, v200, v201
    v_cvt_pk_bf16_f32 v117, v202, v203
    ds_write_b64 v5, v[116:117] offset:256
    v_cvt_pk_bf16_f32 v118, v204, v205
    v_cvt_pk_bf16_f32 v119, v206, v207
    v_mfma_f32_32x32x16_bf16 v[64:79], a[116:119], a[4:7], v[64:79]
    ds_write_b64 v5, v[118:119] offset:384
    v_cvt_pk_bf16_f32 v120, v208, v209
    v_cvt_pk_bf16_f32 v121, v210, v211
    ds_write_b64 v5, v[120:121] offset:16
    v_cvt_pk_bf16_f32 v122, v212, v213
    s_waitcnt lgkmcnt(5)
    v_mfma_f32_32x32x16_bf16 v[80:95], a[120:123], a[24:27], 0
    v_cvt_pk_bf16_f32 v123, v214, v215
    ds_write_b64 v5, v[122:123] offset:144
    v_cvt_pk_bf16_f32 v124, v216, v217
    v_cvt_pk_bf16_f32 v125, v218, v219
    ds_write_b64 v5, v[124:125] offset:272
    v_mfma_f32_32x32x16_bf16 v[80:95], a[124:127], a[28:31], v[80:95]
    v_cvt_pk_bf16_f32 v126, v220, v221
    v_cvt_pk_bf16_f32 v127, v222, v223
    ds_write_b64 v5, v[126:127] offset:400
    v_cvt_pk_bf16_f32 v128, v224, v225
    v_cvt_pk_bf16_f32 v129, v226, v227
    v_mfma_f32_32x32x16_bf16 v[80:95], a[128:131], a[40:43], v[80:95]
    ds_write_b64 v5, v[128:129] offset:512
    v_cvt_pk_bf16_f32 v130, v228, v229
    v_cvt_pk_bf16_f32 v131, v230, v231
    ds_write_b64 v5, v[130:131] offset:640
    v_cvt_pk_bf16_f32 v132, v232, v233
    v_mfma_f32_32x32x16_bf16 v[80:95], a[132:135], a[44:47], v[80:95]
    v_cvt_pk_bf16_f32 v133, v234, v235
    ds_write_b64 v5, v[132:133] offset:768
    v_cvt_pk_bf16_f32 v134, v236, v237
    v_cvt_pk_bf16_f32 v135, v238, v239
    ds_write_b64 v5, v[134:135] offset:896
    v_mfma_f32_32x32x16_bf16 v[96:111], a[120:123], a[32:35], 0
    v_cvt_pk_bf16_f32 v136, v240, v241
    v_cvt_pk_bf16_f32 v137, v242, v243
    ds_write_b64 v5, v[136:137] offset:528
    v_cvt_pk_bf16_f32 v138, v244, v245
    v_cvt_pk_bf16_f32 v139, v246, v247
    v_mfma_f32_32x32x16_bf16 v[96:111], a[124:127], a[36:39], v[96:111]
    ds_write_b64 v5, v[138:139] offset:656
    v_cvt_pk_bf16_f32 v140, v248, v249
    v_cvt_pk_bf16_f32 v141, v250, v251
    ds_write_b64 v5, v[140:141] offset:784
    v_cvt_pk_bf16_f32 v142, v252, v253
    v_mfma_f32_32x32x16_bf16 v[96:111], a[128:131], a[24:27], v[96:111]
    v_cvt_pk_bf16_f32 v143, v254, v255
    ds_write_b64 v5, v[142:143] offset:912
    v_add_u32 v5, 32, v5
    v_mfma_f32_32x32x16_bf16 v[96:111], a[132:135], a[28:31], v[96:111]
    s_nop 11
    s_cbranch_scc1 Lback_23
    s_branch Lskip_24
Lsp_22:
    v_add_u32 v3, 32, v3
    v_add_u32 v4, 32, v4
    ds_read_b64_tr_b16 a[104:105], v3 offset:0
    v_pk_add_f32 v[144:145], v[48:49], v[80:81]
    v_pk_add_f32 v[146:147], v[64:65], v[96:97]
    v_pk_add_f32 v[148:149], v[48:49], v[80:81] neg_lo:[0,1] neg_hi:[0,1]
    v_pk_add_f32 v[150:151], v[64:65], v[96:97] neg_lo:[0,1] neg_hi:[0,1]
    v_pk_add_f32 v[152:153], v[50:51], v[82:83]
    v_pk_add_f32 v[154:155], v[66:67], v[98:99]
    v_pk_add_f32 v[156:157], v[50:51], v[82:83] neg_lo:[0,1] neg_hi:[0,1]
    v_pk_add_f32 v[158:159], v[66:67], v[98:99] neg_lo:[0,1] neg_hi:[0,1]
    v_pk_mul_f32 v[48:49], v[146:147], v[32:33]
    v_pk_mul_f32 v[64:65], v[146:147], v[16:17]
    v_pk_mul_f32 v[80:81], v[150:151], v[32:33]
    v_pk_mul_f32 v[96:97], v[150:151], v[16:17]
    v_pk_mul_f32 v[50:51], v[154:155], v[34:35]
    v_pk_mul_f32 v[66:67], v[154:155], v[18:19]
    v_pk_mul_f32 v[82:83], v[158:159], v[34:35]
    v_pk_mul_f32 v[98:99], v[158:159], v[18:19]
    v_pk_fma_f32 v[48:49], v[144:145], v[16:17], v[48:49] neg_lo:[0,0,1] neg_hi:[0,0,1]
    v_pk_fma_f32 v[64:65], v[144:145], v[32:33], v[64:65]
    v_pk_fma_f32 v[80:81], v[148:149], v[16:17], v[80:81] neg_lo:[0,0,1] neg_hi:[0,0,1]
    v_pk_fma_f32 v[96:97], v[148:149], v[32:33], v[96:97]
    v_pk_fma_f32 v[50:51], v[152:153], v[18:19], v[50:51] neg_lo:[0,0,1] neg_hi:[0,0,1]
    v_pk_fma_f32 v[66:67], v[152:153], v[34:35], v[66:67]
    v_pk_fma_f32 v[82:83], v[156:157], v[18:19], v[82:83] neg_lo:[0,0,1] neg_hi:[0,0,1]
    v_pk_fma_f32 v[98:99], v[156:157], v[34:35], v[98:99]
    v_pk_add_f32 v[144:145], v[52:53], v[84:85]
    v_pk_add_f32 v[146:147], v[68:69], v[100:101]
    v_pk_add_f32 v[148:149], v[52:53], v[84:85] neg_lo:[0,1] neg_hi:[0,1]
    v_pk_add_f32 v[150:151], v[68:69], v[100:101] neg_lo:[0,1] neg_hi:[0,1]
    v_pk_add_f32 v[152:153], v[54:55], v[86:87]
    v_pk_add_f32 v[154:155], v[70:71], v[102:103]
    v_pk_add_f32 v[156:157], v[54:55], v[86:87] neg_lo:[0,1] neg_hi:[0,1]
    v_pk_add_f32 v[158:159], v[70:71], v[102:103] neg_lo:[0,1] neg_hi:[0,1]
    v_pk_mul_f32 v[52:53], v[146:147], v[36:37]
    v_pk_mul_f32 v[84:85], v[150:151], v[36:37]
    v_pk_mul_f32 v[54:55], v[154:155], v[38:39]
    v_pk_mul_f32 v[86:87], v[158:159], v[38:39]
    v_pk_mul_f32 v[68:69], v[146:147], v[20:21]
    v_pk_mul_f32 v[100:101], v[150:151], v[20:21]
    v_pk_mul_f32 v[70:71], v[154:155], v[22:23]
    v_pk_mul_f32 v[102:103], v[158:159], v[22:23]
    v_pk_fma_f32 v[52:53], v[144:145], v[20:21], v[52:53] neg_lo:[0,0,1] neg_hi:[0,0,1]
    v_pk_fma_f32 v[84:85], v[148:149], v[20:21], v[84:85] neg_lo:[0,0,1] neg_hi:[0,0,1]
    v_pk_fma_f32 v[54:55], v[152:153], v[22:23], v[54:55] neg_lo:[0,0,1] neg_hi:[0,0,1]
    v_pk_fma_f32 v[86:87], v[156:157], v[22:23], v[86:87] neg_lo:[0,0,1] neg_hi:[0,0,1]
    v_pk_fma_f32 v[68:69], v[144:145], v[36:37], v[68:69]
    v_pk_fma_f32 v[100:101], v[148:149], v[36:37], v[100:101]
    v_pk_fma_f32 v[70:71], v[152:153], v[38:39], v[70:71]
    v_pk_fma_f32 v[102:103], v[156:157], v[38:39], v[102:103]
    v_pk_add_f32 v[144:145], v[56:57], v[88:89]
    v_pk_add_f32 v[146:147], v[72:73], v[104:105]
    v_pk_add_f32 v[148:149], v[56:57], v[88:89] neg_lo:[0,1] neg_hi:[0,1]
    v_pk_add_f32 v[150:151], v[72:73], v[104:105] neg_lo:[0,1] neg_hi:[0,1]
    v_pk_add_f32 v[152:153], v[58:59], v[90:91]
    v_pk_add_f32 v[154:155], v[74:75], v[106:107]
    v_pk_add_f32 v[156:157], v[58:59], v[90:91] neg_lo:[0,1] neg_hi:[0,1]
    v_pk_add_f32 v[158:159], v[74:75], v[106:107] neg_lo:[0,1] neg_hi:[0,1]
    v_pk_mul_f32 v[56:57], v[146:147], v[40:41]
    v_pk_mul_f32 v[72:73], v[146:147], v[24:25]
    v_pk_mul_f32 v[88:89], v[150:151], v[40:41]
    v_pk_mul_f32 v[104:105], v[150:151], v[24:25]
    v_pk_mul_f32 v[58:59], v[154:155], v[42:43]
    v_pk_mul_f32 v[74:75], v[154:155], v[26:27]
    v_pk_mul_f32 v[90:91], v[158:159], v[42:43]
    v_pk_mul_f32 v[106:107], v[158:159], v[26:27]
    v_pk_fma_f32 v[56:57], v[144:145], v[24:25], v[56:57] neg_lo:[0,0,1] neg_hi:[0,0,1]
    v_pk_fma_f32 v[72:73], v[144:145], v[40:41], v[72:73]
    v_pk_fma_f32 v[88:89], v[148:149], v[24:25], v[88:89] neg_lo:[0,0,1] neg_hi:[0,0,1]
    v_pk_fma_f32 v[104:105], v[148:149], v[40:41], v[104:105]
    v_pk_fma_f32 v[58:59], v[152:153], v[26:27], v[58:59] neg_lo:[0,0,1] neg_hi:[0,0,1]
    v_pk_fma_f32 v[74:75], v[152:153], v[42:43], v[74:75]
    v_pk_fma_f32 v[90:91], v[156:157], v[26:27], v[90:91] neg_lo:[0,0,1] neg_hi:[0,0,1]
    v_pk_fma_f32 v[106:107], v[156:157], v[42:43], v[106:107]
    v_pk_add_f32 v[144:145], v[60:61], v[92:93]
    v_pk_add_f32 v[146:147], v[76:77], v[108:109]
    v_pk_add_f32 v[148:149], v[60:61], v[92:93] neg_lo:[0,1] neg_hi:[0,1]
    v_pk_add_f32 v[150:151], v[76:77], v[108:109] neg_lo:[0,1] neg_hi:[0,1]
    v_pk_add_f32 v[152:153], v[62:63], v[94:95]
    v_pk_add_f32 v[154:155], v[78:79], v[110:111]
    v_pk_add_f32 v[156:157], v[62:63], v[94:95] neg_lo:[0,1] neg_hi:[0,1]
    v_pk_add_f32 v[158:159], v[78:79], v[110:111] neg_lo:[0,1] neg_hi:[0,1]
    v_pk_mul_f32 v[60:61], v[146:147], v[44:45]
    v_pk_mul_f32 v[92:93], v[150:151], v[44:45]
    v_pk_mul_f32 v[62:63], v[154:155], v[46:47]
    v_pk_mul_f32 v[94:95], v[158:159], v[46:47]
    v_pk_fma_f32 v[60:61], v[144:145], v[28:29], v[60:61] neg_lo:[0,0,1] neg_hi:[0,0,1]
    v_pk_fma_f32 v[92:93], v[148:149], v[28:29], v[92:93] neg_lo:[0,0,1] neg_hi:[0,0,1]
    v_pk_fma_f32 v[62:63], v[152:153], v[30:31], v[62:63] neg_lo:[0,0,1] neg_hi:[0,0,1]
    v_pk_fma_f32 v[94:95], v[156:157], v[30:31], v[94:95] neg_lo:[0,0,1] neg_hi:[0,0,1]
    v_pk_mul_f32 v[76:77], v[146:147], v[28:29]
    v_pk_mul_f32 v[108:109], v[150:151], v[28:29]
    v_pk_mul_f32 v[78:79], v[154:155], v[30:31]
    v_pk_mul_f32 v[110:111], v[158:159], v[30:31]
    v_pk_fma_f32 v[76:77], v[144:145], v[44:45], v[76:77]
    v_pk_fma_f32 v[108:109], v[148:149], v[44:45], v[108:109]
    v_pk_fma_f32 v[78:79], v[152:153], v[46:47], v[78:79]
    v_pk_fma_f32 v[110:111], v[156:157], v[46:47], v[110:111]
    v_cvt_pk_bf16_f32 v112, v48, v49
    v_cvt_pk_bf16_f32 v128, v80, v81
    v_cvt_pk_bf16_f32 v113, v50, v51
    v_cvt_pk_bf16_f32 v129, v82, v83
    v_cvt_pk_bf16_f32 v114, v52, v53
    v_cvt_pk_bf16_f32 v130, v84, v85
    v_cvt_pk_bf16_f32 v115, v54, v55
    v_cvt_pk_bf16_f32 v131, v86, v87
    v_cvt_pk_bf16_f32 v116, v56, v57
    v_mfma_f32_32x32x16_bf16 v[192:207], a[0:3], v[112:115], 0
    v_cvt_pk_bf16_f32 v132, v88, v89
    v_cvt_pk_bf16_f32 v117, v58, v59
    v_cvt_pk_bf16_f32 v133, v90, v91
    v_cvt_pk_bf16_f32 v118, v60, v61
    v_cvt_pk_bf16_f32 v134, v92, v93
    v_mfma_f32_32x32x16_bf16 v[208:223], a[8:11], v[112:115], 0
    v_cvt_pk_bf16_f32 v119, v62, v63
    v_cvt_pk_bf16_f32 v135, v94, v95
    v_cvt_pk_bf16_f32 v120, v64, v65
    v_cvt_pk_bf16_f32 v136, v96, v97
    v_cvt_pk_bf16_f32 v121, v66, v67
    v_mfma_f32_32x32x16_bf16 v[224:239], a[48:51], v[128:131], 0
    v_cvt_pk_bf16_f32 v137, v98, v99
    v_cvt_pk_bf16_f32 v122, v68, v69
    v_cvt_pk_bf16_f32 v138, v100, v101
    v_cvt_pk_bf16_f32 v123, v70, v71
    v_cvt_pk_bf16_f32 v139, v102, v103
    v_mfma_f32_32x32x16_bf16 v[240:255], a[56:59], v[128:131], 0
    v_cvt_pk_bf16_f32 v124, v72, v73
    v_cvt_pk_bf16_f32 v140, v104, v105
    v_cvt_pk_bf16_f32 v125, v74, v75
    v_cvt_pk_bf16_f32 v141, v106, v107
    v_cvt_pk_bf16_f32 v126, v76, v77
    v_mfma_f32_32x32x16_bf16 v[192:207], a[4:7], v[116:119], v[192:207]
    v_cvt_pk_bf16_f32 v142, v108, v109
    v_cvt_pk_bf16_f32 v127, v78, v79
    v_cvt_pk_bf16_f32 v143, v110, v111
    ds_read_b64_tr_b16 a[106:107], v3 offset:32896
    ds_read_b64_tr_b16 a[108:109], v4 offset:0
    v_mfma_f32_32x32x16_bf16 v[208:223], a[12:15], v[116:119], v[208:223]
    ds_read_b64_tr_b16 a[110:111], v4 offset:32896
    ds_read_b64_tr_b16 a[112:113], v3 offset:16
    ds_read_b64_tr_b16 a[114:115], v3 offset:32912
    ds_read_b64_tr_b16 a[116:117], v4 offset:16
    ds_read_b64_tr_b16 a[118:119], v4 offset:32912
    v_mfma_f32_32x32x16_bf16 v[224:239], a[52:55], v[132:135], v[224:239]
    ds_read_b64_tr_b16 a[120:121], v3 offset:512
    ds_read_b64_tr_b16 a[122:123], v3 offset:33408
    ds_read_b64_tr_b16 a[124:125], v4 offset:512
    ds_read_b64_tr_b16 a[126:127], v4 offset:33408
    ds_read_b64_tr_b16 a[128:129], v3 offset:528
    v_mfma_f32_32x32x16_bf16 v[240:255], a[60:63], v[132:135], v[240:255]
    ds_read_b64_tr_b16 a[130:131], v3 offset:33424
    ds_read_b64_tr_b16 a[132:133], v4 offset:528
    ds_read_b64_tr_b16 a[134:135], v4 offset:33424
    v_mfma_f32_32x32x16_bf16 v[192:207], a[16:19], v[120:123], v[192:207]
    v_mfma_f32_32x32x16_bf16 v[208:223], a[0:3], v[120:123], v[208:223]
    v_mfma_f32_32x32x16_bf16 v[224:239], a[64:67], v[136:139], v[224:239]
    v_mfma_f32_32x32x16_bf16 v[240:255], a[48:51], v[136:139], v[240:255]
    v_mfma_f32_32x32x16_bf16 v[192:207], a[20:23], v[124:127], v[192:207]
    v_mfma_f32_32x32x16_bf16 v[208:223], a[4:7], v[124:127], v[208:223]
    v_mfma_f32_32x32x16_bf16 v[224:239], a[68:71], v[140:143], v[224:239]
    v_mfma_f32_32x32x16_bf16 v[240:255], a[52:55], v[140:143], v[240:255]
    s_nop 11
    s_waitcnt vmcnt(0)
    v_and_b32 v144, 31, v1
    v_lshrrev_b32 v145, 5, v1
    v_lshlrev_b32 v145, 8, v145
    v_add_u32 v144, v144, v145
    v_lshlrev_b32 v144, 2, v144
    v_add_u32 v12, 132352, v144
    v_sub_u32 v13, 133504, v144
    ds_write_b32 v12, v192 offset:0
    ds_write_b32 v12, v208 offset:8448
    ds_write_b32 v12, v193 offset:256
    ds_write_b32 v12, v209 offset:8704
    ds_write_b32 v12, v194 offset:512
    ds_write_b32 v12, v210 offset:8960
    ds_write_b32 v12, v195 offset:768
    ds_write_b32 v12, v211 offset:9216
    ds_write_b32 v12, v196 offset:2048
    ds_write_b32 v12, v212 offset:10496
    ds_write_b32 v12, v197 offset:2304
    ds_write_b32 v12, v213 offset:10752
    ds_write_b32 v12, v198 offset:2560
    ds_write_b32 v12, v214 offset:11008
    ds_write_b32 v12, v199 offset:2816
    ds_write_b32 v12, v215 offset:11264
    ds_write_b32 v12, v200 offset:4096
    ds_write_b32 v12, v216 offset:12544
    ds_write_b32 v12, v201 offset:4352
    ds_write_b32 v12, v217 offset:12800
    ds_write_b32 v12, v202 offset:4608
    ds_write_b32 v12, v218 offset:13056
    ds_write_b32 v12, v203 offset:4864
    ds_write_b32 v12, v219 offset:13312
    ds_write_b32 v12, v204 offset:6144
    ds_write_b32 v12, v220 offset:14592
    ds_write_b32 v12, v205 offset:6400
    ds_write_b32 v12, v221 offset:14848
    ds_write_b32 v12, v206 offset:6656
    ds_write_b32 v12, v222 offset:15104
    ds_write_b32 v12, v207 offset:6912
    ds_write_b32 v12, v223 offset:15360
    ds_write_b32 v12, v224 offset:128
    ds_write_b32 v12, v240 offset:8576
    ds_write_b32 v12, v225 offset:384
    ds_write_b32 v12, v241 offset:8832
    ds_write_b32 v12, v226 offset:640
    ds_write_b32 v12, v242 offset:9088
    ds_write_b32 v12, v227 offset:896
    ds_write_b32 v12, v243 offset:9344
    ds_write_b32 v12, v228 offset:2176
    ds_write_b32 v12, v244 offset:10624
    ds_write_b32 v12, v229 offset:2432
    ds_write_b32 v12, v245 offset:10880
    ds_write_b32 v12, v230 offset:2688
    ds_write_b32 v12, v246 offset:11136
    ds_write_b32 v12, v231 offset:2944
    ds_write_b32 v12, v247 offset:11392
    ds_write_b32 v12, v232 offset:4224
    ds_write_b32 v12, v248 offset:12672
    ds_write_b32 v12, v233 offset:4480
    ds_write_b32 v12, v249 offset:12928
    ds_write_b32 v12, v234 offset:4736
    ds_write_b32 v12, v250 offset:13184
    ds_write_b32 v12, v235 offset:4992
    ds_write_b32 v12, v251 offset:13440
    ds_write_b32 v12, v236 offset:6272
    ds_write_b32 v12, v252 offset:14720
    ds_write_b32 v12, v237 offset:6528
    ds_write_b32 v12, v253 offset:14976
    ds_write_b32 v12, v238 offset:6784
    ds_write_b32 v12, v254 offset:15232
    ds_write_b32 v12, v239 offset:7040
    ds_write_b32 v12, v255 offset:15488
    s_mov_b64 exec, 1
    ds_write_b32 v12, v192 offset:8192
    ds_write_b32 v12, v208 offset:16640
    s_mov_b64 exec, -1
    ds_read_b32 v48, v13 offset:7040
    ds_read_b32 v49, v13 offset:6784
    ds_read_b32 v50, v13 offset:6528
    ds_read_b32 v51, v13 offset:6272
    ds_read_b32 v64, v13 offset:15488
    ds_read_b32 v65, v13 offset:15232
    ds_read_b32 v66, v13 offset:14976
    ds_read_b32 v67, v13 offset:14720
    ds_read_b32 v52, v13 offset:4992
    ds_read_b32 v53, v13 offset:4736
    ds_read_b32 v54, v13 offset:4480
    ds_read_b32 v55, v13 offset:4224
    ds_read_b32 v68, v13 offset:13440
    ds_read_b32 v69, v13 offset:13184
    ds_read_b32 v70, v13 offset:12928
    ds_read_b32 v71, v13 offset:12672
    ds_read_b32 v56, v13 offset:2944
    ds_read_b32 v57, v13 offset:2688
    ds_read_b32 v58, v13 offset:2432
    ds_read_b32 v59, v13 offset:2176
    ds_read_b32 v72, v13 offset:11392
    ds_read_b32 v73, v13 offset:11136
    ds_read_b32 v74, v13 offset:10880
    ds_read_b32 v75, v13 offset:10624
    ds_read_b32 v60, v13 offset:896
    ds_read_b32 v61, v13 offset:640
    ds_read_b32 v62, v13 offset:384
    ds_read_b32 v63, v13 offset:128
    ds_read_b32 v76, v13 offset:9344
    ds_read_b32 v77, v13 offset:9088
    ds_read_b32 v78, v13 offset:8832
    ds_read_b32 v79, v13 offset:8576
    v_lshlrev_b32 v144, 16, v160
    v_lshlrev_b32 v145, 16, v161
    v_pk_mul_f32 v[148:149], v[192:193], v[144:145]
    v_and_b32 v146, s69, v160
    v_and_b32 v147, s69, v161
    v_pk_mul_f32 v[150:151], v[192:193], v[146:147]
    v_pk_fma_f32 v[148:149], v[208:209], v[146:147], v[148:149] neg_lo:[1,0,0] neg_hi:[1,0,0]
    v_pk_fma_f32 v[150:151], v[208:209], v[144:145], v[150:151]
    v_lshlrev_b32 v152, 16, v162
    v_lshlrev_b32 v153, 16, v163
    v_pk_mul_f32 v[156:157], v[194:195], v[152:153]
    v_and_b32 v154, s69, v162
    v_and_b32 v155, s69, v163
    v_pk_mul_f32 v[158:159], v[194:195], v[154:155]
    v_pk_fma_f32 v[156:157], v[210:211], v[154:155], v[156:157] neg_lo:[1,0,0] neg_hi:[1,0,0]
    v_pk_fma_f32 v[158:159], v[210:211], v[152:153], v[158:159]
    v_accvgpr_read_b32 v160, a136
    v_accvgpr_read_b32 v161, a137
    v_accvgpr_read_b32 v162, a138
    v_accvgpr_read_b32 v163, a139
    v_lshlrev_b32 v144, 16, v160
    v_lshlrev_b32 v145, 16, v161
    s_waitcnt lgkmcnt(15)
    v_pk_fma_f32 v[148:149], v[48:49], v[144:145], v[148:149]
    v_and_b32 v146, s69, v160
    v_and_b32 v147, s69, v161
    v_pk_fma_f32 v[150:151], v[48:49], v[146:147], v[150:151]
    v_pk_fma_f32 v[148:149], v[64:65], v[146:147], v[148:149]
    v_pk_fma_f32 v[150:151], v[64:65], v[144:145], v[150:151] neg_lo:[1,0,0] neg_hi:[1,0,0]
    v_lshlrev_b32 v152, 16, v162
    v_lshlrev_b32 v153, 16, v163
    v_pk_fma_f32 v[156:157], v[50:51], v[152:153], v[156:157]
    v_and_b32 v154, s69, v162
    v_and_b32 v155, s69, v163
    v_pk_fma_f32 v[158:159], v[50:51], v[154:155], v[158:159]
    v_pk_fma_f32 v[156:157], v[66:67], v[154:155], v[156:157]
    v_pk_fma_f32 v[158:159], v[66:67], v[152:153], v[158:159] neg_lo:[1,0,0] neg_hi:[1,0,0]
    ds_read_b32 v80, v13 offset:6912
    ds_read_b32 v81, v13 offset:6656
    ds_read_b32 v82, v13 offset:6400
    ds_read_b32 v83, v13 offset:6144
    v_cvt_pk_bf16_f32 v112, v148, v149
    v_cvt_pk_bf16_f32 v120, v150, v151
    v_cvt_pk_bf16_f32 v113, v156, v157
    v_cvt_pk_bf16_f32 v121, v158, v159
    v_lshlrev_b32 v144, 16, v164
    v_lshlrev_b32 v145, 16, v165
    ds_read_b32 v96, v13 offset:15360
    ds_read_b32 v97, v13 offset:15104
    ds_read_b32 v98, v13 offset:14848
    ds_read_b32 v99, v13 offset:14592
    v_pk_mul_f32 v[148:149], v[196:197], v[144:145]
    v_and_b32 v146, s69, v164
    v_and_b32 v147, s69, v165
    v_pk_mul_f32 v[150:151], v[196:197], v[146:147]
    v_pk_fma_f32 v[148:149], v[212:213], v[146:147], v[148:149] neg_lo:[1,0,0] neg_hi:[1,0,0]
    v_pk_fma_f32 v[150:151], v[212:213], v[144:145], v[150:151]
    v_lshlrev_b32 v152, 16, v166
    v_lshlrev_b32 v153, 16, v167
    v_pk_mul_f32 v[156:157], v[198:199], v[152:153]
    v_and_b32 v154, s69, v166
    v_and_b32 v155, s69, v167
    v_pk_mul_f32 v[158:159], v[198:199], v[154:155]
    v_pk_fma_f32 v[156:157], v[214:215], v[154:155], v[156:157] neg_lo:[1,0,0] neg_hi:[1,0,0]
    v_pk_fma_f32 v[158:159], v[214:215], v[152:153], v[158:159]
    v_accvgpr_read_b32 v164, a140
    v_accvgpr_read_b32 v165, a141
    v_accvgpr_read_b32 v166, a142
    v_accvgpr_read_b32 v167, a143
    v_lshlrev_b32 v144, 16, v164
    v_lshlrev_b32 v145, 16, v165
    v_pk_fma_f32 v[148:149], v[52:53], v[144:145], v[148:149]
    v_and_b32 v146, s69, v164
    v_and_b32 v147, s69, v165
    v_pk_fma_f32 v[150:151], v[52:53], v[146:147], v[150:151]
    v_pk_fma_f32 v[148:149], v[68:69], v[146:147], v[148:149]
    v_pk_fma_f32 v[150:151], v[68:69], v[144:145], v[150:151] neg_lo:[1,0,0] neg_hi:[1,0,0]
    v_lshlrev_b32 v152, 16, v166
    v_lshlrev_b32 v153, 16, v167
    v_pk_fma_f32 v[156:157], v[54:55], v[152:153], v[156:157]
    v_and_b32 v154, s69, v166
    v_and_b32 v155, s69, v167
    v_pk_fma_f32 v[158:159], v[54:55], v[154:155], v[158:159]
    v_pk_fma_f32 v[156:157], v[70:71], v[154:155], v[156:157]
    v_pk_fma_f32 v[158:159], v[70:71], v[152:153], v[158:159] neg_lo:[1,0,0] neg_hi:[1,0,0]
    ds_read_b32 v84, v13 offset:4864
    ds_read_b32 v85, v13 offset:4608
    ds_read_b32 v86, v13 offset:4352
    ds_read_b32 v87, v13 offset:4096
    v_cvt_pk_bf16_f32 v114, v148, v149
    v_cvt_pk_bf16_f32 v122, v150, v151
    v_cvt_pk_bf16_f32 v115, v156, v157
    v_cvt_pk_bf16_f32 v123, v158, v159
    v_lshlrev_b32 v144, 16, v168
    v_lshlrev_b32 v145, 16, v169
    ds_read_b32 v100, v13 offset:13312
    ds_read_b32 v101, v13 offset:13056
    ds_read_b32 v102, v13 offset:12800
    ds_read_b32 v103, v13 offset:12544
    v_pk_mul_f32 v[148:149], v[200:201], v[144:145]
    v_and_b32 v146, s69, v168
    v_and_b32 v147, s69, v169
    v_pk_mul_f32 v[150:151], v[200:201], v[146:147]
    v_pk_fma_f32 v[148:149], v[216:217], v[146:147], v[148:149] neg_lo:[1,0,0] neg_hi:[1,0,0]
    v_pk_fma_f32 v[150:151], v[216:217], v[144:145], v[150:151]
    v_lshlrev_b32 v152, 16, v170
    v_lshlrev_b32 v153, 16, v171
    v_pk_mul_f32 v[156:157], v[202:203], v[152:153]
    v_and_b32 v154, s69, v170
    v_and_b32 v155, s69, v171
    v_pk_mul_f32 v[158:159], v[202:203], v[154:155]
    v_pk_fma_f32 v[156:157], v[218:219], v[154:155], v[156:157] neg_lo:[1,0,0] neg_hi:[1,0,0]
    v_pk_fma_f32 v[158:159], v[218:219], v[152:153], v[158:159]
    v_accvgpr_read_b32 v168, a144
    v_accvgpr_read_b32 v169, a145
    v_accvgpr_read_b32 v170, a146
    v_accvgpr_read_b32 v171, a147
    v_lshlrev_b32 v144, 16, v168
    v_lshlrev_b32 v145, 16, v169
    s_waitcnt lgkmcnt(15)
    v_pk_fma_f32 v[148:149], v[56:57], v[144:145], v[148:149]
    v_and_b32 v146, s69, v168
    v_and_b32 v147, s69, v169
    v_pk_fma_f32 v[150:151], v[56:57], v[146:147], v[150:151]
    v_pk_fma_f32 v[148:149], v[72:73], v[146:147], v[148:149]
    v_pk_fma_f32 v[150:151], v[72:73], v[144:145], v[150:151] neg_lo:[1,0,0] neg_hi:[1,0,0]
    v_lshlrev_b32 v152, 16, v170
    v_lshlrev_b32 v153, 16, v171
    v_pk_fma_f32 v[156:157], v[58:59], v[152:153], v[156:157]
    v_and_b32 v154, s69, v170
    v_and_b32 v155, s69, v171
    v_pk_fma_f32 v[158:159], v[58:59], v[154:155], v[158:159]
    v_pk_fma_f32 v[156:157], v[74:75], v[154:155], v[156:157]
    v_pk_fma_f32 v[158:159], v[74:75], v[152:153], v[158:159] neg_lo:[1,0,0] neg_hi:[1,0,0]
    ds_read_b32 v88, v13 offset:2816
    ds_read_b32 v89, v13 offset:2560
    ds_read_b32 v90, v13 offset:2304
    ds_read_b32 v91, v13 offset:2048
    v_cvt_pk_bf16_f32 v116, v148, v149
    v_cvt_pk_bf16_f32 v124, v150, v151
    v_cvt_pk_bf16_f32 v117, v156, v157
    v_cvt_pk_bf16_f32 v125, v158, v159
    v_lshlrev_b32 v144, 16, v172
    v_lshlrev_b32 v145, 16, v173
    ds_read_b32 v104, v13 offset:11264
    ds_read_b32 v105, v13 offset:11008
    ds_read_b32 v106, v13 offset:10752
    ds_read_b32 v107, v13 offset:10496
    v_pk_mul_f32 v[148:149], v[204:205], v[144:145]
    v_and_b32 v146, s69, v172
    v_and_b32 v147, s69, v173
    v_pk_mul_f32 v[150:151], v[204:205], v[146:147]
    v_pk_fma_f32 v[148:149], v[220:221], v[146:147], v[148:149] neg_lo:[1,0,0] neg_hi:[1,0,0]
    v_pk_fma_f32 v[150:151], v[220:221], v[144:145], v[150:151]
    v_lshlrev_b32 v152, 16, v174
    v_lshlrev_b32 v153, 16, v175
    v_pk_mul_f32 v[156:157], v[206:207], v[152:153]
    v_and_b32 v154, s69, v174
    v_and_b32 v155, s69, v175
    v_pk_mul_f32 v[158:159], v[206:207], v[154:155]
    v_pk_fma_f32 v[156:157], v[222:223], v[154:155], v[156:157] neg_lo:[1,0,0] neg_hi:[1,0,0]
    v_pk_fma_f32 v[158:159], v[222:223], v[152:153], v[158:159]
    v_accvgpr_read_b32 v172, a148
    v_accvgpr_read_b32 v173, a149
    v_accvgpr_read_b32 v174, a150
    v_accvgpr_read_b32 v175, a151
    v_lshlrev_b32 v144, 16, v172
    v_lshlrev_b32 v145, 16, v173
    v_pk_fma_f32 v[148:149], v[60:61], v[144:145], v[148:149]
    v_and_b32 v146, s69, v172
    v_and_b32 v147, s69, v173
    v_pk_fma_f32 v[150:151], v[60:61], v[146:147], v[150:151]
    v_pk_fma_f32 v[148:149], v[76:77], v[146:147], v[148:149]
    v_pk_fma_f32 v[150:151], v[76:77], v[144:145], v[150:151] neg_lo:[1,0,0] neg_hi:[1,0,0]
    v_lshlrev_b32 v152, 16, v174
    v_lshlrev_b32 v153, 16, v175
    v_pk_fma_f32 v[156:157], v[62:63], v[152:153], v[156:157]
    v_and_b32 v154, s69, v174
    v_and_b32 v155, s69, v175
    v_pk_fma_f32 v[158:159], v[62:63], v[154:155], v[158:159]
    v_pk_fma_f32 v[156:157], v[78:79], v[154:155], v[156:157]
    v_pk_fma_f32 v[158:159], v[78:79], v[152:153], v[158:159] neg_lo:[1,0,0] neg_hi:[1,0,0]
    ds_read_b32 v92, v13 offset:768
    ds_read_b32 v93, v13 offset:512
    ds_read_b32 v94, v13 offset:256
    ds_read_b32 v95, v13 offset:0
    v_cvt_pk_bf16_f32 v118, v148, v149
    v_cvt_pk_bf16_f32 v126, v150, v151
    v_cvt_pk_bf16_f32 v119, v156, v157
    v_cvt_pk_bf16_f32 v127, v158, v159
    ds_read_b32 v108, v13 offset:9216
    ds_read_b32 v109, v13 offset:8960
    ds_read_b32 v110, v13 offset:8704
    ds_read_b32 v111, v13 offset:8448
    v_lshlrev_b32 v144, 16, v176
    v_lshlrev_b32 v145, 16, v177
    v_pk_mul_f32 v[148:149], v[224:225], v[144:145]
    v_and_b32 v146, s69, v176
    v_and_b32 v147, s69, v177
    v_pk_mul_f32 v[150:151], v[224:225], v[146:147]
    v_pk_fma_f32 v[148:149], v[240:241], v[146:147], v[148:149] neg_lo:[1,0,0] neg_hi:[1,0,0]
    v_pk_fma_f32 v[150:151], v[240:241], v[144:145], v[150:151]
    v_lshlrev_b32 v152, 16, v178
    v_lshlrev_b32 v153, 16, v179
    v_pk_mul_f32 v[156:157], v[226:227], v[152:153]
    v_and_b32 v154, s69, v178
    v_and_b32 v155, s69, v179
    v_pk_mul_f32 v[158:159], v[226:227], v[154:155]
    v_pk_fma_f32 v[156:157], v[242:243], v[154:155], v[156:157] neg_lo:[1,0,0] neg_hi:[1,0,0]
    v_pk_fma_f32 v[158:159], v[242:243], v[152:153], v[158:159]
    v_accvgpr_read_b32 v176, a152
    v_accvgpr_read_b32 v177, a153
    v_accvgpr_read_b32 v178, a154
    v_accvgpr_read_b32 v179, a155
    v_lshlrev_b32 v144, 16, v176
    v_lshlrev_b32 v145, 16, v177
    s_waitcnt lgkmcnt(15)
    v_pk_fma_f32 v[148:149], v[80:81], v[144:145], v[148:149]
    v_and_b32 v146, s69, v176
    v_and_b32 v147, s69, v177
    v_pk_fma_f32 v[150:151], v[80:81], v[146:147], v[150:151]
    v_pk_fma_f32 v[148:149], v[96:97], v[146:147], v[148:149]
    v_pk_fma_f32 v[150:151], v[96:97], v[144:145], v[150:151] neg_lo:[1,0,0] neg_hi:[1,0,0]
    v_lshlrev_b32 v152, 16, v178
    v_lshlrev_b32 v153, 16, v179
    v_pk_fma_f32 v[156:157], v[82:83], v[152:153], v[156:157]
    v_and_b32 v154, s69, v178
    v_and_b32 v155, s69, v179
    v_pk_fma_f32 v[158:159], v[82:83], v[154:155], v[158:159]
    v_pk_fma_f32 v[156:157], v[98:99], v[154:155], v[156:157]
    v_pk_fma_f32 v[158:159], v[98:99], v[152:153], v[158:159] neg_lo:[1,0,0] neg_hi:[1,0,0]
    v_cvt_pk_bf16_f32 v128, v148, v149
    v_cvt_pk_bf16_f32 v136, v150, v151
    v_cvt_pk_bf16_f32 v129, v156, v157
    v_cvt_pk_bf16_f32 v137, v158, v159
    v_lshlrev_b32 v144, 16, v180
    v_lshlrev_b32 v145, 16, v181
    v_pk_mul_f32 v[148:149], v[228:229], v[144:145]
    v_and_b32 v146, s69, v180
    v_and_b32 v147, s69, v181
    v_pk_mul_f32 v[150:151], v[228:229], v[146:147]
    v_pk_fma_f32 v[148:149], v[244:245], v[146:147], v[148:149] neg_lo:[1,0,0] neg_hi:[1,0,0]
    v_pk_fma_f32 v[150:151], v[244:245], v[144:145], v[150:151]
    v_lshlrev_b32 v152, 16, v182
    v_lshlrev_b32 v153, 16, v183
    v_pk_mul_f32 v[156:157], v[230:231], v[152:153]
    v_and_b32 v154, s69, v182
    v_and_b32 v155, s69, v183
    v_pk_mul_f32 v[158:159], v[230:231], v[154:155]
    v_pk_fma_f32 v[156:157], v[246:247], v[154:155], v[156:157] neg_lo:[1,0,0] neg_hi:[1,0,0]
    v_pk_fma_f32 v[158:159], v[246:247], v[152:153], v[158:159]
    v_accvgpr_read_b32 v180, a156
    v_accvgpr_read_b32 v181, a157
    v_accvgpr_read_b32 v182, a158
    v_accvgpr_read_b32 v183, a159
    v_lshlrev_b32 v144, 16, v180
    v_lshlrev_b32 v145, 16, v181
    v_pk_fma_f32 v[148:149], v[84:85], v[144:145], v[148:149]
    v_and_b32 v146, s69, v180
    v_and_b32 v147, s69, v181
    v_pk_fma_f32 v[150:151], v[84:85], v[146:147], v[150:151]
    v_pk_fma_f32 v[148:149], v[100:101], v[146:147], v[148:149]
    v_pk_fma_f32 v[150:151], v[100:101], v[144:145], v[150:151] neg_lo:[1,0,0] neg_hi:[1,0,0]
    v_lshlrev_b32 v152, 16, v182
    v_lshlrev_b32 v153, 16, v183
    v_pk_fma_f32 v[156:157], v[86:87], v[152:153], v[156:157]
    v_and_b32 v154, s69, v182
    v_and_b32 v155, s69, v183
    v_pk_fma_f32 v[158:159], v[86:87], v[154:155], v[158:159]
    v_pk_fma_f32 v[156:157], v[102:103], v[154:155], v[156:157]
    v_pk_fma_f32 v[158:159], v[102:103], v[152:153], v[158:159] neg_lo:[1,0,0] neg_hi:[1,0,0]
    v_cvt_pk_bf16_f32 v130, v148, v149
    v_cvt_pk_bf16_f32 v138, v150, v151
    v_cvt_pk_bf16_f32 v131, v156, v157
    v_cvt_pk_bf16_f32 v139, v158, v159
    v_lshlrev_b32 v144, 16, v184
    v_lshlrev_b32 v145, 16, v185
    v_pk_mul_f32 v[148:149], v[232:233], v[144:145]
    v_and_b32 v146, s69, v184
    v_and_b32 v147, s69, v185
    v_pk_mul_f32 v[150:151], v[232:233], v[146:147]
    v_pk_fma_f32 v[148:149], v[248:249], v[146:147], v[148:149] neg_lo:[1,0,0] neg_hi:[1,0,0]
    v_pk_fma_f32 v[150:151], v[248:249], v[144:145], v[150:151]
    v_lshlrev_b32 v152, 16, v186
    v_lshlrev_b32 v153, 16, v187
    v_pk_mul_f32 v[156:157], v[234:235], v[152:153]
    v_and_b32 v154, s69, v186
    v_and_b32 v155, s69, v187
    v_pk_mul_f32 v[158:159], v[234:235], v[154:155]
    v_pk_fma_f32 v[156:157], v[250:251], v[154:155], v[156:157] neg_lo:[1,0,0] neg_hi:[1,0,0]
    v_pk_fma_f32 v[158:159], v[250:251], v[152:153], v[158:159]
    v_accvgpr_read_b32 v184, a160
    v_accvgpr_read_b32 v185, a161
    v_accvgpr_read_b32 v186, a162
    v_accvgpr_read_b32 v187, a163
    v_lshlrev_b32 v144, 16, v184
    v_lshlrev_b32 v145, 16, v185
    s_waitcnt lgkmcnt(14)
    v_pk_fma_f32 v[148:149], v[88:89], v[144:145], v[148:149]
    v_and_b32 v146, s69, v184
    v_and_b32 v147, s69, v185
    v_pk_fma_f32 v[150:151], v[88:89], v[146:147], v[150:151]
    s_waitcnt lgkmcnt(10)
    v_pk_fma_f32 v[148:149], v[104:105], v[146:147], v[148:149]
    v_pk_fma_f32 v[150:151], v[104:105], v[144:145], v[150:151] neg_lo:[1,0,0] neg_hi:[1,0,0]
    v_lshlrev_b32 v152, 16, v186
    v_lshlrev_b32 v153, 16, v187
    v_pk_fma_f32 v[156:157], v[90:91], v[152:153], v[156:157]
    v_and_b32 v154, s69, v186
    v_and_b32 v155, s69, v187
    v_pk_fma_f32 v[158:159], v[90:91], v[154:155], v[158:159]
    s_waitcnt lgkmcnt(8)
    v_pk_fma_f32 v[156:157], v[106:107], v[154:155], v[156:157]
    v_pk_fma_f32 v[158:159], v[106:107], v[152:153], v[158:159] neg_lo:[1,0,0] neg_hi:[1,0,0]
    v_cvt_pk_bf16_f32 v132, v148, v149
    v_cvt_pk_bf16_f32 v140, v150, v151
    v_cvt_pk_bf16_f32 v133, v156, v157
    v_cvt_pk_bf16_f32 v141, v158, v159
    v_lshlrev_b32 v144, 16, v188
    v_lshlrev_b32 v145, 16, v189
    v_pk_mul_f32 v[148:149], v[236:237], v[144:145]
    v_and_b32 v146, s69, v188
    v_and_b32 v147, s69, v189
    v_pk_mul_f32 v[150:151], v[236:237], v[146:147]
    v_pk_fma_f32 v[148:149], v[252:253], v[146:147], v[148:149] neg_lo:[1,0,0] neg_hi:[1,0,0]
    v_pk_fma_f32 v[150:151], v[252:253], v[144:145], v[150:151]
    v_lshlrev_b32 v152, 16, v190
    v_lshlrev_b32 v153, 16, v191
    v_pk_mul_f32 v[156:157], v[238:239], v[152:153]
    v_and_b32 v154, s69, v190
    v_and_b32 v155, s69, v191
    v_pk_mul_f32 v[158:159], v[238:239], v[154:155]
    v_pk_fma_f32 v[156:157], v[254:255], v[154:155], v[156:157] neg_lo:[1,0,0] neg_hi:[1,0,0]
    v_pk_fma_f32 v[158:159], v[254:255], v[152:153], v[158:159]
    v_accvgpr_read_b32 v188, a164
    v_accvgpr_read_b32 v189, a165
    v_accvgpr_read_b32 v190, a166
    v_accvgpr_read_b32 v191, a167
    v_lshlrev_b32 v144, 16, v188
    v_lshlrev_b32 v145, 16, v189
    s_waitcnt lgkmcnt(6)
    v_pk_fma_f32 v[148:149], v[92:93], v[144:145], v[148:149]
    v_and_b32 v146, s69, v188
    v_and_b32 v147, s69, v189
    v_pk_fma_f32 v[150:151], v[92:93], v[146:147], v[150:151]
    s_waitcnt lgkmcnt(2)
    v_pk_fma_f32 v[148:149], v[108:109], v[146:147], v[148:149]
    v_pk_fma_f32 v[150:151], v[108:109], v[144:145], v[150:151] neg_lo:[1,0,0] neg_hi:[1,0,0]
    v_lshlrev_b32 v152, 16, v190
    v_lshlrev_b32 v153, 16, v191
    v_pk_fma_f32 v[156:157], v[94:95], v[152:153], v[156:157]
    v_and_b32 v154, s69, v190
    v_and_b32 v155, s69, v191
    v_pk_fma_f32 v[158:159], v[94:95], v[154:155], v[158:159]
    s_waitcnt lgkmcnt(0)
    v_pk_fma_f32 v[156:157], v[110:111], v[154:155], v[156:157]
    v_pk_fma_f32 v[158:159], v[110:111], v[152:153], v[158:159] neg_lo:[1,0,0] neg_hi:[1,0,0]
    v_cvt_pk_bf16_f32 v134, v148, v149
    v_cvt_pk_bf16_f32 v142, v150, v151
    v_cvt_pk_bf16_f32 v135, v156, v157
    v_cvt_pk_bf16_f32 v143, v158, v159
    s_nop 1
    s_waitcnt lgkmcnt(0)
    v_mfma_f32_32x32x16_bf16 v[48:63], v[112:115], a[0:3], 0
    s_add_u32 s40, s40, 274432
    s_cmp_lt_u32 s48, 3
    s_cselect_b32 s34, s40, 0x7ff00000
    buffer_load_dwordx4 v[160:163], v11, s[20:23], s34 offen offset:0 sc1
    buffer_load_dwordx4 v[164:167], v11, s[20:23], s34 offen offset:1024 sc1
    v_mfma_f32_32x32x16_bf16 v[64:79], v[112:115], a[16:19], 0
    s_cmp_le_u32 s48, 2
    buffer_load_dwordx4 v[168:171], v11, s[20:23], s34 offen offset:2048 sc1
    s_cselect_b32 s38, s38, 0x7ff00000
    buffer_load_dwordx4 v[172:175], v11, s[20:23], s34 offen offset:3072 sc1
    s_add_u32 s36, s34, 4096
    v_mfma_f32_32x32x16_bf16 v[80:95], v[128:131], a[24:27], 0
    buffer_load_dwordx4 v[176:179], v11, s[20:23], s36 offen offset:0 sc1
    buffer_load_dwordx4 v[180:183], v11, s[20:23], s36 offen offset:1024 sc1
    buffer_load_dwordx4 v[184:187], v11, s[20:23], s36 offen offset:2048 sc1
    buffer_load_dwordx4 v[188:191], v11, s[20:23], s36 offen offset:3072 sc1
    buffer_load_dword a170, v8, s[12:15], s38 offen
    v_mfma_f32_32x32x16_bf16 v[96:111], v[128:131], a[40:43], 0
    s_add_u32 s38, s38, 4096
    buffer_load_dword a171, v8, s[12:15], s38 offen
    s_add_u32 s38, s38, 4096
    buffer_load_dword a172, v8, s[12:15], s38 offen
    s_add_u32 s38, s38, 4096
    v_mfma_f32_32x32x16_bf16 v[48:63], v[116:119], a[4:7], v[48:63]
    buffer_load_dword a173, v8, s[12:15], s38 offen
    s_add_u32 s38, s38, 4096
    s_add_u32 s48, s48, 1
    s_mov_b32 s41, 0
    s_cmp_lt_u32 s48, 4
    v_mfma_f32_32x32x16_bf16 v[64:79], v[116:119], a[20:23], v[64:79]
    v_mfma_f32_32x32x16_bf16 v[80:95], v[132:135], a[28:31], v[80:95]
    v_mfma_f32_32x32x16_bf16 v[96:111], v[132:135], a[44:47], v[96:111]
    v_mfma_f32_32x32x16_bf16 v[48:63], v[120:123], a[8:11], v[48:63]
    v_mfma_f32_32x32x16_bf16 v[64:79], v[120:123], a[0:3], v[64:79]
    v_mfma_f32_32x32x16_bf16 v[80:95], v[136:139], a[32:35], v[80:95]
    v_mfma_f32_32x32x16_bf16 v[96:111], v[136:139], a[24:27], v[96:111]
    v_mfma_f32_32x32x16_bf16 v[48:63], v[124:127], a[12:15], v[48:63]
    v_mfma_f32_32x32x16_bf16 v[64:79], v[124:127], a[4:7], v[64:79]
    v_mfma_f32_32x32x16_bf16 v[80:95], v[140:143], a[36:39], v[80:95]
    v_mfma_f32_32x32x16_bf16 v[96:111], v[140:143], a[28:31], v[96:111]
    s_nop 10
    v_pk_add_f32 v[144:145], v[48:49], v[80:81]
    v_pk_add_f32 v[146:147], v[64:65], v[96:97]
    v_pk_add_f32 v[148:149], v[48:49], v[80:81] neg_lo:[0,1] neg_hi:[0,1]
    v_pk_add_f32 v[150:151], v[64:65], v[96:97] neg_lo:[0,1] neg_hi:[0,1]
    v_pk_add_f32 v[152:153], v[50:51], v[82:83]
    v_pk_add_f32 v[154:155], v[66:67], v[98:99]
    v_pk_add_f32 v[156:157], v[50:51], v[82:83] neg_lo:[0,1] neg_hi:[0,1]
    v_pk_add_f32 v[158:159], v[66:67], v[98:99] neg_lo:[0,1] neg_hi:[0,1]
    v_pk_mul_f32 v[48:49], v[146:147], v[32:33]
    v_pk_mul_f32 v[64:65], v[146:147], v[16:17]
    v_pk_mul_f32 v[80:81], v[150:151], v[32:33]
    v_pk_mul_f32 v[96:97], v[150:151], v[16:17]
    v_pk_mul_f32 v[50:51], v[154:155], v[34:35]
    v_pk_mul_f32 v[66:67], v[154:155], v[18:19]
    v_pk_mul_f32 v[82:83], v[158:159], v[34:35]
    v_pk_mul_f32 v[98:99], v[158:159], v[18:19]
    v_pk_fma_f32 v[48:49], v[144:145], v[16:17], v[48:49]
    v_pk_fma_f32 v[64:65], v[144:145], v[32:33], v[64:65] neg_lo:[0,1,0] neg_hi:[0,1,0]
    v_pk_fma_f32 v[80:81], v[148:149], v[16:17], v[80:81]
    v_pk_fma_f32 v[96:97], v[148:149], v[32:33], v[96:97] neg_lo:[0,1,0] neg_hi:[0,1,0]
    v_pk_fma_f32 v[50:51], v[152:153], v[18:19], v[50:51]
    v_pk_fma_f32 v[66:67], v[152:153], v[34:35], v[66:67] neg_lo:[0,1,0] neg_hi:[0,1,0]
    v_pk_fma_f32 v[82:83], v[156:157], v[18:19], v[82:83]
    v_pk_fma_f32 v[98:99], v[156:157], v[34:35], v[98:99] neg_lo:[0,1,0] neg_hi:[0,1,0]
    v_pk_add_f32 v[144:145], v[52:53], v[84:85]
    v_pk_add_f32 v[146:147], v[68:69], v[100:101]
    v_pk_add_f32 v[148:149], v[52:53], v[84:85] neg_lo:[0,1] neg_hi:[0,1]
    v_pk_add_f32 v[150:151], v[68:69], v[100:101] neg_lo:[0,1] neg_hi:[0,1]
    v_pk_add_f32 v[152:153], v[54:55], v[86:87]
    v_pk_add_f32 v[154:155], v[70:71], v[102:103]
    v_pk_add_f32 v[156:157], v[54:55], v[86:87] neg_lo:[0,1] neg_hi:[0,1]
    v_pk_add_f32 v[158:159], v[70:71], v[102:103] neg_lo:[0,1] neg_hi:[0,1]
    v_pk_mul_f32 v[52:53], v[146:147], v[36:37]
    v_pk_mul_f32 v[84:85], v[150:151], v[36:37]
    v_pk_mul_f32 v[54:55], v[154:155], v[38:39]
    v_pk_mul_f32 v[86:87], v[158:159], v[38:39]
    v_pk_mul_f32 v[68:69], v[146:147], v[20:21]
    v_pk_mul_f32 v[100:101], v[150:151], v[20:21]
    v_pk_fma_f32 v[52:53], v[144:145], v[20:21], v[52:53]
    v_pk_fma_f32 v[84:85], v[148:149], v[20:21], v[84:85]
    v_pk_mul_f32 v[70:71], v[154:155], v[22:23]
    v_pk_fma_f32 v[54:55], v[152:153], v[22:23], v[54:55]
    v_pk_mul_f32 v[102:103], v[158:159], v[22:23]
    v_pk_fma_f32 v[86:87], v[156:157], v[22:23], v[86:87]
    v_pk_fma_f32 v[68:69], v[144:145], v[36:37], v[68:69] neg_lo:[0,1,0] neg_hi:[0,1,0]
    v_pk_fma_f32 v[100:101], v[148:149], v[36:37], v[100:101] neg_lo:[0,1,0] neg_hi:[0,1,0]
    v_pk_fma_f32 v[70:71], v[152:153], v[38:39], v[70:71] neg_lo:[0,1,0] neg_hi:[0,1,0]
    v_pk_fma_f32 v[102:103], v[156:157], v[38:39], v[102:103] neg_lo:[0,1,0] neg_hi:[0,1,0]
    v_pk_add_f32 v[144:145], v[56:57], v[88:89]
    v_pk_add_f32 v[146:147], v[72:73], v[104:105]
    v_pk_add_f32 v[148:149], v[56:57], v[88:89] neg_lo:[0,1] neg_hi:[0,1]
    v_pk_add_f32 v[150:151], v[72:73], v[104:105] neg_lo:[0,1] neg_hi:[0,1]
    v_pk_add_f32 v[152:153], v[58:59], v[90:91]
    v_pk_add_f32 v[154:155], v[74:75], v[106:107]
    v_pk_add_f32 v[156:157], v[58:59], v[90:91] neg_lo:[0,1] neg_hi:[0,1]
    v_pk_add_f32 v[158:159], v[74:75], v[106:107] neg_lo:[0,1] neg_hi:[0,1]
    v_pk_mul_f32 v[56:57], v[146:147], v[40:41]
    v_pk_mul_f32 v[72:73], v[146:147], v[24:25]
    v_pk_mul_f32 v[88:89], v[150:151], v[40:41]
    v_pk_mul_f32 v[104:105], v[150:151], v[24:25]
    v_pk_mul_f32 v[58:59], v[154:155], v[42:43]
    v_pk_mul_f32 v[74:75], v[154:155], v[26:27]
    v_pk_mul_f32 v[90:91], v[158:159], v[42:43]
    v_pk_mul_f32 v[106:107], v[158:159], v[26:27]
    v_pk_fma_f32 v[56:57], v[144:145], v[24:25], v[56:57]
    v_pk_fma_f32 v[72:73], v[144:145], v[40:41], v[72:73] neg_lo:[0,1,0] neg_hi:[0,1,0]
    v_pk_fma_f32 v[88:89], v[148:149], v[24:25], v[88:89]
    v_pk_fma_f32 v[104:105], v[148:149], v[40:41], v[104:105] neg_lo:[0,1,0] neg_hi:[0,1,0]
    v_pk_fma_f32 v[58:59], v[152:153], v[26:27], v[58:59]
    v_pk_fma_f32 v[74:75], v[152:153], v[42:43], v[74:75] neg_lo:[0,1,0] neg_hi:[0,1,0]
    v_pk_fma_f32 v[90:91], v[156:157], v[26:27], v[90:91]
    v_pk_fma_f32 v[106:107], v[156:157], v[42:43], v[106:107] neg_lo:[0,1,0] neg_hi:[0,1,0]
    v_pk_add_f32 v[144:145], v[60:61], v[92:93]
    v_pk_add_f32 v[146:147], v[76:77], v[108:109]
    v_pk_add_f32 v[148:149], v[60:61], v[92:93] neg_lo:[0,1] neg_hi:[0,1]
    v_pk_add_f32 v[150:151], v[76:77], v[108:109] neg_lo:[0,1] neg_hi:[0,1]
    v_pk_mul_f32 v[60:61], v[146:147], v[44:45]
    v_pk_mul_f32 v[92:93], v[150:151], v[44:45]
    v_pk_fma_f32 v[60:61], v[144:145], v[28:29], v[60:61]
    v_pk_fma_f32 v[92:93], v[148:149], v[28:29], v[92:93]
    v_pk_mul_f32 v[76:77], v[146:147], v[28:29]
    v_pk_mul_f32 v[108:109], v[150:151], v[28:29]
    v_pk_fma_f32 v[76:77], v[144:145], v[44:45], v[76:77] neg_lo:[0,1,0] neg_hi:[0,1,0]
    v_pk_fma_f32 v[108:109], v[148:149], v[44:45], v[108:109] neg_lo:[0,1,0] neg_hi:[0,1,0]
    v_cvt_pk_bf16_f32 v112, v48, v49
    v_cvt_pk_bf16_f32 v128, v80, v81
    v_cvt_pk_bf16_f32 v113, v50, v51
    v_cvt_pk_bf16_f32 v129, v82, v83
    v_cvt_pk_bf16_f32 v114, v52, v53
    v_cvt_pk_bf16_f32 v130, v84, v85
    v_cvt_pk_bf16_f32 v115, v54, v55
    v_cvt_pk_bf16_f32 v131, v86, v87
    v_add_f32 v152, v62, v94
    v_mfma_f32_32x32x16_bf16 v[192:207], v[112:115], a[0:3], 0
    v_add_f32 v153, v63, v95
    v_add_f32 v154, v78, v110
    v_add_f32 v155, v79, v111
    v_sub_f32 v156, v62, v94
    v_sub_f32 v157, v63, v95
    v_sub_f32 v158, v78, v110
    v_mfma_f32_32x32x16_bf16 v[208:223], v[112:115], a[16:19], 0
    v_sub_f32 v159, v79, v111
    v_mul_f32 v62, v154, v46
    v_mul_f32 v63, v155, v47
    v_mul_f32 v94, v158, v46
    v_mul_f32 v95, v159, v47
    v_fmac_f32 v62, v152, v30
    v_mfma_f32_32x32x16_bf16 v[224:239], v[128:131], a[48:51], 0
    v_fmac_f32 v63, v153, v31
    v_fmac_f32 v94, v156, v30
    v_fmac_f32 v95, v157, v31
    v_cvt_pk_bf16_f32 v116, v56, v57
    v_cvt_pk_bf16_f32 v132, v88, v89
    v_mfma_f32_32x32x16_bf16 v[240:255], v[128:131], a[64:67], 0
    v_cvt_pk_bf16_f32 v117, v58, v59
    v_cvt_pk_bf16_f32 v133, v90, v91
    v_cvt_pk_bf16_f32 v118, v60, v61
    v_cvt_pk_bf16_f32 v134, v92, v93
    v_cvt_pk_bf16_f32 v119, v62, v63
    v_mfma_f32_32x32x16_bf16 v[48:63], a[104:107], a[0:3], 0
    v_cvt_pk_bf16_f32 v135, v94, v95
    v_cvt_pk_bf16_f32 v120, v64, v65
    v_cvt_pk_bf16_f32 v136, v96, v97
    v_cvt_pk_bf16_f32 v121, v66, v67
    v_cvt_pk_bf16_f32 v137, v98, v99
    v_mfma_f32_32x32x16_bf16 v[192:207], v[116:119], a[4:7], v[192:207]
    v_cvt_pk_bf16_f32 v122, v68, v69
    v_cvt_pk_bf16_f32 v138, v100, v101
    v_cvt_pk_bf16_f32 v123, v70, v71
    v_cvt_pk_bf16_f32 v139, v102, v103
    v_mul_f32 v78, v154, v30
    v_mfma_f32_32x32x16_bf16 v[208:223], v[116:119], a[20:23], v[208:223]
    v_mul_f32 v79, v155, v31
    v_mul_f32 v110, v158, v30
    v_mul_f32 v111, v159, v31
    v_fma_f32 v78, v152, -v46, v78
    v_fma_f32 v79, v153, -v47, v79
    v_mfma_f32_32x32x16_bf16 v[224:239], v[132:135], a[52:55], v[224:239]
    v_fma_f32 v110, v156, -v46, v110
    v_fma_f32 v111, v157, -v47, v111
    v_cvt_pk_bf16_f32 v124, v72, v73
    v_cvt_pk_bf16_f32 v140, v104, v105
    v_cvt_pk_bf16_f32 v125, v74, v75
    v_mfma_f32_32x32x16_bf16 v[240:255], v[132:135], a[68:71], v[240:255]
    v_cvt_pk_bf16_f32 v141, v106, v107
    v_cvt_pk_bf16_f32 v126, v76, v77
    v_cvt_pk_bf16_f32 v142, v108, v109
    v_cvt_pk_bf16_f32 v127, v78, v79
    v_cvt_pk_bf16_f32 v143, v110, v111
    v_mfma_f32_32x32x16_bf16 v[192:207], v[120:123], a[8:11], v[192:207]
    v_mfma_f32_32x32x16_bf16 v[208:223], v[120:123], a[0:3], v[208:223]
    v_mfma_f32_32x32x16_bf16 v[224:239], v[136:139], a[56:59], v[224:239]
    v_mfma_f32_32x32x16_bf16 v[240:255], v[136:139], a[48:51], v[240:255]
    v_mfma_f32_32x32x16_bf16 v[192:207], v[124:127], a[12:15], v[192:207]
    v_mfma_f32_32x32x16_bf16 v[208:223], v[124:127], a[4:7], v[208:223]
    v_mfma_f32_32x32x16_bf16 v[224:239], v[140:143], a[60:63], v[224:239]
    v_mfma_f32_32x32x16_bf16 v[240:255], v[140:143], a[52:55], v[240:255]
    v_mfma_f32_32x32x16_bf16 v[48:63], a[108:111], a[4:7], v[48:63]
    v_mfma_f32_32x32x16_bf16 v[48:63], a[112:115], a[16:19], v[48:63]
    v_mfma_f32_32x32x16_bf16 v[48:63], a[116:119], a[20:23], v[48:63]
    v_mfma_f32_32x32x16_bf16 v[64:79], a[104:107], a[8:11], 0
    s_nop 4
    v_cvt_pk_bf16_f32 v112, v192, v193
    v_mfma_f32_32x32x16_bf16 v[64:79], a[108:111], a[12:15], v[64:79]
    v_cvt_pk_bf16_f32 v113, v194, v195
    v_cvt_pk_bf16_f32 v114, v196, v197
    v_cvt_pk_bf16_f32 v115, v198, v199
    v_cvt_pk_bf16_f32 v116, v200, v201
    v_cvt_pk_bf16_f32 v117, v202, v203
    v_mfma_f32_32x32x16_bf16 v[64:79], a[112:115], a[0:3], v[64:79]
    v_cvt_pk_bf16_f32 v118, v204, v205
    v_cvt_pk_bf16_f32 v119, v206, v207
    v_cvt_pk_bf16_f32 v120, v208, v209
    v_cvt_pk_bf16_f32 v121, v210, v211
    v_cvt_pk_bf16_f32 v122, v212, v213
    v_mfma_f32_32x32x16_bf16 v[64:79], a[116:119], a[4:7], v[64:79]
    v_cvt_pk_bf16_f32 v123, v214, v215
    v_cvt_pk_bf16_f32 v124, v216, v217
    v_cvt_pk_bf16_f32 v125, v218, v219
    v_cvt_pk_bf16_f32 v126, v220, v221
    v_cvt_pk_bf16_f32 v127, v222, v223
    v_mfma_f32_32x32x16_bf16 v[80:95], a[120:123], a[24:27], 0
    v_cvt_pk_bf16_f32 v128, v224, v225
    v_cvt_pk_bf16_f32 v129, v226, v227
    v_cvt_pk_bf16_f32 v130, v228, v229
    v_cvt_pk_bf16_f32 v131, v230, v231
    v_cvt_pk_bf16_f32 v132, v232, v233
    v_mfma_f32_32x32x16_bf16 v[80:95], a[124:127], a[28:31], v[80:95]
    v_cvt_pk_bf16_f32 v133, v234, v235
    v_cvt_pk_bf16_f32 v134, v236, v237
    v_cvt_pk_bf16_f32 v135, v238, v239
    v_cvt_pk_bf16_f32 v136, v240, v241
    v_cvt_pk_bf16_f32 v137, v242, v243
    v_mfma_f32_32x32x16_bf16 v[80:95], a[128:131], a[40:43], v[80:95]
    v_cvt_pk_bf16_f32 v138, v244, v245
    v_cvt_pk_bf16_f32 v139, v246, v247
    v_cvt_pk_bf16_f32 v140, v248, v249
    v_cvt_pk_bf16_f32 v141, v250, v251
    v_cvt_pk_bf16_f32 v142, v252, v253
    v_mfma_f32_32x32x16_bf16 v[80:95], a[132:135], a[44:47], v[80:95]
    v_cvt_pk_bf16_f32 v143, v254, v255
    ds_write_b64 v5, v[112:113] offset:0
    ds_write_b64 v5, v[114:115] offset:128
    ds_write_b64 v5, v[116:117] offset:256
    ds_write_b64 v5, v[118:119] offset:384
    v_mfma_f32_32x32x16_bf16 v[96:111], a[120:123], a[32:35], 0
    ds_write_b64 v5, v[120:121] offset:16
    ds_write_b64 v5, v[122:123] offset:144
    ds_write_b64 v5, v[124:125] offset:272
    ds_write_b64 v5, v[126:127] offset:400
    ds_write_b64 v5, v[128:129] offset:512
    v_mfma_f32_32x32x16_bf16 v[96:111], a[124:127], a[36:39], v[96:111]
    ds_write_b64 v5, v[130:131] offset:640
    ds_write_b64 v5, v[132:133] offset:768
    ds_write_b64 v5, v[134:135] offset:896
    ds_write_b64 v5, v[136:137] offset:528
    ds_write_b64 v5, v[138:139] offset:656
    v_mfma_f32_32x32x16_bf16 v[96:111], a[128:131], a[24:27], v[96:111]
    ds_write_b64 v5, v[140:141] offset:784
    ds_write_b64 v5, v[142:143] offset:912
    v_add_u32 v5, 32, v5
    v_mfma_f32_32x32x16_bf16 v[96:111], a[132:135], a[28:31], v[96:111]
    s_nop 11
    s_branch Lback_23
Lskip_24:
    s_waitcnt lgkmcnt(0)
    s_lshl_b32 s34, s33, 12
    s_add_u32 s34, s34, s35
    s_add_u32 s34, s34, 37814272
    ds_read_b64_tr_b16 v[48:49], v6 offset:0
    ds_read_b64_tr_b16 v[50:51], v6 offset:64
    ds_read_b64_tr_b16 v[52:53], v6 offset:4112
    ds_read_b64_tr_b16 v[54:55], v6 offset:4176
    ds_read_b64_tr_b16 v[56:57], v6 offset:8224
    ds_read_b64_tr_b16 v[58:59], v6 offset:8288
    ds_read_b64_tr_b16 v[60:61], v6 offset:12336
    ds_read_b64_tr_b16 v[62:63], v6 offset:12400
    ds_read_b64_tr_b16 v[64:65], v6 offset:16448
    ds_read_b64_tr_b16 v[66:67], v6 offset:16512
    ds_read_b64_tr_b16 v[68:69], v6 offset:20560
    ds_read_b64_tr_b16 v[70:71], v6 offset:20624
    ds_read_b64_tr_b16 v[72:73], v6 offset:24672
    ds_read_b64_tr_b16 v[74:75], v6 offset:24736
    ds_read_b64_tr_b16 v[76:77], v6 offset:28784
    ds_read_b64_tr_b16 v[78:79], v6 offset:28848
    s_waitcnt lgkmcnt(8)
    buffer_store_dwordx4 v[48:51], v2, s[20:23], s34 offen sc1
    s_add_u32 s34, s34, 131456
    buffer_store_dwordx4 v[52:55], v2, s[20:23], s34 offen sc1
    s_add_u32 s34, s34, 131456
    buffer_store_dwordx4 v[56:59], v2, s[20:23], s34 offen sc1
    s_add_u32 s34, s34, 131456
    buffer_store_dwordx4 v[60:63], v2, s[20:23], s34 offen sc1
    s_add_u32 s34, s34, 131456
    v_add_u32 v6, 32896, v6
    ds_read_b64_tr_b16 v[80:81], v6 offset:0
    ds_read_b64_tr_b16 v[82:83], v6 offset:64
    ds_read_b64_tr_b16 v[84:85], v6 offset:4112
    ds_read_b64_tr_b16 v[86:87], v6 offset:4176
    ds_read_b64_tr_b16 v[88:89], v6 offset:8224
    ds_read_b64_tr_b16 v[90:91], v6 offset:8288
    ds_read_b64_tr_b16 v[92:93], v6 offset:12336
    ds_read_b64_tr_b16 v[94:95], v6 offset:12400
    s_waitcnt lgkmcnt(8)
    buffer_store_dwordx4 v[64:67], v2, s[20:23], s34 offen sc1
    s_add_u32 s34, s34, 131456
    buffer_store_dwordx4 v[68:71], v2, s[20:23], s34 offen sc1
    s_add_u32 s34, s34, 131456
    buffer_store_dwordx4 v[72:75], v2, s[20:23], s34 offen sc1
    s_add_u32 s34, s34, 131456
    buffer_store_dwordx4 v[76:79], v2, s[20:23], s34 offen sc1
    s_add_u32 s34, s34, 131456
    ds_read_b64_tr_b16 v[96:97], v6 offset:16448
    ds_read_b64_tr_b16 v[98:99], v6 offset:16512
    ds_read_b64_tr_b16 v[100:101], v6 offset:20560
    ds_read_b64_tr_b16 v[102:103], v6 offset:20624
    ds_read_b64_tr_b16 v[104:105], v6 offset:24672
    ds_read_b64_tr_b16 v[106:107], v6 offset:24736
    ds_read_b64_tr_b16 v[108:109], v6 offset:28784
    ds_read_b64_tr_b16 v[110:111], v6 offset:28848
    s_waitcnt lgkmcnt(8)
    buffer_store_dwordx4 v[80:83], v2, s[20:23], s34 offen sc1
    s_add_u32 s34, s34, 131456
    buffer_store_dwordx4 v[84:87], v2, s[20:23], s34 offen sc1
    s_add_u32 s34, s34, 131456
    buffer_store_dwordx4 v[88:91], v2, s[20:23], s34 offen sc1
    s_add_u32 s34, s34, 131456
    buffer_store_dwordx4 v[92:95], v2, s[20:23], s34 offen sc1
    s_add_u32 s34, s34, 131456
    v_add_u32 v6, 32896, v6
    ds_read_b64_tr_b16 v[48:49], v6 offset:0
    ds_read_b64_tr_b16 v[50:51], v6 offset:64
    ds_read_b64_tr_b16 v[52:53], v6 offset:4112
    ds_read_b64_tr_b16 v[54:55], v6 offset:4176
    ds_read_b64_tr_b16 v[56:57], v6 offset:8224
    ds_read_b64_tr_b16 v[58:59], v6 offset:8288
    ds_read_b64_tr_b16 v[60:61], v6 offset:12336
    ds_read_b64_tr_b16 v[62:63], v6 offset:12400
    s_waitcnt lgkmcnt(8)
    buffer_store_dwordx4 v[96:99], v2, s[20:23], s34 offen sc1
    s_add_u32 s34, s34, 131456
    buffer_store_dwordx4 v[100:103], v2, s[20:23], s34 offen sc1
    s_add_u32 s34, s34, 131456
    buffer_store_dwordx4 v[104:107], v2, s[20:23], s34 offen sc1
    s_add_u32 s34, s34, 131456
    buffer_store_dwordx4 v[108:111], v2, s[20:23], s34 offen sc1
    s_add_u32 s34, s34, 131456
    ds_read_b64_tr_b16 v[64:65], v6 offset:16448
    ds_read_b64_tr_b16 v[66:67], v6 offset:16512
    ds_read_b64_tr_b16 v[68:69], v6 offset:20560
    ds_read_b64_tr_b16 v[70:71], v6 offset:20624
    ds_read_b64_tr_b16 v[72:73], v6 offset:24672
    ds_read_b64_tr_b16 v[74:75], v6 offset:24736
    ds_read_b64_tr_b16 v[76:77], v6 offset:28784
    ds_read_b64_tr_b16 v[78:79], v6 offset:28848
    s_waitcnt lgkmcnt(8)
    buffer_store_dwordx4 v[48:51], v2, s[20:23], s34 offen sc1
    s_add_u32 s34, s34, 131456
    buffer_store_dwordx4 v[52:55], v2, s[20:23], s34 offen sc1
    s_add_u32 s34, s34, 131456
    buffer_store_dwordx4 v[56:59], v2, s[20:23], s34 offen sc1
    s_add_u32 s34, s34, 131456
    buffer_store_dwordx4 v[60:63], v2, s[20:23], s34 offen sc1
    s_add_u32 s34, s34, 131456
    v_add_u32 v6, 32896, v6
    ds_read_b64_tr_b16 v[80:81], v6 offset:0
    ds_read_b64_tr_b16 v[82:83], v6 offset:64
    ds_read_b64_tr_b16 v[84:85], v6 offset:4112
    ds_read_b64_tr_b16 v[86:87], v6 offset:4176
    ds_read_b64_tr_b16 v[88:89], v6 offset:8224
    ds_read_b64_tr_b16 v[90:91], v6 offset:8288
    ds_read_b64_tr_b16 v[92:93], v6 offset:12336
    ds_read_b64_tr_b16 v[94:95], v6 offset:12400
    s_waitcnt lgkmcnt(8)
    buffer_store_dwordx4 v[64:67], v2, s[20:23], s34 offen sc1
    s_add_u32 s34, s34, 131456
    buffer_store_dwordx4 v[68:71], v2, s[20:23], s34 offen sc1
    s_add_u32 s34, s34, 131456
    buffer_store_dwordx4 v[72:75], v2, s[20:23], s34 offen sc1
    s_add_u32 s34, s34, 131456
    buffer_store_dwordx4 v[76:79], v2, s[20:23], s34 offen sc1
    s_add_u32 s34, s34, 131456
    ds_read_b64_tr_b16 v[96:97], v6 offset:16448
    ds_read_b64_tr_b16 v[98:99], v6 offset:16512
    ds_read_b64_tr_b16 v[100:101], v6 offset:20560
    ds_read_b64_tr_b16 v[102:103], v6 offset:20624
    ds_read_b64_tr_b16 v[104:105], v6 offset:24672
    ds_read_b64_tr_b16 v[106:107], v6 offset:24736
    ds_read_b64_tr_b16 v[108:109], v6 offset:28784
    ds_read_b64_tr_b16 v[110:111], v6 offset:28848
    s_waitcnt lgkmcnt(8)
    buffer_store_dwordx4 v[80:83], v2, s[20:23], s34 offen sc1
    s_add_u32 s34, s34, 131456
    buffer_store_dwordx4 v[84:87], v2, s[20:23], s34 offen sc1
    s_add_u32 s34, s34, 131456
    buffer_store_dwordx4 v[88:91], v2, s[20:23], s34 offen sc1
    s_add_u32 s34, s34, 131456
    buffer_store_dwordx4 v[92:95], v2, s[20:23], s34 offen sc1
    s_add_u32 s34, s34, 131456
    s_waitcnt lgkmcnt(0)
    buffer_store_dwordx4 v[96:99], v2, s[20:23], s34 offen sc1
    s_add_u32 s34, s34, 131456
    buffer_store_dwordx4 v[100:103], v2, s[20:23], s34 offen sc1
    s_add_u32 s34, s34, 131456
    buffer_store_dwordx4 v[104:107], v2, s[20:23], s34 offen sc1
    s_add_u32 s34, s34, 131456
    buffer_store_dwordx4 v[108:111], v2, s[20:23], s34 offen sc1
    s_add_u32 s34, s34, 131456
    s_waitcnt vmcnt(0) lgkmcnt(0)
    s_barrier
    s_cmp_lg_u32 s32, 0
    s_cbranch_scc1 Lsig_25
    s_add_u32 s49, s70, 3
    v_mov_b32 v15, s49
    s_lshl_b32 s49, s2, 6
    s_add_u32 s49, s49, 47251456
    s_mov_b64 exec, 1
    buffer_store_dword v15, off, s[20:23], s49 sc1
    s_mov_b64 exec, -1
Lsig_25:
    s_load_dwordx2 s[80:81], s[0:1], 48
    s_load_dwordx2 s[82:83], s[0:1], 64
    v_mov_b32 v62, v9
    v_mov_b32 v63, v10
    v_mov_b32 v11, v1
    v_mov_b32 v10, v2
    s_mov_b32 s38, s32
    s_mov_b32 s37, s70
    s_mov_b32 s68, s6
    s_mov_b32 s69, s7
    s_mov_b32 s70, 0x3000000
    s_mov_b32 s71, 0x20000
    s_mov_b32 s20, s6
    s_mov_b32 s21, s7
    s_mov_b32 s22, 0xe00000
    s_mov_b32 s23, 0x20000
    s_lshr_b32 s92, s2, 3
    s_mul_i32 s92, s92, 131456
    s_and_b32 s93, s2, 7
    s_lshl_b32 s93, s93, 7
    s_add_u32 s92, s92, s93
    s_lshl_b32 s93, s38, 15
    s_add_u32 s92, s92, s93
    s_add_u32 s92, s92, 37814272
    v_lshrrev_b32 v24, 5, v11
    s_lshl_b32 s93, s38, 3
    s_and_b32 s93, s93, 8
    v_add_u32 v25, s93, v24
    v_and_b32 v26, 15, v11
    v_xor_b32 v25, v25, v26
    v_bfe_u32 v26, v11, 4, 1
    v_lshlrev_b32 v26, 11, v26
    v_lshl_add_u32 v24, v24, 12, v26
    s_lshl_b32 s93, s38, 12
    s_add_u32 s93, s93, 131072
    v_xor_b32 v26, 0, v25
    v_lshrrev_b32 v27, 3, v26
    v_and_b32 v26, 7, v26
    v_lshlrev_b32 v26, 4, v26
    v_lshl_add_u32 v26, v27, 10, v26
    v_add_u32 v28, v24, v26
    v_xor_b32 v26, 2, v25
    v_lshrrev_b32 v27, 3, v26
    v_and_b32 v26, 7, v26
    v_lshlrev_b32 v26, 4, v26
    v_lshl_add_u32 v26, v27, 10, v26
    v_add_u32 v29, v24, v26
    v_xor_b32 v26, 4, v25
    v_lshrrev_b32 v27, 3, v26
    v_and_b32 v26, 7, v26
    v_lshlrev_b32 v26, 4, v26
    v_lshl_add_u32 v26, v27, 10, v26
    v_add_u32 v30, v24, v26
    v_xor_b32 v26, 6, v25
    v_lshrrev_b32 v27, 3, v26
    v_and_b32 v26, 7, v26
    v_lshlrev_b32 v26, 4, v26
    v_lshl_add_u32 v26, v27, 10, v26
    v_add_u32 v31, v24, v26
    v_and_b32 v32, 31, v11
    v_lshlrev_b32 v32, 6, v32
    s_mov_b32 s95, 47251456
    s_add_u32 s41, s37, 3
    v_mov_b32 v33, s41
    s_lshl_b32 s58, s2, 6
    s_add_u32 s58, s58, 47251456
    s_waitcnt lgkmcnt(0)
    s_mov_b32 s60, s80
    s_mov_b32 s61, s81
    s_mov_b32 s62, 0x700000
    s_mov_b32 s63, 0x20000
    s_mov_b32 s8, s82
    s_mov_b32 s9, s83
    s_mov_b32 s10, 0x400000
    s_mov_b32 s11, 0x20000
    s_mov_b32 s19, 4
    s_mov_b32 s18, 65536
    s_and_b32 s76, s2, 7
    s_lshr_b32 s77, s2, 3
    s_lshr_b32 s14, s76, 2
    s_and_b32 s12, s76, 3
    s_lshl_b32 s12, s12, 2
    s_lshr_b32 s78, s77, 3
    s_add_u32 s12, s12, s78
    s_and_b32 s13, s77, 7
    s_lshl_b32 s76, s12, 2
    s_add_u32 s76, s76, s38
    s_mul_i32 s76, s76, 112
    s_mul_i32 s77, s14, 110
    s_add_u32 s76, s76, s77
    s_lshl_b32 s15, s76, 11
    s_mul_i32 s76, s14, 3520
    s_lshl_b32 s77, s38, 4
    s_add_u32 s76, s76, s77
    s_lshl_b32 s76, s76, 11
    s_lshl_b32 s77, s13, 8
    s_add_u32 s16, s76, s77
    s_lshl_b32 s24, s38, 12
    s_mul_i32 s31, s14, -262144
    s_add_u32 s31, s31, 131072
    v_lshrrev_b32 v35, 4, v11
    v_lshlrev_b32 v9, 1, v35
    v_and_b32 v8, 15, v11
    v_xor_b32 v9, v9, v8
    v_lshlrev_b32 v9, 4, v9
    v_lshl_add_u32 v8, v35, 11, v9
    v_xor_b32 v58, 128, v8
    v_add_u32 v58, 7168, v58
    v_add_u32 v59, 14336, v8
    v_add_u32 v1, 14336, v58
    s_bfe_u32 s76, s12, 0x20001
    s_mul_i32 s76, s76, 56
    s_lshr_b32 s77, s12, 3
    s_lshl_b32 s77, s77, 2
    s_add_u32 s76, s76, s77
    s_add_u32 s76, s76, 32
    s_lshl_b32 s76, s76, 6
    s_and_b32 s77, s12, 1
    s_lshl_b32 s77, s77, 3
    s_add_u32 s76, s76, s77
    s_add_u32 s39, s76, 47251472
    v_bfe_u32 v35, v11, 1, 3
    v_min_u32 v35, 6, v35
    s_mul_i32 s76, s14, 3
    v_lshrrev_b32 v9, 4, v11
    v_min_u32 v9, 2, v9
    v_xor_b32 v9, s76, v9
    v_lshl_add_u32 v35, v35, 3, v9
    v_lshlrev_b32 v35, 6, v35
    v_and_b32 v9, 1, v11
    v_lshl_add_u32 v9, v9, 2, v35
    s_add_u32 s40, s37, 1
    s_add_u32 s79, s18, 0
    s_and_b32 s79, s79, 131071
    s_add_u32 m0, s24, s79
    s_nop 0
    buffer_load_dwordx4 v8, s[60:63], s16 offen offset:0 lds
    buffer_load_dwordx4 v58, s[60:63], s16 offen offset:1024 lds
    buffer_load_dwordx4 v59, s[60:63], s16 offen offset:2048 lds
    buffer_load_dwordx4 v1, s[60:63], s16 offen offset:3072 lds
    s_add_u32 s16, s16, s31
    s_add_u32 s79, s18, 16384
    s_and_b32 s79, s79, 131071
    s_add_u32 m0, s24, s79
    s_nop 0
    buffer_load_dwordx4 v8, s[60:63], s16 offen offset:0 lds
    buffer_load_dwordx4 v58, s[60:63], s16 offen offset:1024 lds
    buffer_load_dwordx4 v59, s[60:63], s16 offen offset:2048 lds
    buffer_load_dwordx4 v1, s[60:63], s16 offen offset:3072 lds
    s_add_u32 s16, s16, s31
    s_add_u32 s79, s18, 32768
    s_and_b32 s79, s79, 131071
    s_add_u32 m0, s24, s79
    s_nop 0
    buffer_load_dwordx4 v8, s[60:63], s16 offen offset:0 lds
    buffer_load_dwordx4 v58, s[60:63], s16 offen offset:1024 lds
    buffer_load_dwordx4 v59, s[60:63], s16 offen offset:2048 lds
    buffer_load_dwordx4 v1, s[60:63], s16 offen offset:3072 lds
    s_add_u32 s16, s16, s31
    s_mov_b32 s34, 0
    s_branch Ltail
Lend0:
    s_endpgm
Lg1:
    s_load_dwordx2 s[4:5], s[0:1], 0
    s_load_dwordx4 s[52:55], s[0:1], 32
    s_load_dwordx2 s[6:7], s[0:1], 80
    s_load_dwordx2 s[80:81], s[0:1], 48
    s_load_dwordx2 s[82:83], s[0:1], 72
    s_load_dwordx2 s[56:57], s[0:1], 56
    s_load_dwordx4 s[92:95], s[0:1], 8
    v_lshrrev_b32 v1, 6, v0
    v_and_b32 v11, 63, v0
    v_readfirstlane_b32 s38, v1
    s_waitcnt lgkmcnt(0)
    s_mov_b32 s8, s4
    s_mov_b32 s9, s5
    s_mov_b32 s10, 0x400000
    s_mov_b32 s11, 0x20000
    v_lshlrev_b32 v10, 4, v11
    s_mov_b32 s64, s56
    s_mov_b32 s65, s57
    s_mov_b32 s66, 0x800
    s_mov_b32 s67, 0x20000
    s_lshl_b32 s84, s2, 14
    s_lshl_b32 s85, s38, 12
    s_add_u32 s84, s84, s85
    s_mul_i32 s85, s38, 4128
    s_add_u32 m0, s85, 65536
    s_nop 0
    buffer_load_dwordx4 v10, s[8:11], s84 offen lds
    s_add_u32 m0, s85, 66560
    s_add_u32 s84, s84, 1024
    buffer_load_dwordx4 v10, s[8:11], s84 offen lds
    s_add_u32 m0, s85, 67600
    s_add_u32 s84, s84, 1024
    buffer_load_dwordx4 v10, s[8:11], s84 offen lds
    s_add_u32 m0, s85, 68624
    s_add_u32 s84, s84, 1024
    buffer_load_dwordx4 v10, s[8:11], s84 offen lds
    v_lshrrev_b32 v224, 5, v11
    v_lshl_add_u32 v224, v224, 12, v10
    s_lshl_b32 s84, s38, 9
    s_lshl_b32 s85, s38, 10
    s_add_u32 m0, s85, 86144
    s_nop 0
    buffer_load_dwordx4 v224, s[64:67], s84 offen lds
    v_bfe_u32 v232, v11, 4, 1
    v_bfe_u32 v233, v11, 2, 1
    v_lshlrev_b32 v232, 3, v232
    v_lshl_add_u32 v232, v233, 2, v232
    v_bfe_u32 v233, v11, 3, 1
    s_mov_b32 s87, 0xbd000000
    s_cmp_eq_u32 s38, 1
    v_lshl_add_u32 v232, v233, 1, v232
    s_cselect_b64 vcc, -1, 0
    s_cselect_b32 s86, 0x3e800000, 0
    s_cselect_b32 s87, 0x3d000000, s87
    v_bfe_u32 v233, v11, 1, 1
    s_cmp_eq_u32 s38, 2
    v_and_b32 v228, 31, v11
    v_add_u32 v232, v232, v233
    s_cselect_b32 s87, 0xba800000, s87
    v_cvt_f32_u32 v228, v228
    v_cvt_f32_u32 v232, v232
    s_cmp_eq_u32 s38, 3
    v_and_b32 v233, 1, v11
    s_cselect_b32 s87, 0x3d000000, s87
    v_cndmask_b32 v228, v228, v232, vcc
    v_cvt_f32_u32 v233, v233
    v_mul_f32 v226, s87, v228
    s_cmp_eq_u32 s38, 3
    v_lshrrev_b32 v229, 5, v11
    v_mul_f32 v233, s86, v233
    s_cselect_b32 s87, -69504, 0
    v_lshlrev_b32 v229, 2, v229
    s_lshl_b32 s86, s38, 12
    v_cvt_f32_u32 v229, v229
    s_add_u32 s86, s86, s87
    v_fma_f32 v227, v226, v229, v233
    s_add_u32 s86, s86, 147456
    v_add_f32 v231, 0x3e800000, v227
    v_add_u32 v232, s86, v10
    s_nop 1
    s_cmp_lg_u32 s38, 3
    s_cbranch_scc1 Lcb_26
    v_fmamk_f32 v82, v226, 0x3f800000, v227
    v_fmamk_f32 v83, v226, 0x3f800000, v231
    v_fmamk_f32 v84, v226, 0x40000000, v227
    v_fmamk_f32 v85, v226, 0x40000000, v231
    v_fmamk_f32 v86, v226, 0x40400000, v227
    v_fmamk_f32 v87, v226, 0x40400000, v231
    v_fmamk_f32 v88, v226, 0x41000000, v227
    v_fmamk_f32 v89, v226, 0x41000000, v231
    v_fmamk_f32 v90, v226, 0x41100000, v227
    v_fmamk_f32 v91, v226, 0x41100000, v231
    v_fmamk_f32 v92, v226, 0x41200000, v227
    v_fmamk_f32 v93, v226, 0x41200000, v231
    v_fmamk_f32 v94, v226, 0x41300000, v227
    v_fmamk_f32 v95, v226, 0x41300000, v231
    v_cos_f32 v66, v82
    v_cos_f32 v67, v83
    v_cos_f32 v68, v84
    v_cos_f32 v69, v85
    v_cos_f32 v70, v86
    v_cos_f32 v71, v87
    v_cos_f32 v72, v88
    v_cos_f32 v73, v89
    v_cos_f32 v74, v90
    v_cos_f32 v75, v91
    v_cos_f32 v76, v92
    v_cos_f32 v77, v93
    v_cos_f32 v78, v94
    v_cos_f32 v79, v95
    v_cos_f32 v64, v227
    v_sin_f32 v80, v227
    v_cos_f32 v65, v231
    v_sin_f32 v81, v231
    v_sin_f32 v82, v82
    v_sin_f32 v83, v83
    v_sin_f32 v84, v84
    v_sin_f32 v85, v85
    v_sin_f32 v86, v86
    v_sin_f32 v87, v87
    v_sin_f32 v88, v88
    v_sin_f32 v89, v89
    v_sin_f32 v90, v90
    v_sin_f32 v91, v91
    v_sin_f32 v92, v92
    v_sin_f32 v93, v93
    v_sin_f32 v94, v94
    v_sin_f32 v95, v95
    s_nop 1
    s_branch Lcp_29
Lcb_26:
    v_fmamk_f32 v81, v226, 0x3f800000, v227
    v_fmamk_f32 v82, v226, 0x40000000, v227
    v_fmamk_f32 v83, v226, 0x40400000, v227
    v_fmamk_f32 v84, v226, 0x41000000, v227
    v_fmamk_f32 v85, v226, 0x41100000, v227
    v_fmamk_f32 v86, v226, 0x41200000, v227
    v_fmamk_f32 v87, v226, 0x41300000, v227
    v_fmamk_f32 v88, v226, 0x41800000, v227
    v_fmamk_f32 v89, v226, 0x41880000, v227
    v_fmamk_f32 v90, v226, 0x41900000, v227
    v_fmamk_f32 v91, v226, 0x41980000, v227
    v_fmamk_f32 v92, v226, 0x41c00000, v227
    v_fmamk_f32 v93, v226, 0x41c80000, v227
    v_fmamk_f32 v94, v226, 0x41d00000, v227
    v_fmamk_f32 v95, v226, 0x41d80000, v227
    v_cos_f32 v65, v81
    v_cos_f32 v66, v82
    v_cos_f32 v67, v83
    v_cos_f32 v68, v84
    v_cos_f32 v69, v85
    v_cos_f32 v70, v86
    v_cos_f32 v71, v87
    v_cos_f32 v72, v88
    v_cos_f32 v73, v89
    v_cos_f32 v74, v90
    v_cos_f32 v75, v91
    v_cos_f32 v76, v92
    v_cos_f32 v77, v93
    v_cos_f32 v78, v94
    v_cos_f32 v79, v95
    v_cos_f32 v64, v227
    v_sin_f32 v80, v227
    v_sin_f32 v81, v81
    v_sin_f32 v82, v82
    v_sin_f32 v83, v83
    v_sin_f32 v84, v84
    v_sin_f32 v85, v85
    v_sin_f32 v86, v86
    v_sin_f32 v87, v87
    v_sin_f32 v88, v88
    v_sin_f32 v89, v89
    v_sin_f32 v90, v90
    v_sin_f32 v91, v91
    v_sin_f32 v92, v92
    v_sin_f32 v93, v93
    v_sin_f32 v94, v94
    v_sin_f32 v95, v95
    s_nop 1
    s_cmp_eq_u32 s38, 2
    s_cbranch_scc1 Lcw_27
Lcp_29:
    v_cvt_pk_bf16_f32 v96, v64, v65
    v_cvt_pk_bf16_f32 v97, v66, v67
    v_cvt_pk_bf16_f32 v98, v68, v69
    v_cvt_pk_bf16_f32 v99, v70, v71
    v_cvt_pk_bf16_f32 v100, v72, v73
    v_cvt_pk_bf16_f32 v101, v74, v75
    v_cvt_pk_bf16_f32 v102, v76, v77
    v_cvt_pk_bf16_f32 v103, v78, v79
    v_cvt_pk_bf16_f32 v104, v80, v81
    v_cvt_pk_bf16_f32 v105, v82, v83
    v_cvt_pk_bf16_f32 v106, v84, v85
    v_cvt_pk_bf16_f32 v107, v86, v87
    v_cvt_pk_bf16_f32 v108, v88, v89
    v_cvt_pk_bf16_f32 v109, v90, v91
    v_cvt_pk_bf16_f32 v110, v92, v93
    v_cvt_pk_bf16_f32 v111, v94, v95
    ds_write_b128 v232, v[96:99] offset:0
    ds_write_b128 v232, v[100:103] offset:1024
    ds_write_b128 v232, v[104:107] offset:2048
    ds_write_b128 v232, v[108:111] offset:3072
    s_branch Lcd_28
Lcw_27:
    ds_write_b128 v232, v[64:67] offset:0
    ds_write_b128 v232, v[68:71] offset:1024
    ds_write_b128 v232, v[72:75] offset:2048
    ds_write_b128 v232, v[76:79] offset:3072
    ds_write_b128 v232, v[80:83] offset:4096
    ds_write_b128 v232, v[84:87] offset:5120
    ds_write_b128 v232, v[88:91] offset:6144
    ds_write_b128 v232, v[92:95] offset:7168
Lcd_28:
    s_mul_i32 s85, s38, 4128
    s_add_u32 s85, s85, 65536
    s_lshl_b32 s86, s38, 9
    s_add_u32 s86, s86, 65536
    s_lshl_b32 s87, s38, 10
    s_add_u32 s88, s87, 86144
    s_add_u32 s87, s87, 82048
    s_and_b32 s41, s2, 7
    s_sub_u32 s42, s2, 32
    s_lshr_b32 s42, s42, 3
    s_mul_i32 s43, s42, 37
    s_lshr_b32 s43, s43, 8
    s_mul_i32 s44, s43, 7
    s_sub_u32 s44, s42, s44
    s_lshr_b32 s39, s41, 2
    s_lshl_b32 s39, s39, 2
    s_add_u32 s39, s39, s43
    s_and_b32 s40, s41, 3
    s_mul_i32 s40, s40, 7
    s_add_u32 s40, s40, s44
    s_lshl_b32 s41, s39, 19
    s_lshl_b32 s42, s38, 14
    s_add_u32 s24, s41, s42
    s_add_u32 s25, s24, 65536
    s_add_u32 s26, s24, 131072
    s_add_u32 s27, s24, 196608
    s_add_u32 s28, s24, 262144
    s_add_u32 s29, s24, 327680
    s_add_u32 s30, s24, 393216
    s_add_u32 s31, s24, 458752
    s_lshl_b32 s36, s38, 10
    s_and_b32 s41, s38, 1
    s_lshl_b32 s41, s41, 1
    s_lshr_b32 s42, s38, 1
    s_add_u32 s41, s41, s42
    s_lshl_b32 s37, s41, 10
    s_add_u32 s37, s37, 98304
    s_mul_i32 s41, s41, 28672
    s_lshl_b32 s42, s40, 8
    s_add_u32 s32, s41, s42
    s_add_u32 s33, s32, 114688
    s_add_u32 s34, s32, 229376
    s_add_u32 s35, s32, 344064
    s_and_b32 s41, s38, 1
    v_lshrrev_b32 v16, 4, v11
    s_lshl_b32 s41, s41, 2
    v_add_u32 v16, s41, v16
    v_and_b32 v17, 7, v11
    v_xor_b32 v16, v16, v17
    v_lshlrev_b32 v16, 4, v16
    v_lshrrev_b32 v17, 3, v11
    v_lshl_add_u32 v8, v17, 11, v16
    v_lshrrev_b32 v16, 4, v11
    v_or_b32 v17, s41, v16
    v_lshlrev_b32 v17, 1, v17
    v_and_b32 v18, 15, v11
    v_xor_b32 v17, v17, v18
    v_mul_u32_u24 v16, 7168, v16
    v_lshlrev_b32 v17, 4, v17
    v_add_u32 v9, v16, v17
    s_mov_b32 s12, s52
    s_mov_b32 s13, s53
    s_mov_b32 s14, 0x700000
    s_mov_b32 s15, 0x20000
    s_add_u32 m0, s37, 0
    v_and_b32 v179, 7, v11
    buffer_load_dwordx4 v9, s[12:15], s32 offen lds
    s_add_u32 m0, s37, 4096
    v_mul_u32_u24 v179, 2064, v179
    v_lshrrev_b32 v180, 4, v11
    v_bfe_u32 v176, v11, 2, 2
    v_lshrrev_b32 v177, 5, v11
    v_lshl_add_u32 v34, v180, 4, v179
    v_lshl_add_u32 v176, v177, 2, v176
    buffer_load_dwordx4 v9, s[12:15], s33 offen lds
    s_add_u32 m0, s37, 8192
    v_and_b32 v179, 15, v11
    v_bfe_u32 v178, v11, 4, 1
    v_lshlrev_b32 v176, 6, v176
    v_cmp_eq_u32 vcc, 1, v179
    v_lshl_add_u32 v176, v178, 5, v176
    v_min_u32 v179, 1, v179
    s_mov_b32 s84, 147456
    buffer_load_dwordx4 v9, s[12:15], s34 offen lds
    s_add_u32 m0, s37, 12288
    v_and_b32 v178, 3, v11
    v_mov_b32 v181, 0xbf803f80
    v_lshlrev_b32 v179, 9, v179
    v_add_u32 v32, s84, v10
    v_lshl_add_u32 v176, v178, 3, v176
    v_lshl_add_u32 v179, v180, 4, v179
    s_mov_b32 s84, 90240
    buffer_load_dwordx4 v9, s[12:15], s35 offen lds
    s_add_u32 m0, s36, 0
    v_cndmask_b32 v40, 0, v181, vcc
    v_add_u32 v39, s84, v10
    v_add_u32 v33, s85, v176
    v_add_u32 v34, s86, v34
    v_mov_b32 v41, v40
    v_mov_b32 v42, v40
    v_mov_b32 v43, v40
    buffer_load_dwordx4 v8, s[8:11], s24 offen lds
    s_add_u32 m0, s36, 4096
    v_add_u32 v35, s88, v179
    v_add_u32 v38, s87, v10
    s_mov_b32 s16, s54
    s_mov_b32 s17, s55
    s_mov_b32 s18, 0x700000
    s_mov_b32 s19, 0x20000
    buffer_load_dwordx4 v8, s[8:11], s25 offen lds
    s_add_u32 m0, s36, 8192
    s_nop 0
    buffer_load_dwordx4 v8, s[8:11], s26 offen lds
    s_add_u32 m0, s36, 12288
    s_nop 0
    buffer_load_dwordx4 v8, s[8:11], s27 offen lds
    s_nop 1
    s_getpc_b64 s[42:43]
Lpc_30:
    s_lshr_b32 s44, s2, 3
    s_lshl_b32 s44, s44, 12
    v_lshl_add_u32 v28, v0, 4, s44
    v_min_u32 v28, Lcode_end-gated_mix__spectral_gfnet__swiglu_ffn__prompt_kernel-4, v28
    s_sub_u32 s42, s42, Lpc_30-gated_mix__spectral_gfnet__swiglu_ffn__prompt_kernel
    s_subb_u32 s43, s43, 0
    v_mov_b32 v29, s43
    v_add_co_u32 v28, vcc, s42, v28
    s_nop 1
    v_addc_co_u32 v29, vcc, 0, v29, vcc
    global_load_dword v1, v[28:29], off
    s_waitcnt vmcnt(9) lgkmcnt(0)
    s_barrier
    s_mov_b32 s72, s82
    s_mov_b32 s73, s83
    s_mov_b32 s74, 0x100
    s_mov_b32 s75, 0x20000
    ds_read_b64_tr_b16 a[224:225], v33 offset:0
    ds_read_b64_tr_b16 a[226:227], v33 offset:512
    ds_read_b64_tr_b16 a[232:233], v33 offset:2064
    ds_read_b64_tr_b16 a[234:235], v33 offset:2576
    ds_read_b64_tr_b16 a[228:229], v33 offset:1024
    ds_read_b64_tr_b16 a[230:231], v33 offset:1536
    ds_read_b64_tr_b16 a[236:237], v33 offset:3088
    ds_read_b64_tr_b16 a[238:239], v33 offset:3600
    ds_read_b128 a[192:195], v32 offset:0
    ds_read_b128 a[200:203], v32 offset:2048
    ds_read_b128 a[196:199], v32 offset:1024
    ds_read_b128 a[204:207], v32 offset:3072
    s_add_u32 m0, s36, 16384
    ds_read_b128 v[160:163], v34 offset:0
    buffer_load_dwordx4 v8, s[8:11], s28 offen lds
    s_add_u32 m0, s36, 20480
    ds_read_b128 v[224:227], v35 offset:0
    ds_read_b128 v[164:167], v34 offset:64
    ds_read_b128 v[228:231], v35 offset:64
    ds_read_b128 v[168:171], v34 offset:128
    ds_read_b128 v[232:235], v35 offset:128
    ds_read_b128 v[172:175], v34 offset:192
    ds_read_b128 v[236:239], v35 offset:192
    ds_read_b128 v[176:179], v34 offset:256
    ds_read_b128 v[240:243], v35 offset:256
    ds_read_b128 v[180:183], v34 offset:320
    ds_read_b128 v[244:247], v35 offset:320
    ds_read_b128 v[184:187], v34 offset:384
    ds_read_b128 v[248:251], v35 offset:384
    ds_read_b128 v[188:191], v34 offset:448
    s_waitcnt lgkmcnt(15)
    v_mfma_f32_32x32x16_bf16 v[96:111], a[224:227], a[192:195], 0
    buffer_load_dwordx4 v8, s[8:11], s29 offen lds
    s_add_u32 m0, s36, 24576
    ds_read_b128 v[252:255], v35 offset:448
    v_bfe_u32 v214, v11, 2, 2
    v_bfe_u32 v23, v11, 2, 1
    s_waitcnt lgkmcnt(15)
    v_mfma_f32_16x16x32_bf16 a[132:135], v[160:163], v[40:43], 0
    v_and_b32 v22, 3, v11
    v_mul_u32_u24 v214, 2064, v214
    s_waitcnt lgkmcnt(14)
    v_mfma_f32_16x16x32_bf16 a[128:131], v[160:163], v[224:227], 0
    v_lshl_add_u32 v22, v23, 5, v22
    s_waitcnt lgkmcnt(12)
    v_mfma_f32_16x16x32_bf16 a[128:131], v[164:167], v[228:231], a[128:131]
    v_lshrrev_b32 v209, 5, v11
    v_lshl_add_u32 v214, v209, 6, v214
    v_mfma_f32_16x16x32_bf16 a[132:135], v[164:167], v[40:43], a[132:135]
    v_mul_u32_u24 v12, 8208, v22
    s_waitcnt lgkmcnt(10)
    v_mfma_f32_16x16x32_bf16 a[128:131], v[168:171], v[232:235], a[128:131]
    buffer_load_dwordx4 v8, s[8:11], s30 offen lds
    v_mfma_f32_16x16x32_bf16 a[132:135], v[168:171], v[40:43], a[132:135]
    s_add_u32 m0, s36, 28672
    v_and_b32 v215, 1, v11
    s_waitcnt lgkmcnt(8)
    v_mfma_f32_16x16x32_bf16 a[128:131], v[172:175], v[236:239], a[128:131]
    v_lshrrev_b32 v23, 3, v11
    v_lshl_add_u32 v214, v215, 3, v214
    v_mfma_f32_16x16x32_bf16 a[132:135], v[172:175], v[40:43], a[132:135]
    v_lshl_add_u32 v12, v23, 4, v12
    s_waitcnt lgkmcnt(6)
    v_mfma_f32_16x16x32_bf16 a[128:131], v[176:179], v[240:243], a[128:131]
    v_bfe_u32 v215, v11, 4, 1
    v_mfma_f32_16x16x32_bf16 a[132:135], v[176:179], v[40:43], a[132:135]
    v_bfe_u32 v216, v11, 1, 1
    s_waitcnt lgkmcnt(4)
    v_mfma_f32_16x16x32_bf16 a[128:131], v[180:183], v[244:247], a[128:131]
    buffer_load_dwordx4 v8, s[8:11], s31 offen lds
    v_mfma_f32_16x16x32_bf16 a[132:135], v[180:183], v[40:43], a[132:135]
    s_add_u32 s8, s8, 128
    s_addc_u32 s9, s9, 0
    v_mfma_f32_32x32x16_bf16 v[112:127], a[224:227], a[200:203], 0
    s_sub_u32 s10, s10, 128
    s_add_u32 m0, s37, 16384
    v_bfe_u32 v210, v11, 1, 2
    v_lshl_add_u32 v215, v215, 1, v216
    v_xor_b32 v210, v210, v209
    v_mfma_f32_32x32x16_bf16 v[128:143], a[232:235], a[192:195], 0
    v_bfe_u32 v216, v11, 3, 2
    v_and_b32 v208, 31, v11
    v_lshlrev_b32 v210, 4, v210
    v_mul_u32_u24 v217, 131456, v209
    v_lshl_add_u32 v208, v208, 6, v210
    v_mfma_f32_32x32x16_bf16 v[144:159], a[232:235], a[200:203], 0
    buffer_load_dwordx4 v9, s[16:19], s32 offen lds
    s_add_u32 s32, s32, 458752
    s_add_u32 m0, s37, 20480
    v_lshlrev_b32 v216, 10, v216
    v_and_b32 v13, 7, v11
    s_waitcnt lgkmcnt(2)
    v_mfma_f32_16x16x32_bf16 a[128:131], v[184:187], v[248:251], a[128:131]
    v_add_u32 v216, v216, v217
    v_mul_u32_u24 v23, 68608, v23
    v_mfma_f32_16x16x32_bf16 a[132:135], v[184:187], v[40:43], a[132:135]
    v_add_u32 v36, s85, v208
    v_lshlrev_b32 v13, 4, v13
    s_waitcnt lgkmcnt(0)
    v_mfma_f32_16x16x32_bf16 a[128:131], v[188:191], v[252:255], a[128:131]
    v_add_u32 v214, s86, v214
    v_xor_b32 v218, 0, v215
    v_mfma_f32_16x16x32_bf16 a[132:135], v[188:191], v[40:43], a[132:135]
    v_xor_b32 v219, 1, v215
    v_xor_b32 v220, 2, v215
    v_mfma_f32_32x32x16_bf16 v[96:111], a[228:231], a[196:199], v[96:111]
    buffer_load_dwordx4 v9, s[16:19], s33 offen lds
    s_add_u32 s33, s33, 458752
    s_add_u32 m0, s37, 24576
    v_xor_b32 v221, 3, v215
    v_and_b32 v217, 7, v11
    v_mfma_f32_32x32x16_bf16 v[112:127], a[228:231], a[204:207], v[112:127]
    v_xor_b32 v208, 32, v208
    v_add_u32 v13, v13, v23
    ds_read_b128 v[64:67], v32 offset:8192
    ds_read_b128 v[68:71], v32 offset:9216
    ds_read_b128 v[72:75], v32 offset:10240
    v_mfma_f32_32x32x16_bf16 v[128:143], a[236:239], a[196:199], v[128:143]
    ds_read_b128 v[76:79], v32 offset:11264
    ds_read_b128 v[80:83], v32 offset:12288
    ds_read_b128 v[84:87], v32 offset:13312
    ds_read_b128 v[88:91], v32 offset:14336
    ds_read_b128 v[92:95], v32 offset:15360
    v_mfma_f32_32x32x16_bf16 v[144:159], a[236:239], a[204:207], v[144:159]
    buffer_load_dwordx4 v9, s[16:19], s34 offen lds
    s_add_u32 s34, s34, 458752
    s_add_u32 m0, s37, 28672
    v_lshl_add_u32 v44, v218, 4, v214
    v_lshl_add_u32 v45, v219, 4, v214
    v_lshl_add_u32 v46, v220, 4, v214
    v_lshl_add_u32 v47, v221, 4, v214
    v_lshl_add_u32 v48, v217, 4, v216
    v_add_u32 v37, s85, v208
    s_mov_b32 s60, s92
    s_mov_b32 s61, s93
    s_mov_b32 s62, 0x201000
    s_mov_b32 s63, 0x20000
    s_mov_b32 s76, s94
    s_mov_b32 s77, s95
    s_mov_b32 s78, 0x201000
    s_mov_b32 s79, 0x20000
    s_mov_b32 s52, 65664
    s_mov_b32 s53, 131328
    s_mov_b32 s54, 196992
    s_mov_b32 s55, 0x05040100
    buffer_load_dwordx4 v9, s[16:19], s35 offen lds
    s_add_u32 s35, s35, 458752
    s_lshr_b32 s89, s2, 3
    s_lshl_b32 s89, s89, 12
    s_and_b32 s90, s2, 7
    s_lshl_b32 s90, s90, 7
    s_add_u32 s89, s89, s90
    s_mul_i32 s90, s38, 1051648
    s_add_u32 s89, s89, s90
    s_add_u32 s89, s89, 33554432
    s_lshl_b32 s41, s2, 1
    s_and_b32 s42, s38, 1
    s_add_u32 s41, s41, s42
    s_cmp_lt_u32 s38, 2
    s_cselect_b32 s46, 0x40000000, 0
    s_and_b32 s42, s41, 7
    s_lshr_b32 s41, s41, 3
    s_and_b32 s43, s41, 7
    s_lshr_b32 s41, s41, 3
    s_lshr_b32 s44, s41, 2
    s_lshl_b32 s44, s44, 5
    s_and_b32 s45, s41, 3
    s_lshl_b32 s45, s45, 9
    s_add_u32 s44, s44, s45
    s_mul_i32 s44, s44, 1026
    s_lshl_b32 s45, s43, 10
    s_add_u32 s44, s44, s45
    s_lshl_b32 s45, s42, 7
    s_add_u32 s44, s44, s45
    s_add_u32 s44, s44, s46
    v_add_u32 v12, s44, v12
    s_mul_i32 s44, s42, 548864
    s_mul_i32 s45, s43, 8448
    s_sub_u32 s44, s44, s45
    s_lshl_b32 s45, s41, 10
    s_add_u32 s44, s44, s45
    s_add_u32 s44, s44, 42142720
    s_add_u32 s44, s44, s46
    v_add_u32 v13, s44, v13
    s_mov_b32 s56, 0x07060302
    s_nop 1
    s_waitcnt lgkmcnt(0)
    s_barrier
    ds_read_b128 a[208:211], v32 offset:4096
    ds_read_b128 a[212:215], v32 offset:5120
    ds_read_b128 a[216:219], v32 offset:6144
    ds_read_b128 a[220:223], v32 offset:7168
    buffer_load_dwordx2 v[14:15], off, s[72:75], 0 sc1
    s_add_u32 m0, s36, 32768
    v_pk_mul_f32 v[192:193], v[112:113], v[80:81]
    v_pk_mul_f32 v[194:195], v[114:115], v[82:83]
    v_pk_mul_f32 v[196:197], v[116:117], v[84:85]
    v_pk_mul_f32 v[198:199], v[118:119], v[86:87]
    v_pk_mul_f32 v[200:201], v[120:121], v[88:89]
    v_pk_mul_f32 v[202:203], v[122:123], v[90:91]
    v_pk_mul_f32 v[204:205], v[124:125], v[92:93]
    v_pk_mul_f32 v[206:207], v[126:127], v[94:95]
    v_pk_mul_f32 v[208:209], v[144:145], v[80:81]
    v_pk_mul_f32 v[210:211], v[146:147], v[82:83]
    v_pk_mul_f32 v[212:213], v[148:149], v[84:85]
    v_pk_mul_f32 v[214:215], v[150:151], v[86:87]
    v_pk_mul_f32 v[216:217], v[152:153], v[88:89]
    v_pk_mul_f32 v[218:219], v[154:155], v[90:91]
    v_pk_mul_f32 v[220:221], v[156:157], v[92:93]
    v_pk_mul_f32 v[222:223], v[158:159], v[94:95]
    buffer_load_dwordx4 v8, s[8:11], s24 offen lds
    s_add_u32 m0, s36, 36864
    v_pk_mul_f32 v[112:113], v[112:113], v[64:65]
    v_pk_fma_f32 v[192:193], v[96:97], v[64:65], v[192:193] neg_lo:[0,0,1] neg_hi:[0,0,1]
    v_pk_mul_f32 v[114:115], v[114:115], v[66:67]
    v_pk_fma_f32 v[194:195], v[98:99], v[66:67], v[194:195] neg_lo:[0,0,1] neg_hi:[0,0,1]
    v_pk_mul_f32 v[116:117], v[116:117], v[68:69]
    v_pk_fma_f32 v[196:197], v[100:101], v[68:69], v[196:197] neg_lo:[0,0,1] neg_hi:[0,0,1]
    v_pk_mul_f32 v[118:119], v[118:119], v[70:71]
    v_pk_fma_f32 v[198:199], v[102:103], v[70:71], v[198:199] neg_lo:[0,0,1] neg_hi:[0,0,1]
    v_pk_mul_f32 v[120:121], v[120:121], v[72:73]
    v_pk_mul_f32 v[122:123], v[122:123], v[74:75]
    v_pk_mul_f32 v[124:125], v[124:125], v[76:77]
    v_pk_mul_f32 v[126:127], v[126:127], v[78:79]
    v_pk_mul_f32 v[144:145], v[144:145], v[64:65]
    v_pk_fma_f32 v[208:209], v[128:129], v[64:65], v[208:209] neg_lo:[0,0,1] neg_hi:[0,0,1]
    v_pk_mul_f32 v[146:147], v[146:147], v[66:67]
    v_pk_fma_f32 v[210:211], v[130:131], v[66:67], v[210:211] neg_lo:[0,0,1] neg_hi:[0,0,1]
    buffer_load_dwordx4 v8, s[8:11], s25 offen lds
    s_add_u32 m0, s36, 40960
    v_pk_mul_f32 v[148:149], v[148:149], v[68:69]
    v_pk_fma_f32 v[212:213], v[132:133], v[68:69], v[212:213] neg_lo:[0,0,1] neg_hi:[0,0,1]
    v_pk_mul_f32 v[150:151], v[150:151], v[70:71]
    v_pk_fma_f32 v[214:215], v[134:135], v[70:71], v[214:215] neg_lo:[0,0,1] neg_hi:[0,0,1]
    v_pk_mul_f32 v[152:153], v[152:153], v[72:73]
    v_pk_mul_f32 v[154:155], v[154:155], v[74:75]
    v_pk_mul_f32 v[156:157], v[156:157], v[76:77]
    v_pk_mul_f32 v[158:159], v[158:159], v[78:79]
    v_pk_fma_f32 v[112:113], v[96:97], v[80:81], v[112:113]
    v_pk_fma_f32 v[114:115], v[98:99], v[82:83], v[114:115]
    v_pk_fma_f32 v[116:117], v[100:101], v[84:85], v[116:117]
    v_pk_fma_f32 v[118:119], v[102:103], v[86:87], v[118:119]
    v_pk_fma_f32 v[200:201], v[104:105], v[72:73], v[200:201] neg_lo:[0,0,1] neg_hi:[0,0,1]
    v_pk_fma_f32 v[120:121], v[104:105], v[88:89], v[120:121]
    v_pk_fma_f32 v[202:203], v[106:107], v[74:75], v[202:203] neg_lo:[0,0,1] neg_hi:[0,0,1]
    v_pk_fma_f32 v[122:123], v[106:107], v[90:91], v[122:123]
    buffer_load_dwordx4 v8, s[8:11], s26 offen lds
    s_add_u32 m0, s36, 45056
    v_pk_fma_f32 v[204:205], v[108:109], v[76:77], v[204:205] neg_lo:[0,0,1] neg_hi:[0,0,1]
    v_pk_fma_f32 v[124:125], v[108:109], v[92:93], v[124:125]
    v_pk_fma_f32 v[206:207], v[110:111], v[78:79], v[206:207] neg_lo:[0,0,1] neg_hi:[0,0,1]
    v_pk_fma_f32 v[126:127], v[110:111], v[94:95], v[126:127]
    v_pk_fma_f32 v[144:145], v[128:129], v[80:81], v[144:145]
    v_pk_fma_f32 v[146:147], v[130:131], v[82:83], v[146:147]
    v_pk_fma_f32 v[148:149], v[132:133], v[84:85], v[148:149]
    v_pk_fma_f32 v[150:151], v[134:135], v[86:87], v[150:151]
    v_pk_fma_f32 v[216:217], v[136:137], v[72:73], v[216:217] neg_lo:[0,0,1] neg_hi:[0,0,1]
    v_pk_fma_f32 v[152:153], v[136:137], v[88:89], v[152:153]
    v_pk_fma_f32 v[218:219], v[138:139], v[74:75], v[218:219] neg_lo:[0,0,1] neg_hi:[0,0,1]
    v_pk_fma_f32 v[154:155], v[138:139], v[90:91], v[154:155]
    v_pk_fma_f32 v[220:221], v[140:141], v[76:77], v[220:221] neg_lo:[0,0,1] neg_hi:[0,0,1]
    v_pk_fma_f32 v[156:157], v[140:141], v[92:93], v[156:157]
    v_pk_fma_f32 v[222:223], v[142:143], v[78:79], v[222:223] neg_lo:[0,0,1] neg_hi:[0,0,1]
    v_pk_fma_f32 v[158:159], v[142:143], v[94:95], v[158:159]
    buffer_load_dwordx4 v8, s[8:11], s27 offen lds
    v_cvt_pk_bf16_f32 v160, v192, v193
    v_cvt_pk_bf16_f32 v161, v194, v195
    v_cvt_pk_bf16_f32 v162, v196, v197
    v_cvt_pk_bf16_f32 v163, v198, v199
    v_cvt_pk_bf16_f32 v176, v208, v209
    v_cvt_pk_bf16_f32 v177, v210, v211
    s_waitcnt lgkmcnt(3)
    v_mfma_f32_32x32x16_bf16 v[96:111], a[208:211], v[160:163], 0
    v_cvt_pk_bf16_f32 v178, v212, v213
    v_cvt_pk_bf16_f32 v179, v214, v215
    s_add_u32 m0, s36, 49152
    v_cvt_pk_bf16_f32 v164, v200, v201
    v_cvt_pk_bf16_f32 v165, v202, v203
    v_mfma_f32_32x32x16_bf16 v[128:143], a[208:211], v[176:179], 0
    v_cvt_pk_bf16_f32 v166, v204, v205
    v_cvt_pk_bf16_f32 v167, v206, v207
    v_cvt_pk_bf16_f32 v180, v216, v217
    buffer_load_dwordx4 v8, s[8:11], s28 offen lds
    s_add_u32 m0, s36, 53248
    s_waitcnt lgkmcnt(2)
    v_mfma_f32_32x32x16_bf16 v[96:111], a[212:215], v[164:167], v[96:111]
    v_cvt_pk_bf16_f32 v181, v218, v219
    v_cvt_pk_bf16_f32 v182, v220, v221
    v_cvt_pk_bf16_f32 v183, v222, v223
    v_and_b32 v16, 15, v11
    v_lshrrev_b32 v17, 1, v16
    v_mfma_f32_32x32x16_bf16 v[128:143], a[212:215], v[180:183], v[128:143]
    v_lshrrev_b32 v18, 4, v11
    v_xor_b32 v17, v17, v18
    v_lshlrev_b32 v17, 4, v17
    v_lshl_add_u32 v17, v16, 7, v17
    v_cvt_pk_bf16_f32 v168, v112, v113
    v_cvt_pk_bf16_f32 v169, v114, v115
    v_cvt_pk_bf16_f32 v170, v116, v117
    v_cvt_pk_bf16_f32 v171, v118, v119
    v_cvt_pk_bf16_f32 v184, v144, v145
    buffer_load_dwordx4 v8, s[8:11], s29 offen lds
    s_waitcnt lgkmcnt(1)
    v_mfma_f32_32x32x16_bf16 v[96:111], a[216:219], v[168:171], v[96:111]
    s_add_u32 m0, s36, 57344
    v_cvt_pk_bf16_f32 v185, v146, v147
    v_cvt_pk_bf16_f32 v186, v148, v149
    v_cvt_pk_bf16_f32 v187, v150, v151
    v_cvt_pk_bf16_f32 v172, v120, v121
    v_cvt_pk_bf16_f32 v173, v122, v123
    v_mfma_f32_32x32x16_bf16 v[128:143], a[216:219], v[184:187], v[128:143]
    v_cvt_pk_bf16_f32 v174, v124, v125
    v_cvt_pk_bf16_f32 v175, v126, v127
    v_cvt_pk_bf16_f32 v188, v152, v153
    v_cvt_pk_bf16_f32 v189, v154, v155
    v_cvt_pk_bf16_f32 v190, v156, v157
    s_waitcnt lgkmcnt(0)
    v_mfma_f32_32x32x16_bf16 v[96:111], a[220:223], v[172:175], v[96:111]
    v_cvt_pk_bf16_f32 v191, v158, v159
    buffer_load_dwordx4 v8, s[8:11], s30 offen lds
    s_add_u32 m0, s36, 61440
    v_and_b32 v20, 3, v11
    s_mov_b32 s84, 82048
    v_mfma_f32_32x32x16_bf16 v[128:143], a[220:223], v[188:191], v[128:143]
    v_accvgpr_read_b32 v224, a128
    v_accvgpr_read_b32 v228, a132
    v_accvgpr_read_b32 v225, a129
    v_accvgpr_read_b32 v229, a133
    v_accvgpr_read_b32 v226, a130
    v_accvgpr_read_b32 v230, a134
    v_accvgpr_read_b32 v227, a131
    v_accvgpr_read_b32 v231, a135
    v_add_u32 v34, s84, v10
    v_cvt_pk_bf16_f32 v192, v96, v97
    v_cvt_pk_bf16_f32 v193, v98, v99
    v_cvt_pk_bf16_f32 v194, v100, v101
    v_cvt_pk_bf16_f32 v195, v102, v103
    buffer_load_dwordx4 v8, s[8:11], s31 offen lds
    ds_write_b128 v36, v[192:195] offset:0
    s_add_u32 s8, s8, 128
    s_addc_u32 s9, s9, 0
    s_sub_u32 s10, s10, 128
    s_lshr_b32 s41, s38, 1
    s_lshl_b32 s41, s41, 14
    v_add_u32 v2, s41, v17
    v_lshrrev_b32 v17, 2, v16
    v_lshl_add_u32 v19, v18, 3, v17
    v_and_b32 v18, 1, v18
    s_and_b32 s41, s38, 1
    v_lshl_or_b32 v17, v18, 2, v17
    s_lshl_b32 s41, s41, 2
    v_xor_b32 v17, s41, v17
    s_lshr_b32 s41, s38, 1
    s_lshl_b32 s41, s41, 2
    s_lshl_b32 s42, s39, 3
    s_add_u32 s41, s41, s42
    s_and_b32 s42, s38, 1
    s_mul_i32 s41, s41, 112
    s_lshl_b32 s42, s42, 1
    s_add_u32 s41, s41, s42
    v_lshlrev_b32 v19, 8, v19
    s_lshl_b32 s42, s40, 2
    v_lshl_add_u32 v19, v20, 3, v19
    s_add_u32 s41, s41, s42
    v_add_u32 v19, 98304, v19
    v_xor_b32 v18, 0, v17
    s_lshl_b32 s50, s41, 11
    v_lshl_add_u32 v4, v18, 5, v19
    s_cmp_eq_u32 s38, 0
    s_cselect_b32 s94, 0, 0x40000000
    v_xor_b32 v18, 1, v17
    s_lshl_b32 s95, s2, 4
    v_lshl_add_u32 v5, v18, 5, v19
    s_add_u32 s95, s95, s94
    v_xor_b32 v18, 2, v17
    s_add_u32 s95, s95, 47316992
    v_lshl_add_u32 v6, v18, 5, v19
    s_add_u32 s94, s94, 29360128
    v_cvt_pk_bf16_f32 v196, v104, v105
    v_cvt_pk_bf16_f32 v197, v106, v107
    v_cvt_pk_bf16_f32 v198, v108, v109
    v_cvt_pk_bf16_f32 v199, v110, v111
    ds_write_b128 v37, v[196:199] offset:0
    v_cvt_pk_bf16_f32 v208, v128, v129
    v_cvt_pk_bf16_f32 v209, v130, v131
    v_cvt_pk_bf16_f32 v210, v132, v133
    v_cvt_pk_bf16_f32 v211, v134, v135
    ds_write_b128 v36, v[208:211] offset:2064
    v_cvt_pk_bf16_f32 v212, v136, v137
    v_cvt_pk_bf16_f32 v213, v138, v139
    v_cvt_pk_bf16_f32 v214, v140, v141
    v_cvt_pk_bf16_f32 v215, v142, v143
    ds_write_b128 v37, v[212:215] offset:2064
    v_add_f32 v224, v224, v228
    v_add_f32 v225, v225, v229
    v_add_f32 v226, v226, v230
    v_add_f32 v227, v227, v231
    ds_write_b128 v38, v[224:227]
    v_xor_b32 v3, 64, v2
    v_xor_b32 v18, 3, v17
    s_lshl_b32 s84, s2, 6
    v_add_u32 v60, 0x10000, v2
    v_add_u32 v61, 0x10000, v3
    v_lshl_add_u32 v7, v18, 5, v19
    s_mov_b32 s20, s6
    s_mov_b32 s21, s7
    s_mov_b32 s22, 0xe00000
    s_mov_b32 s23, 0x20000
    s_mov_b32 s68, s6
    s_mov_b32 s69, s7
    s_mov_b32 s70, 0x3000000
    s_mov_b32 s71, 0x20000
    s_mov_b32 s48, 0xbfb8aa3b
    s_mov_b32 s49, 0xbfb8aa3b
    s_add_u32 s94, s94, s84
    s_nop 1
    s_waitcnt lgkmcnt(0)
    s_barrier
    ds_read_b64_tr_b16 v[160:161], v44 offset:0
    ds_read_b64_tr_b16 v[162:163], v44 offset:8256
    ds_read_b64_tr_b16 v[164:165], v45 offset:128
    ds_read_b64_tr_b16 v[166:167], v45 offset:8384
    ds_read_b64_tr_b16 v[168:169], v46 offset:256
    ds_read_b64_tr_b16 v[170:171], v46 offset:8512
    ds_read_b64_tr_b16 v[172:173], v47 offset:384
    ds_read_b64_tr_b16 v[174:175], v47 offset:8640
    ds_read_b128 v[16:19], v34 offset:0
    ds_read_b128 v[20:23], v34 offset:1024
    ds_read_b128 v[24:27], v34 offset:2048
    ds_read_b128 v[28:31], v34 offset:3072
    s_add_u32 s90, s89, 0
    s_waitcnt lgkmcnt(10)
    buffer_store_dwordx4 v[160:163], v48, s[68:71], s90 offen sc1
    s_add_u32 s90, s89, 262912
    s_waitcnt lgkmcnt(8)
    buffer_store_dwordx4 v[164:167], v48, s[68:71], s90 offen sc1
    s_add_u32 s90, s89, 525824
    s_waitcnt lgkmcnt(6)
    buffer_store_dwordx4 v[168:171], v48, s[68:71], s90 offen sc1
    s_add_u32 s90, s89, 788736
    s_waitcnt lgkmcnt(4)
    buffer_store_dwordx4 v[172:175], v48, s[68:71], s90 offen sc1
    ds_read_b128 a[208:211], v32 offset:8192
    ds_read_b128 a[212:215], v32 offset:9216
    ds_read_b128 a[216:219], v32 offset:10240
    ds_read_b128 a[220:223], v32 offset:11264
    ds_read_b128 a[224:227], v32 offset:12288
    ds_read_b128 a[228:231], v32 offset:13312
    ds_read_b128 a[232:235], v32 offset:14336
    ds_read_b128 a[236:239], v32 offset:15360
    ds_read_b128 a[240:243], v39 offset:0
    ds_read_b128 a[244:247], v39 offset:1024
    ds_read_b128 a[248:251], v39 offset:2048
    ds_read_b128 a[252:255], v39 offset:3072
    s_add_u32 m0, s37, 32768
    s_nop 0
    buffer_load_dwordx4 v9, s[12:15], s32 offen lds
    s_add_u32 m0, s37, 36864
    s_nop 0
    buffer_load_dwordx4 v9, s[12:15], s33 offen lds
    s_add_u32 m0, s37, 40960
    s_nop 0
    buffer_load_dwordx4 v9, s[12:15], s34 offen lds
    s_add_u32 m0, s37, 45056
    s_nop 0
    buffer_load_dwordx4 v9, s[12:15], s35 offen lds
    s_waitcnt vmcnt(16)
    s_mov_b32 s41, 100000
Lbg_31:
    v_readfirstlane_b32 s42, v15
    v_readfirstlane_b32 s43, v14
    s_sub_u32 s41, s41, 1
    s_cbranch_scc1 Lbd_32
    s_cmp_eq_u32 s42, 1
    s_cbranch_scc1 Lbd_32
    s_sleep 4
    buffer_load_dwordx2 v[14:15], off, s[72:75], 0 sc1
    s_waitcnt vmcnt(0)
    s_branch Lbg_31
Lbd_32:
    s_mov_b32 s3, s43
    s_load_dwordx2 s[82:83], s[0:1], 64
    s_add_u32 s43, s43, 1
    s_lshl_b32 s59, s2, 6
    s_add_u32 s59, s59, 47251456
    v_cmp_eq_u32 vcc, 0, v0
    v_mov_b32 v56, 0x7ffffff0
    v_mov_b32 v57, s43
    v_cndmask_b32 v56, v56, 0, vcc
    s_sub_u32 s51, s2, 32
    s_lshl_b32 s51, s51, 2
    s_add_u32 s51, s51, s38
    s_lshl_b32 s51, s51, 13
    v_lshlrev_b32 v58, 6, v11
    s_waitcnt lgkmcnt(0)
    s_barrier
    ds_read_b64_tr_b16 a[64:65], v4 offset:0
    ds_read_b64_tr_b16 a[66:67], v4 offset:1024
    ds_read_b64_tr_b16 a[68:69], v4 offset:8192
    ds_read_b64_tr_b16 a[70:71], v4 offset:9216
    ds_read_b128 a[0:3], v2 offset:0
    ds_read_b128 a[32:35], v3 offset:0
    ds_read_b128 a[4:7], v2 offset:2048
    ds_read_b128 a[36:39], v3 offset:2048
    ds_read_b128 a[8:11], v2 offset:4096
    ds_read_b128 a[40:43], v3 offset:4096
    ds_read_b128 a[12:15], v2 offset:6144
    ds_read_b128 a[44:47], v3 offset:6144
    ds_read_b128 a[16:19], v2 offset:8192
    ds_read_b128 a[48:51], v3 offset:8192
    ds_read_b128 a[20:23], v2 offset:10240
    ds_read_b128 a[52:55], v3 offset:10240
    ds_read_b128 a[24:27], v2 offset:12288
    ds_read_b128 a[56:59], v3 offset:12288
    ds_read_b128 a[28:31], v2 offset:14336
    ds_read_b128 a[60:63], v3 offset:14336
    ds_read_b64_tr_b16 a[72:73], v5 offset:0
    ds_read_b64_tr_b16 a[74:75], v5 offset:1024
    ds_read_b64_tr_b16 a[76:77], v5 offset:8192
    ds_read_b64_tr_b16 a[78:79], v5 offset:9216
    s_waitcnt lgkmcnt(15)
    v_mfma_f32_16x16x32_bf16 v[64:67], a[64:67], a[0:3], 0
    ds_read_b64_tr_b16 a[80:81], v6 offset:0
    v_mfma_f32_16x16x32_bf16 v[64:67], a[68:71], a[32:35], v[64:67]
    v_mfma_f32_16x16x32_bf16 v[68:71], a[64:67], a[4:7], 0
    ds_read_b64_tr_b16 a[82:83], v6 offset:1024
    v_mfma_f32_16x16x32_bf16 v[68:71], a[68:71], a[36:39], v[68:71]
    s_waitcnt lgkmcnt(14)
    v_mfma_f32_16x16x32_bf16 v[72:75], a[64:67], a[8:11], 0
    ds_read_b64_tr_b16 a[84:85], v6 offset:8192
    v_mfma_f32_16x16x32_bf16 v[72:75], a[68:71], a[40:43], v[72:75]
    v_mfma_f32_16x16x32_bf16 v[76:79], a[64:67], a[12:15], 0
    ds_read_b64_tr_b16 a[86:87], v6 offset:9216
    v_mfma_f32_16x16x32_bf16 v[76:79], a[68:71], a[44:47], v[76:79]
    s_waitcnt lgkmcnt(12)
    v_mfma_f32_16x16x32_bf16 v[80:83], a[64:67], a[16:19], 0
    v_mfma_f32_16x16x32_bf16 v[80:83], a[68:71], a[48:51], v[80:83]
    v_mfma_f32_16x16x32_bf16 v[84:87], a[64:67], a[20:23], 0
    v_mfma_f32_16x16x32_bf16 v[84:87], a[68:71], a[52:55], v[84:87]
    s_waitcnt lgkmcnt(8)
    v_mfma_f32_16x16x32_bf16 v[88:91], a[64:67], a[24:27], 0
    v_mfma_f32_16x16x32_bf16 v[88:91], a[68:71], a[56:59], v[88:91]
    v_mfma_f32_16x16x32_bf16 v[92:95], a[64:67], a[28:31], 0
    v_mfma_f32_16x16x32_bf16 v[92:95], a[68:71], a[60:63], v[92:95]
    s_waitcnt lgkmcnt(6)
    v_mfma_f32_16x16x32_bf16 v[96:99], a[72:75], a[0:3], 0
    ds_read_b64_tr_b16 a[88:89], v7 offset:0
    s_waitcnt lgkmcnt(5)
    v_mfma_f32_16x16x32_bf16 v[96:99], a[76:79], a[32:35], v[96:99]
    v_mfma_f32_16x16x32_bf16 v[100:103], a[72:75], a[4:7], 0
    ds_read_b64_tr_b16 a[90:91], v7 offset:1024
    v_mfma_f32_16x16x32_bf16 v[100:103], a[76:79], a[36:39], v[100:103]
    v_mfma_f32_16x16x32_bf16 v[104:107], a[72:75], a[8:11], 0
    ds_read_b64_tr_b16 a[92:93], v7 offset:8192
    v_mfma_f32_16x16x32_bf16 v[104:107], a[76:79], a[40:43], v[104:107]
    v_mfma_f32_16x16x32_bf16 v[108:111], a[72:75], a[12:15], 0
    ds_read_b64_tr_b16 a[94:95], v7 offset:9216
    v_mfma_f32_16x16x32_bf16 v[108:111], a[76:79], a[44:47], v[108:111]
    v_mfma_f32_16x16x32_bf16 v[112:115], a[72:75], a[16:19], 0
    v_mfma_f32_16x16x32_bf16 v[112:115], a[76:79], a[48:51], v[112:115]
    v_mfma_f32_16x16x32_bf16 v[116:119], a[72:75], a[20:23], 0
    v_mfma_f32_16x16x32_bf16 v[116:119], a[76:79], a[52:55], v[116:119]
    v_mfma_f32_16x16x32_bf16 v[120:123], a[72:75], a[24:27], 0
    v_mfma_f32_16x16x32_bf16 v[120:123], a[76:79], a[56:59], v[120:123]
    v_mfma_f32_16x16x32_bf16 v[124:127], a[72:75], a[28:31], 0
    v_mfma_f32_16x16x32_bf16 v[124:127], a[76:79], a[60:63], v[124:127]
    s_waitcnt vmcnt(17) lgkmcnt(0)
    s_barrier
    v_mfma_f32_16x16x32_bf16 v[128:131], a[80:83], a[0:3], 0
    ds_read_b64_tr_b16 a[64:65], v4 offset:16384
    v_mfma_f32_16x16x32_bf16 v[128:131], a[84:87], a[32:35], v[128:131]
    v_mfma_f32_16x16x32_bf16 v[132:135], a[80:83], a[4:7], 0
    ds_read_b64_tr_b16 a[66:67], v4 offset:17408
    v_add_f32 v16, v16, v20
    v_mfma_f32_16x16x32_bf16 v[132:135], a[84:87], a[36:39], v[132:135]
    v_add_f32 v24, v24, v28
    v_mfma_f32_16x16x32_bf16 v[136:139], a[80:83], a[8:11], 0
    ds_read_b64_tr_b16 a[68:69], v4 offset:24576
    s_add_u32 m0, s37, 49152
    v_mfma_f32_16x16x32_bf16 v[136:139], a[84:87], a[40:43], v[136:139]
    v_add_f32 v17, v17, v21
    buffer_load_dwordx4 v9, s[16:19], s32 offen lds
    v_mfma_f32_16x16x32_bf16 v[140:143], a[80:83], a[12:15], 0
    ds_read_b64_tr_b16 a[70:71], v4 offset:25600
    s_add_u32 s32, s32, 458752
    v_mfma_f32_16x16x32_bf16 v[140:143], a[84:87], a[44:47], v[140:143]
    v_add_f32 v25, v25, v29
    v_mfma_f32_16x16x32_bf16 v[144:147], a[80:83], a[16:19], 0
    v_add_f32 v18, v18, v22
    v_mfma_f32_16x16x32_bf16 v[144:147], a[84:87], a[48:51], v[144:147]
    s_add_u32 m0, s37, 53248
    v_mfma_f32_16x16x32_bf16 v[148:151], a[80:83], a[20:23], 0
    v_add_f32 v26, v26, v30
    buffer_load_dwordx4 v9, s[16:19], s33 offen lds
    v_mfma_f32_16x16x32_bf16 v[148:151], a[84:87], a[52:55], v[148:151]
    s_add_u32 s33, s33, 458752
    v_mfma_f32_16x16x32_bf16 v[152:155], a[80:83], a[24:27], 0
    v_add_f32 v19, v19, v23
    v_mfma_f32_16x16x32_bf16 v[152:155], a[84:87], a[56:59], v[152:155]
    s_add_u32 m0, s37, 57344
    v_mfma_f32_16x16x32_bf16 v[156:159], a[80:83], a[28:31], 0
    v_add_f32 v27, v27, v31
    buffer_load_dwordx4 v9, s[16:19], s34 offen lds
    v_mfma_f32_16x16x32_bf16 v[156:159], a[84:87], a[60:63], v[156:159]
    v_add_f32 v16, v16, v24
    s_add_u32 s34, s34, 458752
    v_mfma_f32_16x16x32_bf16 v[160:163], a[88:91], a[0:3], 0
    ds_read_b64_tr_b16 a[72:73], v5 offset:16384
    v_mfma_f32_16x16x32_bf16 v[160:163], a[92:95], a[32:35], v[160:163]
    v_add_f32 v17, v17, v25
    v_mfma_f32_16x16x32_bf16 v[164:167], a[88:91], a[4:7], 0
    ds_read_b64_tr_b16 a[74:75], v5 offset:17408
    v_mfma_f32_16x16x32_bf16 v[164:167], a[92:95], a[36:39], v[164:167]
    v_add_f32 v18, v18, v26
    v_mfma_f32_16x16x32_bf16 v[168:171], a[88:91], a[8:11], 0
    ds_read_b64_tr_b16 a[76:77], v5 offset:24576
    v_add_f32 v19, v19, v27
    s_add_u32 m0, s37, 61440
    v_mfma_f32_16x16x32_bf16 v[168:171], a[92:95], a[40:43], v[168:171]
    buffer_load_dwordx4 v9, s[16:19], s35 offen lds
    v_mfma_f32_16x16x32_bf16 v[172:175], a[88:91], a[12:15], 0
    ds_read_b64_tr_b16 a[78:79], v5 offset:25600
    v_cvt_pk_bf16_f32 v20, v16, v17
    s_add_u32 s35, s35, 458752
    v_mfma_f32_16x16x32_bf16 v[172:175], a[92:95], a[44:47], v[172:175]
    v_mfma_f32_16x16x32_bf16 v[176:179], a[88:91], a[16:19], 0
    v_cvt_pk_bf16_f32 v21, v18, v19
    s_add_u32 m0, s36, 65536
    v_mfma_f32_16x16x32_bf16 v[176:179], a[92:95], a[48:51], v[176:179]
    buffer_load_dwordx4 v8, s[8:11], s24 offen lds
    v_mfma_f32_16x16x32_bf16 v[180:183], a[88:91], a[20:23], 0
    v_and_b32 v50, 0xffff0000, v20
    v_mfma_f32_16x16x32_bf16 v[180:183], a[92:95], a[52:55], v[180:183]
    v_and_b32 v54, 0xffff0000, v21
    v_mfma_f32_16x16x32_bf16 v[184:187], a[88:91], a[24:27], 0
    s_add_u32 m0, s36, 69632
    v_mfma_f32_16x16x32_bf16 v[184:187], a[92:95], a[56:59], v[184:187]
    v_lshlrev_b32 v48, 16, v20
    buffer_load_dwordx4 v8, s[8:11], s25 offen lds
    v_mfma_f32_16x16x32_bf16 v[188:191], a[88:91], a[28:31], 0
    v_mfma_f32_16x16x32_bf16 v[188:191], a[92:95], a[60:63], v[188:191]
    v_lshlrev_b32 v52, 16, v21
    s_waitcnt lgkmcnt(1)
    v_mfma_f32_16x16x32_bf16 v[192:195], a[64:67], a[0:3], 0
    ds_read_b64_tr_b16 a[80:81], v6 offset:16384
    v_mul_f32 v48, 0xbfb8aa3b, v48
    v_mfma_f32_16x16x32_bf16 v[192:195], a[68:71], a[32:35], v[192:195]
    v_mfma_f32_16x16x32_bf16 v[196:199], a[64:67], a[4:7], 0
    ds_read_b64_tr_b16 a[82:83], v6 offset:17408
    v_mul_f32 v50, 0xbfb8aa3b, v50
    s_add_u32 m0, s36, 73728
    v_mfma_f32_16x16x32_bf16 v[196:199], a[68:71], a[36:39], v[196:199]
    buffer_load_dwordx4 v8, s[8:11], s26 offen lds
    v_mfma_f32_16x16x32_bf16 v[200:203], a[64:67], a[8:11], 0
    ds_read_b64_tr_b16 a[84:85], v6 offset:24576
    v_mul_f32 v52, 0xbfb8aa3b, v52
    v_mfma_f32_16x16x32_bf16 v[200:203], a[68:71], a[40:43], v[200:203]
    v_mfma_f32_16x16x32_bf16 v[204:207], a[64:67], a[12:15], 0
    ds_read_b64_tr_b16 a[86:87], v6 offset:25600
    v_mul_f32 v54, 0xbfb8aa3b, v54
    v_mfma_f32_16x16x32_bf16 v[204:207], a[68:71], a[44:47], v[204:207]
    v_exp_f32 v48, v48
    v_mfma_f32_16x16x32_bf16 v[208:211], a[64:67], a[16:19], 0
    s_add_u32 m0, s36, 77824
    v_mfma_f32_16x16x32_bf16 v[208:211], a[68:71], a[48:51], v[208:211]
    v_exp_f32 v50, v50
    buffer_load_dwordx4 v8, s[8:11], s27 offen lds
    v_mfma_f32_16x16x32_bf16 v[212:215], a[64:67], a[20:23], 0
    v_mfma_f32_16x16x32_bf16 v[212:215], a[68:71], a[52:55], v[212:215]
    v_exp_f32 v52, v52
    s_add_u32 m0, s36, 81920
    v_mfma_f32_16x16x32_bf16 v[216:219], a[64:67], a[24:27], 0
    v_exp_f32 v54, v54
    buffer_load_dwordx4 v8, s[8:11], s28 offen lds
    v_mfma_f32_16x16x32_bf16 v[216:219], a[68:71], a[56:59], v[216:219]
    v_mfma_f32_16x16x32_bf16 v[220:223], a[64:67], a[28:31], 0
    v_add_f32 v48, 1.0, v48
    v_mfma_f32_16x16x32_bf16 v[220:223], a[68:71], a[60:63], v[220:223]
    v_mfma_f32_16x16x32_bf16 v[224:227], a[72:75], a[0:3], 0
    ds_read_b64_tr_b16 a[88:89], v7 offset:16384
    v_add_f32 v50, 1.0, v50
    s_add_u32 m0, s36, 86016
    s_waitcnt lgkmcnt(5)
    v_mfma_f32_16x16x32_bf16 v[224:227], a[76:79], a[32:35], v[224:227]
    buffer_load_dwordx4 v8, s[8:11], s29 offen lds
    v_mfma_f32_16x16x32_bf16 v[228:231], a[72:75], a[4:7], 0
    ds_read_b64_tr_b16 a[90:91], v7 offset:17408
    v_add_f32 v52, 1.0, v52
    v_mfma_f32_16x16x32_bf16 v[228:231], a[76:79], a[36:39], v[228:231]
    v_add_f32 v54, 1.0, v54
    v_mfma_f32_16x16x32_bf16 v[232:235], a[72:75], a[8:11], 0
    ds_read_b64_tr_b16 a[92:93], v7 offset:24576
    v_mfma_f32_16x16x32_bf16 v[232:235], a[76:79], a[40:43], v[232:235]
    v_rcp_f32 v48, v48
    v_mfma_f32_16x16x32_bf16 v[236:239], a[72:75], a[12:15], 0
    ds_read_b64_tr_b16 a[94:95], v7 offset:25600
    v_mfma_f32_16x16x32_bf16 v[236:239], a[76:79], a[44:47], v[236:239]
    v_rcp_f32 v50, v50
    s_add_u32 m0, s36, 90112
    v_mfma_f32_16x16x32_bf16 v[240:243], a[72:75], a[16:19], 0
    v_rcp_f32 v52, v52
    buffer_load_dwordx4 v8, s[8:11], s30 offen lds
    v_mfma_f32_16x16x32_bf16 v[240:243], a[76:79], a[48:51], v[240:243]
    v_mfma_f32_16x16x32_bf16 v[244:247], a[72:75], a[20:23], 0
    v_rcp_f32 v54, v54
    v_mfma_f32_16x16x32_bf16 v[244:247], a[76:79], a[52:55], v[244:247]
    s_add_u32 m0, s36, 94208
    v_mfma_f32_16x16x32_bf16 v[248:251], a[72:75], a[24:27], 0
    v_cvt_pk_bf16_f32 v48, v48, v48
    buffer_load_dwordx4 v8, s[8:11], s31 offen lds
    v_mfma_f32_16x16x32_bf16 v[248:251], a[76:79], a[56:59], v[248:251]
    s_add_u32 s8, s8, 128
    s_addc_u32 s9, s9, 0
    s_sub_u32 s10, s10, 128
    v_mfma_f32_16x16x32_bf16 v[252:255], a[72:75], a[28:31], 0
    v_mfma_f32_16x16x32_bf16 v[252:255], a[76:79], a[60:63], v[252:255]
    s_waitcnt vmcnt(12) lgkmcnt(0)
    s_barrier
    v_mfma_f32_16x16x32_bf16 a[128:131], a[80:83], a[0:3], 0
    ds_read_b64_tr_b16 a[64:65], v4 offset:32768
    v_mfma_f32_16x16x32_bf16 a[128:131], a[84:87], a[32:35], a[128:131]
    ds_read_b64_tr_b16 a[66:67], v4 offset:33792
    v_mfma_f32_16x16x32_bf16 a[132:135], a[80:83], a[4:7], 0
    v_cvt_pk_bf16_f32 v50, v50, v50
    v_mfma_f32_16x16x32_bf16 a[132:135], a[84:87], a[36:39], a[132:135]
    ds_read_b64_tr_b16 a[68:69], v4 offset:40960
    v_cvt_pk_bf16_f32 v52, v52, v52
    v_mfma_f32_16x16x32_bf16 a[136:139], a[80:83], a[8:11], 0
    ds_read_b64_tr_b16 a[70:71], v4 offset:41984
    v_mfma_f32_16x16x32_bf16 a[136:139], a[84:87], a[40:43], a[136:139]
    v_cvt_pk_bf16_f32 v54, v54, v54
    v_mfma_f32_16x16x32_bf16 a[140:143], a[80:83], a[12:15], 0
    ds_read_b64_tr_b16 a[72:73], v5 offset:32768
    v_mfma_f32_16x16x32_bf16 a[140:143], a[84:87], a[44:47], a[140:143]
    ds_read_b64_tr_b16 a[74:75], v5 offset:33792
    v_and_b32 v14, 47, v11
    s_add_u32 m0, s37, 0
    v_mfma_f32_16x16x32_bf16 a[144:147], a[80:83], a[16:19], 0
    v_lshrrev_b32 v15, 4, v11
    buffer_load_dwordx4 v9, s[12:15], s32 offen lds
    v_mfma_f32_16x16x32_bf16 a[144:147], a[84:87], a[48:51], a[144:147]
    ds_read_b64_tr_b16 a[76:77], v5 offset:40960
    v_mfma_f32_16x16x32_bf16 a[148:151], a[80:83], a[20:23], 0
    ds_read_b64_tr_b16 a[78:79], v5 offset:41984
    v_mov_b32 v23, 0x40000000
    v_mfma_f32_16x16x32_bf16 a[148:151], a[84:87], a[52:55], a[148:151]
    s_add_u32 m0, s37, 4096
    v_mfma_f32_16x16x32_bf16 a[152:155], a[80:83], a[24:27], 0
    v_lshlrev_b32 v48, 16, v48
    buffer_load_dwordx4 v9, s[12:15], s33 offen lds
    v_mfma_f32_16x16x32_bf16 a[152:155], a[84:87], a[56:59], a[152:155]
    v_mfma_f32_16x16x32_bf16 a[156:159], a[80:83], a[28:31], 0
    v_lshlrev_b32 v50, 16, v50
    v_mfma_f32_16x16x32_bf16 a[156:159], a[84:87], a[60:63], a[156:159]
    v_lshlrev_b32 v52, 16, v52
    v_mfma_f32_16x16x32_bf16 a[160:163], a[88:91], a[0:3], 0
    ds_read_b128 a[0:3], v2 offset:32768
    v_mfma_f32_16x16x32_bf16 a[160:163], a[92:95], a[32:35], a[160:163]
    ds_read_b128 a[32:35], v3 offset:32768
    v_lshlrev_b32 v54, 16, v54
    v_mfma_f32_16x16x32_bf16 a[164:167], a[88:91], a[4:7], 0
    ds_read_b128 a[4:7], v2 offset:34816
    v_mfma_f32_16x16x32_bf16 a[164:167], a[92:95], a[36:39], a[164:167]
    ds_read_b128 a[36:39], v3 offset:34816
    v_cmp_eq_u32 vcc, 1, v14
    v_mfma_f32_16x16x32_bf16 a[168:171], a[88:91], a[8:11], 0
    ds_read_b128 a[8:11], v2 offset:36864
    v_lshlrev_b32 v22, 3, v15
    v_mfma_f32_16x16x32_bf16 a[168:171], a[92:95], a[40:43], a[168:171]
    ds_read_b128 a[40:43], v3 offset:36864
    v_mfma_f32_16x16x32_bf16 a[172:175], a[88:91], a[12:15], 0
    ds_read_b128 a[12:15], v2 offset:38912
    v_sub_f32 v49, 1.0, v48
    v_mfma_f32_16x16x32_bf16 a[172:175], a[92:95], a[44:47], a[172:175]
    ds_read_b128 a[44:47], v3 offset:38912
    v_mfma_f32_16x16x32_bf16 a[176:179], a[88:91], a[16:19], 0
    ds_read_b128 a[16:19], v2 offset:40960
    v_sub_f32 v51, 1.0, v50
    v_mfma_f32_16x16x32_bf16 a[176:179], a[92:95], a[48:51], a[176:179]
    ds_read_b128 a[48:51], v3 offset:40960
    v_mfma_f32_16x16x32_bf16 a[180:183], a[88:91], a[20:23], 0
    ds_read_b128 a[20:23], v2 offset:43008
    v_sub_f32 v53, 1.0, v52
    v_mfma_f32_16x16x32_bf16 a[180:183], a[92:95], a[52:55], a[180:183]
    ds_read_b128 a[52:55], v3 offset:43008
    v_sub_f32 v55, 1.0, v54
    v_mfma_f32_16x16x32_bf16 a[184:187], a[88:91], a[24:27], 0
    ds_read_b128 a[24:27], v2 offset:45056
    v_mfma_f32_16x16x32_bf16 a[184:187], a[92:95], a[56:59], a[184:187]
    ds_read_b128 a[56:59], v3 offset:45056
    v_cndmask_b32 v22, v23, v22, vcc
    v_mfma_f32_16x16x32_bf16 a[188:191], a[88:91], a[28:31], 0
    ds_read_b128 a[28:31], v2 offset:47104
    v_mfma_f32_16x16x32_bf16 a[188:191], a[92:95], a[60:63], a[188:191]
    ds_read_b128 a[60:63], v3 offset:47104
    v_cvt_pk_bf16_f32 v49, v49, v49
    s_waitcnt lgkmcnt(10)
    v_mfma_f32_16x16x32_bf16 v[64:67], a[64:67], a[0:3], v[64:67]
    ds_read_b64_tr_b16 a[80:81], v6 offset:32768
    v_cvt_pk_bf16_f32 v51, v51, v51
    v_mfma_f32_16x16x32_bf16 v[64:67], a[68:71], a[32:35], v[64:67]
    v_mfma_f32_16x16x32_bf16 v[68:71], a[64:67], a[4:7], v[68:71]
    ds_read_b64_tr_b16 a[82:83], v6 offset:33792
    v_cvt_pk_bf16_f32 v53, v53, v53
    s_add_u32 m0, s37, 8192
    v_mfma_f32_16x16x32_bf16 v[68:71], a[68:71], a[36:39], v[68:71]
    buffer_load_dwordx4 v9, s[12:15], s34 offen lds
    v_mfma_f32_16x16x32_bf16 v[72:75], a[64:67], a[8:11], v[72:75]
    ds_read_b64_tr_b16 a[84:85], v6 offset:40960
    v_cvt_pk_bf16_f32 v55, v55, v55
    v_mfma_f32_16x16x32_bf16 v[72:75], a[68:71], a[40:43], v[72:75]
    s_waitcnt lgkmcnt(7)
    v_mfma_f32_16x16x32_bf16 v[76:79], a[64:67], a[12:15], v[76:79]
    ds_read_b64_tr_b16 a[86:87], v6 offset:41984
    v_cmp_eq_u32 vcc, 0, v14
    s_add_u32 m0, s37, 12288
    v_mfma_f32_16x16x32_bf16 v[76:79], a[68:71], a[44:47], v[76:79]
    v_lshlrev_b32 v15, 5, v15
    buffer_load_dwordx4 v9, s[12:15], s35 offen lds
    v_mfma_f32_16x16x32_bf16 v[80:83], a[64:67], a[16:19], v[80:83]
    s_add_u32 m0, s37, 16384
    v_mfma_f32_16x16x32_bf16 v[80:83], a[68:71], a[48:51], v[80:83]
    v_mul_f32 v48, 0x35800000, v48
    buffer_load_dwordx4 v9, s[16:19], s32 offen lds
    v_mfma_f32_16x16x32_bf16 v[84:87], a[64:67], a[20:23], v[84:87]
    s_add_u32 s32, s32, 458752
    s_add_u32 m0, s37, 20480
    v_mfma_f32_16x16x32_bf16 v[84:87], a[68:71], a[52:55], v[84:87]
    v_mul_f32 v50, 0x35800000, v50
    buffer_load_dwordx4 v9, s[16:19], s33 offen lds
    s_waitcnt lgkmcnt(2)
    v_mfma_f32_16x16x32_bf16 v[88:91], a[64:67], a[24:27], v[88:91]
    v_mul_f32 v52, 0x35800000, v52
    s_add_u32 s33, s33, 458752
    v_mfma_f32_16x16x32_bf16 v[88:91], a[68:71], a[56:59], v[88:91]
    s_add_u32 m0, s37, 24576
    v_mfma_f32_16x16x32_bf16 v[92:95], a[64:67], a[28:31], v[92:95]
    v_mul_f32 v54, 0x35800000, v54
    buffer_load_dwordx4 v9, s[16:19], s34 offen lds
    v_mfma_f32_16x16x32_bf16 v[92:95], a[68:71], a[60:63], v[92:95]
    s_add_u32 s34, s34, 458752
    v_mfma_f32_16x16x32_bf16 v[96:99], a[72:75], a[0:3], v[96:99]
    ds_read_b64_tr_b16 a[88:89], v7 offset:32768
    v_lshlrev_b32 v49, 16, v49
    s_add_u32 m0, s37, 28672
    v_mfma_f32_16x16x32_bf16 v[96:99], a[76:79], a[32:35], v[96:99]
    buffer_load_dwordx4 v9, s[16:19], s35 offen lds
    v_mfma_f32_16x16x32_bf16 v[100:103], a[72:75], a[4:7], v[100:103]
    ds_read_b64_tr_b16 a[90:91], v7 offset:33792
    v_lshlrev_b32 v51, 16, v51
    s_add_u32 s35, s35, 458752
    v_mfma_f32_16x16x32_bf16 v[100:103], a[76:79], a[36:39], v[100:103]
    v_lshlrev_b32 v53, 16, v53
    v_mfma_f32_16x16x32_bf16 v[104:107], a[72:75], a[8:11], v[104:107]
    ds_read_b64_tr_b16 a[92:93], v7 offset:40960
    s_add_u32 m0, s36, 0
    v_mfma_f32_16x16x32_bf16 v[104:107], a[76:79], a[40:43], v[104:107]
    v_lshlrev_b32 v55, 16, v55
    buffer_load_dwordx4 v8, s[8:11], s24 offen lds
    v_mfma_f32_16x16x32_bf16 v[108:111], a[72:75], a[12:15], v[108:111]
    ds_read_b64_tr_b16 a[94:95], v7 offset:41984
    v_mfma_f32_16x16x32_bf16 v[108:111], a[76:79], a[44:47], v[108:111]
    v_cndmask_b32 v15, v23, v15, vcc
    s_add_u32 m0, s36, 4096
    v_mfma_f32_16x16x32_bf16 v[112:115], a[72:75], a[16:19], v[112:115]
    buffer_load_dwordx4 v8, s[8:11], s25 offen lds
    buffer_store_dwordx2 v[20:21], v22, s[68:71], s95 offen sc1
    v_mfma_f32_16x16x32_bf16 v[112:115], a[76:79], a[48:51], v[112:115]
    s_add_u32 m0, s36, 8192
    v_mfma_f32_16x16x32_bf16 v[116:119], a[72:75], a[20:23], v[116:119]
    buffer_load_dwordx4 v8, s[8:11], s26 offen lds
    buffer_store_dwordx4 v[48:51], v15, s[68:71], s94 offen sc1
    v_mfma_f32_16x16x32_bf16 v[116:119], a[76:79], a[52:55], v[116:119]
    s_add_u32 m0, s36, 12288
    v_mfma_f32_16x16x32_bf16 v[120:123], a[72:75], a[24:27], v[120:123]
    buffer_load_dwordx4 v8, s[8:11], s27 offen lds
    buffer_store_dwordx4 v[52:55], v15, s[68:71], s94 offen offset:16 sc1
    v_mfma_f32_16x16x32_bf16 v[120:123], a[76:79], a[56:59], v[120:123]
    v_mfma_f32_16x16x32_bf16 v[124:127], a[72:75], a[28:31], v[124:127]
    v_mfma_f32_16x16x32_bf16 v[124:127], a[76:79], a[60:63], v[124:127]
    s_waitcnt vmcnt(23) lgkmcnt(0)
    s_barrier
    v_mfma_f32_16x16x32_bf16 v[128:131], a[80:83], a[0:3], v[128:131]
    ds_read_b64_tr_b16 a[64:65], v4 offset:49152
    v_mfma_f32_16x16x32_bf16 v[128:131], a[84:87], a[32:35], v[128:131]
    v_mfma_f32_16x16x32_bf16 v[132:135], a[80:83], a[4:7], v[132:135]
    ds_read_b64_tr_b16 a[66:67], v4 offset:50176
    v_mfma_f32_16x16x32_bf16 v[132:135], a[84:87], a[36:39], v[132:135]
    v_mfma_f32_16x16x32_bf16 v[136:139], a[80:83], a[8:11], v[136:139]
    ds_read_b64_tr_b16 a[68:69], v4 offset:57344
    v_mfma_f32_16x16x32_bf16 v[136:139], a[84:87], a[40:43], v[136:139]
    v_mfma_f32_16x16x32_bf16 v[140:143], a[80:83], a[12:15], v[140:143]
    ds_read_b64_tr_b16 a[70:71], v4 offset:58368
    v_mfma_f32_16x16x32_bf16 v[140:143], a[84:87], a[44:47], v[140:143]
    v_mfma_f32_16x16x32_bf16 v[144:147], a[80:83], a[16:19], v[144:147]
    s_add_u32 m0, s37, 32768
    v_mfma_f32_16x16x32_bf16 v[144:147], a[84:87], a[48:51], v[144:147]
    buffer_load_dwordx4 v9, s[12:15], s32 offen lds
    v_mfma_f32_16x16x32_bf16 v[148:151], a[80:83], a[20:23], v[148:151]
    v_mfma_f32_16x16x32_bf16 v[148:151], a[84:87], a[52:55], v[148:151]
    buffer_load_dwordx4 v[24:27], v12, s[60:63], 0 offen offset:0
    v_mfma_f32_16x16x32_bf16 v[152:155], a[80:83], a[24:27], v[152:155]
    s_add_u32 m0, s37, 36864
    v_mfma_f32_16x16x32_bf16 v[152:155], a[84:87], a[56:59], v[152:155]
    buffer_load_dwordx4 v9, s[12:15], s33 offen lds
    v_mfma_f32_16x16x32_bf16 v[156:159], a[80:83], a[28:31], v[156:159]
    v_mfma_f32_16x16x32_bf16 v[156:159], a[84:87], a[60:63], v[156:159]
    buffer_load_dwordx4 v[28:31], v12, s[76:79], 0 offen offset:0
    v_mfma_f32_16x16x32_bf16 v[160:163], a[88:91], a[0:3], v[160:163]
    ds_read_b64_tr_b16 a[72:73], v5 offset:49152
    v_mfma_f32_16x16x32_bf16 v[160:163], a[92:95], a[32:35], v[160:163]
    v_mfma_f32_16x16x32_bf16 v[164:167], a[88:91], a[4:7], v[164:167]
    ds_read_b64_tr_b16 a[74:75], v5 offset:50176
    v_mfma_f32_16x16x32_bf16 v[164:167], a[92:95], a[36:39], v[164:167]
    v_mfma_f32_16x16x32_bf16 v[168:171], a[88:91], a[8:11], v[168:171]
    ds_read_b64_tr_b16 a[76:77], v5 offset:57344
    v_mfma_f32_16x16x32_bf16 v[168:171], a[92:95], a[40:43], v[168:171]
    v_mfma_f32_16x16x32_bf16 v[172:175], a[88:91], a[12:15], v[172:175]
    ds_read_b64_tr_b16 a[78:79], v5 offset:58368
    v_mfma_f32_16x16x32_bf16 v[172:175], a[92:95], a[44:47], v[172:175]
    v_mfma_f32_16x16x32_bf16 v[176:179], a[88:91], a[16:19], v[176:179]
    s_add_u32 m0, s37, 40960
    v_mfma_f32_16x16x32_bf16 v[176:179], a[92:95], a[48:51], v[176:179]
    buffer_load_dwordx4 v9, s[12:15], s34 offen lds
    v_mfma_f32_16x16x32_bf16 v[180:183], a[88:91], a[20:23], v[180:183]
    v_mfma_f32_16x16x32_bf16 v[180:183], a[92:95], a[52:55], v[180:183]
    buffer_load_dwordx4 v[32:35], v12, s[60:63], s52 offen offset:0
    v_mfma_f32_16x16x32_bf16 v[184:187], a[88:91], a[24:27], v[184:187]
    s_add_u32 m0, s37, 45056
    v_mfma_f32_16x16x32_bf16 v[184:187], a[92:95], a[56:59], v[184:187]
    buffer_load_dwordx4 v9, s[12:15], s35 offen lds
    v_mfma_f32_16x16x32_bf16 v[188:191], a[88:91], a[28:31], v[188:191]
    v_mfma_f32_16x16x32_bf16 v[188:191], a[92:95], a[60:63], v[188:191]
    buffer_load_dwordx4 v[36:39], v12, s[76:79], s52 offen offset:0
    s_waitcnt lgkmcnt(1)
    v_mfma_f32_16x16x32_bf16 v[192:195], a[64:67], a[0:3], v[192:195]
    ds_read_b64_tr_b16 a[80:81], v6 offset:49152
    v_mfma_f32_16x16x32_bf16 v[192:195], a[68:71], a[32:35], v[192:195]
    v_mfma_f32_16x16x32_bf16 v[196:199], a[64:67], a[4:7], v[196:199]
    ds_read_b64_tr_b16 a[82:83], v6 offset:50176
    v_mfma_f32_16x16x32_bf16 v[196:199], a[68:71], a[36:39], v[196:199]
    v_mfma_f32_16x16x32_bf16 v[200:203], a[64:67], a[8:11], v[200:203]
    ds_read_b64_tr_b16 a[84:85], v6 offset:57344
    v_mfma_f32_16x16x32_bf16 v[200:203], a[68:71], a[40:43], v[200:203]
    v_mfma_f32_16x16x32_bf16 v[204:207], a[64:67], a[12:15], v[204:207]
    ds_read_b64_tr_b16 a[86:87], v6 offset:58368
    v_mfma_f32_16x16x32_bf16 v[204:207], a[68:71], a[44:47], v[204:207]
    s_add_u32 m0, s36, 16384
    v_mfma_f32_16x16x32_bf16 v[208:211], a[64:67], a[16:19], v[208:211]
    buffer_load_dwordx4 v8, s[8:11], s28 offen lds
    v_mfma_f32_16x16x32_bf16 v[208:211], a[68:71], a[48:51], v[208:211]
    v_mfma_f32_16x16x32_bf16 v[212:215], a[64:67], a[20:23], v[212:215]
    buffer_load_dwordx4 v[40:43], v12, s[60:63], s53 offen offset:0
    v_mfma_f32_16x16x32_bf16 v[212:215], a[68:71], a[52:55], v[212:215]
    s_add_u32 m0, s36, 20480
    v_mfma_f32_16x16x32_bf16 v[216:219], a[64:67], a[24:27], v[216:219]
    buffer_load_dwordx4 v8, s[8:11], s29 offen lds
    v_mfma_f32_16x16x32_bf16 v[216:219], a[68:71], a[56:59], v[216:219]
    v_mfma_f32_16x16x32_bf16 v[220:223], a[64:67], a[28:31], v[220:223]
    buffer_load_dwordx4 v[44:47], v12, s[76:79], s53 offen offset:0
    v_mfma_f32_16x16x32_bf16 v[220:223], a[68:71], a[60:63], v[220:223]
    buffer_load_dwordx4 v[48:51], v12, s[60:63], s54 offen offset:0
    v_mfma_f32_16x16x32_bf16 v[224:227], a[72:75], a[0:3], v[224:227]
    ds_read_b64_tr_b16 a[88:89], v7 offset:49152
    s_waitcnt lgkmcnt(5)
    v_mfma_f32_16x16x32_bf16 v[224:227], a[76:79], a[32:35], v[224:227]
    v_mfma_f32_16x16x32_bf16 v[228:231], a[72:75], a[4:7], v[228:231]
    ds_read_b64_tr_b16 a[90:91], v7 offset:50176
    v_mfma_f32_16x16x32_bf16 v[228:231], a[76:79], a[36:39], v[228:231]
    v_mfma_f32_16x16x32_bf16 v[232:235], a[72:75], a[8:11], v[232:235]
    ds_read_b64_tr_b16 a[92:93], v7 offset:57344
    v_mfma_f32_16x16x32_bf16 v[232:235], a[76:79], a[40:43], v[232:235]
    v_mfma_f32_16x16x32_bf16 v[236:239], a[72:75], a[12:15], v[236:239]
    ds_read_b64_tr_b16 a[94:95], v7 offset:58368
    v_mfma_f32_16x16x32_bf16 v[236:239], a[76:79], a[44:47], v[236:239]
    s_add_u32 m0, s36, 24576
    v_mfma_f32_16x16x32_bf16 v[240:243], a[72:75], a[16:19], v[240:243]
    buffer_load_dwordx4 v8, s[8:11], s30 offen lds
    v_mfma_f32_16x16x32_bf16 v[240:243], a[76:79], a[48:51], v[240:243]
    v_mfma_f32_16x16x32_bf16 v[244:247], a[72:75], a[20:23], v[244:247]
    buffer_load_dwordx4 v[52:55], v12, s[76:79], s54 offen offset:0
    v_mfma_f32_16x16x32_bf16 v[244:247], a[76:79], a[52:55], v[244:247]
    s_add_u32 m0, s36, 28672
    v_mfma_f32_16x16x32_bf16 v[248:251], a[72:75], a[24:27], v[248:251]
    buffer_load_dwordx4 v8, s[8:11], s31 offen lds
    v_mfma_f32_16x16x32_bf16 v[248:251], a[76:79], a[56:59], v[248:251]
    s_add_u32 s8, s8, 128
    s_addc_u32 s9, s9, 0
    s_sub_u32 s10, s10, 128
    v_mfma_f32_16x16x32_bf16 v[252:255], a[72:75], a[28:31], v[252:255]
    v_mfma_f32_16x16x32_bf16 v[252:255], a[76:79], a[60:63], v[252:255]
    s_waitcnt vmcnt(16) lgkmcnt(0)
    s_barrier
    v_mfma_f32_16x16x32_bf16 a[128:131], a[80:83], a[0:3], a[128:131]
    ds_read_b64_tr_b16 a[64:65], v4 offset:0
    v_mfma_f32_16x16x32_bf16 a[128:131], a[84:87], a[32:35], a[128:131]
    ds_read_b64_tr_b16 a[66:67], v4 offset:1024
    v_mfma_f32_16x16x32_bf16 a[132:135], a[80:83], a[4:7], a[132:135]
    v_mfma_f32_16x16x32_bf16 a[132:135], a[84:87], a[36:39], a[132:135]
    ds_read_b64_tr_b16 a[68:69], v4 offset:8192
    v_mfma_f32_16x16x32_bf16 a[136:139], a[80:83], a[8:11], a[136:139]
    ds_read_b64_tr_b16 a[70:71], v4 offset:9216
    v_mfma_f32_16x16x32_bf16 a[136:139], a[84:87], a[40:43], a[136:139]
    v_mfma_f32_16x16x32_bf16 a[140:143], a[80:83], a[12:15], a[140:143]
    ds_read_b64_tr_b16 a[72:73], v5 offset:0
    v_mfma_f32_16x16x32_bf16 a[140:143], a[84:87], a[44:47], a[140:143]
    ds_read_b64_tr_b16 a[74:75], v5 offset:1024
    v_mfma_f32_16x16x32_bf16 a[144:147], a[80:83], a[16:19], a[144:147]
    v_mfma_f32_16x16x32_bf16 a[144:147], a[84:87], a[48:51], a[144:147]
    ds_read_b64_tr_b16 a[76:77], v5 offset:8192
    v_mfma_f32_16x16x32_bf16 a[148:151], a[80:83], a[20:23], a[148:151]
    ds_read_b64_tr_b16 a[78:79], v5 offset:9216
    v_mfma_f32_16x16x32_bf16 a[148:151], a[84:87], a[52:55], a[148:151]
    v_mfma_f32_16x16x32_bf16 a[152:155], a[80:83], a[24:27], a[152:155]
    s_add_u32 m0, s37, 49152
    v_mfma_f32_16x16x32_bf16 a[152:155], a[84:87], a[56:59], a[152:155]
    buffer_load_dwordx4 v9, s[16:19], s32 offen lds
    v_mfma_f32_16x16x32_bf16 a[156:159], a[80:83], a[28:31], a[156:159]
    s_add_u32 s32, s32, 458752
    v_mfma_f32_16x16x32_bf16 a[156:159], a[84:87], a[60:63], a[156:159]
    v_mfma_f32_16x16x32_bf16 a[160:163], a[88:91], a[0:3], a[160:163]
    ds_read_b128 a[0:3], v60 offset:0
    v_mfma_f32_16x16x32_bf16 a[160:163], a[92:95], a[32:35], a[160:163]
    ds_read_b128 a[32:35], v61 offset:0
    buffer_store_dword v57, v56, s[68:71], s59 offen sc1
    v_mfma_f32_16x16x32_bf16 a[164:167], a[88:91], a[4:7], a[164:167]
    ds_read_b128 a[4:7], v60 offset:2048
    v_mfma_f32_16x16x32_bf16 a[164:167], a[92:95], a[36:39], a[164:167]
    ds_read_b128 a[36:39], v61 offset:2048
    v_mfma_f32_16x16x32_bf16 a[168:171], a[88:91], a[8:11], a[168:171]
    ds_read_b128 a[8:11], v60 offset:4096
    v_mfma_f32_16x16x32_bf16 a[168:171], a[92:95], a[40:43], a[168:171]
    ds_read_b128 a[40:43], v61 offset:4096
    v_mfma_f32_16x16x32_bf16 a[172:175], a[88:91], a[12:15], a[172:175]
    ds_read_b128 a[12:15], v60 offset:6144
    v_mfma_f32_16x16x32_bf16 a[172:175], a[92:95], a[44:47], a[172:175]
    ds_read_b128 a[44:47], v61 offset:6144
    v_mfma_f32_16x16x32_bf16 a[176:179], a[88:91], a[16:19], a[176:179]
    ds_read_b128 a[16:19], v60 offset:8192
    v_mfma_f32_16x16x32_bf16 a[176:179], a[92:95], a[48:51], a[176:179]
    ds_read_b128 a[48:51], v61 offset:8192
    v_mfma_f32_16x16x32_bf16 a[180:183], a[88:91], a[20:23], a[180:183]
    ds_read_b128 a[20:23], v60 offset:10240
    v_mfma_f32_16x16x32_bf16 a[180:183], a[92:95], a[52:55], a[180:183]
    ds_read_b128 a[52:55], v61 offset:10240
    v_mfma_f32_16x16x32_bf16 a[184:187], a[88:91], a[24:27], a[184:187]
    ds_read_b128 a[24:27], v60 offset:12288
    v_mfma_f32_16x16x32_bf16 a[184:187], a[92:95], a[56:59], a[184:187]
    ds_read_b128 a[56:59], v61 offset:12288
    v_mfma_f32_16x16x32_bf16 a[188:191], a[88:91], a[28:31], a[188:191]
    ds_read_b128 a[28:31], v60 offset:14336
    v_mfma_f32_16x16x32_bf16 a[188:191], a[92:95], a[60:63], a[188:191]
    ds_read_b128 a[60:63], v61 offset:14336
    s_waitcnt lgkmcnt(10)
    v_mfma_f32_16x16x32_bf16 v[64:67], a[64:67], a[0:3], v[64:67]
    ds_read_b64_tr_b16 a[80:81], v6 offset:0
    v_mfma_f32_16x16x32_bf16 v[64:67], a[68:71], a[32:35], v[64:67]
    v_mfma_f32_16x16x32_bf16 v[68:71], a[64:67], a[4:7], v[68:71]
    ds_read_b64_tr_b16 a[82:83], v6 offset:1024
    v_mfma_f32_16x16x32_bf16 v[68:71], a[68:71], a[36:39], v[68:71]
    v_mfma_f32_16x16x32_bf16 v[72:75], a[64:67], a[8:11], v[72:75]
    ds_read_b64_tr_b16 a[84:85], v6 offset:8192
    v_mfma_f32_16x16x32_bf16 v[72:75], a[68:71], a[40:43], v[72:75]
    s_waitcnt lgkmcnt(7)
    v_mfma_f32_16x16x32_bf16 v[76:79], a[64:67], a[12:15], v[76:79]
    ds_read_b64_tr_b16 a[86:87], v6 offset:9216
    v_mfma_f32_16x16x32_bf16 v[76:79], a[68:71], a[44:47], v[76:79]
    v_mfma_f32_16x16x32_bf16 v[80:83], a[64:67], a[16:19], v[80:83]
    s_add_u32 m0, s37, 53248
    v_mfma_f32_16x16x32_bf16 v[80:83], a[68:71], a[48:51], v[80:83]
    buffer_load_dwordx4 v9, s[16:19], s33 offen lds
    v_mfma_f32_16x16x32_bf16 v[84:87], a[64:67], a[20:23], v[84:87]
    s_add_u32 s33, s33, 458752
    s_add_u32 m0, s37, 57344
    v_mfma_f32_16x16x32_bf16 v[84:87], a[68:71], a[52:55], v[84:87]
    buffer_load_dwordx4 v9, s[16:19], s34 offen lds
    s_waitcnt lgkmcnt(2)
    v_mfma_f32_16x16x32_bf16 v[88:91], a[64:67], a[24:27], v[88:91]
    s_add_u32 s34, s34, 458752
    s_add_u32 m0, s37, 61440
    v_mfma_f32_16x16x32_bf16 v[88:91], a[68:71], a[56:59], v[88:91]
    buffer_load_dwordx4 v9, s[16:19], s35 offen lds
    v_mfma_f32_16x16x32_bf16 v[92:95], a[64:67], a[28:31], v[92:95]
    s_add_u32 s35, s35, 458752
    s_add_u32 m0, s36, 32768
    v_mfma_f32_16x16x32_bf16 v[92:95], a[68:71], a[60:63], v[92:95]
    buffer_load_dwordx4 v8, s[8:11], s24 offen lds
    v_mfma_f32_16x16x32_bf16 v[96:99], a[72:75], a[0:3], v[96:99]
    ds_read_b64_tr_b16 a[88:89], v7 offset:0
    v_mfma_f32_16x16x32_bf16 v[96:99], a[76:79], a[32:35], v[96:99]
    v_mfma_f32_16x16x32_bf16 v[100:103], a[72:75], a[4:7], v[100:103]
    ds_read_b64_tr_b16 a[90:91], v7 offset:1024
    v_mfma_f32_16x16x32_bf16 v[100:103], a[76:79], a[36:39], v[100:103]
    v_mfma_f32_16x16x32_bf16 v[104:107], a[72:75], a[8:11], v[104:107]
    ds_read_b64_tr_b16 a[92:93], v7 offset:8192
    v_mfma_f32_16x16x32_bf16 v[104:107], a[76:79], a[40:43], v[104:107]
    v_mfma_f32_16x16x32_bf16 v[108:111], a[72:75], a[12:15], v[108:111]
    ds_read_b64_tr_b16 a[94:95], v7 offset:9216
    v_mfma_f32_16x16x32_bf16 v[108:111], a[76:79], a[44:47], v[108:111]
    v_mfma_f32_16x16x32_bf16 v[112:115], a[72:75], a[16:19], v[112:115]
    s_add_u32 m0, s36, 36864
    v_mfma_f32_16x16x32_bf16 v[112:115], a[76:79], a[48:51], v[112:115]
    buffer_load_dwordx4 v8, s[8:11], s25 offen lds
    v_mfma_f32_16x16x32_bf16 v[116:119], a[72:75], a[20:23], v[116:119]
    s_add_u32 m0, s36, 40960
    v_mfma_f32_16x16x32_bf16 v[116:119], a[76:79], a[52:55], v[116:119]
    buffer_load_dwordx4 v8, s[8:11], s26 offen lds
    v_mfma_f32_16x16x32_bf16 v[120:123], a[72:75], a[24:27], v[120:123]
    s_add_u32 m0, s36, 45056
    v_mfma_f32_16x16x32_bf16 v[120:123], a[76:79], a[56:59], v[120:123]
    buffer_load_dwordx4 v8, s[8:11], s27 offen lds
    v_mfma_f32_16x16x32_bf16 v[124:127], a[72:75], a[28:31], v[124:127]
    v_mfma_f32_16x16x32_bf16 v[124:127], a[76:79], a[60:63], v[124:127]
    s_waitcnt vmcnt(10) lgkmcnt(0)
    s_barrier
    v_mfma_f32_16x16x32_bf16 v[128:131], a[80:83], a[0:3], v[128:131]
    ds_read_b64_tr_b16 a[64:65], v4 offset:16384
    v_mfma_f32_16x16x32_bf16 v[128:131], a[84:87], a[32:35], v[128:131]
    v_mfma_f32_16x16x32_bf16 v[132:135], a[80:83], a[4:7], v[132:135]
    ds_read_b64_tr_b16 a[66:67], v4 offset:17408
    v_mfma_f32_16x16x32_bf16 v[132:135], a[84:87], a[36:39], v[132:135]
    v_mfma_f32_16x16x32_bf16 v[136:139], a[80:83], a[8:11], v[136:139]
    ds_read_b64_tr_b16 a[68:69], v4 offset:24576
    v_mfma_f32_16x16x32_bf16 v[136:139], a[84:87], a[40:43], v[136:139]
    v_mfma_f32_16x16x32_bf16 v[140:143], a[80:83], a[12:15], v[140:143]
    ds_read_b64_tr_b16 a[70:71], v4 offset:25600
    v_mfma_f32_16x16x32_bf16 v[140:143], a[84:87], a[44:47], v[140:143]
    v_perm_b32 v16, v28, v24, s55
    v_mfma_f32_16x16x32_bf16 v[144:147], a[80:83], a[16:19], v[144:147]
    s_add_u32 m0, s37, 0
    v_mfma_f32_16x16x32_bf16 v[144:147], a[84:87], a[48:51], v[144:147]
    v_perm_b32 v17, v36, v32, s55
    buffer_load_dwordx4 v9, s[12:15], s32 offen lds
    v_mfma_f32_16x16x32_bf16 v[148:151], a[80:83], a[20:23], v[148:151]
    v_mfma_f32_16x16x32_bf16 v[148:151], a[84:87], a[52:55], v[148:151]
    v_perm_b32 v18, v44, v40, s55
    v_perm_b32 v19, v52, v48, s55
    v_mfma_f32_16x16x32_bf16 v[152:155], a[80:83], a[24:27], v[152:155]
    s_add_u32 m0, s37, 4096
    v_mfma_f32_16x16x32_bf16 v[152:155], a[84:87], a[56:59], v[152:155]
    buffer_load_dwordx4 v9, s[12:15], s33 offen lds
    v_mfma_f32_16x16x32_bf16 v[156:159], a[80:83], a[28:31], v[156:159]
    v_mfma_f32_16x16x32_bf16 v[156:159], a[84:87], a[60:63], v[156:159]
    s_mov_b32 s57, 0
    buffer_store_dwordx4 v[16:19], v13, s[68:71], s57 offen sc1
    v_mfma_f32_16x16x32_bf16 v[160:163], a[88:91], a[0:3], v[160:163]
    ds_read_b64_tr_b16 a[72:73], v5 offset:16384
    v_mfma_f32_16x16x32_bf16 v[160:163], a[92:95], a[32:35], v[160:163]
    v_mfma_f32_16x16x32_bf16 v[164:167], a[88:91], a[4:7], v[164:167]
    ds_read_b64_tr_b16 a[74:75], v5 offset:17408
    v_mfma_f32_16x16x32_bf16 v[164:167], a[92:95], a[36:39], v[164:167]
    v_mfma_f32_16x16x32_bf16 v[168:171], a[88:91], a[8:11], v[168:171]
    ds_read_b64_tr_b16 a[76:77], v5 offset:24576
    v_mfma_f32_16x16x32_bf16 v[168:171], a[92:95], a[40:43], v[168:171]
    v_mfma_f32_16x16x32_bf16 v[172:175], a[88:91], a[12:15], v[172:175]
    ds_read_b64_tr_b16 a[78:79], v5 offset:25600
    v_mfma_f32_16x16x32_bf16 v[172:175], a[92:95], a[44:47], v[172:175]
    v_perm_b32 v20, v28, v24, s56
    v_mfma_f32_16x16x32_bf16 v[176:179], a[88:91], a[16:19], v[176:179]
    s_add_u32 m0, s37, 8192
    v_mfma_f32_16x16x32_bf16 v[176:179], a[92:95], a[48:51], v[176:179]
    v_perm_b32 v21, v36, v32, s56
    buffer_load_dwordx4 v9, s[12:15], s34 offen lds
    v_mfma_f32_16x16x32_bf16 v[180:183], a[88:91], a[20:23], v[180:183]
    v_mfma_f32_16x16x32_bf16 v[180:183], a[92:95], a[52:55], v[180:183]
    v_perm_b32 v22, v44, v40, s56
    v_perm_b32 v23, v52, v48, s56
    v_mfma_f32_16x16x32_bf16 v[184:187], a[88:91], a[24:27], v[184:187]
    s_add_u32 m0, s37, 12288
    v_mfma_f32_16x16x32_bf16 v[184:187], a[92:95], a[56:59], v[184:187]
    buffer_load_dwordx4 v9, s[12:15], s35 offen lds
    v_mfma_f32_16x16x32_bf16 v[188:191], a[88:91], a[28:31], v[188:191]
    v_mfma_f32_16x16x32_bf16 v[188:191], a[92:95], a[60:63], v[188:191]
    s_mov_b32 s58, 8576
    buffer_store_dwordx4 v[20:23], v13, s[68:71], s58 offen sc1
    s_waitcnt lgkmcnt(1)
    v_mfma_f32_16x16x32_bf16 v[192:195], a[64:67], a[0:3], v[192:195]
    ds_read_b64_tr_b16 a[80:81], v6 offset:16384
    v_mfma_f32_16x16x32_bf16 v[192:195], a[68:71], a[32:35], v[192:195]
    v_mfma_f32_16x16x32_bf16 v[196:199], a[64:67], a[4:7], v[196:199]
    ds_read_b64_tr_b16 a[82:83], v6 offset:17408
    v_mfma_f32_16x16x32_bf16 v[196:199], a[68:71], a[36:39], v[196:199]
    v_mfma_f32_16x16x32_bf16 v[200:203], a[64:67], a[8:11], v[200:203]
    ds_read_b64_tr_b16 a[84:85], v6 offset:24576
    v_mfma_f32_16x16x32_bf16 v[200:203], a[68:71], a[40:43], v[200:203]
    v_mfma_f32_16x16x32_bf16 v[204:207], a[64:67], a[12:15], v[204:207]
    ds_read_b64_tr_b16 a[86:87], v6 offset:25600
    v_mfma_f32_16x16x32_bf16 v[204:207], a[68:71], a[44:47], v[204:207]
    v_perm_b32 v16, v29, v25, s55
    s_add_u32 m0, s36, 49152
    v_mfma_f32_16x16x32_bf16 v[208:211], a[64:67], a[16:19], v[208:211]
    buffer_load_dwordx4 v8, s[8:11], s28 offen lds
    v_mfma_f32_16x16x32_bf16 v[208:211], a[68:71], a[48:51], v[208:211]
    v_perm_b32 v17, v37, v33, s55
    v_mfma_f32_16x16x32_bf16 v[212:215], a[64:67], a[20:23], v[212:215]
    v_mfma_f32_16x16x32_bf16 v[212:215], a[68:71], a[52:55], v[212:215]
    v_perm_b32 v18, v45, v41, s55
    v_perm_b32 v19, v53, v49, s55
    s_add_u32 m0, s36, 53248
    v_mfma_f32_16x16x32_bf16 v[216:219], a[64:67], a[24:27], v[216:219]
    buffer_load_dwordx4 v8, s[8:11], s29 offen lds
    v_mfma_f32_16x16x32_bf16 v[216:219], a[68:71], a[56:59], v[216:219]
    v_mfma_f32_16x16x32_bf16 v[220:223], a[64:67], a[28:31], v[220:223]
    v_mfma_f32_16x16x32_bf16 v[220:223], a[68:71], a[60:63], v[220:223]
    s_mov_b32 s57, 17152
    buffer_store_dwordx4 v[16:19], v13, s[68:71], s57 offen sc1
    v_mfma_f32_16x16x32_bf16 v[224:227], a[72:75], a[0:3], v[224:227]
    ds_read_b64_tr_b16 a[88:89], v7 offset:16384
    s_waitcnt lgkmcnt(5)
    v_mfma_f32_16x16x32_bf16 v[224:227], a[76:79], a[32:35], v[224:227]
    v_mfma_f32_16x16x32_bf16 v[228:231], a[72:75], a[4:7], v[228:231]
    ds_read_b64_tr_b16 a[90:91], v7 offset:17408
    v_mfma_f32_16x16x32_bf16 v[228:231], a[76:79], a[36:39], v[228:231]
    v_mfma_f32_16x16x32_bf16 v[232:235], a[72:75], a[8:11], v[232:235]
    ds_read_b64_tr_b16 a[92:93], v7 offset:24576
    v_mfma_f32_16x16x32_bf16 v[232:235], a[76:79], a[40:43], v[232:235]
    v_mfma_f32_16x16x32_bf16 v[236:239], a[72:75], a[12:15], v[236:239]
    ds_read_b64_tr_b16 a[94:95], v7 offset:25600
    v_mfma_f32_16x16x32_bf16 v[236:239], a[76:79], a[44:47], v[236:239]
    v_perm_b32 v20, v29, v25, s56
    s_add_u32 m0, s36, 57344
    v_mfma_f32_16x16x32_bf16 v[240:243], a[72:75], a[16:19], v[240:243]
    buffer_load_dwordx4 v8, s[8:11], s30 offen lds
    v_mfma_f32_16x16x32_bf16 v[240:243], a[76:79], a[48:51], v[240:243]
    v_perm_b32 v21, v37, v33, s56
    v_mfma_f32_16x16x32_bf16 v[244:247], a[72:75], a[20:23], v[244:247]
    v_mfma_f32_16x16x32_bf16 v[244:247], a[76:79], a[52:55], v[244:247]
    v_perm_b32 v22, v45, v41, s56
    v_perm_b32 v23, v53, v49, s56
    s_add_u32 m0, s36, 61440
    v_mfma_f32_16x16x32_bf16 v[248:251], a[72:75], a[24:27], v[248:251]
    buffer_load_dwordx4 v8, s[8:11], s31 offen lds
    v_mfma_f32_16x16x32_bf16 v[248:251], a[76:79], a[56:59], v[248:251]
    s_add_u32 s8, s8, 128
    s_addc_u32 s9, s9, 0
    s_sub_u32 s10, s10, 128
    v_mfma_f32_16x16x32_bf16 v[252:255], a[72:75], a[28:31], v[252:255]
    v_mfma_f32_16x16x32_bf16 v[252:255], a[76:79], a[60:63], v[252:255]
    s_mov_b32 s58, 25728
    buffer_store_dwordx4 v[20:23], v13, s[68:71], s58 offen sc1
    s_waitcnt vmcnt(21) lgkmcnt(0)
    s_barrier
    v_mfma_f32_16x16x32_bf16 a[128:131], a[80:83], a[0:3], a[128:131]
    ds_read_b64_tr_b16 a[64:65], v4 offset:32768
    v_mfma_f32_16x16x32_bf16 a[128:131], a[84:87], a[32:35], a[128:131]
    ds_read_b64_tr_b16 a[66:67], v4 offset:33792
    v_mfma_f32_16x16x32_bf16 a[132:135], a[80:83], a[4:7], a[132:135]
    v_mfma_f32_16x16x32_bf16 a[132:135], a[84:87], a[36:39], a[132:135]
    ds_read_b64_tr_b16 a[68:69], v4 offset:40960
    v_mfma_f32_16x16x32_bf16 a[136:139], a[80:83], a[8:11], a[136:139]
    ds_read_b64_tr_b16 a[70:71], v4 offset:41984
    v_mfma_f32_16x16x32_bf16 a[136:139], a[84:87], a[40:43], a[136:139]
    v_mfma_f32_16x16x32_bf16 a[140:143], a[80:83], a[12:15], a[140:143]
    ds_read_b64_tr_b16 a[72:73], v5 offset:32768
    v_mfma_f32_16x16x32_bf16 a[140:143], a[84:87], a[44:47], a[140:143]
    ds_read_b64_tr_b16 a[74:75], v5 offset:33792
    v_perm_b32 v16, v30, v26, s55
    v_mfma_f32_16x16x32_bf16 a[144:147], a[80:83], a[16:19], a[144:147]
    v_mfma_f32_16x16x32_bf16 a[144:147], a[84:87], a[48:51], a[144:147]
    ds_read_b64_tr_b16 a[76:77], v5 offset:40960
    v_perm_b32 v17, v38, v34, s55
    v_mfma_f32_16x16x32_bf16 a[148:151], a[80:83], a[20:23], a[148:151]
    ds_read_b64_tr_b16 a[78:79], v5 offset:41984
    v_mfma_f32_16x16x32_bf16 a[148:151], a[84:87], a[52:55], a[148:151]
    v_perm_b32 v18, v46, v42, s55
    v_perm_b32 v19, v54, v50, s55
    v_mfma_f32_16x16x32_bf16 a[152:155], a[80:83], a[24:27], a[152:155]
    s_add_u32 m0, s37, 16384
    v_mfma_f32_16x16x32_bf16 a[152:155], a[84:87], a[56:59], a[152:155]
    buffer_load_dwordx4 v9, s[16:19], s32 offen lds
    v_mfma_f32_16x16x32_bf16 a[156:159], a[80:83], a[28:31], a[156:159]
    s_add_u32 s32, s32, 458752
    v_mfma_f32_16x16x32_bf16 a[156:159], a[84:87], a[60:63], a[156:159]
    s_mov_b32 s57, 34304
    buffer_store_dwordx4 v[16:19], v13, s[68:71], s57 offen sc1
    v_mfma_f32_16x16x32_bf16 a[160:163], a[88:91], a[0:3], a[160:163]
    ds_read_b128 a[0:3], v2 offset:0
    v_mfma_f32_16x16x32_bf16 a[160:163], a[92:95], a[32:35], a[160:163]
    ds_read_b128 a[32:35], v3 offset:0
    v_mfma_f32_16x16x32_bf16 a[164:167], a[88:91], a[4:7], a[164:167]
    ds_read_b128 a[4:7], v2 offset:2048
    v_mfma_f32_16x16x32_bf16 a[164:167], a[92:95], a[36:39], a[164:167]
    ds_read_b128 a[36:39], v3 offset:2048
    v_mfma_f32_16x16x32_bf16 a[168:171], a[88:91], a[8:11], a[168:171]
    ds_read_b128 a[8:11], v2 offset:4096
    v_mfma_f32_16x16x32_bf16 a[168:171], a[92:95], a[40:43], a[168:171]
    ds_read_b128 a[40:43], v3 offset:4096
    v_mfma_f32_16x16x32_bf16 a[172:175], a[88:91], a[12:15], a[172:175]
    ds_read_b128 a[12:15], v2 offset:6144
    v_mfma_f32_16x16x32_bf16 a[172:175], a[92:95], a[44:47], a[172:175]
    ds_read_b128 a[44:47], v3 offset:6144
    v_perm_b32 v20, v30, v26, s56
    v_mfma_f32_16x16x32_bf16 a[176:179], a[88:91], a[16:19], a[176:179]
    ds_read_b128 a[16:19], v2 offset:8192
    v_mfma_f32_16x16x32_bf16 a[176:179], a[92:95], a[48:51], a[176:179]
    ds_read_b128 a[48:51], v3 offset:8192
    v_perm_b32 v21, v38, v34, s56
    v_mfma_f32_16x16x32_bf16 a[180:183], a[88:91], a[20:23], a[180:183]
    ds_read_b128 a[20:23], v2 offset:10240
    v_mfma_f32_16x16x32_bf16 a[180:183], a[92:95], a[52:55], a[180:183]
    ds_read_b128 a[52:55], v3 offset:10240
    v_perm_b32 v22, v46, v42, s56
    v_perm_b32 v23, v54, v50, s56
    v_mfma_f32_16x16x32_bf16 a[184:187], a[88:91], a[24:27], a[184:187]
    ds_read_b128 a[24:27], v2 offset:12288
    v_mfma_f32_16x16x32_bf16 a[184:187], a[92:95], a[56:59], a[184:187]
    ds_read_b128 a[56:59], v3 offset:12288
    v_mfma_f32_16x16x32_bf16 a[188:191], a[88:91], a[28:31], a[188:191]
    ds_read_b128 a[28:31], v2 offset:14336
    v_mfma_f32_16x16x32_bf16 a[188:191], a[92:95], a[60:63], a[188:191]
    ds_read_b128 a[60:63], v3 offset:14336
    s_mov_b32 s58, 42880
    buffer_store_dwordx4 v[20:23], v13, s[68:71], s58 offen sc1
    s_waitcnt lgkmcnt(10)
    v_mfma_f32_16x16x32_bf16 v[64:67], a[64:67], a[0:3], v[64:67]
    ds_read_b64_tr_b16 a[80:81], v6 offset:32768
    v_mfma_f32_16x16x32_bf16 v[64:67], a[68:71], a[32:35], v[64:67]
    v_mfma_f32_16x16x32_bf16 v[68:71], a[64:67], a[4:7], v[68:71]
    ds_read_b64_tr_b16 a[82:83], v6 offset:33792
    v_mfma_f32_16x16x32_bf16 v[68:71], a[68:71], a[36:39], v[68:71]
    v_mfma_f32_16x16x32_bf16 v[72:75], a[64:67], a[8:11], v[72:75]
    ds_read_b64_tr_b16 a[84:85], v6 offset:40960
    v_mfma_f32_16x16x32_bf16 v[72:75], a[68:71], a[40:43], v[72:75]
    s_waitcnt lgkmcnt(7)
    v_mfma_f32_16x16x32_bf16 v[76:79], a[64:67], a[12:15], v[76:79]
    ds_read_b64_tr_b16 a[86:87], v6 offset:41984
    v_mfma_f32_16x16x32_bf16 v[76:79], a[68:71], a[44:47], v[76:79]
    v_perm_b32 v16, v31, v27, s55
    v_mfma_f32_16x16x32_bf16 v[80:83], a[64:67], a[16:19], v[80:83]
    s_add_u32 m0, s37, 20480
    v_mfma_f32_16x16x32_bf16 v[80:83], a[68:71], a[48:51], v[80:83]
    v_perm_b32 v17, v39, v35, s55
    buffer_load_dwordx4 v9, s[16:19], s33 offen lds
    v_mfma_f32_16x16x32_bf16 v[84:87], a[64:67], a[20:23], v[84:87]
    s_add_u32 s33, s33, 458752
    s_add_u32 m0, s37, 24576
    v_mfma_f32_16x16x32_bf16 v[84:87], a[68:71], a[52:55], v[84:87]
    v_perm_b32 v18, v47, v43, s55
    v_perm_b32 v19, v55, v51, s55
    buffer_load_dwordx4 v9, s[16:19], s34 offen lds
    s_waitcnt lgkmcnt(2)
    v_mfma_f32_16x16x32_bf16 v[88:91], a[64:67], a[24:27], v[88:91]
    s_add_u32 s34, s34, 458752
    s_add_u32 m0, s37, 28672
    v_mfma_f32_16x16x32_bf16 v[88:91], a[68:71], a[56:59], v[88:91]
    buffer_load_dwordx4 v9, s[16:19], s35 offen lds
    v_mfma_f32_16x16x32_bf16 v[92:95], a[64:67], a[28:31], v[92:95]
    s_add_u32 s35, s35, 458752
    s_add_u32 m0, s36, 65536
    v_mfma_f32_16x16x32_bf16 v[92:95], a[68:71], a[60:63], v[92:95]
    buffer_load_dwordx4 v8, s[8:11], s24 offen lds
    s_mov_b32 s57, 51456
    buffer_store_dwordx4 v[16:19], v13, s[68:71], s57 offen sc1
    v_mfma_f32_16x16x32_bf16 v[96:99], a[72:75], a[0:3], v[96:99]
    ds_read_b64_tr_b16 a[88:89], v7 offset:32768
    v_mfma_f32_16x16x32_bf16 v[96:99], a[76:79], a[32:35], v[96:99]
    v_mfma_f32_16x16x32_bf16 v[100:103], a[72:75], a[4:7], v[100:103]
    ds_read_b64_tr_b16 a[90:91], v7 offset:33792
    v_mfma_f32_16x16x32_bf16 v[100:103], a[76:79], a[36:39], v[100:103]
    v_mfma_f32_16x16x32_bf16 v[104:107], a[72:75], a[8:11], v[104:107]
    ds_read_b64_tr_b16 a[92:93], v7 offset:40960
    v_mfma_f32_16x16x32_bf16 v[104:107], a[76:79], a[40:43], v[104:107]
    v_mfma_f32_16x16x32_bf16 v[108:111], a[72:75], a[12:15], v[108:111]
    ds_read_b64_tr_b16 a[94:95], v7 offset:41984
    v_mfma_f32_16x16x32_bf16 v[108:111], a[76:79], a[44:47], v[108:111]
    v_perm_b32 v20, v31, v27, s56
    v_mfma_f32_16x16x32_bf16 v[112:115], a[72:75], a[16:19], v[112:115]
    s_add_u32 m0, s36, 69632
    v_mfma_f32_16x16x32_bf16 v[112:115], a[76:79], a[48:51], v[112:115]
    v_perm_b32 v21, v39, v35, s56
    buffer_load_dwordx4 v8, s[8:11], s25 offen lds
    v_mfma_f32_16x16x32_bf16 v[116:119], a[72:75], a[20:23], v[116:119]
    s_add_u32 m0, s36, 73728
    v_mfma_f32_16x16x32_bf16 v[116:119], a[76:79], a[52:55], v[116:119]
    v_perm_b32 v22, v47, v43, s56
    v_perm_b32 v23, v55, v51, s56
    buffer_load_dwordx4 v8, s[8:11], s26 offen lds
    v_mfma_f32_16x16x32_bf16 v[120:123], a[72:75], a[24:27], v[120:123]
    s_add_u32 m0, s36, 77824
    v_mfma_f32_16x16x32_bf16 v[120:123], a[76:79], a[56:59], v[120:123]
    buffer_load_dwordx4 v8, s[8:11], s27 offen lds
    v_mfma_f32_16x16x32_bf16 v[124:127], a[72:75], a[28:31], v[124:127]
    v_mfma_f32_16x16x32_bf16 v[124:127], a[76:79], a[60:63], v[124:127]
    s_mov_b32 s58, 60032
    buffer_store_dwordx4 v[20:23], v13, s[68:71], s58 offen sc1
    s_waitcnt vmcnt(28) lgkmcnt(0)
    s_barrier
    v_mfma_f32_16x16x32_bf16 v[128:131], a[80:83], a[0:3], v[128:131]
    ds_read_b64_tr_b16 a[64:65], v4 offset:49152
    v_mfma_f32_16x16x32_bf16 v[128:131], a[84:87], a[32:35], v[128:131]
    v_mfma_f32_16x16x32_bf16 v[132:135], a[80:83], a[4:7], v[132:135]
    ds_read_b64_tr_b16 a[66:67], v4 offset:50176
    v_mfma_f32_16x16x32_bf16 v[132:135], a[84:87], a[36:39], v[132:135]
    v_mfma_f32_16x16x32_bf16 v[136:139], a[80:83], a[8:11], v[136:139]
    ds_read_b64_tr_b16 a[68:69], v4 offset:57344
    v_mfma_f32_16x16x32_bf16 v[136:139], a[84:87], a[40:43], v[136:139]
    v_mfma_f32_16x16x32_bf16 v[140:143], a[80:83], a[12:15], v[140:143]
    ds_read_b64_tr_b16 a[70:71], v4 offset:58368
    v_mfma_f32_16x16x32_bf16 v[140:143], a[84:87], a[44:47], v[140:143]
    v_mfma_f32_16x16x32_bf16 v[144:147], a[80:83], a[16:19], v[144:147]
    s_add_u32 m0, s37, 32768
    v_mfma_f32_16x16x32_bf16 v[144:147], a[84:87], a[48:51], v[144:147]
    buffer_load_dwordx4 v9, s[12:15], s32 offen lds
    v_mfma_f32_16x16x32_bf16 v[148:151], a[80:83], a[20:23], v[148:151]
    v_mfma_f32_16x16x32_bf16 v[148:151], a[84:87], a[52:55], v[148:151]
    v_mfma_f32_16x16x32_bf16 v[152:155], a[80:83], a[24:27], v[152:155]
    s_add_u32 m0, s37, 36864
    v_mfma_f32_16x16x32_bf16 v[152:155], a[84:87], a[56:59], v[152:155]
    buffer_load_dwordx4 v9, s[12:15], s33 offen lds
    v_mfma_f32_16x16x32_bf16 v[156:159], a[80:83], a[28:31], v[156:159]
    v_mfma_f32_16x16x32_bf16 v[156:159], a[84:87], a[60:63], v[156:159]
    v_mfma_f32_16x16x32_bf16 v[160:163], a[88:91], a[0:3], v[160:163]
    ds_read_b64_tr_b16 a[72:73], v5 offset:49152
    v_mfma_f32_16x16x32_bf16 v[160:163], a[92:95], a[32:35], v[160:163]
    v_mfma_f32_16x16x32_bf16 v[164:167], a[88:91], a[4:7], v[164:167]
    ds_read_b64_tr_b16 a[74:75], v5 offset:50176
    v_mfma_f32_16x16x32_bf16 v[164:167], a[92:95], a[36:39], v[164:167]
    v_mfma_f32_16x16x32_bf16 v[168:171], a[88:91], a[8:11], v[168:171]
    ds_read_b64_tr_b16 a[76:77], v5 offset:57344
    v_mfma_f32_16x16x32_bf16 v[168:171], a[92:95], a[40:43], v[168:171]
    v_mfma_f32_16x16x32_bf16 v[172:175], a[88:91], a[12:15], v[172:175]
    ds_read_b64_tr_b16 a[78:79], v5 offset:58368
    v_mfma_f32_16x16x32_bf16 v[172:175], a[92:95], a[44:47], v[172:175]
    v_mfma_f32_16x16x32_bf16 v[176:179], a[88:91], a[16:19], v[176:179]
    s_add_u32 m0, s37, 40960
    v_mfma_f32_16x16x32_bf16 v[176:179], a[92:95], a[48:51], v[176:179]
    buffer_load_dwordx4 v9, s[12:15], s34 offen lds
    v_mfma_f32_16x16x32_bf16 v[180:183], a[88:91], a[20:23], v[180:183]
    v_mfma_f32_16x16x32_bf16 v[180:183], a[92:95], a[52:55], v[180:183]
    v_mfma_f32_16x16x32_bf16 v[184:187], a[88:91], a[24:27], v[184:187]
    s_add_u32 m0, s37, 45056
    v_mfma_f32_16x16x32_bf16 v[184:187], a[92:95], a[56:59], v[184:187]
    buffer_load_dwordx4 v9, s[12:15], s35 offen lds
    v_mfma_f32_16x16x32_bf16 v[188:191], a[88:91], a[28:31], v[188:191]
    v_mfma_f32_16x16x32_bf16 v[188:191], a[92:95], a[60:63], v[188:191]
    s_waitcnt lgkmcnt(1)
    v_mfma_f32_16x16x32_bf16 v[192:195], a[64:67], a[0:3], v[192:195]
    ds_read_b64_tr_b16 a[80:81], v6 offset:49152
    v_mfma_f32_16x16x32_bf16 v[192:195], a[68:71], a[32:35], v[192:195]
    v_mfma_f32_16x16x32_bf16 v[196:199], a[64:67], a[4:7], v[196:199]
    ds_read_b64_tr_b16 a[82:83], v6 offset:50176
    v_mfma_f32_16x16x32_bf16 v[196:199], a[68:71], a[36:39], v[196:199]
    v_mfma_f32_16x16x32_bf16 v[200:203], a[64:67], a[8:11], v[200:203]
    ds_read_b64_tr_b16 a[84:85], v6 offset:57344
    v_mfma_f32_16x16x32_bf16 v[200:203], a[68:71], a[40:43], v[200:203]
    v_mfma_f32_16x16x32_bf16 v[204:207], a[64:67], a[12:15], v[204:207]
    ds_read_b64_tr_b16 a[86:87], v6 offset:58368
    v_mfma_f32_16x16x32_bf16 v[204:207], a[68:71], a[44:47], v[204:207]
    s_add_u32 m0, s36, 81920
    v_mfma_f32_16x16x32_bf16 v[208:211], a[64:67], a[16:19], v[208:211]
    buffer_load_dwordx4 v8, s[8:11], s28 offen lds
    v_mfma_f32_16x16x32_bf16 v[208:211], a[68:71], a[48:51], v[208:211]
    v_mfma_f32_16x16x32_bf16 v[212:215], a[64:67], a[20:23], v[212:215]
    v_mfma_f32_16x16x32_bf16 v[212:215], a[68:71], a[52:55], v[212:215]
    s_add_u32 m0, s36, 86016
    v_mfma_f32_16x16x32_bf16 v[216:219], a[64:67], a[24:27], v[216:219]
    buffer_load_dwordx4 v8, s[8:11], s29 offen lds
    v_mfma_f32_16x16x32_bf16 v[216:219], a[68:71], a[56:59], v[216:219]
    v_mfma_f32_16x16x32_bf16 v[220:223], a[64:67], a[28:31], v[220:223]
    v_mfma_f32_16x16x32_bf16 v[220:223], a[68:71], a[60:63], v[220:223]
    v_mfma_f32_16x16x32_bf16 v[224:227], a[72:75], a[0:3], v[224:227]
    ds_read_b64_tr_b16 a[88:89], v7 offset:49152
    s_waitcnt lgkmcnt(5)
    v_mfma_f32_16x16x32_bf16 v[224:227], a[76:79], a[32:35], v[224:227]
    v_mfma_f32_16x16x32_bf16 v[228:231], a[72:75], a[4:7], v[228:231]
    ds_read_b64_tr_b16 a[90:91], v7 offset:50176
    v_mfma_f32_16x16x32_bf16 v[228:231], a[76:79], a[36:39], v[228:231]
    v_mfma_f32_16x16x32_bf16 v[232:235], a[72:75], a[8:11], v[232:235]
    ds_read_b64_tr_b16 a[92:93], v7 offset:57344
    v_mfma_f32_16x16x32_bf16 v[232:235], a[76:79], a[40:43], v[232:235]
    v_mfma_f32_16x16x32_bf16 v[236:239], a[72:75], a[12:15], v[236:239]
    ds_read_b64_tr_b16 a[94:95], v7 offset:58368
    v_mfma_f32_16x16x32_bf16 v[236:239], a[76:79], a[44:47], v[236:239]
    s_add_u32 m0, s36, 90112
    v_mfma_f32_16x16x32_bf16 v[240:243], a[72:75], a[16:19], v[240:243]
    buffer_load_dwordx4 v8, s[8:11], s30 offen lds
    v_mfma_f32_16x16x32_bf16 v[240:243], a[76:79], a[48:51], v[240:243]
    v_mfma_f32_16x16x32_bf16 v[244:247], a[72:75], a[20:23], v[244:247]
    v_mfma_f32_16x16x32_bf16 v[244:247], a[76:79], a[52:55], v[244:247]
    s_add_u32 m0, s36, 94208
    v_mfma_f32_16x16x32_bf16 v[248:251], a[72:75], a[24:27], v[248:251]
    buffer_load_dwordx4 v8, s[8:11], s31 offen lds
    v_mfma_f32_16x16x32_bf16 v[248:251], a[76:79], a[56:59], v[248:251]
    s_add_u32 s8, s8, 128
    s_addc_u32 s9, s9, 0
    s_sub_u32 s10, s10, 128
    v_mfma_f32_16x16x32_bf16 v[252:255], a[72:75], a[28:31], v[252:255]
    v_mfma_f32_16x16x32_bf16 v[252:255], a[76:79], a[60:63], v[252:255]
    s_waitcnt vmcnt(8) lgkmcnt(0)
    s_barrier
    v_mfma_f32_16x16x32_bf16 a[128:131], a[80:83], a[0:3], a[128:131]
    ds_read_b64_tr_b16 a[64:65], v4 offset:0
    v_mfma_f32_16x16x32_bf16 a[128:131], a[84:87], a[32:35], a[128:131]
    ds_read_b64_tr_b16 a[66:67], v4 offset:1024
    v_mfma_f32_16x16x32_bf16 a[132:135], a[80:83], a[4:7], a[132:135]
    v_mfma_f32_16x16x32_bf16 a[132:135], a[84:87], a[36:39], a[132:135]
    ds_read_b64_tr_b16 a[68:69], v4 offset:8192
    v_mfma_f32_16x16x32_bf16 a[136:139], a[80:83], a[8:11], a[136:139]
    ds_read_b64_tr_b16 a[70:71], v4 offset:9216
    v_mfma_f32_16x16x32_bf16 a[136:139], a[84:87], a[40:43], a[136:139]
    v_mfma_f32_16x16x32_bf16 a[140:143], a[80:83], a[12:15], a[140:143]
    ds_read_b64_tr_b16 a[72:73], v5 offset:0
    v_mfma_f32_16x16x32_bf16 a[140:143], a[84:87], a[44:47], a[140:143]
    ds_read_b64_tr_b16 a[74:75], v5 offset:1024
    v_mfma_f32_16x16x32_bf16 a[144:147], a[80:83], a[16:19], a[144:147]
    v_mfma_f32_16x16x32_bf16 a[144:147], a[84:87], a[48:51], a[144:147]
    ds_read_b64_tr_b16 a[76:77], v5 offset:8192
    v_mfma_f32_16x16x32_bf16 a[148:151], a[80:83], a[20:23], a[148:151]
    ds_read_b64_tr_b16 a[78:79], v5 offset:9216
    v_mfma_f32_16x16x32_bf16 a[148:151], a[84:87], a[52:55], a[148:151]
    v_mfma_f32_16x16x32_bf16 a[152:155], a[80:83], a[24:27], a[152:155]
    s_add_u32 m0, s37, 49152
    v_mfma_f32_16x16x32_bf16 a[152:155], a[84:87], a[56:59], a[152:155]
    buffer_load_dwordx4 v9, s[16:19], s32 offen lds
    v_mfma_f32_16x16x32_bf16 a[156:159], a[80:83], a[28:31], a[156:159]
    s_add_u32 s32, s32, 458752
    v_mfma_f32_16x16x32_bf16 a[156:159], a[84:87], a[60:63], a[156:159]
    v_mfma_f32_16x16x32_bf16 a[160:163], a[88:91], a[0:3], a[160:163]
    ds_read_b128 a[0:3], v2 offset:32768
    v_mfma_f32_16x16x32_bf16 a[160:163], a[92:95], a[32:35], a[160:163]
    ds_read_b128 a[32:35], v3 offset:32768
    v_mfma_f32_16x16x32_bf16 a[164:167], a[88:91], a[4:7], a[164:167]
    ds_read_b128 a[4:7], v2 offset:34816
    v_mfma_f32_16x16x32_bf16 a[164:167], a[92:95], a[36:39], a[164:167]
    ds_read_b128 a[36:39], v3 offset:34816
    v_add_u32 v57, 1, v57
    buffer_store_dword v57, v56, s[68:71], s59 offen sc1
    v_mfma_f32_16x16x32_bf16 a[168:171], a[88:91], a[8:11], a[168:171]
    ds_read_b128 a[8:11], v2 offset:36864
    v_mfma_f32_16x16x32_bf16 a[168:171], a[92:95], a[40:43], a[168:171]
    ds_read_b128 a[40:43], v3 offset:36864
    v_mfma_f32_16x16x32_bf16 a[172:175], a[88:91], a[12:15], a[172:175]
    ds_read_b128 a[12:15], v2 offset:38912
    v_mfma_f32_16x16x32_bf16 a[172:175], a[92:95], a[44:47], a[172:175]
    ds_read_b128 a[44:47], v3 offset:38912
    v_mfma_f32_16x16x32_bf16 a[176:179], a[88:91], a[16:19], a[176:179]
    ds_read_b128 a[16:19], v2 offset:40960
    v_mfma_f32_16x16x32_bf16 a[176:179], a[92:95], a[48:51], a[176:179]
    ds_read_b128 a[48:51], v3 offset:40960
    v_mfma_f32_16x16x32_bf16 a[180:183], a[88:91], a[20:23], a[180:183]
    ds_read_b128 a[20:23], v2 offset:43008
    v_mfma_f32_16x16x32_bf16 a[180:183], a[92:95], a[52:55], a[180:183]
    ds_read_b128 a[52:55], v3 offset:43008
    v_mfma_f32_16x16x32_bf16 a[184:187], a[88:91], a[24:27], a[184:187]
    ds_read_b128 a[24:27], v2 offset:45056
    v_mfma_f32_16x16x32_bf16 a[184:187], a[92:95], a[56:59], a[184:187]
    ds_read_b128 a[56:59], v3 offset:45056
    v_mfma_f32_16x16x32_bf16 a[188:191], a[88:91], a[28:31], a[188:191]
    ds_read_b128 a[28:31], v2 offset:47104
    v_mfma_f32_16x16x32_bf16 a[188:191], a[92:95], a[60:63], a[188:191]
    ds_read_b128 a[60:63], v3 offset:47104
    s_waitcnt lgkmcnt(10)
    v_mfma_f32_16x16x32_bf16 v[64:67], a[64:67], a[0:3], v[64:67]
    ds_read_b64_tr_b16 a[80:81], v6 offset:0
    v_mfma_f32_16x16x32_bf16 v[64:67], a[68:71], a[32:35], v[64:67]
    v_mfma_f32_16x16x32_bf16 v[68:71], a[64:67], a[4:7], v[68:71]
    ds_read_b64_tr_b16 a[82:83], v6 offset:1024
    v_mfma_f32_16x16x32_bf16 v[68:71], a[68:71], a[36:39], v[68:71]
    v_mfma_f32_16x16x32_bf16 v[72:75], a[64:67], a[8:11], v[72:75]
    ds_read_b64_tr_b16 a[84:85], v6 offset:8192
    v_mfma_f32_16x16x32_bf16 v[72:75], a[68:71], a[40:43], v[72:75]
    s_waitcnt lgkmcnt(7)
    v_mfma_f32_16x16x32_bf16 v[76:79], a[64:67], a[12:15], v[76:79]
    ds_read_b64_tr_b16 a[86:87], v6 offset:9216
    v_mfma_f32_16x16x32_bf16 v[76:79], a[68:71], a[44:47], v[76:79]
    v_mfma_f32_16x16x32_bf16 v[80:83], a[64:67], a[16:19], v[80:83]
    s_add_u32 m0, s37, 53248
    v_mfma_f32_16x16x32_bf16 v[80:83], a[68:71], a[48:51], v[80:83]
    buffer_load_dwordx4 v9, s[16:19], s33 offen lds
    v_mfma_f32_16x16x32_bf16 v[84:87], a[64:67], a[20:23], v[84:87]
    s_add_u32 s33, s33, 458752
    s_add_u32 m0, s37, 57344
    v_mfma_f32_16x16x32_bf16 v[84:87], a[68:71], a[52:55], v[84:87]
    buffer_load_dwordx4 v9, s[16:19], s34 offen lds
    s_waitcnt lgkmcnt(2)
    v_mfma_f32_16x16x32_bf16 v[88:91], a[64:67], a[24:27], v[88:91]
    s_add_u32 s34, s34, 458752
    s_add_u32 m0, s37, 61440
    v_mfma_f32_16x16x32_bf16 v[88:91], a[68:71], a[56:59], v[88:91]
    buffer_load_dwordx4 v9, s[16:19], s35 offen lds
    v_mfma_f32_16x16x32_bf16 v[92:95], a[64:67], a[28:31], v[92:95]
    s_add_u32 s35, s35, 458752
    s_add_u32 m0, s36, 0
    v_mfma_f32_16x16x32_bf16 v[92:95], a[68:71], a[60:63], v[92:95]
    buffer_load_dwordx4 v8, s[8:11], s24 offen lds
    v_mfma_f32_16x16x32_bf16 v[96:99], a[72:75], a[0:3], v[96:99]
    ds_read_b64_tr_b16 a[88:89], v7 offset:0
    v_mfma_f32_16x16x32_bf16 v[96:99], a[76:79], a[32:35], v[96:99]
    v_mfma_f32_16x16x32_bf16 v[100:103], a[72:75], a[4:7], v[100:103]
    ds_read_b64_tr_b16 a[90:91], v7 offset:1024
    v_mfma_f32_16x16x32_bf16 v[100:103], a[76:79], a[36:39], v[100:103]
    v_mfma_f32_16x16x32_bf16 v[104:107], a[72:75], a[8:11], v[104:107]
    ds_read_b64_tr_b16 a[92:93], v7 offset:8192
    v_mfma_f32_16x16x32_bf16 v[104:107], a[76:79], a[40:43], v[104:107]
    v_mfma_f32_16x16x32_bf16 v[108:111], a[72:75], a[12:15], v[108:111]
    ds_read_b64_tr_b16 a[94:95], v7 offset:9216
    v_mfma_f32_16x16x32_bf16 v[108:111], a[76:79], a[44:47], v[108:111]
    v_mfma_f32_16x16x32_bf16 v[112:115], a[72:75], a[16:19], v[112:115]
    s_add_u32 m0, s36, 4096
    v_mfma_f32_16x16x32_bf16 v[112:115], a[76:79], a[48:51], v[112:115]
    buffer_load_dwordx4 v8, s[8:11], s25 offen lds
    v_mfma_f32_16x16x32_bf16 v[116:119], a[72:75], a[20:23], v[116:119]
    s_add_u32 m0, s36, 8192
    v_mfma_f32_16x16x32_bf16 v[116:119], a[76:79], a[52:55], v[116:119]
    buffer_load_dwordx4 v8, s[8:11], s26 offen lds
    v_mfma_f32_16x16x32_bf16 v[120:123], a[72:75], a[24:27], v[120:123]
    s_add_u32 m0, s36, 12288
    v_mfma_f32_16x16x32_bf16 v[120:123], a[76:79], a[56:59], v[120:123]
    buffer_load_dwordx4 v8, s[8:11], s27 offen lds
    v_mfma_f32_16x16x32_bf16 v[124:127], a[72:75], a[28:31], v[124:127]
    v_mfma_f32_16x16x32_bf16 v[124:127], a[76:79], a[60:63], v[124:127]
    s_waitcnt vmcnt(23) lgkmcnt(0)
    s_barrier
    v_mfma_f32_16x16x32_bf16 v[128:131], a[80:83], a[0:3], v[128:131]
    ds_read_b64_tr_b16 a[64:65], v4 offset:16384
    v_mfma_f32_16x16x32_bf16 v[128:131], a[84:87], a[32:35], v[128:131]
    v_mfma_f32_16x16x32_bf16 v[132:135], a[80:83], a[4:7], v[132:135]
    ds_read_b64_tr_b16 a[66:67], v4 offset:17408
    v_mfma_f32_16x16x32_bf16 v[132:135], a[84:87], a[36:39], v[132:135]
    v_mfma_f32_16x16x32_bf16 v[136:139], a[80:83], a[8:11], v[136:139]
    ds_read_b64_tr_b16 a[68:69], v4 offset:24576
    v_mfma_f32_16x16x32_bf16 v[136:139], a[84:87], a[40:43], v[136:139]
    v_mfma_f32_16x16x32_bf16 v[140:143], a[80:83], a[12:15], v[140:143]
    ds_read_b64_tr_b16 a[70:71], v4 offset:25600
    v_mfma_f32_16x16x32_bf16 v[140:143], a[84:87], a[44:47], v[140:143]
    v_mfma_f32_16x16x32_bf16 v[144:147], a[80:83], a[16:19], v[144:147]
    s_add_u32 m0, s37, 0
    v_mfma_f32_16x16x32_bf16 v[144:147], a[84:87], a[48:51], v[144:147]
    buffer_load_dwordx4 v9, s[12:15], s32 offen lds
    v_mfma_f32_16x16x32_bf16 v[148:151], a[80:83], a[20:23], v[148:151]
    v_mfma_f32_16x16x32_bf16 v[148:151], a[84:87], a[52:55], v[148:151]
    v_mfma_f32_16x16x32_bf16 v[152:155], a[80:83], a[24:27], v[152:155]
    s_add_u32 m0, s37, 4096
    v_mfma_f32_16x16x32_bf16 v[152:155], a[84:87], a[56:59], v[152:155]
    buffer_load_dwordx4 v9, s[12:15], s33 offen lds
    v_mfma_f32_16x16x32_bf16 v[156:159], a[80:83], a[28:31], v[156:159]
    v_mfma_f32_16x16x32_bf16 v[156:159], a[84:87], a[60:63], v[156:159]
    v_mfma_f32_16x16x32_bf16 v[160:163], a[88:91], a[0:3], v[160:163]
    ds_read_b64_tr_b16 a[72:73], v5 offset:16384
    v_mfma_f32_16x16x32_bf16 v[160:163], a[92:95], a[32:35], v[160:163]
    v_mfma_f32_16x16x32_bf16 v[164:167], a[88:91], a[4:7], v[164:167]
    ds_read_b64_tr_b16 a[74:75], v5 offset:17408
    v_mfma_f32_16x16x32_bf16 v[164:167], a[92:95], a[36:39], v[164:167]
    v_mfma_f32_16x16x32_bf16 v[168:171], a[88:91], a[8:11], v[168:171]
    ds_read_b64_tr_b16 a[76:77], v5 offset:24576
    v_mfma_f32_16x16x32_bf16 v[168:171], a[92:95], a[40:43], v[168:171]
    v_mfma_f32_16x16x32_bf16 v[172:175], a[88:91], a[12:15], v[172:175]
    ds_read_b64_tr_b16 a[78:79], v5 offset:25600
    v_mfma_f32_16x16x32_bf16 v[172:175], a[92:95], a[44:47], v[172:175]
    v_mfma_f32_16x16x32_bf16 v[176:179], a[88:91], a[16:19], v[176:179]
    s_add_u32 m0, s37, 8192
    v_mfma_f32_16x16x32_bf16 v[176:179], a[92:95], a[48:51], v[176:179]
    buffer_load_dwordx4 v9, s[12:15], s34 offen lds
    v_mfma_f32_16x16x32_bf16 v[180:183], a[88:91], a[20:23], v[180:183]
    v_mfma_f32_16x16x32_bf16 v[180:183], a[92:95], a[52:55], v[180:183]
    v_mfma_f32_16x16x32_bf16 v[184:187], a[88:91], a[24:27], v[184:187]
    s_add_u32 m0, s37, 12288
    v_mfma_f32_16x16x32_bf16 v[184:187], a[92:95], a[56:59], v[184:187]
    buffer_load_dwordx4 v9, s[12:15], s35 offen lds
    v_mfma_f32_16x16x32_bf16 v[188:191], a[88:91], a[28:31], v[188:191]
    v_mfma_f32_16x16x32_bf16 v[188:191], a[92:95], a[60:63], v[188:191]
    s_waitcnt lgkmcnt(1)
    v_mfma_f32_16x16x32_bf16 v[192:195], a[64:67], a[0:3], v[192:195]
    ds_read_b64_tr_b16 a[80:81], v6 offset:16384
    v_mfma_f32_16x16x32_bf16 v[192:195], a[68:71], a[32:35], v[192:195]
    v_mfma_f32_16x16x32_bf16 v[196:199], a[64:67], a[4:7], v[196:199]
    ds_read_b64_tr_b16 a[82:83], v6 offset:17408
    v_mfma_f32_16x16x32_bf16 v[196:199], a[68:71], a[36:39], v[196:199]
    v_mfma_f32_16x16x32_bf16 v[200:203], a[64:67], a[8:11], v[200:203]
    ds_read_b64_tr_b16 a[84:85], v6 offset:24576
    v_mfma_f32_16x16x32_bf16 v[200:203], a[68:71], a[40:43], v[200:203]
    v_mfma_f32_16x16x32_bf16 v[204:207], a[64:67], a[12:15], v[204:207]
    ds_read_b64_tr_b16 a[86:87], v6 offset:25600
    v_mfma_f32_16x16x32_bf16 v[204:207], a[68:71], a[44:47], v[204:207]
    s_add_u32 m0, s36, 16384
    v_mfma_f32_16x16x32_bf16 v[208:211], a[64:67], a[16:19], v[208:211]
    buffer_load_dwordx4 v8, s[8:11], s28 offen lds
    v_mfma_f32_16x16x32_bf16 v[208:211], a[68:71], a[48:51], v[208:211]
    v_mfma_f32_16x16x32_bf16 v[212:215], a[64:67], a[20:23], v[212:215]
    v_mfma_f32_16x16x32_bf16 v[212:215], a[68:71], a[52:55], v[212:215]
    s_add_u32 m0, s36, 20480
    v_mfma_f32_16x16x32_bf16 v[216:219], a[64:67], a[24:27], v[216:219]
    buffer_load_dwordx4 v8, s[8:11], s29 offen lds
    v_mfma_f32_16x16x32_bf16 v[216:219], a[68:71], a[56:59], v[216:219]
    v_mfma_f32_16x16x32_bf16 v[220:223], a[64:67], a[28:31], v[220:223]
    v_mfma_f32_16x16x32_bf16 v[220:223], a[68:71], a[60:63], v[220:223]
    v_mfma_f32_16x16x32_bf16 v[224:227], a[72:75], a[0:3], v[224:227]
    ds_read_b64_tr_b16 a[88:89], v7 offset:16384
    s_waitcnt lgkmcnt(5)
    v_mfma_f32_16x16x32_bf16 v[224:227], a[76:79], a[32:35], v[224:227]
    v_mfma_f32_16x16x32_bf16 v[228:231], a[72:75], a[4:7], v[228:231]
    ds_read_b64_tr_b16 a[90:91], v7 offset:17408
    v_mfma_f32_16x16x32_bf16 v[228:231], a[76:79], a[36:39], v[228:231]
    v_mfma_f32_16x16x32_bf16 v[232:235], a[72:75], a[8:11], v[232:235]
    ds_read_b64_tr_b16 a[92:93], v7 offset:24576
    v_mfma_f32_16x16x32_bf16 v[232:235], a[76:79], a[40:43], v[232:235]
    v_mfma_f32_16x16x32_bf16 v[236:239], a[72:75], a[12:15], v[236:239]
    ds_read_b64_tr_b16 a[94:95], v7 offset:25600
    v_mfma_f32_16x16x32_bf16 v[236:239], a[76:79], a[44:47], v[236:239]
    s_add_u32 m0, s36, 24576
    v_mfma_f32_16x16x32_bf16 v[240:243], a[72:75], a[16:19], v[240:243]
    buffer_load_dwordx4 v8, s[8:11], s30 offen lds
    v_mfma_f32_16x16x32_bf16 v[240:243], a[76:79], a[48:51], v[240:243]
    v_mfma_f32_16x16x32_bf16 v[244:247], a[72:75], a[20:23], v[244:247]
    v_mfma_f32_16x16x32_bf16 v[244:247], a[76:79], a[52:55], v[244:247]
    s_add_u32 m0, s36, 28672
    v_mfma_f32_16x16x32_bf16 v[248:251], a[72:75], a[24:27], v[248:251]
    buffer_load_dwordx4 v8, s[8:11], s31 offen lds
    v_mfma_f32_16x16x32_bf16 v[248:251], a[76:79], a[56:59], v[248:251]
    s_add_u32 s8, s8, 128
    s_addc_u32 s9, s9, 0
    s_sub_u32 s10, s10, 128
    v_mfma_f32_16x16x32_bf16 v[252:255], a[72:75], a[28:31], v[252:255]
    v_mfma_f32_16x16x32_bf16 v[252:255], a[76:79], a[60:63], v[252:255]
    s_waitcnt vmcnt(17) lgkmcnt(0)
    s_barrier
    v_mfma_f32_16x16x32_bf16 a[128:131], a[80:83], a[0:3], a[128:131]
    ds_read_b64_tr_b16 a[64:65], v4 offset:32768
    v_mfma_f32_16x16x32_bf16 a[128:131], a[84:87], a[32:35], a[128:131]
    ds_read_b64_tr_b16 a[66:67], v4 offset:33792
    v_mfma_f32_16x16x32_bf16 a[132:135], a[80:83], a[4:7], a[132:135]
    v_mfma_f32_16x16x32_bf16 a[132:135], a[84:87], a[36:39], a[132:135]
    ds_read_b64_tr_b16 a[68:69], v4 offset:40960
    v_mfma_f32_16x16x32_bf16 a[136:139], a[80:83], a[8:11], a[136:139]
    ds_read_b64_tr_b16 a[70:71], v4 offset:41984
    v_mfma_f32_16x16x32_bf16 a[136:139], a[84:87], a[40:43], a[136:139]
    v_mfma_f32_16x16x32_bf16 a[140:143], a[80:83], a[12:15], a[140:143]
    ds_read_b64_tr_b16 a[72:73], v5 offset:32768
    v_mfma_f32_16x16x32_bf16 a[140:143], a[84:87], a[44:47], a[140:143]
    ds_read_b64_tr_b16 a[74:75], v5 offset:33792
    v_mfma_f32_16x16x32_bf16 a[144:147], a[80:83], a[16:19], a[144:147]
    v_mfma_f32_16x16x32_bf16 a[144:147], a[84:87], a[48:51], a[144:147]
    ds_read_b64_tr_b16 a[76:77], v5 offset:40960
    v_mfma_f32_16x16x32_bf16 a[148:151], a[80:83], a[20:23], a[148:151]
    ds_read_b64_tr_b16 a[78:79], v5 offset:41984
    v_mfma_f32_16x16x32_bf16 a[148:151], a[84:87], a[52:55], a[148:151]
    v_mfma_f32_16x16x32_bf16 a[152:155], a[80:83], a[24:27], a[152:155]
    s_add_u32 m0, s37, 16384
    v_mfma_f32_16x16x32_bf16 a[152:155], a[84:87], a[56:59], a[152:155]
    buffer_load_dwordx4 v9, s[16:19], s32 offen lds
    v_mfma_f32_16x16x32_bf16 a[156:159], a[80:83], a[28:31], a[156:159]
    s_add_u32 s32, s32, 458752
    v_mfma_f32_16x16x32_bf16 a[156:159], a[84:87], a[60:63], a[156:159]
    v_mfma_f32_16x16x32_bf16 a[160:163], a[88:91], a[0:3], a[160:163]
    ds_read_b128 a[0:3], v60 offset:0
    v_mfma_f32_16x16x32_bf16 a[160:163], a[92:95], a[32:35], a[160:163]
    ds_read_b128 a[32:35], v61 offset:0
    v_mfma_f32_16x16x32_bf16 a[164:167], a[88:91], a[4:7], a[164:167]
    ds_read_b128 a[4:7], v60 offset:2048
    v_mfma_f32_16x16x32_bf16 a[164:167], a[92:95], a[36:39], a[164:167]
    ds_read_b128 a[36:39], v61 offset:2048
    v_mfma_f32_16x16x32_bf16 a[168:171], a[88:91], a[8:11], a[168:171]
    ds_read_b128 a[8:11], v60 offset:4096
    v_mfma_f32_16x16x32_bf16 a[168:171], a[92:95], a[40:43], a[168:171]
    ds_read_b128 a[40:43], v61 offset:4096
    v_mfma_f32_16x16x32_bf16 a[172:175], a[88:91], a[12:15], a[172:175]
    ds_read_b128 a[12:15], v60 offset:6144
    v_mfma_f32_16x16x32_bf16 a[172:175], a[92:95], a[44:47], a[172:175]
    ds_read_b128 a[44:47], v61 offset:6144
    v_mfma_f32_16x16x32_bf16 a[176:179], a[88:91], a[16:19], a[176:179]
    ds_read_b128 a[16:19], v60 offset:8192
    v_mfma_f32_16x16x32_bf16 a[176:179], a[92:95], a[48:51], a[176:179]
    ds_read_b128 a[48:51], v61 offset:8192
    v_mfma_f32_16x16x32_bf16 a[180:183], a[88:91], a[20:23], a[180:183]
    ds_read_b128 a[20:23], v60 offset:10240
    v_mfma_f32_16x16x32_bf16 a[180:183], a[92:95], a[52:55], a[180:183]
    ds_read_b128 a[52:55], v61 offset:10240
    v_mfma_f32_16x16x32_bf16 a[184:187], a[88:91], a[24:27], a[184:187]
    ds_read_b128 a[24:27], v60 offset:12288
    v_mfma_f32_16x16x32_bf16 a[184:187], a[92:95], a[56:59], a[184:187]
    ds_read_b128 a[56:59], v61 offset:12288
    v_mfma_f32_16x16x32_bf16 a[188:191], a[88:91], a[28:31], a[188:191]
    ds_read_b128 a[28:31], v60 offset:14336
    v_mfma_f32_16x16x32_bf16 a[188:191], a[92:95], a[60:63], a[188:191]
    ds_read_b128 a[60:63], v61 offset:14336
    s_waitcnt lgkmcnt(10)
    v_mfma_f32_16x16x32_bf16 v[64:67], a[64:67], a[0:3], v[64:67]
    ds_read_b64_tr_b16 a[80:81], v6 offset:32768
    v_mfma_f32_16x16x32_bf16 v[64:67], a[68:71], a[32:35], v[64:67]
    v_mfma_f32_16x16x32_bf16 v[68:71], a[64:67], a[4:7], v[68:71]
    ds_read_b64_tr_b16 a[82:83], v6 offset:33792
    v_mfma_f32_16x16x32_bf16 v[68:71], a[68:71], a[36:39], v[68:71]
    v_mfma_f32_16x16x32_bf16 v[72:75], a[64:67], a[8:11], v[72:75]
    ds_read_b64_tr_b16 a[84:85], v6 offset:40960
    v_mfma_f32_16x16x32_bf16 v[72:75], a[68:71], a[40:43], v[72:75]
    s_waitcnt lgkmcnt(7)
    v_mfma_f32_16x16x32_bf16 v[76:79], a[64:67], a[12:15], v[76:79]
    ds_read_b64_tr_b16 a[86:87], v6 offset:41984
    v_mfma_f32_16x16x32_bf16 v[76:79], a[68:71], a[44:47], v[76:79]
    v_mfma_f32_16x16x32_bf16 v[80:83], a[64:67], a[16:19], v[80:83]
    s_add_u32 m0, s37, 20480
    v_mfma_f32_16x16x32_bf16 v[80:83], a[68:71], a[48:51], v[80:83]
    buffer_load_dwordx4 v9, s[16:19], s33 offen lds
    v_mfma_f32_16x16x32_bf16 v[84:87], a[64:67], a[20:23], v[84:87]
    s_add_u32 s33, s33, 458752
    s_add_u32 m0, s37, 24576
    v_mfma_f32_16x16x32_bf16 v[84:87], a[68:71], a[52:55], v[84:87]
    buffer_load_dwordx4 v9, s[16:19], s34 offen lds
    s_waitcnt lgkmcnt(2)
    v_mfma_f32_16x16x32_bf16 v[88:91], a[64:67], a[24:27], v[88:91]
    s_add_u32 s34, s34, 458752
    s_add_u32 m0, s37, 28672
    v_mfma_f32_16x16x32_bf16 v[88:91], a[68:71], a[56:59], v[88:91]
    buffer_load_dwordx4 v9, s[16:19], s35 offen lds
    v_mfma_f32_16x16x32_bf16 v[92:95], a[64:67], a[28:31], v[92:95]
    s_add_u32 s35, s35, 458752
    s_add_u32 m0, s36, 32768
    v_mfma_f32_16x16x32_bf16 v[92:95], a[68:71], a[60:63], v[92:95]
    buffer_load_dwordx4 v8, s[8:11], s24 offen lds
    v_mfma_f32_16x16x32_bf16 v[96:99], a[72:75], a[0:3], v[96:99]
    ds_read_b64_tr_b16 a[88:89], v7 offset:32768
    v_mfma_f32_16x16x32_bf16 v[96:99], a[76:79], a[32:35], v[96:99]
    v_mfma_f32_16x16x32_bf16 v[100:103], a[72:75], a[4:7], v[100:103]
    ds_read_b64_tr_b16 a[90:91], v7 offset:33792
    v_mfma_f32_16x16x32_bf16 v[100:103], a[76:79], a[36:39], v[100:103]
    v_mfma_f32_16x16x32_bf16 v[104:107], a[72:75], a[8:11], v[104:107]
    ds_read_b64_tr_b16 a[92:93], v7 offset:40960
    v_mfma_f32_16x16x32_bf16 v[104:107], a[76:79], a[40:43], v[104:107]
    v_mfma_f32_16x16x32_bf16 v[108:111], a[72:75], a[12:15], v[108:111]
    ds_read_b64_tr_b16 a[94:95], v7 offset:41984
    v_mfma_f32_16x16x32_bf16 v[108:111], a[76:79], a[44:47], v[108:111]
    v_mfma_f32_16x16x32_bf16 v[112:115], a[72:75], a[16:19], v[112:115]
    s_add_u32 m0, s36, 36864
    v_mfma_f32_16x16x32_bf16 v[112:115], a[76:79], a[48:51], v[112:115]
    buffer_load_dwordx4 v8, s[8:11], s25 offen lds
    v_mfma_f32_16x16x32_bf16 v[116:119], a[72:75], a[20:23], v[116:119]
    s_add_u32 m0, s36, 40960
    v_mfma_f32_16x16x32_bf16 v[116:119], a[76:79], a[52:55], v[116:119]
    buffer_load_dwordx4 v8, s[8:11], s26 offen lds
    v_mfma_f32_16x16x32_bf16 v[120:123], a[72:75], a[24:27], v[120:123]
    s_add_u32 m0, s36, 45056
    v_mfma_f32_16x16x32_bf16 v[120:123], a[76:79], a[56:59], v[120:123]
    buffer_load_dwordx4 v8, s[8:11], s27 offen lds
    v_mfma_f32_16x16x32_bf16 v[124:127], a[72:75], a[28:31], v[124:127]
    v_mfma_f32_16x16x32_bf16 v[124:127], a[76:79], a[60:63], v[124:127]
    s_waitcnt vmcnt(20) lgkmcnt(0)
    s_barrier
    v_mfma_f32_16x16x32_bf16 v[128:131], a[80:83], a[0:3], v[128:131]
    ds_read_b64_tr_b16 a[64:65], v4 offset:49152
    v_mfma_f32_16x16x32_bf16 v[128:131], a[84:87], a[32:35], v[128:131]
    v_mfma_f32_16x16x32_bf16 v[132:135], a[80:83], a[4:7], v[132:135]
    ds_read_b64_tr_b16 a[66:67], v4 offset:50176
    v_mfma_f32_16x16x32_bf16 v[132:135], a[84:87], a[36:39], v[132:135]
    v_mfma_f32_16x16x32_bf16 v[136:139], a[80:83], a[8:11], v[136:139]
    ds_read_b64_tr_b16 a[68:69], v4 offset:57344
    v_mfma_f32_16x16x32_bf16 v[136:139], a[84:87], a[40:43], v[136:139]
    v_mfma_f32_16x16x32_bf16 v[140:143], a[80:83], a[12:15], v[140:143]
    ds_read_b64_tr_b16 a[70:71], v4 offset:58368
    v_mfma_f32_16x16x32_bf16 v[140:143], a[84:87], a[44:47], v[140:143]
    v_mfma_f32_16x16x32_bf16 v[144:147], a[80:83], a[16:19], v[144:147]
    s_add_u32 m0, s37, 32768
    v_mfma_f32_16x16x32_bf16 v[144:147], a[84:87], a[48:51], v[144:147]
    buffer_load_dwordx4 v9, s[12:15], s32 offen lds
    v_mfma_f32_16x16x32_bf16 v[148:151], a[80:83], a[20:23], v[148:151]
    v_mfma_f32_16x16x32_bf16 v[148:151], a[84:87], a[52:55], v[148:151]
    v_mfma_f32_16x16x32_bf16 v[152:155], a[80:83], a[24:27], v[152:155]
    s_add_u32 m0, s37, 36864
    v_mfma_f32_16x16x32_bf16 v[152:155], a[84:87], a[56:59], v[152:155]
    buffer_load_dwordx4 v9, s[12:15], s33 offen lds
    v_mfma_f32_16x16x32_bf16 v[156:159], a[80:83], a[28:31], v[156:159]
    v_mfma_f32_16x16x32_bf16 v[156:159], a[84:87], a[60:63], v[156:159]
    v_mfma_f32_16x16x32_bf16 v[160:163], a[88:91], a[0:3], v[160:163]
    ds_read_b64_tr_b16 a[72:73], v5 offset:49152
    v_mfma_f32_16x16x32_bf16 v[160:163], a[92:95], a[32:35], v[160:163]
    v_mfma_f32_16x16x32_bf16 v[164:167], a[88:91], a[4:7], v[164:167]
    ds_read_b64_tr_b16 a[74:75], v5 offset:50176
    v_mfma_f32_16x16x32_bf16 v[164:167], a[92:95], a[36:39], v[164:167]
    v_mfma_f32_16x16x32_bf16 v[168:171], a[88:91], a[8:11], v[168:171]
    ds_read_b64_tr_b16 a[76:77], v5 offset:57344
    v_mfma_f32_16x16x32_bf16 v[168:171], a[92:95], a[40:43], v[168:171]
    v_mfma_f32_16x16x32_bf16 v[172:175], a[88:91], a[12:15], v[172:175]
    ds_read_b64_tr_b16 a[78:79], v5 offset:58368
    v_mfma_f32_16x16x32_bf16 v[172:175], a[92:95], a[44:47], v[172:175]
    v_mfma_f32_16x16x32_bf16 v[176:179], a[88:91], a[16:19], v[176:179]
    s_add_u32 m0, s37, 40960
    v_mfma_f32_16x16x32_bf16 v[176:179], a[92:95], a[48:51], v[176:179]
    buffer_load_dwordx4 v9, s[12:15], s34 offen lds
    v_mfma_f32_16x16x32_bf16 v[180:183], a[88:91], a[20:23], v[180:183]
    v_mfma_f32_16x16x32_bf16 v[180:183], a[92:95], a[52:55], v[180:183]
    v_mfma_f32_16x16x32_bf16 v[184:187], a[88:91], a[24:27], v[184:187]
    s_add_u32 m0, s37, 45056
    v_mfma_f32_16x16x32_bf16 v[184:187], a[92:95], a[56:59], v[184:187]
    buffer_load_dwordx4 v9, s[12:15], s35 offen lds
    v_mfma_f32_16x16x32_bf16 v[188:191], a[88:91], a[28:31], v[188:191]
    v_mfma_f32_16x16x32_bf16 v[188:191], a[92:95], a[60:63], v[188:191]
    s_waitcnt lgkmcnt(1)
    v_mfma_f32_16x16x32_bf16 v[192:195], a[64:67], a[0:3], v[192:195]
    ds_read_b64_tr_b16 a[80:81], v6 offset:49152
    v_mfma_f32_16x16x32_bf16 v[192:195], a[68:71], a[32:35], v[192:195]
    v_mfma_f32_16x16x32_bf16 v[196:199], a[64:67], a[4:7], v[196:199]
    ds_read_b64_tr_b16 a[82:83], v6 offset:50176
    v_mfma_f32_16x16x32_bf16 v[196:199], a[68:71], a[36:39], v[196:199]
    v_mfma_f32_16x16x32_bf16 v[200:203], a[64:67], a[8:11], v[200:203]
    ds_read_b64_tr_b16 a[84:85], v6 offset:57344
    v_mfma_f32_16x16x32_bf16 v[200:203], a[68:71], a[40:43], v[200:203]
    v_mfma_f32_16x16x32_bf16 v[204:207], a[64:67], a[12:15], v[204:207]
    ds_read_b64_tr_b16 a[86:87], v6 offset:58368
    v_mfma_f32_16x16x32_bf16 v[204:207], a[68:71], a[44:47], v[204:207]
    s_add_u32 m0, s36, 49152
    v_mfma_f32_16x16x32_bf16 v[208:211], a[64:67], a[16:19], v[208:211]
    buffer_load_dwordx4 v8, s[8:11], s28 offen lds
    v_mfma_f32_16x16x32_bf16 v[208:211], a[68:71], a[48:51], v[208:211]
    v_mfma_f32_16x16x32_bf16 v[212:215], a[64:67], a[20:23], v[212:215]
    v_mfma_f32_16x16x32_bf16 v[212:215], a[68:71], a[52:55], v[212:215]
    s_add_u32 m0, s36, 53248
    v_mfma_f32_16x16x32_bf16 v[216:219], a[64:67], a[24:27], v[216:219]
    buffer_load_dwordx4 v8, s[8:11], s29 offen lds
    v_mfma_f32_16x16x32_bf16 v[216:219], a[68:71], a[56:59], v[216:219]
    v_mfma_f32_16x16x32_bf16 v[220:223], a[64:67], a[28:31], v[220:223]
    v_mfma_f32_16x16x32_bf16 v[220:223], a[68:71], a[60:63], v[220:223]
    v_mfma_f32_16x16x32_bf16 v[224:227], a[72:75], a[0:3], v[224:227]
    ds_read_b64_tr_b16 a[88:89], v7 offset:49152
    s_waitcnt lgkmcnt(5)
    v_mfma_f32_16x16x32_bf16 v[224:227], a[76:79], a[32:35], v[224:227]
    v_mfma_f32_16x16x32_bf16 v[228:231], a[72:75], a[4:7], v[228:231]
    ds_read_b64_tr_b16 a[90:91], v7 offset:50176
    v_mfma_f32_16x16x32_bf16 v[228:231], a[76:79], a[36:39], v[228:231]
    v_mfma_f32_16x16x32_bf16 v[232:235], a[72:75], a[8:11], v[232:235]
    ds_read_b64_tr_b16 a[92:93], v7 offset:57344
    v_mfma_f32_16x16x32_bf16 v[232:235], a[76:79], a[40:43], v[232:235]
    v_mfma_f32_16x16x32_bf16 v[236:239], a[72:75], a[12:15], v[236:239]
    ds_read_b64_tr_b16 a[94:95], v7 offset:58368
    v_mfma_f32_16x16x32_bf16 v[236:239], a[76:79], a[44:47], v[236:239]
    s_add_u32 m0, s36, 57344
    v_mfma_f32_16x16x32_bf16 v[240:243], a[72:75], a[16:19], v[240:243]
    buffer_load_dwordx4 v8, s[8:11], s30 offen lds
    v_mfma_f32_16x16x32_bf16 v[240:243], a[76:79], a[48:51], v[240:243]
    v_mfma_f32_16x16x32_bf16 v[244:247], a[72:75], a[20:23], v[244:247]
    v_mfma_f32_16x16x32_bf16 v[244:247], a[76:79], a[52:55], v[244:247]
    s_add_u32 m0, s36, 61440
    v_mfma_f32_16x16x32_bf16 v[248:251], a[72:75], a[24:27], v[248:251]
    buffer_load_dwordx4 v8, s[8:11], s31 offen lds
    v_mfma_f32_16x16x32_bf16 v[248:251], a[76:79], a[56:59], v[248:251]
    s_add_u32 s8, s8, 128
    s_addc_u32 s9, s9, 0
    s_sub_u32 s10, s10, 128
    v_mfma_f32_16x16x32_bf16 v[252:255], a[72:75], a[28:31], v[252:255]
    v_mfma_f32_16x16x32_bf16 v[252:255], a[76:79], a[60:63], v[252:255]
    s_waitcnt vmcnt(16) lgkmcnt(0)
    s_barrier
    v_mfma_f32_16x16x32_bf16 a[128:131], a[80:83], a[0:3], a[128:131]
    ds_read_b64_tr_b16 a[64:65], v4 offset:0
    v_mfma_f32_16x16x32_bf16 a[128:131], a[84:87], a[32:35], a[128:131]
    ds_read_b64_tr_b16 a[66:67], v4 offset:1024
    v_mfma_f32_16x16x32_bf16 a[132:135], a[80:83], a[4:7], a[132:135]
    v_mfma_f32_16x16x32_bf16 a[132:135], a[84:87], a[36:39], a[132:135]
    ds_read_b64_tr_b16 a[68:69], v4 offset:8192
    v_mfma_f32_16x16x32_bf16 a[136:139], a[80:83], a[8:11], a[136:139]
    ds_read_b64_tr_b16 a[70:71], v4 offset:9216
    v_mfma_f32_16x16x32_bf16 a[136:139], a[84:87], a[40:43], a[136:139]
    v_mfma_f32_16x16x32_bf16 a[140:143], a[80:83], a[12:15], a[140:143]
    ds_read_b64_tr_b16 a[72:73], v5 offset:0
    v_mfma_f32_16x16x32_bf16 a[140:143], a[84:87], a[44:47], a[140:143]
    ds_read_b64_tr_b16 a[74:75], v5 offset:1024
    v_mfma_f32_16x16x32_bf16 a[144:147], a[80:83], a[16:19], a[144:147]
    v_mfma_f32_16x16x32_bf16 a[144:147], a[84:87], a[48:51], a[144:147]
    ds_read_b64_tr_b16 a[76:77], v5 offset:8192
    v_mfma_f32_16x16x32_bf16 a[148:151], a[80:83], a[20:23], a[148:151]
    ds_read_b64_tr_b16 a[78:79], v5 offset:9216
    v_mfma_f32_16x16x32_bf16 a[148:151], a[84:87], a[52:55], a[148:151]
    v_mfma_f32_16x16x32_bf16 a[152:155], a[80:83], a[24:27], a[152:155]
    s_add_u32 m0, s37, 49152
    v_mfma_f32_16x16x32_bf16 a[152:155], a[84:87], a[56:59], a[152:155]
    buffer_load_dwordx4 v9, s[16:19], s32 offen lds
    v_mfma_f32_16x16x32_bf16 a[156:159], a[80:83], a[28:31], a[156:159]
    s_add_u32 s32, s32, 458752
    v_mfma_f32_16x16x32_bf16 a[156:159], a[84:87], a[60:63], a[156:159]
    v_mfma_f32_16x16x32_bf16 a[160:163], a[88:91], a[0:3], a[160:163]
    ds_read_b128 a[0:3], v2 offset:0
    v_mfma_f32_16x16x32_bf16 a[160:163], a[92:95], a[32:35], a[160:163]
    ds_read_b128 a[32:35], v3 offset:0
    v_mfma_f32_16x16x32_bf16 a[164:167], a[88:91], a[4:7], a[164:167]
    ds_read_b128 a[4:7], v2 offset:2048
    v_mfma_f32_16x16x32_bf16 a[164:167], a[92:95], a[36:39], a[164:167]
    ds_read_b128 a[36:39], v3 offset:2048
    v_mfma_f32_16x16x32_bf16 a[168:171], a[88:91], a[8:11], a[168:171]
    ds_read_b128 a[8:11], v2 offset:4096
    v_mfma_f32_16x16x32_bf16 a[168:171], a[92:95], a[40:43], a[168:171]
    ds_read_b128 a[40:43], v3 offset:4096
    v_mfma_f32_16x16x32_bf16 a[172:175], a[88:91], a[12:15], a[172:175]
    ds_read_b128 a[12:15], v2 offset:6144
    v_mfma_f32_16x16x32_bf16 a[172:175], a[92:95], a[44:47], a[172:175]
    ds_read_b128 a[44:47], v3 offset:6144
    v_mfma_f32_16x16x32_bf16 a[176:179], a[88:91], a[16:19], a[176:179]
    ds_read_b128 a[16:19], v2 offset:8192
    v_mfma_f32_16x16x32_bf16 a[176:179], a[92:95], a[48:51], a[176:179]
    ds_read_b128 a[48:51], v3 offset:8192
    v_mfma_f32_16x16x32_bf16 a[180:183], a[88:91], a[20:23], a[180:183]
    ds_read_b128 a[20:23], v2 offset:10240
    v_mfma_f32_16x16x32_bf16 a[180:183], a[92:95], a[52:55], a[180:183]
    ds_read_b128 a[52:55], v3 offset:10240
    v_mfma_f32_16x16x32_bf16 a[184:187], a[88:91], a[24:27], a[184:187]
    ds_read_b128 a[24:27], v2 offset:12288
    v_mfma_f32_16x16x32_bf16 a[184:187], a[92:95], a[56:59], a[184:187]
    ds_read_b128 a[56:59], v3 offset:12288
    v_mfma_f32_16x16x32_bf16 a[188:191], a[88:91], a[28:31], a[188:191]
    ds_read_b128 a[28:31], v2 offset:14336
    v_mfma_f32_16x16x32_bf16 a[188:191], a[92:95], a[60:63], a[188:191]
    ds_read_b128 a[60:63], v3 offset:14336
    s_waitcnt lgkmcnt(10)
    v_mfma_f32_16x16x32_bf16 v[64:67], a[64:67], a[0:3], v[64:67]
    ds_read_b64_tr_b16 a[80:81], v6 offset:0
    v_mfma_f32_16x16x32_bf16 v[64:67], a[68:71], a[32:35], v[64:67]
    v_mfma_f32_16x16x32_bf16 v[68:71], a[64:67], a[4:7], v[68:71]
    ds_read_b64_tr_b16 a[82:83], v6 offset:1024
    v_mfma_f32_16x16x32_bf16 v[68:71], a[68:71], a[36:39], v[68:71]
    v_mfma_f32_16x16x32_bf16 v[72:75], a[64:67], a[8:11], v[72:75]
    ds_read_b64_tr_b16 a[84:85], v6 offset:8192
    v_mfma_f32_16x16x32_bf16 v[72:75], a[68:71], a[40:43], v[72:75]
    s_waitcnt lgkmcnt(7)
    v_mfma_f32_16x16x32_bf16 v[76:79], a[64:67], a[12:15], v[76:79]
    ds_read_b64_tr_b16 a[86:87], v6 offset:9216
    v_mfma_f32_16x16x32_bf16 v[76:79], a[68:71], a[44:47], v[76:79]
    v_mfma_f32_16x16x32_bf16 v[80:83], a[64:67], a[16:19], v[80:83]
    s_add_u32 m0, s37, 53248
    v_mfma_f32_16x16x32_bf16 v[80:83], a[68:71], a[48:51], v[80:83]
    buffer_load_dwordx4 v9, s[16:19], s33 offen lds
    v_mfma_f32_16x16x32_bf16 v[84:87], a[64:67], a[20:23], v[84:87]
    s_add_u32 s33, s33, 458752
    s_add_u32 m0, s37, 57344
    v_mfma_f32_16x16x32_bf16 v[84:87], a[68:71], a[52:55], v[84:87]
    buffer_load_dwordx4 v9, s[16:19], s34 offen lds
    s_waitcnt lgkmcnt(2)
    v_mfma_f32_16x16x32_bf16 v[88:91], a[64:67], a[24:27], v[88:91]
    s_add_u32 s34, s34, 458752
    s_add_u32 m0, s37, 61440
    v_mfma_f32_16x16x32_bf16 v[88:91], a[68:71], a[56:59], v[88:91]
    buffer_load_dwordx4 v9, s[16:19], s35 offen lds
    v_mfma_f32_16x16x32_bf16 v[92:95], a[64:67], a[28:31], v[92:95]
    s_add_u32 s35, s35, 458752
    s_add_u32 m0, s36, 65536
    v_mfma_f32_16x16x32_bf16 v[92:95], a[68:71], a[60:63], v[92:95]
    buffer_load_dwordx4 v8, s[8:11], s24 offen lds
    v_mfma_f32_16x16x32_bf16 v[96:99], a[72:75], a[0:3], v[96:99]
    ds_read_b64_tr_b16 a[88:89], v7 offset:0
    v_mfma_f32_16x16x32_bf16 v[96:99], a[76:79], a[32:35], v[96:99]
    v_mfma_f32_16x16x32_bf16 v[100:103], a[72:75], a[4:7], v[100:103]
    ds_read_b64_tr_b16 a[90:91], v7 offset:1024
    v_mfma_f32_16x16x32_bf16 v[100:103], a[76:79], a[36:39], v[100:103]
    v_mfma_f32_16x16x32_bf16 v[104:107], a[72:75], a[8:11], v[104:107]
    ds_read_b64_tr_b16 a[92:93], v7 offset:8192
    v_mfma_f32_16x16x32_bf16 v[104:107], a[76:79], a[40:43], v[104:107]
    v_mfma_f32_16x16x32_bf16 v[108:111], a[72:75], a[12:15], v[108:111]
    ds_read_b64_tr_b16 a[94:95], v7 offset:9216
    v_mfma_f32_16x16x32_bf16 v[108:111], a[76:79], a[44:47], v[108:111]
    v_mfma_f32_16x16x32_bf16 v[112:115], a[72:75], a[16:19], v[112:115]
    s_add_u32 m0, s36, 69632
    v_mfma_f32_16x16x32_bf16 v[112:115], a[76:79], a[48:51], v[112:115]
    buffer_load_dwordx4 v8, s[8:11], s25 offen lds
    v_mfma_f32_16x16x32_bf16 v[116:119], a[72:75], a[20:23], v[116:119]
    s_add_u32 m0, s36, 73728
    v_mfma_f32_16x16x32_bf16 v[116:119], a[76:79], a[52:55], v[116:119]
    buffer_load_dwordx4 v8, s[8:11], s26 offen lds
    v_mfma_f32_16x16x32_bf16 v[120:123], a[72:75], a[24:27], v[120:123]
    s_add_u32 m0, s36, 77824
    v_mfma_f32_16x16x32_bf16 v[120:123], a[76:79], a[56:59], v[120:123]
    buffer_load_dwordx4 v8, s[8:11], s27 offen lds
    v_mfma_f32_16x16x32_bf16 v[124:127], a[72:75], a[28:31], v[124:127]
    v_mfma_f32_16x16x32_bf16 v[124:127], a[76:79], a[60:63], v[124:127]
    s_waitcnt vmcnt(20) lgkmcnt(0)
    s_barrier
    v_mfma_f32_16x16x32_bf16 v[128:131], a[80:83], a[0:3], v[128:131]
    ds_read_b64_tr_b16 a[64:65], v4 offset:16384
    v_mfma_f32_16x16x32_bf16 v[128:131], a[84:87], a[32:35], v[128:131]
    v_mfma_f32_16x16x32_bf16 v[132:135], a[80:83], a[4:7], v[132:135]
    ds_read_b64_tr_b16 a[66:67], v4 offset:17408
    v_mfma_f32_16x16x32_bf16 v[132:135], a[84:87], a[36:39], v[132:135]
    v_mfma_f32_16x16x32_bf16 v[136:139], a[80:83], a[8:11], v[136:139]
    ds_read_b64_tr_b16 a[68:69], v4 offset:24576
    v_mfma_f32_16x16x32_bf16 v[136:139], a[84:87], a[40:43], v[136:139]
    v_mfma_f32_16x16x32_bf16 v[140:143], a[80:83], a[12:15], v[140:143]
    ds_read_b64_tr_b16 a[70:71], v4 offset:25600
    v_mfma_f32_16x16x32_bf16 v[140:143], a[84:87], a[44:47], v[140:143]
    v_mfma_f32_16x16x32_bf16 v[144:147], a[80:83], a[16:19], v[144:147]
    s_add_u32 m0, s37, 0
    v_mfma_f32_16x16x32_bf16 v[144:147], a[84:87], a[48:51], v[144:147]
    buffer_load_dwordx4 v9, s[12:15], s32 offen lds
    v_mfma_f32_16x16x32_bf16 v[148:151], a[80:83], a[20:23], v[148:151]
    v_mfma_f32_16x16x32_bf16 v[148:151], a[84:87], a[52:55], v[148:151]
    v_mfma_f32_16x16x32_bf16 v[152:155], a[80:83], a[24:27], v[152:155]
    s_add_u32 m0, s37, 4096
    v_mfma_f32_16x16x32_bf16 v[152:155], a[84:87], a[56:59], v[152:155]
    buffer_load_dwordx4 v9, s[12:15], s33 offen lds
    v_mfma_f32_16x16x32_bf16 v[156:159], a[80:83], a[28:31], v[156:159]
    v_mfma_f32_16x16x32_bf16 v[156:159], a[84:87], a[60:63], v[156:159]
    v_mfma_f32_16x16x32_bf16 v[160:163], a[88:91], a[0:3], v[160:163]
    ds_read_b64_tr_b16 a[72:73], v5 offset:16384
    v_mfma_f32_16x16x32_bf16 v[160:163], a[92:95], a[32:35], v[160:163]
    v_mfma_f32_16x16x32_bf16 v[164:167], a[88:91], a[4:7], v[164:167]
    ds_read_b64_tr_b16 a[74:75], v5 offset:17408
    v_mfma_f32_16x16x32_bf16 v[164:167], a[92:95], a[36:39], v[164:167]
    v_mfma_f32_16x16x32_bf16 v[168:171], a[88:91], a[8:11], v[168:171]
    ds_read_b64_tr_b16 a[76:77], v5 offset:24576
    v_mfma_f32_16x16x32_bf16 v[168:171], a[92:95], a[40:43], v[168:171]
    v_mfma_f32_16x16x32_bf16 v[172:175], a[88:91], a[12:15], v[172:175]
    ds_read_b64_tr_b16 a[78:79], v5 offset:25600
    v_mfma_f32_16x16x32_bf16 v[172:175], a[92:95], a[44:47], v[172:175]
    v_mfma_f32_16x16x32_bf16 v[176:179], a[88:91], a[16:19], v[176:179]
    s_add_u32 m0, s37, 8192
    v_mfma_f32_16x16x32_bf16 v[176:179], a[92:95], a[48:51], v[176:179]
    buffer_load_dwordx4 v9, s[12:15], s34 offen lds
    v_mfma_f32_16x16x32_bf16 v[180:183], a[88:91], a[20:23], v[180:183]
    v_mfma_f32_16x16x32_bf16 v[180:183], a[92:95], a[52:55], v[180:183]
    v_mfma_f32_16x16x32_bf16 v[184:187], a[88:91], a[24:27], v[184:187]
    s_add_u32 m0, s37, 12288
    v_mfma_f32_16x16x32_bf16 v[184:187], a[92:95], a[56:59], v[184:187]
    buffer_load_dwordx4 v9, s[12:15], s35 offen lds
    v_mfma_f32_16x16x32_bf16 v[188:191], a[88:91], a[28:31], v[188:191]
    v_mfma_f32_16x16x32_bf16 v[188:191], a[92:95], a[60:63], v[188:191]
    s_waitcnt lgkmcnt(1)
    v_mfma_f32_16x16x32_bf16 v[192:195], a[64:67], a[0:3], v[192:195]
    ds_read_b64_tr_b16 a[80:81], v6 offset:16384
    v_mfma_f32_16x16x32_bf16 v[192:195], a[68:71], a[32:35], v[192:195]
    v_mfma_f32_16x16x32_bf16 v[196:199], a[64:67], a[4:7], v[196:199]
    ds_read_b64_tr_b16 a[82:83], v6 offset:17408
    v_mfma_f32_16x16x32_bf16 v[196:199], a[68:71], a[36:39], v[196:199]
    v_mfma_f32_16x16x32_bf16 v[200:203], a[64:67], a[8:11], v[200:203]
    ds_read_b64_tr_b16 a[84:85], v6 offset:24576
    v_mfma_f32_16x16x32_bf16 v[200:203], a[68:71], a[40:43], v[200:203]
    v_mfma_f32_16x16x32_bf16 v[204:207], a[64:67], a[12:15], v[204:207]
    ds_read_b64_tr_b16 a[86:87], v6 offset:25600
    v_mfma_f32_16x16x32_bf16 v[204:207], a[68:71], a[44:47], v[204:207]
    s_add_u32 m0, s36, 81920
    v_mfma_f32_16x16x32_bf16 v[208:211], a[64:67], a[16:19], v[208:211]
    buffer_load_dwordx4 v8, s[8:11], s28 offen lds
    v_mfma_f32_16x16x32_bf16 v[208:211], a[68:71], a[48:51], v[208:211]
    v_mfma_f32_16x16x32_bf16 v[212:215], a[64:67], a[20:23], v[212:215]
    v_mfma_f32_16x16x32_bf16 v[212:215], a[68:71], a[52:55], v[212:215]
    s_add_u32 m0, s36, 86016
    v_mfma_f32_16x16x32_bf16 v[216:219], a[64:67], a[24:27], v[216:219]
    buffer_load_dwordx4 v8, s[8:11], s29 offen lds
    v_mfma_f32_16x16x32_bf16 v[216:219], a[68:71], a[56:59], v[216:219]
    v_mfma_f32_16x16x32_bf16 v[220:223], a[64:67], a[28:31], v[220:223]
    v_mfma_f32_16x16x32_bf16 v[220:223], a[68:71], a[60:63], v[220:223]
    v_mfma_f32_16x16x32_bf16 v[224:227], a[72:75], a[0:3], v[224:227]
    ds_read_b64_tr_b16 a[88:89], v7 offset:16384
    s_waitcnt lgkmcnt(5)
    v_mfma_f32_16x16x32_bf16 v[224:227], a[76:79], a[32:35], v[224:227]
    v_mfma_f32_16x16x32_bf16 v[228:231], a[72:75], a[4:7], v[228:231]
    ds_read_b64_tr_b16 a[90:91], v7 offset:17408
    v_mfma_f32_16x16x32_bf16 v[228:231], a[76:79], a[36:39], v[228:231]
    v_mfma_f32_16x16x32_bf16 v[232:235], a[72:75], a[8:11], v[232:235]
    ds_read_b64_tr_b16 a[92:93], v7 offset:24576
    v_mfma_f32_16x16x32_bf16 v[232:235], a[76:79], a[40:43], v[232:235]
    v_mfma_f32_16x16x32_bf16 v[236:239], a[72:75], a[12:15], v[236:239]
    ds_read_b64_tr_b16 a[94:95], v7 offset:25600
    v_mfma_f32_16x16x32_bf16 v[236:239], a[76:79], a[44:47], v[236:239]
    s_add_u32 m0, s36, 90112
    v_mfma_f32_16x16x32_bf16 v[240:243], a[72:75], a[16:19], v[240:243]
    buffer_load_dwordx4 v8, s[8:11], s30 offen lds
    v_mfma_f32_16x16x32_bf16 v[240:243], a[76:79], a[48:51], v[240:243]
    v_mfma_f32_16x16x32_bf16 v[244:247], a[72:75], a[20:23], v[244:247]
    v_mfma_f32_16x16x32_bf16 v[244:247], a[76:79], a[52:55], v[244:247]
    s_add_u32 m0, s36, 94208
    v_mfma_f32_16x16x32_bf16 v[248:251], a[72:75], a[24:27], v[248:251]
    buffer_load_dwordx4 v8, s[8:11], s31 offen lds
    v_mfma_f32_16x16x32_bf16 v[248:251], a[76:79], a[56:59], v[248:251]
    s_add_u32 s8, s8, 128
    s_addc_u32 s9, s9, 0
    s_sub_u32 s10, s10, 128
    v_mfma_f32_16x16x32_bf16 v[252:255], a[72:75], a[28:31], v[252:255]
    v_mfma_f32_16x16x32_bf16 v[252:255], a[76:79], a[60:63], v[252:255]
    s_waitcnt vmcnt(16) lgkmcnt(0)
    s_barrier
    v_mfma_f32_16x16x32_bf16 a[128:131], a[80:83], a[0:3], a[128:131]
    ds_read_b64_tr_b16 a[64:65], v4 offset:32768
    v_mfma_f32_16x16x32_bf16 a[128:131], a[84:87], a[32:35], a[128:131]
    ds_read_b64_tr_b16 a[66:67], v4 offset:33792
    v_mfma_f32_16x16x32_bf16 a[132:135], a[80:83], a[4:7], a[132:135]
    v_mfma_f32_16x16x32_bf16 a[132:135], a[84:87], a[36:39], a[132:135]
    ds_read_b64_tr_b16 a[68:69], v4 offset:40960
    v_mfma_f32_16x16x32_bf16 a[136:139], a[80:83], a[8:11], a[136:139]
    ds_read_b64_tr_b16 a[70:71], v4 offset:41984
    v_mfma_f32_16x16x32_bf16 a[136:139], a[84:87], a[40:43], a[136:139]
    v_mfma_f32_16x16x32_bf16 a[140:143], a[80:83], a[12:15], a[140:143]
    ds_read_b64_tr_b16 a[72:73], v5 offset:32768
    v_mfma_f32_16x16x32_bf16 a[140:143], a[84:87], a[44:47], a[140:143]
    ds_read_b64_tr_b16 a[74:75], v5 offset:33792
    v_mfma_f32_16x16x32_bf16 a[144:147], a[80:83], a[16:19], a[144:147]
    v_mfma_f32_16x16x32_bf16 a[144:147], a[84:87], a[48:51], a[144:147]
    ds_read_b64_tr_b16 a[76:77], v5 offset:40960
    v_mfma_f32_16x16x32_bf16 a[148:151], a[80:83], a[20:23], a[148:151]
    ds_read_b64_tr_b16 a[78:79], v5 offset:41984
    v_mfma_f32_16x16x32_bf16 a[148:151], a[84:87], a[52:55], a[148:151]
    v_mfma_f32_16x16x32_bf16 a[152:155], a[80:83], a[24:27], a[152:155]
    s_add_u32 m0, s37, 16384
    v_mfma_f32_16x16x32_bf16 a[152:155], a[84:87], a[56:59], a[152:155]
    buffer_load_dwordx4 v9, s[16:19], s32 offen lds
    v_mfma_f32_16x16x32_bf16 a[156:159], a[80:83], a[28:31], a[156:159]
    s_add_u32 s32, s32, 458752
    v_mfma_f32_16x16x32_bf16 a[156:159], a[84:87], a[60:63], a[156:159]
    v_mfma_f32_16x16x32_bf16 a[160:163], a[88:91], a[0:3], a[160:163]
    ds_read_b128 a[0:3], v2 offset:32768
    v_mfma_f32_16x16x32_bf16 a[160:163], a[92:95], a[32:35], a[160:163]
    ds_read_b128 a[32:35], v3 offset:32768
    v_mfma_f32_16x16x32_bf16 a[164:167], a[88:91], a[4:7], a[164:167]
    ds_read_b128 a[4:7], v2 offset:34816
    v_mfma_f32_16x16x32_bf16 a[164:167], a[92:95], a[36:39], a[164:167]
    ds_read_b128 a[36:39], v3 offset:34816
    v_mfma_f32_16x16x32_bf16 a[168:171], a[88:91], a[8:11], a[168:171]
    ds_read_b128 a[8:11], v2 offset:36864
    v_mfma_f32_16x16x32_bf16 a[168:171], a[92:95], a[40:43], a[168:171]
    ds_read_b128 a[40:43], v3 offset:36864
    v_mfma_f32_16x16x32_bf16 a[172:175], a[88:91], a[12:15], a[172:175]
    ds_read_b128 a[12:15], v2 offset:38912
    v_mfma_f32_16x16x32_bf16 a[172:175], a[92:95], a[44:47], a[172:175]
    ds_read_b128 a[44:47], v3 offset:38912
    v_mfma_f32_16x16x32_bf16 a[176:179], a[88:91], a[16:19], a[176:179]
    ds_read_b128 a[16:19], v2 offset:40960
    v_mfma_f32_16x16x32_bf16 a[176:179], a[92:95], a[48:51], a[176:179]
    ds_read_b128 a[48:51], v3 offset:40960
    v_mfma_f32_16x16x32_bf16 a[180:183], a[88:91], a[20:23], a[180:183]
    ds_read_b128 a[20:23], v2 offset:43008
    v_mfma_f32_16x16x32_bf16 a[180:183], a[92:95], a[52:55], a[180:183]
    ds_read_b128 a[52:55], v3 offset:43008
    v_mfma_f32_16x16x32_bf16 a[184:187], a[88:91], a[24:27], a[184:187]
    ds_read_b128 a[24:27], v2 offset:45056
    v_mfma_f32_16x16x32_bf16 a[184:187], a[92:95], a[56:59], a[184:187]
    ds_read_b128 a[56:59], v3 offset:45056
    v_mfma_f32_16x16x32_bf16 a[188:191], a[88:91], a[28:31], a[188:191]
    ds_read_b128 a[28:31], v2 offset:47104
    v_mfma_f32_16x16x32_bf16 a[188:191], a[92:95], a[60:63], a[188:191]
    ds_read_b128 a[60:63], v3 offset:47104
    s_waitcnt lgkmcnt(10)
    v_mfma_f32_16x16x32_bf16 v[64:67], a[64:67], a[0:3], v[64:67]
    ds_read_b64_tr_b16 a[80:81], v6 offset:32768
    v_mfma_f32_16x16x32_bf16 v[64:67], a[68:71], a[32:35], v[64:67]
    v_mfma_f32_16x16x32_bf16 v[68:71], a[64:67], a[4:7], v[68:71]
    ds_read_b64_tr_b16 a[82:83], v6 offset:33792
    v_mfma_f32_16x16x32_bf16 v[68:71], a[68:71], a[36:39], v[68:71]
    v_mfma_f32_16x16x32_bf16 v[72:75], a[64:67], a[8:11], v[72:75]
    ds_read_b64_tr_b16 a[84:85], v6 offset:40960
    v_mfma_f32_16x16x32_bf16 v[72:75], a[68:71], a[40:43], v[72:75]
    s_waitcnt lgkmcnt(7)
    v_mfma_f32_16x16x32_bf16 v[76:79], a[64:67], a[12:15], v[76:79]
    ds_read_b64_tr_b16 a[86:87], v6 offset:41984
    v_mfma_f32_16x16x32_bf16 v[76:79], a[68:71], a[44:47], v[76:79]
    v_mfma_f32_16x16x32_bf16 v[80:83], a[64:67], a[16:19], v[80:83]
    s_add_u32 m0, s37, 20480
    v_mfma_f32_16x16x32_bf16 v[80:83], a[68:71], a[48:51], v[80:83]
    buffer_load_dwordx4 v9, s[16:19], s33 offen lds
    v_mfma_f32_16x16x32_bf16 v[84:87], a[64:67], a[20:23], v[84:87]
    s_add_u32 s33, s33, 458752
    s_add_u32 m0, s37, 24576
    v_mfma_f32_16x16x32_bf16 v[84:87], a[68:71], a[52:55], v[84:87]
    buffer_load_dwordx4 v9, s[16:19], s34 offen lds
    s_waitcnt lgkmcnt(2)
    v_mfma_f32_16x16x32_bf16 v[88:91], a[64:67], a[24:27], v[88:91]
    s_add_u32 s34, s34, 458752
    s_add_u32 m0, s37, 28672
    v_mfma_f32_16x16x32_bf16 v[88:91], a[68:71], a[56:59], v[88:91]
    buffer_load_dwordx4 v9, s[16:19], s35 offen lds
    v_mfma_f32_16x16x32_bf16 v[92:95], a[64:67], a[28:31], v[92:95]
    s_add_u32 s35, s35, 458752
    s_add_u32 m0, s36, 0
    v_mfma_f32_16x16x32_bf16 v[92:95], a[68:71], a[60:63], v[92:95]
    buffer_load_dwordx4 v8, s[8:11], s24 offen lds
    v_mfma_f32_16x16x32_bf16 v[96:99], a[72:75], a[0:3], v[96:99]
    ds_read_b64_tr_b16 a[88:89], v7 offset:32768
    v_mfma_f32_16x16x32_bf16 v[96:99], a[76:79], a[32:35], v[96:99]
    v_mfma_f32_16x16x32_bf16 v[100:103], a[72:75], a[4:7], v[100:103]
    ds_read_b64_tr_b16 a[90:91], v7 offset:33792
    v_mfma_f32_16x16x32_bf16 v[100:103], a[76:79], a[36:39], v[100:103]
    v_mfma_f32_16x16x32_bf16 v[104:107], a[72:75], a[8:11], v[104:107]
    ds_read_b64_tr_b16 a[92:93], v7 offset:40960
    v_mfma_f32_16x16x32_bf16 v[104:107], a[76:79], a[40:43], v[104:107]
    v_mfma_f32_16x16x32_bf16 v[108:111], a[72:75], a[12:15], v[108:111]
    ds_read_b64_tr_b16 a[94:95], v7 offset:41984
    v_mfma_f32_16x16x32_bf16 v[108:111], a[76:79], a[44:47], v[108:111]
    v_mfma_f32_16x16x32_bf16 v[112:115], a[72:75], a[16:19], v[112:115]
    s_add_u32 m0, s36, 4096
    v_mfma_f32_16x16x32_bf16 v[112:115], a[76:79], a[48:51], v[112:115]
    buffer_load_dwordx4 v8, s[8:11], s25 offen lds
    v_mfma_f32_16x16x32_bf16 v[116:119], a[72:75], a[20:23], v[116:119]
    s_add_u32 m0, s36, 8192
    v_mfma_f32_16x16x32_bf16 v[116:119], a[76:79], a[52:55], v[116:119]
    buffer_load_dwordx4 v8, s[8:11], s26 offen lds
    v_mfma_f32_16x16x32_bf16 v[120:123], a[72:75], a[24:27], v[120:123]
    s_add_u32 m0, s36, 12288
    v_mfma_f32_16x16x32_bf16 v[120:123], a[76:79], a[56:59], v[120:123]
    buffer_load_dwordx4 v8, s[8:11], s27 offen lds
    v_mfma_f32_16x16x32_bf16 v[124:127], a[72:75], a[28:31], v[124:127]
    v_mfma_f32_16x16x32_bf16 v[124:127], a[76:79], a[60:63], v[124:127]
    s_waitcnt vmcnt(20) lgkmcnt(0)
    s_barrier
    v_mfma_f32_16x16x32_bf16 v[128:131], a[80:83], a[0:3], v[128:131]
    ds_read_b64_tr_b16 a[64:65], v4 offset:49152
    v_mfma_f32_16x16x32_bf16 v[128:131], a[84:87], a[32:35], v[128:131]
    v_mfma_f32_16x16x32_bf16 v[132:135], a[80:83], a[4:7], v[132:135]
    ds_read_b64_tr_b16 a[66:67], v4 offset:50176
    v_mfma_f32_16x16x32_bf16 v[132:135], a[84:87], a[36:39], v[132:135]
    v_mfma_f32_16x16x32_bf16 v[136:139], a[80:83], a[8:11], v[136:139]
    ds_read_b64_tr_b16 a[68:69], v4 offset:57344
    v_mfma_f32_16x16x32_bf16 v[136:139], a[84:87], a[40:43], v[136:139]
    v_mfma_f32_16x16x32_bf16 v[140:143], a[80:83], a[12:15], v[140:143]
    ds_read_b64_tr_b16 a[70:71], v4 offset:58368
    v_mfma_f32_16x16x32_bf16 v[140:143], a[84:87], a[44:47], v[140:143]
    v_mfma_f32_16x16x32_bf16 v[144:147], a[80:83], a[16:19], v[144:147]
    s_add_u32 m0, s37, 32768
    v_mfma_f32_16x16x32_bf16 v[144:147], a[84:87], a[48:51], v[144:147]
    buffer_load_dwordx4 v9, s[12:15], s32 offen lds
    v_mfma_f32_16x16x32_bf16 v[148:151], a[80:83], a[20:23], v[148:151]
    v_mfma_f32_16x16x32_bf16 v[148:151], a[84:87], a[52:55], v[148:151]
    v_mfma_f32_16x16x32_bf16 v[152:155], a[80:83], a[24:27], v[152:155]
    s_add_u32 m0, s37, 36864
    v_mfma_f32_16x16x32_bf16 v[152:155], a[84:87], a[56:59], v[152:155]
    buffer_load_dwordx4 v9, s[12:15], s33 offen lds
    v_mfma_f32_16x16x32_bf16 v[156:159], a[80:83], a[28:31], v[156:159]
    v_mfma_f32_16x16x32_bf16 v[156:159], a[84:87], a[60:63], v[156:159]
    v_mfma_f32_16x16x32_bf16 v[160:163], a[88:91], a[0:3], v[160:163]
    ds_read_b64_tr_b16 a[72:73], v5 offset:49152
    v_mfma_f32_16x16x32_bf16 v[160:163], a[92:95], a[32:35], v[160:163]
    v_mfma_f32_16x16x32_bf16 v[164:167], a[88:91], a[4:7], v[164:167]
    ds_read_b64_tr_b16 a[74:75], v5 offset:50176
    v_mfma_f32_16x16x32_bf16 v[164:167], a[92:95], a[36:39], v[164:167]
    v_mfma_f32_16x16x32_bf16 v[168:171], a[88:91], a[8:11], v[168:171]
    ds_read_b64_tr_b16 a[76:77], v5 offset:57344
    v_mfma_f32_16x16x32_bf16 v[168:171], a[92:95], a[40:43], v[168:171]
    v_mfma_f32_16x16x32_bf16 v[172:175], a[88:91], a[12:15], v[172:175]
    ds_read_b64_tr_b16 a[78:79], v5 offset:58368
    v_mfma_f32_16x16x32_bf16 v[172:175], a[92:95], a[44:47], v[172:175]
    v_mfma_f32_16x16x32_bf16 v[176:179], a[88:91], a[16:19], v[176:179]
    s_add_u32 m0, s37, 40960
    v_mfma_f32_16x16x32_bf16 v[176:179], a[92:95], a[48:51], v[176:179]
    buffer_load_dwordx4 v9, s[12:15], s34 offen lds
    v_mfma_f32_16x16x32_bf16 v[180:183], a[88:91], a[20:23], v[180:183]
    v_mfma_f32_16x16x32_bf16 v[180:183], a[92:95], a[52:55], v[180:183]
    v_mfma_f32_16x16x32_bf16 v[184:187], a[88:91], a[24:27], v[184:187]
    s_add_u32 m0, s37, 45056
    v_mfma_f32_16x16x32_bf16 v[184:187], a[92:95], a[56:59], v[184:187]
    buffer_load_dwordx4 v9, s[12:15], s35 offen lds
    v_mfma_f32_16x16x32_bf16 v[188:191], a[88:91], a[28:31], v[188:191]
    v_mfma_f32_16x16x32_bf16 v[188:191], a[92:95], a[60:63], v[188:191]
    s_waitcnt lgkmcnt(1)
    v_mfma_f32_16x16x32_bf16 v[192:195], a[64:67], a[0:3], v[192:195]
    ds_read_b64_tr_b16 a[80:81], v6 offset:49152
    v_mfma_f32_16x16x32_bf16 v[192:195], a[68:71], a[32:35], v[192:195]
    v_mfma_f32_16x16x32_bf16 v[196:199], a[64:67], a[4:7], v[196:199]
    ds_read_b64_tr_b16 a[82:83], v6 offset:50176
    v_mfma_f32_16x16x32_bf16 v[196:199], a[68:71], a[36:39], v[196:199]
    v_mfma_f32_16x16x32_bf16 v[200:203], a[64:67], a[8:11], v[200:203]
    ds_read_b64_tr_b16 a[84:85], v6 offset:57344
    v_mfma_f32_16x16x32_bf16 v[200:203], a[68:71], a[40:43], v[200:203]
    v_mfma_f32_16x16x32_bf16 v[204:207], a[64:67], a[12:15], v[204:207]
    ds_read_b64_tr_b16 a[86:87], v6 offset:58368
    v_mfma_f32_16x16x32_bf16 v[204:207], a[68:71], a[44:47], v[204:207]
    s_add_u32 m0, s36, 16384
    v_mfma_f32_16x16x32_bf16 v[208:211], a[64:67], a[16:19], v[208:211]
    buffer_load_dwordx4 v8, s[8:11], s28 offen lds
    v_mfma_f32_16x16x32_bf16 v[208:211], a[68:71], a[48:51], v[208:211]
    v_mfma_f32_16x16x32_bf16 v[212:215], a[64:67], a[20:23], v[212:215]
    v_mfma_f32_16x16x32_bf16 v[212:215], a[68:71], a[52:55], v[212:215]
    s_add_u32 m0, s36, 20480
    v_mfma_f32_16x16x32_bf16 v[216:219], a[64:67], a[24:27], v[216:219]
    buffer_load_dwordx4 v8, s[8:11], s29 offen lds
    v_mfma_f32_16x16x32_bf16 v[216:219], a[68:71], a[56:59], v[216:219]
    v_mfma_f32_16x16x32_bf16 v[220:223], a[64:67], a[28:31], v[220:223]
    v_mfma_f32_16x16x32_bf16 v[220:223], a[68:71], a[60:63], v[220:223]
    v_mfma_f32_16x16x32_bf16 v[224:227], a[72:75], a[0:3], v[224:227]
    ds_read_b64_tr_b16 a[88:89], v7 offset:49152
    s_waitcnt lgkmcnt(5)
    v_mfma_f32_16x16x32_bf16 v[224:227], a[76:79], a[32:35], v[224:227]
    v_mfma_f32_16x16x32_bf16 v[228:231], a[72:75], a[4:7], v[228:231]
    ds_read_b64_tr_b16 a[90:91], v7 offset:50176
    v_mfma_f32_16x16x32_bf16 v[228:231], a[76:79], a[36:39], v[228:231]
    v_mfma_f32_16x16x32_bf16 v[232:235], a[72:75], a[8:11], v[232:235]
    ds_read_b64_tr_b16 a[92:93], v7 offset:57344
    v_mfma_f32_16x16x32_bf16 v[232:235], a[76:79], a[40:43], v[232:235]
    v_mfma_f32_16x16x32_bf16 v[236:239], a[72:75], a[12:15], v[236:239]
    ds_read_b64_tr_b16 a[94:95], v7 offset:58368
    v_mfma_f32_16x16x32_bf16 v[236:239], a[76:79], a[44:47], v[236:239]
    s_add_u32 m0, s36, 24576
    v_mfma_f32_16x16x32_bf16 v[240:243], a[72:75], a[16:19], v[240:243]
    buffer_load_dwordx4 v8, s[8:11], s30 offen lds
    v_mfma_f32_16x16x32_bf16 v[240:243], a[76:79], a[48:51], v[240:243]
    v_mfma_f32_16x16x32_bf16 v[244:247], a[72:75], a[20:23], v[244:247]
    v_mfma_f32_16x16x32_bf16 v[244:247], a[76:79], a[52:55], v[244:247]
    s_add_u32 m0, s36, 28672
    v_mfma_f32_16x16x32_bf16 v[248:251], a[72:75], a[24:27], v[248:251]
    buffer_load_dwordx4 v8, s[8:11], s31 offen lds
    v_mfma_f32_16x16x32_bf16 v[248:251], a[76:79], a[56:59], v[248:251]
    s_add_u32 s8, s8, 128
    s_addc_u32 s9, s9, 0
    s_sub_u32 s10, s10, 128
    v_mfma_f32_16x16x32_bf16 v[252:255], a[72:75], a[28:31], v[252:255]
    v_mfma_f32_16x16x32_bf16 v[252:255], a[76:79], a[60:63], v[252:255]
    s_waitcnt vmcnt(16) lgkmcnt(0)
    s_barrier
    v_mfma_f32_16x16x32_bf16 a[128:131], a[80:83], a[0:3], a[128:131]
    ds_read_b64_tr_b16 a[64:65], v4 offset:0
    v_mfma_f32_16x16x32_bf16 a[128:131], a[84:87], a[32:35], a[128:131]
    ds_read_b64_tr_b16 a[66:67], v4 offset:1024
    v_mfma_f32_16x16x32_bf16 a[132:135], a[80:83], a[4:7], a[132:135]
    v_mfma_f32_16x16x32_bf16 a[132:135], a[84:87], a[36:39], a[132:135]
    ds_read_b64_tr_b16 a[68:69], v4 offset:8192
    v_mfma_f32_16x16x32_bf16 a[136:139], a[80:83], a[8:11], a[136:139]
    ds_read_b64_tr_b16 a[70:71], v4 offset:9216
    v_mfma_f32_16x16x32_bf16 a[136:139], a[84:87], a[40:43], a[136:139]
    v_mfma_f32_16x16x32_bf16 a[140:143], a[80:83], a[12:15], a[140:143]
    ds_read_b64_tr_b16 a[72:73], v5 offset:0
    v_mfma_f32_16x16x32_bf16 a[140:143], a[84:87], a[44:47], a[140:143]
    ds_read_b64_tr_b16 a[74:75], v5 offset:1024
    v_mfma_f32_16x16x32_bf16 a[144:147], a[80:83], a[16:19], a[144:147]
    v_mfma_f32_16x16x32_bf16 a[144:147], a[84:87], a[48:51], a[144:147]
    ds_read_b64_tr_b16 a[76:77], v5 offset:8192
    v_mfma_f32_16x16x32_bf16 a[148:151], a[80:83], a[20:23], a[148:151]
    ds_read_b64_tr_b16 a[78:79], v5 offset:9216
    v_mfma_f32_16x16x32_bf16 a[148:151], a[84:87], a[52:55], a[148:151]
    v_mfma_f32_16x16x32_bf16 a[152:155], a[80:83], a[24:27], a[152:155]
    s_add_u32 m0, s37, 49152
    v_mfma_f32_16x16x32_bf16 a[152:155], a[84:87], a[56:59], a[152:155]
    buffer_load_dwordx4 v9, s[16:19], s32 offen lds
    v_mfma_f32_16x16x32_bf16 a[156:159], a[80:83], a[28:31], a[156:159]
    s_add_u32 s32, s32, 458752
    v_mfma_f32_16x16x32_bf16 a[156:159], a[84:87], a[60:63], a[156:159]
    v_mfma_f32_16x16x32_bf16 a[160:163], a[88:91], a[0:3], a[160:163]
    ds_read_b128 a[0:3], v60 offset:0
    v_mfma_f32_16x16x32_bf16 a[160:163], a[92:95], a[32:35], a[160:163]
    ds_read_b128 a[32:35], v61 offset:0
    v_mfma_f32_16x16x32_bf16 a[164:167], a[88:91], a[4:7], a[164:167]
    ds_read_b128 a[4:7], v60 offset:2048
    v_mfma_f32_16x16x32_bf16 a[164:167], a[92:95], a[36:39], a[164:167]
    ds_read_b128 a[36:39], v61 offset:2048
    v_mfma_f32_16x16x32_bf16 a[168:171], a[88:91], a[8:11], a[168:171]
    ds_read_b128 a[8:11], v60 offset:4096
    v_mfma_f32_16x16x32_bf16 a[168:171], a[92:95], a[40:43], a[168:171]
    ds_read_b128 a[40:43], v61 offset:4096
    v_mfma_f32_16x16x32_bf16 a[172:175], a[88:91], a[12:15], a[172:175]
    ds_read_b128 a[12:15], v60 offset:6144
    v_mfma_f32_16x16x32_bf16 a[172:175], a[92:95], a[44:47], a[172:175]
    ds_read_b128 a[44:47], v61 offset:6144
    v_mfma_f32_16x16x32_bf16 a[176:179], a[88:91], a[16:19], a[176:179]
    ds_read_b128 a[16:19], v60 offset:8192
    v_mfma_f32_16x16x32_bf16 a[176:179], a[92:95], a[48:51], a[176:179]
    ds_read_b128 a[48:51], v61 offset:8192
    v_mfma_f32_16x16x32_bf16 a[180:183], a[88:91], a[20:23], a[180:183]
    ds_read_b128 a[20:23], v60 offset:10240
    v_mfma_f32_16x16x32_bf16 a[180:183], a[92:95], a[52:55], a[180:183]
    ds_read_b128 a[52:55], v61 offset:10240
    v_mfma_f32_16x16x32_bf16 a[184:187], a[88:91], a[24:27], a[184:187]
    ds_read_b128 a[24:27], v60 offset:12288
    v_mfma_f32_16x16x32_bf16 a[184:187], a[92:95], a[56:59], a[184:187]
    ds_read_b128 a[56:59], v61 offset:12288
    v_mfma_f32_16x16x32_bf16 a[188:191], a[88:91], a[28:31], a[188:191]
    ds_read_b128 a[28:31], v60 offset:14336
    v_mfma_f32_16x16x32_bf16 a[188:191], a[92:95], a[60:63], a[188:191]
    ds_read_b128 a[60:63], v61 offset:14336
    s_waitcnt lgkmcnt(10)
    v_mfma_f32_16x16x32_bf16 v[64:67], a[64:67], a[0:3], v[64:67]
    ds_read_b64_tr_b16 a[80:81], v6 offset:0
    v_mfma_f32_16x16x32_bf16 v[64:67], a[68:71], a[32:35], v[64:67]
    v_mfma_f32_16x16x32_bf16 v[68:71], a[64:67], a[4:7], v[68:71]
    ds_read_b64_tr_b16 a[82:83], v6 offset:1024
    v_mfma_f32_16x16x32_bf16 v[68:71], a[68:71], a[36:39], v[68:71]
    v_mfma_f32_16x16x32_bf16 v[72:75], a[64:67], a[8:11], v[72:75]
    ds_read_b64_tr_b16 a[84:85], v6 offset:8192
    v_mfma_f32_16x16x32_bf16 v[72:75], a[68:71], a[40:43], v[72:75]
    s_waitcnt lgkmcnt(7)
    v_mfma_f32_16x16x32_bf16 v[76:79], a[64:67], a[12:15], v[76:79]
    ds_read_b64_tr_b16 a[86:87], v6 offset:9216
    v_mfma_f32_16x16x32_bf16 v[76:79], a[68:71], a[44:47], v[76:79]
    v_mfma_f32_16x16x32_bf16 v[80:83], a[64:67], a[16:19], v[80:83]
    s_add_u32 m0, s37, 53248
    v_mfma_f32_16x16x32_bf16 v[80:83], a[68:71], a[48:51], v[80:83]
    buffer_load_dwordx4 v9, s[16:19], s33 offen lds
    v_mfma_f32_16x16x32_bf16 v[84:87], a[64:67], a[20:23], v[84:87]
    s_add_u32 s33, s33, 458752
    s_add_u32 m0, s37, 57344
    v_mfma_f32_16x16x32_bf16 v[84:87], a[68:71], a[52:55], v[84:87]
    buffer_load_dwordx4 v9, s[16:19], s34 offen lds
    s_waitcnt lgkmcnt(2)
    v_mfma_f32_16x16x32_bf16 v[88:91], a[64:67], a[24:27], v[88:91]
    s_add_u32 s34, s34, 458752
    s_add_u32 m0, s37, 61440
    v_mfma_f32_16x16x32_bf16 v[88:91], a[68:71], a[56:59], v[88:91]
    buffer_load_dwordx4 v9, s[16:19], s35 offen lds
    v_mfma_f32_16x16x32_bf16 v[92:95], a[64:67], a[28:31], v[92:95]
    s_add_u32 s35, s35, 458752
    s_add_u32 m0, s36, 32768
    v_mfma_f32_16x16x32_bf16 v[92:95], a[68:71], a[60:63], v[92:95]
    buffer_load_dwordx4 v8, s[8:11], s24 offen lds
    v_mfma_f32_16x16x32_bf16 v[96:99], a[72:75], a[0:3], v[96:99]
    ds_read_b64_tr_b16 a[88:89], v7 offset:0
    v_mfma_f32_16x16x32_bf16 v[96:99], a[76:79], a[32:35], v[96:99]
    v_mfma_f32_16x16x32_bf16 v[100:103], a[72:75], a[4:7], v[100:103]
    ds_read_b64_tr_b16 a[90:91], v7 offset:1024
    v_mfma_f32_16x16x32_bf16 v[100:103], a[76:79], a[36:39], v[100:103]
    v_mfma_f32_16x16x32_bf16 v[104:107], a[72:75], a[8:11], v[104:107]
    ds_read_b64_tr_b16 a[92:93], v7 offset:8192
    v_mfma_f32_16x16x32_bf16 v[104:107], a[76:79], a[40:43], v[104:107]
    v_mfma_f32_16x16x32_bf16 v[108:111], a[72:75], a[12:15], v[108:111]
    ds_read_b64_tr_b16 a[94:95], v7 offset:9216
    v_mfma_f32_16x16x32_bf16 v[108:111], a[76:79], a[44:47], v[108:111]
    v_mfma_f32_16x16x32_bf16 v[112:115], a[72:75], a[16:19], v[112:115]
    s_add_u32 m0, s36, 36864
    v_mfma_f32_16x16x32_bf16 v[112:115], a[76:79], a[48:51], v[112:115]
    buffer_load_dwordx4 v8, s[8:11], s25 offen lds
    v_mfma_f32_16x16x32_bf16 v[116:119], a[72:75], a[20:23], v[116:119]
    s_add_u32 m0, s36, 40960
    v_mfma_f32_16x16x32_bf16 v[116:119], a[76:79], a[52:55], v[116:119]
    buffer_load_dwordx4 v8, s[8:11], s26 offen lds
    v_mfma_f32_16x16x32_bf16 v[120:123], a[72:75], a[24:27], v[120:123]
    s_add_u32 m0, s36, 45056
    v_mfma_f32_16x16x32_bf16 v[120:123], a[76:79], a[56:59], v[120:123]
    buffer_load_dwordx4 v8, s[8:11], s27 offen lds
    v_mfma_f32_16x16x32_bf16 v[124:127], a[72:75], a[28:31], v[124:127]
    v_mfma_f32_16x16x32_bf16 v[124:127], a[76:79], a[60:63], v[124:127]
    s_waitcnt vmcnt(20) lgkmcnt(0)
    s_barrier
    v_mfma_f32_16x16x32_bf16 v[128:131], a[80:83], a[0:3], v[128:131]
    ds_read_b64_tr_b16 a[64:65], v4 offset:16384
    v_mfma_f32_16x16x32_bf16 v[128:131], a[84:87], a[32:35], v[128:131]
    v_mfma_f32_16x16x32_bf16 v[132:135], a[80:83], a[4:7], v[132:135]
    ds_read_b64_tr_b16 a[66:67], v4 offset:17408
    v_mfma_f32_16x16x32_bf16 v[132:135], a[84:87], a[36:39], v[132:135]
    v_mfma_f32_16x16x32_bf16 v[136:139], a[80:83], a[8:11], v[136:139]
    ds_read_b64_tr_b16 a[68:69], v4 offset:24576
    v_mfma_f32_16x16x32_bf16 v[136:139], a[84:87], a[40:43], v[136:139]
    v_mfma_f32_16x16x32_bf16 v[140:143], a[80:83], a[12:15], v[140:143]
    ds_read_b64_tr_b16 a[70:71], v4 offset:25600
    v_mfma_f32_16x16x32_bf16 v[140:143], a[84:87], a[44:47], v[140:143]
    v_mfma_f32_16x16x32_bf16 v[144:147], a[80:83], a[16:19], v[144:147]
    s_add_u32 m0, s37, 0
    v_mfma_f32_16x16x32_bf16 v[144:147], a[84:87], a[48:51], v[144:147]
    buffer_load_dwordx4 v9, s[12:15], s32 offen lds
    v_mfma_f32_16x16x32_bf16 v[148:151], a[80:83], a[20:23], v[148:151]
    v_mfma_f32_16x16x32_bf16 v[148:151], a[84:87], a[52:55], v[148:151]
    v_mfma_f32_16x16x32_bf16 v[152:155], a[80:83], a[24:27], v[152:155]
    s_add_u32 m0, s37, 4096
    v_mfma_f32_16x16x32_bf16 v[152:155], a[84:87], a[56:59], v[152:155]
    buffer_load_dwordx4 v9, s[12:15], s33 offen lds
    v_mfma_f32_16x16x32_bf16 v[156:159], a[80:83], a[28:31], v[156:159]
    v_mfma_f32_16x16x32_bf16 v[156:159], a[84:87], a[60:63], v[156:159]
    v_mfma_f32_16x16x32_bf16 v[160:163], a[88:91], a[0:3], v[160:163]
    ds_read_b64_tr_b16 a[72:73], v5 offset:16384
    v_mfma_f32_16x16x32_bf16 v[160:163], a[92:95], a[32:35], v[160:163]
    v_mfma_f32_16x16x32_bf16 v[164:167], a[88:91], a[4:7], v[164:167]
    ds_read_b64_tr_b16 a[74:75], v5 offset:17408
    v_mfma_f32_16x16x32_bf16 v[164:167], a[92:95], a[36:39], v[164:167]
    v_mfma_f32_16x16x32_bf16 v[168:171], a[88:91], a[8:11], v[168:171]
    ds_read_b64_tr_b16 a[76:77], v5 offset:24576
    v_mfma_f32_16x16x32_bf16 v[168:171], a[92:95], a[40:43], v[168:171]
    v_mfma_f32_16x16x32_bf16 v[172:175], a[88:91], a[12:15], v[172:175]
    ds_read_b64_tr_b16 a[78:79], v5 offset:25600
    v_mfma_f32_16x16x32_bf16 v[172:175], a[92:95], a[44:47], v[172:175]
    v_mfma_f32_16x16x32_bf16 v[176:179], a[88:91], a[16:19], v[176:179]
    s_add_u32 m0, s37, 8192
    v_mfma_f32_16x16x32_bf16 v[176:179], a[92:95], a[48:51], v[176:179]
    buffer_load_dwordx4 v9, s[12:15], s34 offen lds
    v_mfma_f32_16x16x32_bf16 v[180:183], a[88:91], a[20:23], v[180:183]
    v_mfma_f32_16x16x32_bf16 v[180:183], a[92:95], a[52:55], v[180:183]
    v_mfma_f32_16x16x32_bf16 v[184:187], a[88:91], a[24:27], v[184:187]
    s_add_u32 m0, s37, 12288
    v_mfma_f32_16x16x32_bf16 v[184:187], a[92:95], a[56:59], v[184:187]
    buffer_load_dwordx4 v9, s[12:15], s35 offen lds
    v_mfma_f32_16x16x32_bf16 v[188:191], a[88:91], a[28:31], v[188:191]
    v_mfma_f32_16x16x32_bf16 v[188:191], a[92:95], a[60:63], v[188:191]
    s_waitcnt lgkmcnt(1)
    v_mfma_f32_16x16x32_bf16 v[192:195], a[64:67], a[0:3], v[192:195]
    ds_read_b64_tr_b16 a[80:81], v6 offset:16384
    v_mfma_f32_16x16x32_bf16 v[192:195], a[68:71], a[32:35], v[192:195]
    v_mfma_f32_16x16x32_bf16 v[196:199], a[64:67], a[4:7], v[196:199]
    ds_read_b64_tr_b16 a[82:83], v6 offset:17408
    v_mfma_f32_16x16x32_bf16 v[196:199], a[68:71], a[36:39], v[196:199]
    v_mfma_f32_16x16x32_bf16 v[200:203], a[64:67], a[8:11], v[200:203]
    ds_read_b64_tr_b16 a[84:85], v6 offset:24576
    v_mfma_f32_16x16x32_bf16 v[200:203], a[68:71], a[40:43], v[200:203]
    v_mfma_f32_16x16x32_bf16 v[204:207], a[64:67], a[12:15], v[204:207]
    ds_read_b64_tr_b16 a[86:87], v6 offset:25600
    v_mfma_f32_16x16x32_bf16 v[204:207], a[68:71], a[44:47], v[204:207]
    s_add_u32 m0, s36, 49152
    v_mfma_f32_16x16x32_bf16 v[208:211], a[64:67], a[16:19], v[208:211]
    buffer_load_dwordx4 v8, s[8:11], s28 offen lds
    v_mfma_f32_16x16x32_bf16 v[208:211], a[68:71], a[48:51], v[208:211]
    v_mfma_f32_16x16x32_bf16 v[212:215], a[64:67], a[20:23], v[212:215]
    v_mfma_f32_16x16x32_bf16 v[212:215], a[68:71], a[52:55], v[212:215]
    s_add_u32 m0, s36, 53248
    v_mfma_f32_16x16x32_bf16 v[216:219], a[64:67], a[24:27], v[216:219]
    buffer_load_dwordx4 v8, s[8:11], s29 offen lds
    v_mfma_f32_16x16x32_bf16 v[216:219], a[68:71], a[56:59], v[216:219]
    v_mfma_f32_16x16x32_bf16 v[220:223], a[64:67], a[28:31], v[220:223]
    v_mfma_f32_16x16x32_bf16 v[220:223], a[68:71], a[60:63], v[220:223]
    v_mfma_f32_16x16x32_bf16 v[224:227], a[72:75], a[0:3], v[224:227]
    ds_read_b64_tr_b16 a[88:89], v7 offset:16384
    s_waitcnt lgkmcnt(5)
    v_mfma_f32_16x16x32_bf16 v[224:227], a[76:79], a[32:35], v[224:227]
    v_mfma_f32_16x16x32_bf16 v[228:231], a[72:75], a[4:7], v[228:231]
    ds_read_b64_tr_b16 a[90:91], v7 offset:17408
    v_mfma_f32_16x16x32_bf16 v[228:231], a[76:79], a[36:39], v[228:231]
    v_mfma_f32_16x16x32_bf16 v[232:235], a[72:75], a[8:11], v[232:235]
    ds_read_b64_tr_b16 a[92:93], v7 offset:24576
    v_mfma_f32_16x16x32_bf16 v[232:235], a[76:79], a[40:43], v[232:235]
    v_mfma_f32_16x16x32_bf16 v[236:239], a[72:75], a[12:15], v[236:239]
    ds_read_b64_tr_b16 a[94:95], v7 offset:25600
    v_mfma_f32_16x16x32_bf16 v[236:239], a[76:79], a[44:47], v[236:239]
    s_add_u32 m0, s36, 57344
    v_mfma_f32_16x16x32_bf16 v[240:243], a[72:75], a[16:19], v[240:243]
    buffer_load_dwordx4 v8, s[8:11], s30 offen lds
    v_mfma_f32_16x16x32_bf16 v[240:243], a[76:79], a[48:51], v[240:243]
    v_mfma_f32_16x16x32_bf16 v[244:247], a[72:75], a[20:23], v[244:247]
    v_mfma_f32_16x16x32_bf16 v[244:247], a[76:79], a[52:55], v[244:247]
    s_add_u32 m0, s36, 61440
    v_mfma_f32_16x16x32_bf16 v[248:251], a[72:75], a[24:27], v[248:251]
    buffer_load_dwordx4 v8, s[8:11], s31 offen lds
    v_mfma_f32_16x16x32_bf16 v[248:251], a[76:79], a[56:59], v[248:251]
    s_add_u32 s8, s8, 128
    s_addc_u32 s9, s9, 0
    s_sub_u32 s10, s10, 128
    v_mfma_f32_16x16x32_bf16 v[252:255], a[72:75], a[28:31], v[252:255]
    v_mfma_f32_16x16x32_bf16 v[252:255], a[76:79], a[60:63], v[252:255]
    s_waitcnt vmcnt(16) lgkmcnt(0)
    s_barrier
    v_mfma_f32_16x16x32_bf16 a[128:131], a[80:83], a[0:3], a[128:131]
    ds_read_b64_tr_b16 a[64:65], v4 offset:32768
    v_mfma_f32_16x16x32_bf16 a[128:131], a[84:87], a[32:35], a[128:131]
    ds_read_b64_tr_b16 a[66:67], v4 offset:33792
    v_mfma_f32_16x16x32_bf16 a[132:135], a[80:83], a[4:7], a[132:135]
    v_mfma_f32_16x16x32_bf16 a[132:135], a[84:87], a[36:39], a[132:135]
    ds_read_b64_tr_b16 a[68:69], v4 offset:40960
    v_mfma_f32_16x16x32_bf16 a[136:139], a[80:83], a[8:11], a[136:139]
    ds_read_b64_tr_b16 a[70:71], v4 offset:41984
    v_mfma_f32_16x16x32_bf16 a[136:139], a[84:87], a[40:43], a[136:139]
    v_mfma_f32_16x16x32_bf16 a[140:143], a[80:83], a[12:15], a[140:143]
    ds_read_b64_tr_b16 a[72:73], v5 offset:32768
    v_mfma_f32_16x16x32_bf16 a[140:143], a[84:87], a[44:47], a[140:143]
    ds_read_b64_tr_b16 a[74:75], v5 offset:33792
    v_mfma_f32_16x16x32_bf16 a[144:147], a[80:83], a[16:19], a[144:147]
    v_mfma_f32_16x16x32_bf16 a[144:147], a[84:87], a[48:51], a[144:147]
    ds_read_b64_tr_b16 a[76:77], v5 offset:40960
    v_mfma_f32_16x16x32_bf16 a[148:151], a[80:83], a[20:23], a[148:151]
    ds_read_b64_tr_b16 a[78:79], v5 offset:41984
    v_mfma_f32_16x16x32_bf16 a[148:151], a[84:87], a[52:55], a[148:151]
    v_mfma_f32_16x16x32_bf16 a[152:155], a[80:83], a[24:27], a[152:155]
    s_add_u32 m0, s37, 16384
    v_mfma_f32_16x16x32_bf16 a[152:155], a[84:87], a[56:59], a[152:155]
    buffer_load_dwordx4 v9, s[16:19], s32 offen lds
    v_mfma_f32_16x16x32_bf16 a[156:159], a[80:83], a[28:31], a[156:159]
    s_add_u32 s32, s32, 458752
    v_mfma_f32_16x16x32_bf16 a[156:159], a[84:87], a[60:63], a[156:159]
    v_mfma_f32_16x16x32_bf16 a[160:163], a[88:91], a[0:3], a[160:163]
    ds_read_b128 a[0:3], v2 offset:0
    v_mfma_f32_16x16x32_bf16 a[160:163], a[92:95], a[32:35], a[160:163]
    ds_read_b128 a[32:35], v3 offset:0
    v_mfma_f32_16x16x32_bf16 a[164:167], a[88:91], a[4:7], a[164:167]
    ds_read_b128 a[4:7], v2 offset:2048
    v_mfma_f32_16x16x32_bf16 a[164:167], a[92:95], a[36:39], a[164:167]
    ds_read_b128 a[36:39], v3 offset:2048
    v_mfma_f32_16x16x32_bf16 a[168:171], a[88:91], a[8:11], a[168:171]
    ds_read_b128 a[8:11], v2 offset:4096
    v_mfma_f32_16x16x32_bf16 a[168:171], a[92:95], a[40:43], a[168:171]
    ds_read_b128 a[40:43], v3 offset:4096
    v_mfma_f32_16x16x32_bf16 a[172:175], a[88:91], a[12:15], a[172:175]
    ds_read_b128 a[12:15], v2 offset:6144
    v_mfma_f32_16x16x32_bf16 a[172:175], a[92:95], a[44:47], a[172:175]
    ds_read_b128 a[44:47], v3 offset:6144
    v_mfma_f32_16x16x32_bf16 a[176:179], a[88:91], a[16:19], a[176:179]
    ds_read_b128 a[16:19], v2 offset:8192
    v_mfma_f32_16x16x32_bf16 a[176:179], a[92:95], a[48:51], a[176:179]
    ds_read_b128 a[48:51], v3 offset:8192
    v_mfma_f32_16x16x32_bf16 a[180:183], a[88:91], a[20:23], a[180:183]
    ds_read_b128 a[20:23], v2 offset:10240
    v_mfma_f32_16x16x32_bf16 a[180:183], a[92:95], a[52:55], a[180:183]
    ds_read_b128 a[52:55], v3 offset:10240
    v_mfma_f32_16x16x32_bf16 a[184:187], a[88:91], a[24:27], a[184:187]
    ds_read_b128 a[24:27], v2 offset:12288
    v_mfma_f32_16x16x32_bf16 a[184:187], a[92:95], a[56:59], a[184:187]
    ds_read_b128 a[56:59], v3 offset:12288
    v_mfma_f32_16x16x32_bf16 a[188:191], a[88:91], a[28:31], a[188:191]
    ds_read_b128 a[28:31], v2 offset:14336
    v_mfma_f32_16x16x32_bf16 a[188:191], a[92:95], a[60:63], a[188:191]
    ds_read_b128 a[60:63], v3 offset:14336
    s_waitcnt lgkmcnt(10)
    v_mfma_f32_16x16x32_bf16 v[64:67], a[64:67], a[0:3], v[64:67]
    ds_read_b64_tr_b16 a[80:81], v6 offset:32768
    v_mfma_f32_16x16x32_bf16 v[64:67], a[68:71], a[32:35], v[64:67]
    v_mfma_f32_16x16x32_bf16 v[68:71], a[64:67], a[4:7], v[68:71]
    ds_read_b64_tr_b16 a[82:83], v6 offset:33792
    v_mfma_f32_16x16x32_bf16 v[68:71], a[68:71], a[36:39], v[68:71]
    v_mfma_f32_16x16x32_bf16 v[72:75], a[64:67], a[8:11], v[72:75]
    ds_read_b64_tr_b16 a[84:85], v6 offset:40960
    v_mfma_f32_16x16x32_bf16 v[72:75], a[68:71], a[40:43], v[72:75]
    s_waitcnt lgkmcnt(7)
    v_mfma_f32_16x16x32_bf16 v[76:79], a[64:67], a[12:15], v[76:79]
    ds_read_b64_tr_b16 a[86:87], v6 offset:41984
    v_mfma_f32_16x16x32_bf16 v[76:79], a[68:71], a[44:47], v[76:79]
    v_mfma_f32_16x16x32_bf16 v[80:83], a[64:67], a[16:19], v[80:83]
    s_add_u32 m0, s37, 20480
    v_mfma_f32_16x16x32_bf16 v[80:83], a[68:71], a[48:51], v[80:83]
    buffer_load_dwordx4 v9, s[16:19], s33 offen lds
    v_mfma_f32_16x16x32_bf16 v[84:87], a[64:67], a[20:23], v[84:87]
    s_add_u32 s33, s33, 458752
    s_add_u32 m0, s37, 24576
    v_mfma_f32_16x16x32_bf16 v[84:87], a[68:71], a[52:55], v[84:87]
    buffer_load_dwordx4 v9, s[16:19], s34 offen lds
    s_waitcnt lgkmcnt(2)
    v_mfma_f32_16x16x32_bf16 v[88:91], a[64:67], a[24:27], v[88:91]
    s_add_u32 s34, s34, 458752
    s_add_u32 m0, s37, 28672
    v_mfma_f32_16x16x32_bf16 v[88:91], a[68:71], a[56:59], v[88:91]
    buffer_load_dwordx4 v9, s[16:19], s35 offen lds
    v_mfma_f32_16x16x32_bf16 v[92:95], a[64:67], a[28:31], v[92:95]
    s_add_u32 s35, s35, 458752
    s_add_u32 m0, s36, 65536
    v_mfma_f32_16x16x32_bf16 v[92:95], a[68:71], a[60:63], v[92:95]
    buffer_load_dwordx4 v8, s[8:11], s24 offen lds
    v_mfma_f32_16x16x32_bf16 v[96:99], a[72:75], a[0:3], v[96:99]
    ds_read_b64_tr_b16 a[88:89], v7 offset:32768
    v_mfma_f32_16x16x32_bf16 v[96:99], a[76:79], a[32:35], v[96:99]
    v_mfma_f32_16x16x32_bf16 v[100:103], a[72:75], a[4:7], v[100:103]
    ds_read_b64_tr_b16 a[90:91], v7 offset:33792
    v_mfma_f32_16x16x32_bf16 v[100:103], a[76:79], a[36:39], v[100:103]
    v_mfma_f32_16x16x32_bf16 v[104:107], a[72:75], a[8:11], v[104:107]
    ds_read_b64_tr_b16 a[92:93], v7 offset:40960
    v_mfma_f32_16x16x32_bf16 v[104:107], a[76:79], a[40:43], v[104:107]
    v_mfma_f32_16x16x32_bf16 v[108:111], a[72:75], a[12:15], v[108:111]
    ds_read_b64_tr_b16 a[94:95], v7 offset:41984
    v_mfma_f32_16x16x32_bf16 v[108:111], a[76:79], a[44:47], v[108:111]
    v_mfma_f32_16x16x32_bf16 v[112:115], a[72:75], a[16:19], v[112:115]
    s_add_u32 m0, s36, 69632
    v_mfma_f32_16x16x32_bf16 v[112:115], a[76:79], a[48:51], v[112:115]
    buffer_load_dwordx4 v8, s[8:11], s25 offen lds
    v_mfma_f32_16x16x32_bf16 v[116:119], a[72:75], a[20:23], v[116:119]
    s_add_u32 m0, s36, 73728
    v_mfma_f32_16x16x32_bf16 v[116:119], a[76:79], a[52:55], v[116:119]
    buffer_load_dwordx4 v8, s[8:11], s26 offen lds
    v_mfma_f32_16x16x32_bf16 v[120:123], a[72:75], a[24:27], v[120:123]
    s_add_u32 m0, s36, 77824
    v_mfma_f32_16x16x32_bf16 v[120:123], a[76:79], a[56:59], v[120:123]
    buffer_load_dwordx4 v8, s[8:11], s27 offen lds
    v_mfma_f32_16x16x32_bf16 v[124:127], a[72:75], a[28:31], v[124:127]
    v_mfma_f32_16x16x32_bf16 v[124:127], a[76:79], a[60:63], v[124:127]
    s_waitcnt vmcnt(20) lgkmcnt(0)
    s_barrier
    v_mfma_f32_16x16x32_bf16 v[128:131], a[80:83], a[0:3], v[128:131]
    ds_read_b64_tr_b16 a[64:65], v4 offset:49152
    v_mfma_f32_16x16x32_bf16 v[128:131], a[84:87], a[32:35], v[128:131]
    v_mfma_f32_16x16x32_bf16 v[132:135], a[80:83], a[4:7], v[132:135]
    ds_read_b64_tr_b16 a[66:67], v4 offset:50176
    v_mfma_f32_16x16x32_bf16 v[132:135], a[84:87], a[36:39], v[132:135]
    s_lshr_b32 s92, s2, 3
    s_mul_i32 s92, s92, 131456
    v_mfma_f32_16x16x32_bf16 v[136:139], a[80:83], a[8:11], v[136:139]
    ds_read_b64_tr_b16 a[68:69], v4 offset:57344
    v_mfma_f32_16x16x32_bf16 v[136:139], a[84:87], a[40:43], v[136:139]
    s_and_b32 s93, s2, 7
    s_lshl_b32 s93, s93, 7
    v_mfma_f32_16x16x32_bf16 v[140:143], a[80:83], a[12:15], v[140:143]
    ds_read_b64_tr_b16 a[70:71], v4 offset:58368
    v_mfma_f32_16x16x32_bf16 v[140:143], a[84:87], a[44:47], v[140:143]
    s_add_u32 s92, s92, s93
    s_lshl_b32 s93, s38, 15
    v_mfma_f32_16x16x32_bf16 v[144:147], a[80:83], a[16:19], v[144:147]
    s_add_u32 m0, s37, 32768
    v_mfma_f32_16x16x32_bf16 v[144:147], a[84:87], a[48:51], v[144:147]
    s_add_u32 s92, s92, s93
    s_add_u32 s92, s92, 37814272
    buffer_load_dwordx4 v9, s[12:15], s32 offen lds
    v_mfma_f32_16x16x32_bf16 v[148:151], a[80:83], a[20:23], v[148:151]
    v_mfma_f32_16x16x32_bf16 v[148:151], a[84:87], a[52:55], v[148:151]
    v_lshrrev_b32 v24, 5, v11
    s_lshl_b32 s93, s38, 3
    v_mfma_f32_16x16x32_bf16 v[152:155], a[80:83], a[24:27], v[152:155]
    s_add_u32 m0, s37, 36864
    v_mfma_f32_16x16x32_bf16 v[152:155], a[84:87], a[56:59], v[152:155]
    s_and_b32 s93, s93, 8
    v_add_u32 v25, s93, v24
    buffer_load_dwordx4 v9, s[12:15], s33 offen lds
    v_mfma_f32_16x16x32_bf16 v[156:159], a[80:83], a[28:31], v[156:159]
    v_mfma_f32_16x16x32_bf16 v[156:159], a[84:87], a[60:63], v[156:159]
    v_and_b32 v26, 15, v11
    v_xor_b32 v25, v25, v26
    v_mfma_f32_16x16x32_bf16 v[160:163], a[88:91], a[0:3], v[160:163]
    ds_read_b64_tr_b16 a[72:73], v5 offset:49152
    v_mfma_f32_16x16x32_bf16 v[160:163], a[92:95], a[32:35], v[160:163]
    v_bfe_u32 v26, v11, 4, 1
    v_lshlrev_b32 v26, 11, v26
    v_mfma_f32_16x16x32_bf16 v[164:167], a[88:91], a[4:7], v[164:167]
    ds_read_b64_tr_b16 a[74:75], v5 offset:50176
    v_mfma_f32_16x16x32_bf16 v[164:167], a[92:95], a[36:39], v[164:167]
    v_lshl_add_u32 v24, v24, 12, v26
    s_lshl_b32 s93, s38, 12
    v_mfma_f32_16x16x32_bf16 v[168:171], a[88:91], a[8:11], v[168:171]
    ds_read_b64_tr_b16 a[76:77], v5 offset:57344
    v_mfma_f32_16x16x32_bf16 v[168:171], a[92:95], a[40:43], v[168:171]
    s_add_u32 s93, s93, 131072
    v_xor_b32 v26, 0, v25
    v_mfma_f32_16x16x32_bf16 v[172:175], a[88:91], a[12:15], v[172:175]
    ds_read_b64_tr_b16 a[78:79], v5 offset:58368
    v_mfma_f32_16x16x32_bf16 v[172:175], a[92:95], a[44:47], v[172:175]
    v_lshrrev_b32 v27, 3, v26
    v_and_b32 v26, 7, v26
    v_mfma_f32_16x16x32_bf16 v[176:179], a[88:91], a[16:19], v[176:179]
    s_add_u32 m0, s37, 40960
    v_mfma_f32_16x16x32_bf16 v[176:179], a[92:95], a[48:51], v[176:179]
    v_lshlrev_b32 v26, 4, v26
    v_lshl_add_u32 v26, v27, 10, v26
    buffer_load_dwordx4 v9, s[12:15], s34 offen lds
    v_mfma_f32_16x16x32_bf16 v[180:183], a[88:91], a[20:23], v[180:183]
    v_mfma_f32_16x16x32_bf16 v[180:183], a[92:95], a[52:55], v[180:183]
    v_add_u32 v28, v24, v26
    v_xor_b32 v26, 2, v25
    v_mfma_f32_16x16x32_bf16 v[184:187], a[88:91], a[24:27], v[184:187]
    s_add_u32 m0, s37, 45056
    v_mfma_f32_16x16x32_bf16 v[184:187], a[92:95], a[56:59], v[184:187]
    v_lshrrev_b32 v27, 3, v26
    v_and_b32 v26, 7, v26
    buffer_load_dwordx4 v9, s[12:15], s35 offen lds
    v_mfma_f32_16x16x32_bf16 v[188:191], a[88:91], a[28:31], v[188:191]
    v_mfma_f32_16x16x32_bf16 v[188:191], a[92:95], a[60:63], v[188:191]
    v_lshlrev_b32 v26, 4, v26
    v_lshl_add_u32 v26, v27, 10, v26
    s_waitcnt lgkmcnt(1)
    v_mfma_f32_16x16x32_bf16 v[192:195], a[64:67], a[0:3], v[192:195]
    ds_read_b64_tr_b16 a[80:81], v6 offset:49152
    v_mfma_f32_16x16x32_bf16 v[192:195], a[68:71], a[32:35], v[192:195]
    v_add_u32 v29, v24, v26
    v_xor_b32 v26, 4, v25
    v_mfma_f32_16x16x32_bf16 v[196:199], a[64:67], a[4:7], v[196:199]
    ds_read_b64_tr_b16 a[82:83], v6 offset:50176
    v_mfma_f32_16x16x32_bf16 v[196:199], a[68:71], a[36:39], v[196:199]
    v_lshrrev_b32 v27, 3, v26
    v_and_b32 v26, 7, v26
    v_mfma_f32_16x16x32_bf16 v[200:203], a[64:67], a[8:11], v[200:203]
    ds_read_b64_tr_b16 a[84:85], v6 offset:57344
    v_mfma_f32_16x16x32_bf16 v[200:203], a[68:71], a[40:43], v[200:203]
    v_lshlrev_b32 v26, 4, v26
    v_lshl_add_u32 v26, v27, 10, v26
    v_mfma_f32_16x16x32_bf16 v[204:207], a[64:67], a[12:15], v[204:207]
    ds_read_b64_tr_b16 a[86:87], v6 offset:58368
    v_mfma_f32_16x16x32_bf16 v[204:207], a[68:71], a[44:47], v[204:207]
    v_add_u32 v30, v24, v26
    v_xor_b32 v26, 6, v25
    s_add_u32 m0, s36, 81920
    v_mfma_f32_16x16x32_bf16 v[208:211], a[64:67], a[16:19], v[208:211]
    buffer_load_dwordx4 v8, s[8:11], s28 offen lds
    v_mfma_f32_16x16x32_bf16 v[208:211], a[68:71], a[48:51], v[208:211]
    v_lshrrev_b32 v27, 3, v26
    v_and_b32 v26, 7, v26
    v_mfma_f32_16x16x32_bf16 v[212:215], a[64:67], a[20:23], v[212:215]
    v_mfma_f32_16x16x32_bf16 v[212:215], a[68:71], a[52:55], v[212:215]
    v_lshlrev_b32 v26, 4, v26
    v_lshl_add_u32 v26, v27, 10, v26
    s_add_u32 m0, s36, 86016
    v_mfma_f32_16x16x32_bf16 v[216:219], a[64:67], a[24:27], v[216:219]
    buffer_load_dwordx4 v8, s[8:11], s29 offen lds
    v_mfma_f32_16x16x32_bf16 v[216:219], a[68:71], a[56:59], v[216:219]
    v_add_u32 v31, v24, v26
    v_mfma_f32_16x16x32_bf16 v[220:223], a[64:67], a[28:31], v[220:223]
    v_mfma_f32_16x16x32_bf16 v[220:223], a[68:71], a[60:63], v[220:223]
    v_mfma_f32_16x16x32_bf16 v[224:227], a[72:75], a[0:3], v[224:227]
    ds_read_b64_tr_b16 a[88:89], v7 offset:49152
    s_waitcnt lgkmcnt(5)
    v_mfma_f32_16x16x32_bf16 v[224:227], a[76:79], a[32:35], v[224:227]
    v_mfma_f32_16x16x32_bf16 v[228:231], a[72:75], a[4:7], v[228:231]
    ds_read_b64_tr_b16 a[90:91], v7 offset:50176
    v_mfma_f32_16x16x32_bf16 v[228:231], a[76:79], a[36:39], v[228:231]
    v_mfma_f32_16x16x32_bf16 v[232:235], a[72:75], a[8:11], v[232:235]
    ds_read_b64_tr_b16 a[92:93], v7 offset:57344
    v_mfma_f32_16x16x32_bf16 v[232:235], a[76:79], a[40:43], v[232:235]
    v_mfma_f32_16x16x32_bf16 v[236:239], a[72:75], a[12:15], v[236:239]
    ds_read_b64_tr_b16 a[94:95], v7 offset:58368
    v_mfma_f32_16x16x32_bf16 v[236:239], a[76:79], a[44:47], v[236:239]
    s_add_u32 m0, s36, 90112
    v_mfma_f32_16x16x32_bf16 v[240:243], a[72:75], a[16:19], v[240:243]
    buffer_load_dwordx4 v8, s[8:11], s30 offen lds
    v_mfma_f32_16x16x32_bf16 v[240:243], a[76:79], a[48:51], v[240:243]
    v_mfma_f32_16x16x32_bf16 v[244:247], a[72:75], a[20:23], v[244:247]
    v_mfma_f32_16x16x32_bf16 v[244:247], a[76:79], a[52:55], v[244:247]
    s_add_u32 m0, s36, 94208
    v_mfma_f32_16x16x32_bf16 v[248:251], a[72:75], a[24:27], v[248:251]
    buffer_load_dwordx4 v8, s[8:11], s31 offen lds
    v_mfma_f32_16x16x32_bf16 v[248:251], a[76:79], a[56:59], v[248:251]
    s_add_u32 s8, s8, 128
    s_addc_u32 s9, s9, 0
    s_sub_u32 s10, s10, 128
    v_mfma_f32_16x16x32_bf16 v[252:255], a[72:75], a[28:31], v[252:255]
    v_mfma_f32_16x16x32_bf16 v[252:255], a[76:79], a[60:63], v[252:255]
    s_waitcnt vmcnt(16) lgkmcnt(0)
    s_barrier
    v_mfma_f32_16x16x32_bf16 a[128:131], a[80:83], a[0:3], a[128:131]
    ds_read_b64_tr_b16 a[64:65], v4 offset:0
    v_mfma_f32_16x16x32_bf16 a[128:131], a[84:87], a[32:35], a[128:131]
    ds_read_b64_tr_b16 a[66:67], v4 offset:1024
    v_mfma_f32_16x16x32_bf16 a[132:135], a[80:83], a[4:7], a[132:135]
    v_mfma_f32_16x16x32_bf16 a[132:135], a[84:87], a[36:39], a[132:135]
    ds_read_b64_tr_b16 a[68:69], v4 offset:8192
    v_mfma_f32_16x16x32_bf16 a[136:139], a[80:83], a[8:11], a[136:139]
    ds_read_b64_tr_b16 a[70:71], v4 offset:9216
    v_mfma_f32_16x16x32_bf16 a[136:139], a[84:87], a[40:43], a[136:139]
    v_mfma_f32_16x16x32_bf16 a[140:143], a[80:83], a[12:15], a[140:143]
    ds_read_b64_tr_b16 a[72:73], v5 offset:0
    v_mfma_f32_16x16x32_bf16 a[140:143], a[84:87], a[44:47], a[140:143]
    ds_read_b64_tr_b16 a[74:75], v5 offset:1024
    v_mfma_f32_16x16x32_bf16 a[144:147], a[80:83], a[16:19], a[144:147]
    v_mfma_f32_16x16x32_bf16 a[144:147], a[84:87], a[48:51], a[144:147]
    ds_read_b64_tr_b16 a[76:77], v5 offset:8192
    v_mfma_f32_16x16x32_bf16 a[148:151], a[80:83], a[20:23], a[148:151]
    ds_read_b64_tr_b16 a[78:79], v5 offset:9216
    v_mfma_f32_16x16x32_bf16 a[148:151], a[84:87], a[52:55], a[148:151]
    v_mfma_f32_16x16x32_bf16 a[152:155], a[80:83], a[24:27], a[152:155]
    s_add_u32 m0, s37, 49152
    v_mfma_f32_16x16x32_bf16 a[152:155], a[84:87], a[56:59], a[152:155]
    buffer_load_dwordx4 v9, s[16:19], s32 offen lds
    v_mfma_f32_16x16x32_bf16 a[156:159], a[80:83], a[28:31], a[156:159]
    s_add_u32 s32, s32, 458752
    v_mfma_f32_16x16x32_bf16 a[156:159], a[84:87], a[60:63], a[156:159]
    v_mfma_f32_16x16x32_bf16 a[160:163], a[88:91], a[0:3], a[160:163]
    ds_read_b128 a[0:3], v2 offset:32768
    v_mfma_f32_16x16x32_bf16 a[160:163], a[92:95], a[32:35], a[160:163]
    ds_read_b128 a[32:35], v3 offset:32768
    v_mfma_f32_16x16x32_bf16 a[164:167], a[88:91], a[4:7], a[164:167]
    ds_read_b128 a[4:7], v2 offset:34816
    v_mfma_f32_16x16x32_bf16 a[164:167], a[92:95], a[36:39], a[164:167]
    ds_read_b128 a[36:39], v3 offset:34816
    v_mfma_f32_16x16x32_bf16 a[168:171], a[88:91], a[8:11], a[168:171]
    ds_read_b128 a[8:11], v2 offset:36864
    v_mfma_f32_16x16x32_bf16 a[168:171], a[92:95], a[40:43], a[168:171]
    ds_read_b128 a[40:43], v3 offset:36864
    v_mfma_f32_16x16x32_bf16 a[172:175], a[88:91], a[12:15], a[172:175]
    ds_read_b128 a[12:15], v2 offset:38912
    v_mfma_f32_16x16x32_bf16 a[172:175], a[92:95], a[44:47], a[172:175]
    ds_read_b128 a[44:47], v3 offset:38912
    v_mfma_f32_16x16x32_bf16 a[176:179], a[88:91], a[16:19], a[176:179]
    ds_read_b128 a[16:19], v2 offset:40960
    v_mfma_f32_16x16x32_bf16 a[176:179], a[92:95], a[48:51], a[176:179]
    ds_read_b128 a[48:51], v3 offset:40960
    v_mfma_f32_16x16x32_bf16 a[180:183], a[88:91], a[20:23], a[180:183]
    ds_read_b128 a[20:23], v2 offset:43008
    v_mfma_f32_16x16x32_bf16 a[180:183], a[92:95], a[52:55], a[180:183]
    ds_read_b128 a[52:55], v3 offset:43008
    v_mfma_f32_16x16x32_bf16 a[184:187], a[88:91], a[24:27], a[184:187]
    ds_read_b128 a[24:27], v2 offset:45056
    v_mfma_f32_16x16x32_bf16 a[184:187], a[92:95], a[56:59], a[184:187]
    ds_read_b128 a[56:59], v3 offset:45056
    v_mfma_f32_16x16x32_bf16 a[188:191], a[88:91], a[28:31], a[188:191]
    ds_read_b128 a[28:31], v2 offset:47104
    v_mfma_f32_16x16x32_bf16 a[188:191], a[92:95], a[60:63], a[188:191]
    ds_read_b128 a[60:63], v3 offset:47104
    s_waitcnt lgkmcnt(10)
    v_mfma_f32_16x16x32_bf16 v[64:67], a[64:67], a[0:3], v[64:67]
    ds_read_b64_tr_b16 a[80:81], v6 offset:0
    v_mfma_f32_16x16x32_bf16 v[64:67], a[68:71], a[32:35], v[64:67]
    v_mfma_f32_16x16x32_bf16 v[68:71], a[64:67], a[4:7], v[68:71]
    ds_read_b64_tr_b16 a[82:83], v6 offset:1024
    v_mfma_f32_16x16x32_bf16 v[68:71], a[68:71], a[36:39], v[68:71]
    v_mfma_f32_16x16x32_bf16 v[72:75], a[64:67], a[8:11], v[72:75]
    ds_read_b64_tr_b16 a[84:85], v6 offset:8192
    v_mfma_f32_16x16x32_bf16 v[72:75], a[68:71], a[40:43], v[72:75]
    s_waitcnt lgkmcnt(7)
    v_mfma_f32_16x16x32_bf16 v[76:79], a[64:67], a[12:15], v[76:79]
    ds_read_b64_tr_b16 a[86:87], v6 offset:9216
    v_mfma_f32_16x16x32_bf16 v[76:79], a[68:71], a[44:47], v[76:79]
    v_mfma_f32_16x16x32_bf16 v[80:83], a[64:67], a[16:19], v[80:83]
    s_add_u32 m0, s37, 53248
    v_mfma_f32_16x16x32_bf16 v[80:83], a[68:71], a[48:51], v[80:83]
    buffer_load_dwordx4 v9, s[16:19], s33 offen lds
    v_mfma_f32_16x16x32_bf16 v[84:87], a[64:67], a[20:23], v[84:87]
    s_add_u32 s33, s33, 458752
    s_add_u32 m0, s37, 57344
    v_mfma_f32_16x16x32_bf16 v[84:87], a[68:71], a[52:55], v[84:87]
    buffer_load_dwordx4 v9, s[16:19], s34 offen lds
    s_waitcnt lgkmcnt(2)
    v_mfma_f32_16x16x32_bf16 v[88:91], a[64:67], a[24:27], v[88:91]
    s_add_u32 s34, s34, 458752
    s_add_u32 m0, s37, 61440
    v_mfma_f32_16x16x32_bf16 v[88:91], a[68:71], a[56:59], v[88:91]
    buffer_load_dwordx4 v9, s[16:19], s35 offen lds
    v_mfma_f32_16x16x32_bf16 v[92:95], a[64:67], a[28:31], v[92:95]
    s_add_u32 s35, s35, 458752
    s_add_u32 m0, s36, 0
    v_mfma_f32_16x16x32_bf16 v[92:95], a[68:71], a[60:63], v[92:95]
    buffer_load_dwordx4 v8, s[8:11], s24 offen lds
    v_mfma_f32_16x16x32_bf16 v[96:99], a[72:75], a[0:3], v[96:99]
    ds_read_b64_tr_b16 a[88:89], v7 offset:0
    v_mfma_f32_16x16x32_bf16 v[96:99], a[76:79], a[32:35], v[96:99]
    v_mfma_f32_16x16x32_bf16 v[100:103], a[72:75], a[4:7], v[100:103]
    ds_read_b64_tr_b16 a[90:91], v7 offset:1024
    v_mfma_f32_16x16x32_bf16 v[100:103], a[76:79], a[36:39], v[100:103]
    v_mfma_f32_16x16x32_bf16 v[104:107], a[72:75], a[8:11], v[104:107]
    ds_read_b64_tr_b16 a[92:93], v7 offset:8192
    v_mfma_f32_16x16x32_bf16 v[104:107], a[76:79], a[40:43], v[104:107]
    v_mfma_f32_16x16x32_bf16 v[108:111], a[72:75], a[12:15], v[108:111]
    ds_read_b64_tr_b16 a[94:95], v7 offset:9216
    v_mfma_f32_16x16x32_bf16 v[108:111], a[76:79], a[44:47], v[108:111]
    v_mfma_f32_16x16x32_bf16 v[112:115], a[72:75], a[16:19], v[112:115]
    s_add_u32 m0, s36, 4096
    v_mfma_f32_16x16x32_bf16 v[112:115], a[76:79], a[48:51], v[112:115]
    buffer_load_dwordx4 v8, s[8:11], s25 offen lds
    v_mfma_f32_16x16x32_bf16 v[116:119], a[72:75], a[20:23], v[116:119]
    s_add_u32 m0, s36, 8192
    v_mfma_f32_16x16x32_bf16 v[116:119], a[76:79], a[52:55], v[116:119]
    buffer_load_dwordx4 v8, s[8:11], s26 offen lds
    v_mfma_f32_16x16x32_bf16 v[120:123], a[72:75], a[24:27], v[120:123]
    s_add_u32 m0, s36, 12288
    v_mfma_f32_16x16x32_bf16 v[120:123], a[76:79], a[56:59], v[120:123]
    buffer_load_dwordx4 v8, s[8:11], s27 offen lds
    v_mfma_f32_16x16x32_bf16 v[124:127], a[72:75], a[28:31], v[124:127]
    s_memrealtime s[44:45]
    v_mfma_f32_16x16x32_bf16 v[124:127], a[76:79], a[60:63], v[124:127]
    s_waitcnt vmcnt(20) lgkmcnt(0)
    s_barrier
    v_mfma_f32_16x16x32_bf16 v[128:131], a[80:83], a[0:3], v[128:131]
    ds_read_b64_tr_b16 a[64:65], v4 offset:16384
    v_mfma_f32_16x16x32_bf16 v[128:131], a[84:87], a[32:35], v[128:131]
    s_add_u32 s45, s3, 1
    v_mfma_f32_16x16x32_bf16 v[132:135], a[80:83], a[4:7], v[132:135]
    ds_read_b64_tr_b16 a[66:67], v4 offset:17408
    v_mfma_f32_16x16x32_bf16 v[132:135], a[84:87], a[36:39], v[132:135]
    v_mov_b32 v14, s44
    v_mfma_f32_16x16x32_bf16 v[136:139], a[80:83], a[8:11], v[136:139]
    ds_read_b64_tr_b16 a[68:69], v4 offset:24576
    v_mfma_f32_16x16x32_bf16 v[136:139], a[84:87], a[40:43], v[136:139]
    v_mov_b32 v15, s45
    v_mfma_f32_16x16x32_bf16 v[140:143], a[80:83], a[12:15], v[140:143]
    ds_read_b64_tr_b16 a[70:71], v4 offset:25600
    v_mfma_f32_16x16x32_bf16 v[140:143], a[84:87], a[44:47], v[140:143]
    s_mov_b32 s60, s80
    s_mov_b32 s61, s81
    buffer_store_dwordx2 v[14:15], v56, s[68:71], s59 offen offset:40 sc1
    v_mfma_f32_16x16x32_bf16 v[144:147], a[80:83], a[16:19], v[144:147]
    s_add_u32 m0, s37, 0
    v_mfma_f32_16x16x32_bf16 v[144:147], a[84:87], a[48:51], v[144:147]
    s_mov_b32 s62, 7340032
    buffer_load_dwordx4 v9, s[12:15], s32 offen lds
    v_and_b32 v18, 1, v11
    v_mfma_f32_16x16x32_bf16 v[148:151], a[80:83], a[20:23], v[148:151]
    v_mfma_f32_16x16x32_bf16 v[148:151], a[84:87], a[52:55], v[148:151]
    v_lshlrev_b32 v18, 8, v18
    v_mfma_f32_16x16x32_bf16 v[152:155], a[80:83], a[24:27], v[152:155]
    s_add_u32 m0, s37, 4096
    v_mfma_f32_16x16x32_bf16 v[152:155], a[84:87], a[56:59], v[152:155]
    buffer_load_dwordx4 v9, s[12:15], s33 offen lds
    v_xor_b32 v18, s59, v18
    v_mfma_f32_16x16x32_bf16 v[156:159], a[80:83], a[28:31], v[156:159]
    v_mfma_f32_16x16x32_bf16 v[156:159], a[84:87], a[60:63], v[156:159]
    v_mfma_f32_16x16x32_bf16 v[160:163], a[88:91], a[0:3], v[160:163]
    ds_read_b64_tr_b16 a[72:73], v5 offset:16384
    v_mfma_f32_16x16x32_bf16 v[160:163], a[92:95], a[32:35], v[160:163]
    v_mfma_f32_16x16x32_bf16 v[164:167], a[88:91], a[4:7], v[164:167]
    ds_read_b64_tr_b16 a[74:75], v5 offset:17408
    v_mfma_f32_16x16x32_bf16 v[164:167], a[92:95], a[36:39], v[164:167]
    v_mfma_f32_16x16x32_bf16 v[168:171], a[88:91], a[8:11], v[168:171]
    ds_read_b64_tr_b16 a[76:77], v5 offset:24576
    v_mfma_f32_16x16x32_bf16 v[168:171], a[92:95], a[40:43], v[168:171]
    v_mfma_f32_16x16x32_bf16 v[172:175], a[88:91], a[12:15], v[172:175]
    ds_read_b64_tr_b16 a[78:79], v5 offset:25600
    v_mfma_f32_16x16x32_bf16 v[172:175], a[92:95], a[44:47], v[172:175]
    v_mfma_f32_16x16x32_bf16 v[176:179], a[88:91], a[16:19], v[176:179]
    s_add_u32 m0, s37, 8192
    v_mfma_f32_16x16x32_bf16 v[176:179], a[92:95], a[48:51], v[176:179]
    buffer_load_dwordx4 v9, s[12:15], s34 offen lds
    v_mfma_f32_16x16x32_bf16 v[180:183], a[88:91], a[20:23], v[180:183]
    v_mfma_f32_16x16x32_bf16 v[180:183], a[92:95], a[52:55], v[180:183]
    v_mfma_f32_16x16x32_bf16 v[184:187], a[88:91], a[24:27], v[184:187]
    s_add_u32 m0, s37, 12288
    v_mfma_f32_16x16x32_bf16 v[184:187], a[92:95], a[56:59], v[184:187]
    buffer_load_dwordx4 v9, s[12:15], s35 offen lds
    v_mfma_f32_16x16x32_bf16 v[188:191], a[88:91], a[28:31], v[188:191]
    v_mfma_f32_16x16x32_bf16 v[188:191], a[92:95], a[60:63], v[188:191]
    s_waitcnt lgkmcnt(1)
    v_mfma_f32_16x16x32_bf16 v[192:195], a[64:67], a[0:3], v[192:195]
    ds_read_b64_tr_b16 a[80:81], v6 offset:16384
    v_mfma_f32_16x16x32_bf16 v[192:195], a[68:71], a[32:35], v[192:195]
    v_mfma_f32_16x16x32_bf16 v[196:199], a[64:67], a[4:7], v[196:199]
    ds_read_b64_tr_b16 a[82:83], v6 offset:17408
    v_mfma_f32_16x16x32_bf16 v[196:199], a[68:71], a[36:39], v[196:199]
    v_mfma_f32_16x16x32_bf16 v[200:203], a[64:67], a[8:11], v[200:203]
    ds_read_b64_tr_b16 a[84:85], v6 offset:24576
    v_mfma_f32_16x16x32_bf16 v[200:203], a[68:71], a[40:43], v[200:203]
    v_mfma_f32_16x16x32_bf16 v[204:207], a[64:67], a[12:15], v[204:207]
    ds_read_b64_tr_b16 a[86:87], v6 offset:25600
    v_mfma_f32_16x16x32_bf16 v[204:207], a[68:71], a[44:47], v[204:207]
    s_add_u32 m0, s36, 16384
    v_mfma_f32_16x16x32_bf16 v[208:211], a[64:67], a[16:19], v[208:211]
    buffer_load_dwordx4 v8, s[8:11], s28 offen lds
    v_mfma_f32_16x16x32_bf16 v[208:211], a[68:71], a[48:51], v[208:211]
    v_mfma_f32_16x16x32_bf16 v[212:215], a[64:67], a[20:23], v[212:215]
    v_mfma_f32_16x16x32_bf16 v[212:215], a[68:71], a[52:55], v[212:215]
    s_add_u32 m0, s36, 20480
    v_mfma_f32_16x16x32_bf16 v[216:219], a[64:67], a[24:27], v[216:219]
    buffer_load_dwordx4 v8, s[8:11], s29 offen lds
    v_mfma_f32_16x16x32_bf16 v[216:219], a[68:71], a[56:59], v[216:219]
    v_mfma_f32_16x16x32_bf16 v[220:223], a[64:67], a[28:31], v[220:223]
    v_mfma_f32_16x16x32_bf16 v[220:223], a[68:71], a[60:63], v[220:223]
    v_mfma_f32_16x16x32_bf16 v[224:227], a[72:75], a[0:3], v[224:227]
    ds_read_b64_tr_b16 a[88:89], v7 offset:16384
    s_waitcnt lgkmcnt(5)
    v_mfma_f32_16x16x32_bf16 v[224:227], a[76:79], a[32:35], v[224:227]
    v_mfma_f32_16x16x32_bf16 v[228:231], a[72:75], a[4:7], v[228:231]
    ds_read_b64_tr_b16 a[90:91], v7 offset:17408
    v_mfma_f32_16x16x32_bf16 v[228:231], a[76:79], a[36:39], v[228:231]
    v_mfma_f32_16x16x32_bf16 v[232:235], a[72:75], a[8:11], v[232:235]
    ds_read_b64_tr_b16 a[92:93], v7 offset:24576
    v_mfma_f32_16x16x32_bf16 v[232:235], a[76:79], a[40:43], v[232:235]
    v_mfma_f32_16x16x32_bf16 v[236:239], a[72:75], a[12:15], v[236:239]
    ds_read_b64_tr_b16 a[94:95], v7 offset:25600
    v_mfma_f32_16x16x32_bf16 v[236:239], a[76:79], a[44:47], v[236:239]
    s_add_u32 m0, s36, 24576
    v_mfma_f32_16x16x32_bf16 v[240:243], a[72:75], a[16:19], v[240:243]
    buffer_load_dwordx4 v8, s[8:11], s30 offen lds
    v_mfma_f32_16x16x32_bf16 v[240:243], a[76:79], a[48:51], v[240:243]
    v_mfma_f32_16x16x32_bf16 v[244:247], a[72:75], a[20:23], v[244:247]
    v_mfma_f32_16x16x32_bf16 v[244:247], a[76:79], a[52:55], v[244:247]
    s_add_u32 m0, s36, 28672
    v_mfma_f32_16x16x32_bf16 v[248:251], a[72:75], a[24:27], v[248:251]
    buffer_load_dwordx4 v8, s[8:11], s31 offen lds
    v_mfma_f32_16x16x32_bf16 v[248:251], a[76:79], a[56:59], v[248:251]
    s_add_u32 s8, s8, 128
    s_addc_u32 s9, s9, 0
    s_sub_u32 s10, s10, 128
    v_mfma_f32_16x16x32_bf16 v[252:255], a[72:75], a[28:31], v[252:255]
    v_mfma_f32_16x16x32_bf16 v[252:255], a[76:79], a[60:63], v[252:255]
    s_waitcnt vmcnt(17) lgkmcnt(0)
    s_barrier
    v_mfma_f32_16x16x32_bf16 a[128:131], a[80:83], a[0:3], a[128:131]
    ds_read_b64_tr_b16 a[64:65], v4 offset:32768
    v_mfma_f32_16x16x32_bf16 a[128:131], a[84:87], a[32:35], a[128:131]
    ds_read_b64_tr_b16 a[66:67], v4 offset:33792
    v_mfma_f32_16x16x32_bf16 a[132:135], a[80:83], a[4:7], a[132:135]
    v_mfma_f32_16x16x32_bf16 a[132:135], a[84:87], a[36:39], a[132:135]
    ds_read_b64_tr_b16 a[68:69], v4 offset:40960
    v_mfma_f32_16x16x32_bf16 a[136:139], a[80:83], a[8:11], a[136:139]
    ds_read_b64_tr_b16 a[70:71], v4 offset:41984
    v_mfma_f32_16x16x32_bf16 a[136:139], a[84:87], a[40:43], a[136:139]
    v_mfma_f32_16x16x32_bf16 a[140:143], a[80:83], a[12:15], a[140:143]
    ds_read_b64_tr_b16 a[72:73], v5 offset:32768
    v_mfma_f32_16x16x32_bf16 a[140:143], a[84:87], a[44:47], a[140:143]
    ds_read_b64_tr_b16 a[74:75], v5 offset:33792
    v_mfma_f32_16x16x32_bf16 a[144:147], a[80:83], a[16:19], a[144:147]
    v_mfma_f32_16x16x32_bf16 a[144:147], a[84:87], a[48:51], a[144:147]
    ds_read_b64_tr_b16 a[76:77], v5 offset:40960
    v_mfma_f32_16x16x32_bf16 a[148:151], a[80:83], a[20:23], a[148:151]
    ds_read_b64_tr_b16 a[78:79], v5 offset:41984
    v_mfma_f32_16x16x32_bf16 a[148:151], a[84:87], a[52:55], a[148:151]
    v_mfma_f32_16x16x32_bf16 a[152:155], a[80:83], a[24:27], a[152:155]
    s_add_u32 m0, s37, 16384
    v_mfma_f32_16x16x32_bf16 a[152:155], a[84:87], a[56:59], a[152:155]
    buffer_load_dwordx4 v9, s[16:19], s32 offen lds
    v_mfma_f32_16x16x32_bf16 a[156:159], a[80:83], a[28:31], a[156:159]
    s_add_u32 s32, s32, 458752
    v_mfma_f32_16x16x32_bf16 a[156:159], a[84:87], a[60:63], a[156:159]
    v_mfma_f32_16x16x32_bf16 a[160:163], a[88:91], a[0:3], a[160:163]
    ds_read_b128 a[0:3], v60 offset:0
    v_mfma_f32_16x16x32_bf16 a[160:163], a[92:95], a[32:35], a[160:163]
    ds_read_b128 a[32:35], v61 offset:0
    v_mfma_f32_16x16x32_bf16 a[164:167], a[88:91], a[4:7], a[164:167]
    ds_read_b128 a[4:7], v60 offset:2048
    v_mfma_f32_16x16x32_bf16 a[164:167], a[92:95], a[36:39], a[164:167]
    ds_read_b128 a[36:39], v61 offset:2048
    v_mfma_f32_16x16x32_bf16 a[168:171], a[88:91], a[8:11], a[168:171]
    ds_read_b128 a[8:11], v60 offset:4096
    v_mfma_f32_16x16x32_bf16 a[168:171], a[92:95], a[40:43], a[168:171]
    ds_read_b128 a[40:43], v61 offset:4096
    v_mfma_f32_16x16x32_bf16 a[172:175], a[88:91], a[12:15], a[172:175]
    ds_read_b128 a[12:15], v60 offset:6144
    v_mfma_f32_16x16x32_bf16 a[172:175], a[92:95], a[44:47], a[172:175]
    ds_read_b128 a[44:47], v61 offset:6144
    v_mfma_f32_16x16x32_bf16 a[176:179], a[88:91], a[16:19], a[176:179]
    ds_read_b128 a[16:19], v60 offset:8192
    v_mfma_f32_16x16x32_bf16 a[176:179], a[92:95], a[48:51], a[176:179]
    ds_read_b128 a[48:51], v61 offset:8192
    v_mfma_f32_16x16x32_bf16 a[180:183], a[88:91], a[20:23], a[180:183]
    ds_read_b128 a[20:23], v60 offset:10240
    v_mfma_f32_16x16x32_bf16 a[180:183], a[92:95], a[52:55], a[180:183]
    ds_read_b128 a[52:55], v61 offset:10240
    v_mfma_f32_16x16x32_bf16 a[184:187], a[88:91], a[24:27], a[184:187]
    ds_read_b128 a[24:27], v60 offset:12288
    v_mfma_f32_16x16x32_bf16 a[184:187], a[92:95], a[56:59], a[184:187]
    ds_read_b128 a[56:59], v61 offset:12288
    v_mfma_f32_16x16x32_bf16 a[188:191], a[88:91], a[28:31], a[188:191]
    ds_read_b128 a[28:31], v60 offset:14336
    v_mfma_f32_16x16x32_bf16 a[188:191], a[92:95], a[60:63], a[188:191]
    ds_read_b128 a[60:63], v61 offset:14336
    s_waitcnt lgkmcnt(10)
    v_mfma_f32_16x16x32_bf16 v[64:67], a[64:67], a[0:3], v[64:67]
    ds_read_b64_tr_b16 a[80:81], v6 offset:32768
    v_mfma_f32_16x16x32_bf16 v[64:67], a[68:71], a[32:35], v[64:67]
    v_mfma_f32_16x16x32_bf16 v[68:71], a[64:67], a[4:7], v[68:71]
    ds_read_b64_tr_b16 a[82:83], v6 offset:33792
    v_mfma_f32_16x16x32_bf16 v[68:71], a[68:71], a[36:39], v[68:71]
    v_mfma_f32_16x16x32_bf16 v[72:75], a[64:67], a[8:11], v[72:75]
    ds_read_b64_tr_b16 a[84:85], v6 offset:40960
    v_mfma_f32_16x16x32_bf16 v[72:75], a[68:71], a[40:43], v[72:75]
    s_waitcnt lgkmcnt(7)
    v_mfma_f32_16x16x32_bf16 v[76:79], a[64:67], a[12:15], v[76:79]
    ds_read_b64_tr_b16 a[86:87], v6 offset:41984
    v_mfma_f32_16x16x32_bf16 v[76:79], a[68:71], a[44:47], v[76:79]
    v_mfma_f32_16x16x32_bf16 v[80:83], a[64:67], a[16:19], v[80:83]
    s_add_u32 m0, s37, 20480
    v_mfma_f32_16x16x32_bf16 v[80:83], a[68:71], a[48:51], v[80:83]
    buffer_load_dwordx4 v9, s[16:19], s33 offen lds
    v_mfma_f32_16x16x32_bf16 v[84:87], a[64:67], a[20:23], v[84:87]
    s_add_u32 s33, s33, 458752
    s_add_u32 m0, s37, 24576
    v_mfma_f32_16x16x32_bf16 v[84:87], a[68:71], a[52:55], v[84:87]
    buffer_load_dwordx4 v9, s[16:19], s34 offen lds
    s_waitcnt lgkmcnt(2)
    v_mfma_f32_16x16x32_bf16 v[88:91], a[64:67], a[24:27], v[88:91]
    s_add_u32 s34, s34, 458752
    s_add_u32 m0, s37, 28672
    v_mfma_f32_16x16x32_bf16 v[88:91], a[68:71], a[56:59], v[88:91]
    buffer_load_dwordx4 v9, s[16:19], s35 offen lds
    v_mfma_f32_16x16x32_bf16 v[92:95], a[64:67], a[28:31], v[92:95]
    s_add_u32 s35, s35, 458752
    s_add_u32 m0, s36, 32768
    v_mfma_f32_16x16x32_bf16 v[92:95], a[68:71], a[60:63], v[92:95]
    buffer_load_dwordx4 v8, s[8:11], s24 offen lds
    v_mfma_f32_16x16x32_bf16 v[96:99], a[72:75], a[0:3], v[96:99]
    ds_read_b64_tr_b16 a[88:89], v7 offset:32768
    v_mfma_f32_16x16x32_bf16 v[96:99], a[76:79], a[32:35], v[96:99]
    v_mfma_f32_16x16x32_bf16 v[100:103], a[72:75], a[4:7], v[100:103]
    ds_read_b64_tr_b16 a[90:91], v7 offset:33792
    v_mfma_f32_16x16x32_bf16 v[100:103], a[76:79], a[36:39], v[100:103]
    v_mfma_f32_16x16x32_bf16 v[104:107], a[72:75], a[8:11], v[104:107]
    ds_read_b64_tr_b16 a[92:93], v7 offset:40960
    v_mfma_f32_16x16x32_bf16 v[104:107], a[76:79], a[40:43], v[104:107]
    v_mfma_f32_16x16x32_bf16 v[108:111], a[72:75], a[12:15], v[108:111]
    ds_read_b64_tr_b16 a[94:95], v7 offset:41984
    v_mfma_f32_16x16x32_bf16 v[108:111], a[76:79], a[44:47], v[108:111]
    v_mfma_f32_16x16x32_bf16 v[112:115], a[72:75], a[16:19], v[112:115]
    s_add_u32 m0, s36, 36864
    v_mfma_f32_16x16x32_bf16 v[112:115], a[76:79], a[48:51], v[112:115]
    buffer_load_dwordx4 v8, s[8:11], s25 offen lds
    v_mfma_f32_16x16x32_bf16 v[116:119], a[72:75], a[20:23], v[116:119]
    s_add_u32 m0, s36, 40960
    v_mfma_f32_16x16x32_bf16 v[116:119], a[76:79], a[52:55], v[116:119]
    buffer_load_dwordx4 v8, s[8:11], s26 offen lds
    v_mfma_f32_16x16x32_bf16 v[120:123], a[72:75], a[24:27], v[120:123]
    s_add_u32 m0, s36, 45056
    v_mfma_f32_16x16x32_bf16 v[120:123], a[76:79], a[56:59], v[120:123]
    buffer_load_dwordx4 v8, s[8:11], s27 offen lds
    v_mfma_f32_16x16x32_bf16 v[124:127], a[72:75], a[28:31], v[124:127]
    v_mfma_f32_16x16x32_bf16 v[124:127], a[76:79], a[60:63], v[124:127]
    s_waitcnt vmcnt(21) lgkmcnt(0)
    s_barrier
    v_mfma_f32_16x16x32_bf16 v[128:131], a[80:83], a[0:3], v[128:131]
    ds_read_b64_tr_b16 a[64:65], v4 offset:49152
    v_mfma_f32_16x16x32_bf16 v[128:131], a[84:87], a[32:35], v[128:131]
    v_mfma_f32_16x16x32_bf16 v[132:135], a[80:83], a[4:7], v[132:135]
    ds_read_b64_tr_b16 a[66:67], v4 offset:50176
    v_mfma_f32_16x16x32_bf16 v[132:135], a[84:87], a[36:39], v[132:135]
    v_mfma_f32_16x16x32_bf16 v[136:139], a[80:83], a[8:11], v[136:139]
    ds_read_b64_tr_b16 a[68:69], v4 offset:57344
    v_mfma_f32_16x16x32_bf16 v[136:139], a[84:87], a[40:43], v[136:139]
    v_mfma_f32_16x16x32_bf16 v[140:143], a[80:83], a[12:15], v[140:143]
    ds_read_b64_tr_b16 a[70:71], v4 offset:58368
    v_mfma_f32_16x16x32_bf16 v[140:143], a[84:87], a[44:47], v[140:143]
    v_mfma_f32_16x16x32_bf16 v[144:147], a[80:83], a[16:19], v[144:147]
    s_add_u32 m0, s37, 32768
    v_mfma_f32_16x16x32_bf16 v[144:147], a[84:87], a[48:51], v[144:147]
    buffer_load_dwordx4 v9, s[12:15], s32 offen lds
    v_mfma_f32_16x16x32_bf16 v[148:151], a[80:83], a[20:23], v[148:151]
    v_mfma_f32_16x16x32_bf16 v[148:151], a[84:87], a[52:55], v[148:151]
    v_mfma_f32_16x16x32_bf16 v[152:155], a[80:83], a[24:27], v[152:155]
    s_add_u32 m0, s37, 36864
    v_mfma_f32_16x16x32_bf16 v[152:155], a[84:87], a[56:59], v[152:155]
    buffer_load_dwordx4 v9, s[12:15], s33 offen lds
    v_mfma_f32_16x16x32_bf16 v[156:159], a[80:83], a[28:31], v[156:159]
    v_mfma_f32_16x16x32_bf16 v[156:159], a[84:87], a[60:63], v[156:159]
    v_mfma_f32_16x16x32_bf16 v[160:163], a[88:91], a[0:3], v[160:163]
    ds_read_b64_tr_b16 a[72:73], v5 offset:49152
    v_mfma_f32_16x16x32_bf16 v[160:163], a[92:95], a[32:35], v[160:163]
    v_mfma_f32_16x16x32_bf16 v[164:167], a[88:91], a[4:7], v[164:167]
    ds_read_b64_tr_b16 a[74:75], v5 offset:50176
    v_mfma_f32_16x16x32_bf16 v[164:167], a[92:95], a[36:39], v[164:167]
    v_mfma_f32_16x16x32_bf16 v[168:171], a[88:91], a[8:11], v[168:171]
    ds_read_b64_tr_b16 a[76:77], v5 offset:57344
    v_mfma_f32_16x16x32_bf16 v[168:171], a[92:95], a[40:43], v[168:171]
    v_mfma_f32_16x16x32_bf16 v[172:175], a[88:91], a[12:15], v[172:175]
    ds_read_b64_tr_b16 a[78:79], v5 offset:58368
    v_mfma_f32_16x16x32_bf16 v[172:175], a[92:95], a[44:47], v[172:175]
    v_mfma_f32_16x16x32_bf16 v[176:179], a[88:91], a[16:19], v[176:179]
    s_add_u32 m0, s37, 40960
    v_mfma_f32_16x16x32_bf16 v[176:179], a[92:95], a[48:51], v[176:179]
    buffer_load_dwordx4 v9, s[12:15], s34 offen lds
    v_mfma_f32_16x16x32_bf16 v[180:183], a[88:91], a[20:23], v[180:183]
    v_mfma_f32_16x16x32_bf16 v[180:183], a[92:95], a[52:55], v[180:183]
    v_mfma_f32_16x16x32_bf16 v[184:187], a[88:91], a[24:27], v[184:187]
    s_add_u32 m0, s37, 45056
    v_mfma_f32_16x16x32_bf16 v[184:187], a[92:95], a[56:59], v[184:187]
    buffer_load_dwordx4 v9, s[12:15], s35 offen lds
    v_mfma_f32_16x16x32_bf16 v[188:191], a[88:91], a[28:31], v[188:191]
    v_mfma_f32_16x16x32_bf16 v[188:191], a[92:95], a[60:63], v[188:191]
    s_waitcnt lgkmcnt(1)
    v_mfma_f32_16x16x32_bf16 v[192:195], a[64:67], a[0:3], v[192:195]
    ds_read_b64_tr_b16 a[80:81], v6 offset:49152
    v_mfma_f32_16x16x32_bf16 v[192:195], a[68:71], a[32:35], v[192:195]
    v_mfma_f32_16x16x32_bf16 v[196:199], a[64:67], a[4:7], v[196:199]
    ds_read_b64_tr_b16 a[82:83], v6 offset:50176
    v_mfma_f32_16x16x32_bf16 v[196:199], a[68:71], a[36:39], v[196:199]
    v_mfma_f32_16x16x32_bf16 v[200:203], a[64:67], a[8:11], v[200:203]
    ds_read_b64_tr_b16 a[84:85], v6 offset:57344
    v_mfma_f32_16x16x32_bf16 v[200:203], a[68:71], a[40:43], v[200:203]
    v_mfma_f32_16x16x32_bf16 v[204:207], a[64:67], a[12:15], v[204:207]
    ds_read_b64_tr_b16 a[86:87], v6 offset:58368
    v_mfma_f32_16x16x32_bf16 v[204:207], a[68:71], a[44:47], v[204:207]
    s_add_u32 m0, s36, 49152
    v_mfma_f32_16x16x32_bf16 v[208:211], a[64:67], a[16:19], v[208:211]
    buffer_load_dwordx4 v8, s[8:11], s28 offen lds
    v_mfma_f32_16x16x32_bf16 v[208:211], a[68:71], a[48:51], v[208:211]
    v_mfma_f32_16x16x32_bf16 v[212:215], a[64:67], a[20:23], v[212:215]
    v_mfma_f32_16x16x32_bf16 v[212:215], a[68:71], a[52:55], v[212:215]
    s_add_u32 m0, s36, 53248
    v_mfma_f32_16x16x32_bf16 v[216:219], a[64:67], a[24:27], v[216:219]
    buffer_load_dwordx4 v8, s[8:11], s29 offen lds
    v_mfma_f32_16x16x32_bf16 v[216:219], a[68:71], a[56:59], v[216:219]
    v_mfma_f32_16x16x32_bf16 v[220:223], a[64:67], a[28:31], v[220:223]
    v_mfma_f32_16x16x32_bf16 v[220:223], a[68:71], a[60:63], v[220:223]
    v_mfma_f32_16x16x32_bf16 v[224:227], a[72:75], a[0:3], v[224:227]
    ds_read_b64_tr_b16 a[88:89], v7 offset:49152
    s_waitcnt lgkmcnt(5)
    v_mfma_f32_16x16x32_bf16 v[224:227], a[76:79], a[32:35], v[224:227]
    v_mfma_f32_16x16x32_bf16 v[228:231], a[72:75], a[4:7], v[228:231]
    ds_read_b64_tr_b16 a[90:91], v7 offset:50176
    v_mfma_f32_16x16x32_bf16 v[228:231], a[76:79], a[36:39], v[228:231]
    v_mfma_f32_16x16x32_bf16 v[232:235], a[72:75], a[8:11], v[232:235]
    ds_read_b64_tr_b16 a[92:93], v7 offset:57344
    v_mfma_f32_16x16x32_bf16 v[232:235], a[76:79], a[40:43], v[232:235]
    v_mfma_f32_16x16x32_bf16 v[236:239], a[72:75], a[12:15], v[236:239]
    ds_read_b64_tr_b16 a[94:95], v7 offset:58368
    v_mfma_f32_16x16x32_bf16 v[236:239], a[76:79], a[44:47], v[236:239]
    s_add_u32 m0, s36, 57344
    v_mfma_f32_16x16x32_bf16 v[240:243], a[72:75], a[16:19], v[240:243]
    buffer_load_dwordx4 v8, s[8:11], s30 offen lds
    v_mfma_f32_16x16x32_bf16 v[240:243], a[76:79], a[48:51], v[240:243]
    v_mfma_f32_16x16x32_bf16 v[244:247], a[72:75], a[20:23], v[244:247]
    v_mfma_f32_16x16x32_bf16 v[244:247], a[76:79], a[52:55], v[244:247]
    s_add_u32 m0, s36, 61440
    v_mfma_f32_16x16x32_bf16 v[248:251], a[72:75], a[24:27], v[248:251]
    buffer_load_dwordx4 v8, s[8:11], s31 offen lds
    v_mfma_f32_16x16x32_bf16 v[248:251], a[76:79], a[56:59], v[248:251]
    s_add_u32 s8, s8, 128
    s_addc_u32 s9, s9, 0
    s_sub_u32 s10, s10, 128
    v_mfma_f32_16x16x32_bf16 v[252:255], a[72:75], a[28:31], v[252:255]
    v_mfma_f32_16x16x32_bf16 v[252:255], a[76:79], a[60:63], v[252:255]
    s_waitcnt vmcnt(17) lgkmcnt(0)
    s_barrier
    v_mfma_f32_16x16x32_bf16 a[128:131], a[80:83], a[0:3], a[128:131]
    ds_read_b64_tr_b16 a[64:65], v4 offset:0
    v_mfma_f32_16x16x32_bf16 a[128:131], a[84:87], a[32:35], a[128:131]
    ds_read_b64_tr_b16 a[66:67], v4 offset:1024
    v_mfma_f32_16x16x32_bf16 a[132:135], a[80:83], a[4:7], a[132:135]
    v_mfma_f32_16x16x32_bf16 a[132:135], a[84:87], a[36:39], a[132:135]
    ds_read_b64_tr_b16 a[68:69], v4 offset:8192
    v_mfma_f32_16x16x32_bf16 a[136:139], a[80:83], a[8:11], a[136:139]
    ds_read_b64_tr_b16 a[70:71], v4 offset:9216
    v_mfma_f32_16x16x32_bf16 a[136:139], a[84:87], a[40:43], a[136:139]
    v_mfma_f32_16x16x32_bf16 a[140:143], a[80:83], a[12:15], a[140:143]
    ds_read_b64_tr_b16 a[72:73], v5 offset:0
    v_mfma_f32_16x16x32_bf16 a[140:143], a[84:87], a[44:47], a[140:143]
    ds_read_b64_tr_b16 a[74:75], v5 offset:1024
    v_mfma_f32_16x16x32_bf16 a[144:147], a[80:83], a[16:19], a[144:147]
    v_mfma_f32_16x16x32_bf16 a[144:147], a[84:87], a[48:51], a[144:147]
    ds_read_b64_tr_b16 a[76:77], v5 offset:8192
    v_mfma_f32_16x16x32_bf16 a[148:151], a[80:83], a[20:23], a[148:151]
    ds_read_b64_tr_b16 a[78:79], v5 offset:9216
    v_mfma_f32_16x16x32_bf16 a[148:151], a[84:87], a[52:55], a[148:151]
    v_mfma_f32_16x16x32_bf16 a[152:155], a[80:83], a[24:27], a[152:155]
    s_add_u32 m0, s37, 49152
    v_mfma_f32_16x16x32_bf16 a[152:155], a[84:87], a[56:59], a[152:155]
    buffer_load_dwordx4 v9, s[16:19], s32 offen lds
    v_mfma_f32_16x16x32_bf16 a[156:159], a[80:83], a[28:31], a[156:159]
    s_add_u32 s32, s32, 458752
    v_mfma_f32_16x16x32_bf16 a[156:159], a[84:87], a[60:63], a[156:159]
    v_mfma_f32_16x16x32_bf16 a[160:163], a[88:91], a[0:3], a[160:163]
    ds_read_b128 a[0:3], v2 offset:0
    v_mfma_f32_16x16x32_bf16 a[160:163], a[92:95], a[32:35], a[160:163]
    ds_read_b128 a[32:35], v3 offset:0
    v_mfma_f32_16x16x32_bf16 a[164:167], a[88:91], a[4:7], a[164:167]
    ds_read_b128 a[4:7], v2 offset:2048
    v_mfma_f32_16x16x32_bf16 a[164:167], a[92:95], a[36:39], a[164:167]
    ds_read_b128 a[36:39], v3 offset:2048
    v_mfma_f32_16x16x32_bf16 a[168:171], a[88:91], a[8:11], a[168:171]
    ds_read_b128 a[8:11], v2 offset:4096
    v_mfma_f32_16x16x32_bf16 a[168:171], a[92:95], a[40:43], a[168:171]
    ds_read_b128 a[40:43], v3 offset:4096
    v_mfma_f32_16x16x32_bf16 a[172:175], a[88:91], a[12:15], a[172:175]
    ds_read_b128 a[12:15], v2 offset:6144
    v_mfma_f32_16x16x32_bf16 a[172:175], a[92:95], a[44:47], a[172:175]
    ds_read_b128 a[44:47], v3 offset:6144
    v_mfma_f32_16x16x32_bf16 a[176:179], a[88:91], a[16:19], a[176:179]
    ds_read_b128 a[16:19], v2 offset:8192
    v_mfma_f32_16x16x32_bf16 a[176:179], a[92:95], a[48:51], a[176:179]
    ds_read_b128 a[48:51], v3 offset:8192
    v_mfma_f32_16x16x32_bf16 a[180:183], a[88:91], a[20:23], a[180:183]
    ds_read_b128 a[20:23], v2 offset:10240
    v_mfma_f32_16x16x32_bf16 a[180:183], a[92:95], a[52:55], a[180:183]
    ds_read_b128 a[52:55], v3 offset:10240
    v_mfma_f32_16x16x32_bf16 a[184:187], a[88:91], a[24:27], a[184:187]
    ds_read_b128 a[24:27], v2 offset:12288
    v_mfma_f32_16x16x32_bf16 a[184:187], a[92:95], a[56:59], a[184:187]
    ds_read_b128 a[56:59], v3 offset:12288
    v_mfma_f32_16x16x32_bf16 a[188:191], a[88:91], a[28:31], a[188:191]
    ds_read_b128 a[28:31], v2 offset:14336
    v_mfma_f32_16x16x32_bf16 a[188:191], a[92:95], a[60:63], a[188:191]
    ds_read_b128 a[60:63], v3 offset:14336
    s_waitcnt lgkmcnt(10)
    v_mfma_f32_16x16x32_bf16 v[64:67], a[64:67], a[0:3], v[64:67]
    ds_read_b64_tr_b16 a[80:81], v6 offset:0
    v_mfma_f32_16x16x32_bf16 v[64:67], a[68:71], a[32:35], v[64:67]
    v_mfma_f32_16x16x32_bf16 v[68:71], a[64:67], a[4:7], v[68:71]
    ds_read_b64_tr_b16 a[82:83], v6 offset:1024
    v_mfma_f32_16x16x32_bf16 v[68:71], a[68:71], a[36:39], v[68:71]
    v_mfma_f32_16x16x32_bf16 v[72:75], a[64:67], a[8:11], v[72:75]
    ds_read_b64_tr_b16 a[84:85], v6 offset:8192
    v_mfma_f32_16x16x32_bf16 v[72:75], a[68:71], a[40:43], v[72:75]
    s_waitcnt lgkmcnt(7)
    v_mfma_f32_16x16x32_bf16 v[76:79], a[64:67], a[12:15], v[76:79]
    ds_read_b64_tr_b16 a[86:87], v6 offset:9216
    v_mfma_f32_16x16x32_bf16 v[76:79], a[68:71], a[44:47], v[76:79]
    v_mfma_f32_16x16x32_bf16 v[80:83], a[64:67], a[16:19], v[80:83]
    s_add_u32 m0, s37, 53248
    v_mfma_f32_16x16x32_bf16 v[80:83], a[68:71], a[48:51], v[80:83]
    buffer_load_dwordx4 v9, s[16:19], s33 offen lds
    v_mfma_f32_16x16x32_bf16 v[84:87], a[64:67], a[20:23], v[84:87]
    s_add_u32 s33, s33, 458752
    s_add_u32 m0, s37, 57344
    v_mfma_f32_16x16x32_bf16 v[84:87], a[68:71], a[52:55], v[84:87]
    buffer_load_dwordx4 v9, s[16:19], s34 offen lds
    s_waitcnt lgkmcnt(2)
    v_mfma_f32_16x16x32_bf16 v[88:91], a[64:67], a[24:27], v[88:91]
    s_add_u32 s34, s34, 458752
    s_add_u32 m0, s37, 61440
    v_mfma_f32_16x16x32_bf16 v[88:91], a[68:71], a[56:59], v[88:91]
    buffer_load_dwordx4 v9, s[16:19], s35 offen lds
    v_mfma_f32_16x16x32_bf16 v[92:95], a[64:67], a[28:31], v[92:95]
    s_add_u32 s35, s35, 458752
    s_add_u32 m0, s36, 65536
    v_mfma_f32_16x16x32_bf16 v[92:95], a[68:71], a[60:63], v[92:95]
    buffer_load_dwordx4 v8, s[8:11], s24 offen lds
    v_mfma_f32_16x16x32_bf16 v[96:99], a[72:75], a[0:3], v[96:99]
    ds_read_b64_tr_b16 a[88:89], v7 offset:0
    v_mfma_f32_16x16x32_bf16 v[96:99], a[76:79], a[32:35], v[96:99]
    v_mfma_f32_16x16x32_bf16 v[100:103], a[72:75], a[4:7], v[100:103]
    ds_read_b64_tr_b16 a[90:91], v7 offset:1024
    v_mfma_f32_16x16x32_bf16 v[100:103], a[76:79], a[36:39], v[100:103]
    v_mfma_f32_16x16x32_bf16 v[104:107], a[72:75], a[8:11], v[104:107]
    ds_read_b64_tr_b16 a[92:93], v7 offset:8192
    v_mfma_f32_16x16x32_bf16 v[104:107], a[76:79], a[40:43], v[104:107]
    v_mfma_f32_16x16x32_bf16 v[108:111], a[72:75], a[12:15], v[108:111]
    ds_read_b64_tr_b16 a[94:95], v7 offset:9216
    v_mfma_f32_16x16x32_bf16 v[108:111], a[76:79], a[44:47], v[108:111]
    v_mfma_f32_16x16x32_bf16 v[112:115], a[72:75], a[16:19], v[112:115]
    s_add_u32 m0, s36, 69632
    v_mfma_f32_16x16x32_bf16 v[112:115], a[76:79], a[48:51], v[112:115]
    buffer_load_dwordx4 v8, s[8:11], s25 offen lds
    v_mfma_f32_16x16x32_bf16 v[116:119], a[72:75], a[20:23], v[116:119]
    s_add_u32 m0, s36, 73728
    v_mfma_f32_16x16x32_bf16 v[116:119], a[76:79], a[52:55], v[116:119]
    buffer_load_dwordx4 v8, s[8:11], s26 offen lds
    v_mfma_f32_16x16x32_bf16 v[120:123], a[72:75], a[24:27], v[120:123]
    s_add_u32 m0, s36, 77824
    v_mfma_f32_16x16x32_bf16 v[120:123], a[76:79], a[56:59], v[120:123]
    buffer_load_dwordx4 v8, s[8:11], s27 offen lds
    v_mfma_f32_16x16x32_bf16 v[124:127], a[72:75], a[28:31], v[124:127]
    v_mfma_f32_16x16x32_bf16 v[124:127], a[76:79], a[60:63], v[124:127]
    s_waitcnt vmcnt(20) lgkmcnt(0)
    s_barrier
    v_mfma_f32_16x16x32_bf16 v[128:131], a[80:83], a[0:3], v[128:131]
    ds_read_b64_tr_b16 a[64:65], v4 offset:16384
    v_mfma_f32_16x16x32_bf16 v[128:131], a[84:87], a[32:35], v[128:131]
    v_mfma_f32_16x16x32_bf16 v[132:135], a[80:83], a[4:7], v[132:135]
    ds_read_b64_tr_b16 a[66:67], v4 offset:17408
    v_mfma_f32_16x16x32_bf16 v[132:135], a[84:87], a[36:39], v[132:135]
    v_mfma_f32_16x16x32_bf16 v[136:139], a[80:83], a[8:11], v[136:139]
    ds_read_b64_tr_b16 a[68:69], v4 offset:24576
    v_mfma_f32_16x16x32_bf16 v[136:139], a[84:87], a[40:43], v[136:139]
    v_mfma_f32_16x16x32_bf16 v[140:143], a[80:83], a[12:15], v[140:143]
    ds_read_b64_tr_b16 a[70:71], v4 offset:25600
    v_mfma_f32_16x16x32_bf16 v[140:143], a[84:87], a[44:47], v[140:143]
    v_mfma_f32_16x16x32_bf16 v[144:147], a[80:83], a[16:19], v[144:147]
    s_add_u32 m0, s37, 0
    v_mfma_f32_16x16x32_bf16 v[144:147], a[84:87], a[48:51], v[144:147]
    buffer_load_dwordx4 v9, s[12:15], s32 offen lds
    v_mfma_f32_16x16x32_bf16 v[148:151], a[80:83], a[20:23], v[148:151]
    v_mfma_f32_16x16x32_bf16 v[148:151], a[84:87], a[52:55], v[148:151]
    v_mfma_f32_16x16x32_bf16 v[152:155], a[80:83], a[24:27], v[152:155]
    s_add_u32 m0, s37, 4096
    v_mfma_f32_16x16x32_bf16 v[152:155], a[84:87], a[56:59], v[152:155]
    buffer_load_dwordx4 v9, s[12:15], s33 offen lds
    v_mfma_f32_16x16x32_bf16 v[156:159], a[80:83], a[28:31], v[156:159]
    v_mfma_f32_16x16x32_bf16 v[156:159], a[84:87], a[60:63], v[156:159]
    v_mfma_f32_16x16x32_bf16 v[160:163], a[88:91], a[0:3], v[160:163]
    ds_read_b64_tr_b16 a[72:73], v5 offset:16384
    v_mfma_f32_16x16x32_bf16 v[160:163], a[92:95], a[32:35], v[160:163]
    v_mfma_f32_16x16x32_bf16 v[164:167], a[88:91], a[4:7], v[164:167]
    ds_read_b64_tr_b16 a[74:75], v5 offset:17408
    v_mfma_f32_16x16x32_bf16 v[164:167], a[92:95], a[36:39], v[164:167]
    v_mfma_f32_16x16x32_bf16 v[168:171], a[88:91], a[8:11], v[168:171]
    ds_read_b64_tr_b16 a[76:77], v5 offset:24576
    v_mfma_f32_16x16x32_bf16 v[168:171], a[92:95], a[40:43], v[168:171]
    v_mfma_f32_16x16x32_bf16 v[172:175], a[88:91], a[12:15], v[172:175]
    ds_read_b64_tr_b16 a[78:79], v5 offset:25600
    v_mfma_f32_16x16x32_bf16 v[172:175], a[92:95], a[44:47], v[172:175]
    v_mfma_f32_16x16x32_bf16 v[176:179], a[88:91], a[16:19], v[176:179]
    s_add_u32 m0, s37, 8192
    v_mfma_f32_16x16x32_bf16 v[176:179], a[92:95], a[48:51], v[176:179]
    buffer_load_dwordx4 v9, s[12:15], s34 offen lds
    v_mfma_f32_16x16x32_bf16 v[180:183], a[88:91], a[20:23], v[180:183]
    v_mfma_f32_16x16x32_bf16 v[180:183], a[92:95], a[52:55], v[180:183]
    v_mfma_f32_16x16x32_bf16 v[184:187], a[88:91], a[24:27], v[184:187]
    s_add_u32 m0, s37, 12288
    v_mfma_f32_16x16x32_bf16 v[184:187], a[92:95], a[56:59], v[184:187]
    buffer_load_dwordx4 v9, s[12:15], s35 offen lds
    v_mfma_f32_16x16x32_bf16 v[188:191], a[88:91], a[28:31], v[188:191]
    v_mfma_f32_16x16x32_bf16 v[188:191], a[92:95], a[60:63], v[188:191]
    s_waitcnt lgkmcnt(1)
    v_mfma_f32_16x16x32_bf16 v[192:195], a[64:67], a[0:3], v[192:195]
    ds_read_b64_tr_b16 a[80:81], v6 offset:16384
    v_mfma_f32_16x16x32_bf16 v[192:195], a[68:71], a[32:35], v[192:195]
    v_mfma_f32_16x16x32_bf16 v[196:199], a[64:67], a[4:7], v[196:199]
    ds_read_b64_tr_b16 a[82:83], v6 offset:17408
    v_mfma_f32_16x16x32_bf16 v[196:199], a[68:71], a[36:39], v[196:199]
    v_mfma_f32_16x16x32_bf16 v[200:203], a[64:67], a[8:11], v[200:203]
    ds_read_b64_tr_b16 a[84:85], v6 offset:24576
    s_sub_u32 s46, s2, 32
    v_mfma_f32_16x16x32_bf16 v[200:203], a[68:71], a[40:43], v[200:203]
    v_mfma_f32_16x16x32_bf16 v[204:207], a[64:67], a[12:15], v[204:207]
    ds_read_b64_tr_b16 a[86:87], v6 offset:25600
    s_lshr_b32 s46, s46, 3
    v_mfma_f32_16x16x32_bf16 v[204:207], a[68:71], a[44:47], v[204:207]
    s_add_u32 m0, s36, 81920
    v_mfma_f32_16x16x32_bf16 v[208:211], a[64:67], a[16:19], v[208:211]
    buffer_load_dwordx4 v8, s[8:11], s28 offen lds
    s_lshl_b32 s46, s46, 2
    v_mfma_f32_16x16x32_bf16 v[208:211], a[68:71], a[48:51], v[208:211]
    v_mfma_f32_16x16x32_bf16 v[212:215], a[64:67], a[20:23], v[212:215]
    s_add_u32 s46, s46, s38
    v_mfma_f32_16x16x32_bf16 v[212:215], a[68:71], a[52:55], v[212:215]
    s_add_u32 m0, s36, 86016
    v_mfma_f32_16x16x32_bf16 v[216:219], a[64:67], a[24:27], v[216:219]
    buffer_load_dwordx4 v8, s[8:11], s29 offen lds
    s_mul_i32 s46, s46, 8192
    v_mfma_f32_16x16x32_bf16 v[216:219], a[68:71], a[56:59], v[216:219]
    v_mfma_f32_16x16x32_bf16 v[220:223], a[64:67], a[28:31], v[220:223]
    v_mul_u32_u24 v19, 128, v11
    v_mfma_f32_16x16x32_bf16 v[220:223], a[68:71], a[60:63], v[220:223]
    v_mfma_f32_16x16x32_bf16 v[224:227], a[72:75], a[0:3], v[224:227]
    ds_read_b64_tr_b16 a[88:89], v7 offset:16384
    v_add_u32 v19, s46, v19
    s_waitcnt lgkmcnt(5)
    v_mfma_f32_16x16x32_bf16 v[224:227], a[76:79], a[32:35], v[224:227]
    v_mfma_f32_16x16x32_bf16 v[228:231], a[72:75], a[4:7], v[228:231]
    ds_read_b64_tr_b16 a[90:91], v7 offset:17408
    s_mov_b32 s46, 917504
    v_mfma_f32_16x16x32_bf16 v[228:231], a[76:79], a[36:39], v[228:231]
    v_mfma_f32_16x16x32_bf16 v[232:235], a[72:75], a[8:11], v[232:235]
    ds_read_b64_tr_b16 a[92:93], v7 offset:24576
    s_bitcmp1_b32 s2, 2
    s_cselect_b64 vcc, -1, 0
    s_cselect_b32 s47, -1, 1
    v_mfma_f32_16x16x32_bf16 v[232:235], a[76:79], a[40:43], v[232:235]
    v_mfma_f32_16x16x32_bf16 v[236:239], a[72:75], a[12:15], v[236:239]
    ds_read_b64_tr_b16 a[94:95], v7 offset:25600
    v_mfma_f32_16x16x32_bf16 v[236:239], a[76:79], a[44:47], v[236:239]
    s_add_u32 m0, s36, 90112
    v_mfma_f32_16x16x32_bf16 v[240:243], a[72:75], a[16:19], v[240:243]
    buffer_load_dwordx4 v8, s[8:11], s30 offen lds
    v_sub_u32 v20, 7339904, v19
    v_mfma_f32_16x16x32_bf16 v[240:243], a[76:79], a[48:51], v[240:243]
    v_mfma_f32_16x16x32_bf16 v[244:247], a[72:75], a[20:23], v[244:247]
    v_mfma_f32_16x16x32_bf16 v[244:247], a[76:79], a[52:55], v[244:247]
    s_add_u32 m0, s36, 94208
    v_mfma_f32_16x16x32_bf16 v[248:251], a[72:75], a[24:27], v[248:251]
    buffer_load_dwordx4 v8, s[8:11], s31 offen lds
    v_cndmask_b32 v19, v19, v20, vcc
    v_mfma_f32_16x16x32_bf16 v[248:251], a[76:79], a[56:59], v[248:251]
    s_add_u32 s8, s8, 128
    s_addc_u32 s9, s9, 0
    s_sub_u32 s10, s10, 128
    v_mfma_f32_16x16x32_bf16 v[252:255], a[72:75], a[28:31], v[252:255]
    s_mul_i32 s46, s46, s47
    v_mfma_f32_16x16x32_bf16 v[252:255], a[76:79], a[60:63], v[252:255]
    s_waitcnt vmcnt(16) lgkmcnt(0)
    s_barrier
    v_mfma_f32_16x16x32_bf16 a[128:131], a[80:83], a[0:3], a[128:131]
    ds_read_b64_tr_b16 a[64:65], v4 offset:32768
    v_mfma_f32_16x16x32_bf16 a[128:131], a[84:87], a[32:35], a[128:131]
    ds_read_b64_tr_b16 a[66:67], v4 offset:33792
    v_mfma_f32_16x16x32_bf16 a[132:135], a[80:83], a[4:7], a[132:135]
    v_mfma_f32_16x16x32_bf16 a[132:135], a[84:87], a[36:39], a[132:135]
    ds_read_b64_tr_b16 a[68:69], v4 offset:40960
    v_mfma_f32_16x16x32_bf16 a[136:139], a[80:83], a[8:11], a[136:139]
    ds_read_b64_tr_b16 a[70:71], v4 offset:41984
    v_mfma_f32_16x16x32_bf16 a[136:139], a[84:87], a[40:43], a[136:139]
    v_mfma_f32_16x16x32_bf16 a[140:143], a[80:83], a[12:15], a[140:143]
    ds_read_b64_tr_b16 a[72:73], v5 offset:32768
    v_mfma_f32_16x16x32_bf16 a[140:143], a[84:87], a[44:47], a[140:143]
    ds_read_b64_tr_b16 a[74:75], v5 offset:33792
    v_mfma_f32_16x16x32_bf16 a[144:147], a[80:83], a[16:19], a[144:147]
    v_mfma_f32_16x16x32_bf16 a[144:147], a[84:87], a[48:51], a[144:147]
    ds_read_b64_tr_b16 a[76:77], v5 offset:40960
    v_mfma_f32_16x16x32_bf16 a[148:151], a[80:83], a[20:23], a[148:151]
    ds_read_b64_tr_b16 a[78:79], v5 offset:41984
    v_mfma_f32_16x16x32_bf16 a[148:151], a[84:87], a[52:55], a[148:151]
    v_mfma_f32_16x16x32_bf16 a[152:155], a[80:83], a[24:27], a[152:155]
    s_add_u32 m0, s37, 16384
    v_mfma_f32_16x16x32_bf16 a[152:155], a[84:87], a[56:59], a[152:155]
    buffer_load_dwordx4 v9, s[16:19], s32 offen lds
    v_mfma_f32_16x16x32_bf16 a[156:159], a[80:83], a[28:31], a[156:159]
    s_add_u32 s32, s32, 458752
    v_mfma_f32_16x16x32_bf16 a[156:159], a[84:87], a[60:63], a[156:159]
    v_mfma_f32_16x16x32_bf16 a[160:163], a[88:91], a[0:3], a[160:163]
    ds_read_b128 a[0:3], v2 offset:32768
    v_mfma_f32_16x16x32_bf16 a[160:163], a[92:95], a[32:35], a[160:163]
    ds_read_b128 a[32:35], v3 offset:32768
    v_mfma_f32_16x16x32_bf16 a[164:167], a[88:91], a[4:7], a[164:167]
    ds_read_b128 a[4:7], v2 offset:34816
    v_mfma_f32_16x16x32_bf16 a[164:167], a[92:95], a[36:39], a[164:167]
    ds_read_b128 a[36:39], v3 offset:34816
    v_mfma_f32_16x16x32_bf16 a[168:171], a[88:91], a[8:11], a[168:171]
    ds_read_b128 a[8:11], v2 offset:36864
    v_mfma_f32_16x16x32_bf16 a[168:171], a[92:95], a[40:43], a[168:171]
    ds_read_b128 a[40:43], v3 offset:36864
    v_mfma_f32_16x16x32_bf16 a[172:175], a[88:91], a[12:15], a[172:175]
    ds_read_b128 a[12:15], v2 offset:38912
    v_mfma_f32_16x16x32_bf16 a[172:175], a[92:95], a[44:47], a[172:175]
    ds_read_b128 a[44:47], v3 offset:38912
    v_mfma_f32_16x16x32_bf16 a[176:179], a[88:91], a[16:19], a[176:179]
    ds_read_b128 a[16:19], v2 offset:40960
    v_mfma_f32_16x16x32_bf16 a[176:179], a[92:95], a[48:51], a[176:179]
    ds_read_b128 a[48:51], v3 offset:40960
    v_mfma_f32_16x16x32_bf16 a[180:183], a[88:91], a[20:23], a[180:183]
    ds_read_b128 a[20:23], v2 offset:43008
    v_mfma_f32_16x16x32_bf16 a[180:183], a[92:95], a[52:55], a[180:183]
    ds_read_b128 a[52:55], v3 offset:43008
    v_mfma_f32_16x16x32_bf16 a[184:187], a[88:91], a[24:27], a[184:187]
    ds_read_b128 a[24:27], v2 offset:45056
    v_mfma_f32_16x16x32_bf16 a[184:187], a[92:95], a[56:59], a[184:187]
    ds_read_b128 a[56:59], v3 offset:45056
    v_mfma_f32_16x16x32_bf16 a[188:191], a[88:91], a[28:31], a[188:191]
    ds_read_b128 a[28:31], v2 offset:47104
    v_mfma_f32_16x16x32_bf16 a[188:191], a[92:95], a[60:63], a[188:191]
    ds_read_b128 a[60:63], v3 offset:47104
    s_waitcnt lgkmcnt(10)
    v_mfma_f32_16x16x32_bf16 v[64:67], a[64:67], a[0:3], v[64:67]
    ds_read_b64_tr_b16 a[80:81], v6 offset:32768
    v_mfma_f32_16x16x32_bf16 v[64:67], a[68:71], a[32:35], v[64:67]
    v_mfma_f32_16x16x32_bf16 v[68:71], a[64:67], a[4:7], v[68:71]
    ds_read_b64_tr_b16 a[82:83], v6 offset:33792
    v_mfma_f32_16x16x32_bf16 v[68:71], a[68:71], a[36:39], v[68:71]
    v_mfma_f32_16x16x32_bf16 v[72:75], a[64:67], a[8:11], v[72:75]
    ds_read_b64_tr_b16 a[84:85], v6 offset:40960
    v_mfma_f32_16x16x32_bf16 v[72:75], a[68:71], a[40:43], v[72:75]
    s_waitcnt lgkmcnt(7)
    v_mfma_f32_16x16x32_bf16 v[76:79], a[64:67], a[12:15], v[76:79]
    ds_read_b64_tr_b16 a[86:87], v6 offset:41984
    v_mfma_f32_16x16x32_bf16 v[76:79], a[68:71], a[44:47], v[76:79]
    v_mfma_f32_16x16x32_bf16 v[80:83], a[64:67], a[16:19], v[80:83]
    s_add_u32 m0, s37, 20480
    v_mfma_f32_16x16x32_bf16 v[80:83], a[68:71], a[48:51], v[80:83]
    buffer_load_dwordx4 v9, s[16:19], s33 offen lds
    v_mfma_f32_16x16x32_bf16 v[84:87], a[64:67], a[20:23], v[84:87]
    s_add_u32 s33, s33, 458752
    s_add_u32 m0, s37, 24576
    v_mfma_f32_16x16x32_bf16 v[84:87], a[68:71], a[52:55], v[84:87]
    buffer_load_dwordx4 v9, s[16:19], s34 offen lds
    s_waitcnt lgkmcnt(2)
    v_mfma_f32_16x16x32_bf16 v[88:91], a[64:67], a[24:27], v[88:91]
    s_add_u32 s34, s34, 458752
    s_add_u32 m0, s37, 28672
    v_mfma_f32_16x16x32_bf16 v[88:91], a[68:71], a[56:59], v[88:91]
    buffer_load_dwordx4 v9, s[16:19], s35 offen lds
    v_mfma_f32_16x16x32_bf16 v[92:95], a[64:67], a[28:31], v[92:95]
    s_add_u32 s35, s35, 458752
    s_add_u32 m0, s36, 0
    v_mfma_f32_16x16x32_bf16 v[92:95], a[68:71], a[60:63], v[92:95]
    buffer_load_dwordx4 v8, s[8:11], s24 offen lds
    v_mfma_f32_16x16x32_bf16 v[96:99], a[72:75], a[0:3], v[96:99]
    ds_read_b64_tr_b16 a[88:89], v7 offset:32768
    v_mfma_f32_16x16x32_bf16 v[96:99], a[76:79], a[32:35], v[96:99]
    v_mfma_f32_16x16x32_bf16 v[100:103], a[72:75], a[4:7], v[100:103]
    ds_read_b64_tr_b16 a[90:91], v7 offset:33792
    v_mfma_f32_16x16x32_bf16 v[100:103], a[76:79], a[36:39], v[100:103]
    v_mfma_f32_16x16x32_bf16 v[104:107], a[72:75], a[8:11], v[104:107]
    ds_read_b64_tr_b16 a[92:93], v7 offset:40960
    v_mfma_f32_16x16x32_bf16 v[104:107], a[76:79], a[40:43], v[104:107]
    v_mfma_f32_16x16x32_bf16 v[108:111], a[72:75], a[12:15], v[108:111]
    ds_read_b64_tr_b16 a[94:95], v7 offset:41984
    v_mfma_f32_16x16x32_bf16 v[108:111], a[76:79], a[44:47], v[108:111]
    v_mfma_f32_16x16x32_bf16 v[112:115], a[72:75], a[16:19], v[112:115]
    s_add_u32 m0, s36, 4096
    v_mfma_f32_16x16x32_bf16 v[112:115], a[76:79], a[48:51], v[112:115]
    buffer_load_dwordx4 v8, s[8:11], s25 offen lds
    v_mfma_f32_16x16x32_bf16 v[116:119], a[72:75], a[20:23], v[116:119]
    s_add_u32 m0, s36, 8192
    v_mfma_f32_16x16x32_bf16 v[116:119], a[76:79], a[52:55], v[116:119]
    buffer_load_dwordx4 v8, s[8:11], s26 offen lds
    v_mfma_f32_16x16x32_bf16 v[120:123], a[72:75], a[24:27], v[120:123]
    s_add_u32 m0, s36, 12288
    v_mfma_f32_16x16x32_bf16 v[120:123], a[76:79], a[56:59], v[120:123]
    buffer_load_dwordx4 v8, s[8:11], s27 offen lds
    v_mfma_f32_16x16x32_bf16 v[124:127], a[72:75], a[28:31], v[124:127]
    v_mfma_f32_16x16x32_bf16 v[124:127], a[76:79], a[60:63], v[124:127]
    buffer_load_dword v21, v19, s[60:63], 0 offen
    v_add_u32 v19, s46, v19
    s_waitcnt vmcnt(21) lgkmcnt(0)
    s_barrier
    v_mfma_f32_16x16x32_bf16 v[128:131], a[80:83], a[0:3], v[128:131]
    ds_read_b64_tr_b16 a[64:65], v4 offset:49152
    v_mfma_f32_16x16x32_bf16 v[128:131], a[84:87], a[32:35], v[128:131]
    v_mfma_f32_16x16x32_bf16 v[132:135], a[80:83], a[4:7], v[132:135]
    ds_read_b64_tr_b16 a[66:67], v4 offset:50176
    v_mfma_f32_16x16x32_bf16 v[132:135], a[84:87], a[36:39], v[132:135]
    v_mfma_f32_16x16x32_bf16 v[136:139], a[80:83], a[8:11], v[136:139]
    ds_read_b64_tr_b16 a[68:69], v4 offset:57344
    v_mfma_f32_16x16x32_bf16 v[136:139], a[84:87], a[40:43], v[136:139]
    v_mfma_f32_16x16x32_bf16 v[140:143], a[80:83], a[12:15], v[140:143]
    ds_read_b64_tr_b16 a[70:71], v4 offset:58368
    v_mfma_f32_16x16x32_bf16 v[140:143], a[84:87], a[44:47], v[140:143]
    v_mfma_f32_16x16x32_bf16 v[144:147], a[80:83], a[16:19], v[144:147]
    s_add_u32 m0, s37, 32768
    v_mfma_f32_16x16x32_bf16 v[144:147], a[84:87], a[48:51], v[144:147]
    buffer_load_dwordx4 v9, s[12:15], s32 offen lds
    v_mfma_f32_16x16x32_bf16 v[148:151], a[80:83], a[20:23], v[148:151]
    v_mfma_f32_16x16x32_bf16 v[148:151], a[84:87], a[52:55], v[148:151]
    v_mfma_f32_16x16x32_bf16 v[152:155], a[80:83], a[24:27], v[152:155]
    s_add_u32 m0, s37, 36864
    v_mfma_f32_16x16x32_bf16 v[152:155], a[84:87], a[56:59], v[152:155]
    buffer_load_dwordx4 v9, s[12:15], s33 offen lds
    v_mfma_f32_16x16x32_bf16 v[156:159], a[80:83], a[28:31], v[156:159]
    v_mfma_f32_16x16x32_bf16 v[156:159], a[84:87], a[60:63], v[156:159]
    v_mfma_f32_16x16x32_bf16 v[160:163], a[88:91], a[0:3], v[160:163]
    ds_read_b64_tr_b16 a[72:73], v5 offset:49152
    v_mfma_f32_16x16x32_bf16 v[160:163], a[92:95], a[32:35], v[160:163]
    v_mfma_f32_16x16x32_bf16 v[164:167], a[88:91], a[4:7], v[164:167]
    ds_read_b64_tr_b16 a[74:75], v5 offset:50176
    v_mfma_f32_16x16x32_bf16 v[164:167], a[92:95], a[36:39], v[164:167]
    v_mfma_f32_16x16x32_bf16 v[168:171], a[88:91], a[8:11], v[168:171]
    ds_read_b64_tr_b16 a[76:77], v5 offset:57344
    v_mfma_f32_16x16x32_bf16 v[168:171], a[92:95], a[40:43], v[168:171]
    v_mfma_f32_16x16x32_bf16 v[172:175], a[88:91], a[12:15], v[172:175]
    ds_read_b64_tr_b16 a[78:79], v5 offset:58368
    v_mfma_f32_16x16x32_bf16 v[172:175], a[92:95], a[44:47], v[172:175]
    v_mfma_f32_16x16x32_bf16 v[176:179], a[88:91], a[16:19], v[176:179]
    s_add_u32 m0, s37, 40960
    v_mfma_f32_16x16x32_bf16 v[176:179], a[92:95], a[48:51], v[176:179]
    buffer_load_dwordx4 v9, s[12:15], s34 offen lds
    v_mfma_f32_16x16x32_bf16 v[180:183], a[88:91], a[20:23], v[180:183]
    v_mfma_f32_16x16x32_bf16 v[180:183], a[92:95], a[52:55], v[180:183]
    v_mfma_f32_16x16x32_bf16 v[184:187], a[88:91], a[24:27], v[184:187]
    s_add_u32 m0, s37, 45056
    v_mfma_f32_16x16x32_bf16 v[184:187], a[92:95], a[56:59], v[184:187]
    buffer_load_dwordx4 v9, s[12:15], s35 offen lds
    v_mfma_f32_16x16x32_bf16 v[188:191], a[88:91], a[28:31], v[188:191]
    v_mfma_f32_16x16x32_bf16 v[188:191], a[92:95], a[60:63], v[188:191]
    s_waitcnt lgkmcnt(1)
    v_mfma_f32_16x16x32_bf16 v[192:195], a[64:67], a[0:3], v[192:195]
    ds_read_b64_tr_b16 a[80:81], v6 offset:49152
    v_mfma_f32_16x16x32_bf16 v[192:195], a[68:71], a[32:35], v[192:195]
    v_mfma_f32_16x16x32_bf16 v[196:199], a[64:67], a[4:7], v[196:199]
    ds_read_b64_tr_b16 a[82:83], v6 offset:50176
    v_mfma_f32_16x16x32_bf16 v[196:199], a[68:71], a[36:39], v[196:199]
    v_mfma_f32_16x16x32_bf16 v[200:203], a[64:67], a[8:11], v[200:203]
    ds_read_b64_tr_b16 a[84:85], v6 offset:57344
    v_mfma_f32_16x16x32_bf16 v[200:203], a[68:71], a[40:43], v[200:203]
    v_mfma_f32_16x16x32_bf16 v[204:207], a[64:67], a[12:15], v[204:207]
    ds_read_b64_tr_b16 a[86:87], v6 offset:58368
    v_mfma_f32_16x16x32_bf16 v[204:207], a[68:71], a[44:47], v[204:207]
    s_add_u32 m0, s36, 16384
    v_mfma_f32_16x16x32_bf16 v[208:211], a[64:67], a[16:19], v[208:211]
    buffer_load_dwordx4 v8, s[8:11], s28 offen lds
    v_mfma_f32_16x16x32_bf16 v[208:211], a[68:71], a[48:51], v[208:211]
    v_mfma_f32_16x16x32_bf16 v[212:215], a[64:67], a[20:23], v[212:215]
    v_mfma_f32_16x16x32_bf16 v[212:215], a[68:71], a[52:55], v[212:215]
    s_add_u32 m0, s36, 20480
    v_mfma_f32_16x16x32_bf16 v[216:219], a[64:67], a[24:27], v[216:219]
    buffer_load_dwordx4 v8, s[8:11], s29 offen lds
    v_mfma_f32_16x16x32_bf16 v[216:219], a[68:71], a[56:59], v[216:219]
    v_mfma_f32_16x16x32_bf16 v[220:223], a[64:67], a[28:31], v[220:223]
    v_mfma_f32_16x16x32_bf16 v[220:223], a[68:71], a[60:63], v[220:223]
    v_mfma_f32_16x16x32_bf16 v[224:227], a[72:75], a[0:3], v[224:227]
    ds_read_b64_tr_b16 a[88:89], v7 offset:49152
    s_waitcnt lgkmcnt(5)
    v_mfma_f32_16x16x32_bf16 v[224:227], a[76:79], a[32:35], v[224:227]
    v_mfma_f32_16x16x32_bf16 v[228:231], a[72:75], a[4:7], v[228:231]
    ds_read_b64_tr_b16 a[90:91], v7 offset:50176
    v_mfma_f32_16x16x32_bf16 v[228:231], a[76:79], a[36:39], v[228:231]
    v_mfma_f32_16x16x32_bf16 v[232:235], a[72:75], a[8:11], v[232:235]
    ds_read_b64_tr_b16 a[92:93], v7 offset:57344
    v_mfma_f32_16x16x32_bf16 v[232:235], a[76:79], a[40:43], v[232:235]
    v_mfma_f32_16x16x32_bf16 v[236:239], a[72:75], a[12:15], v[236:239]
    ds_read_b64_tr_b16 a[94:95], v7 offset:58368
    v_mfma_f32_16x16x32_bf16 v[236:239], a[76:79], a[44:47], v[236:239]
    s_add_u32 m0, s36, 24576
    v_mfma_f32_16x16x32_bf16 v[240:243], a[72:75], a[16:19], v[240:243]
    buffer_load_dwordx4 v8, s[8:11], s30 offen lds
    v_mfma_f32_16x16x32_bf16 v[240:243], a[76:79], a[48:51], v[240:243]
    v_mfma_f32_16x16x32_bf16 v[244:247], a[72:75], a[20:23], v[244:247]
    v_mfma_f32_16x16x32_bf16 v[244:247], a[76:79], a[52:55], v[244:247]
    s_add_u32 m0, s36, 28672
    v_mfma_f32_16x16x32_bf16 v[248:251], a[72:75], a[24:27], v[248:251]
    buffer_load_dwordx4 v8, s[8:11], s31 offen lds
    v_mfma_f32_16x16x32_bf16 v[248:251], a[76:79], a[56:59], v[248:251]
    s_add_u32 s8, s8, 128
    s_addc_u32 s9, s9, 0
    s_sub_u32 s10, s10, 128
    v_mfma_f32_16x16x32_bf16 v[252:255], a[72:75], a[28:31], v[252:255]
    v_mfma_f32_16x16x32_bf16 v[252:255], a[76:79], a[60:63], v[252:255]
    buffer_load_dword v21, v19, s[60:63], 0 offen
    v_add_u32 v19, s46, v19
    buffer_load_dwordx2 v[16:17], v18, s[68:71], 0 offen offset:40 sc1
    s_waitcnt vmcnt(19) lgkmcnt(0)
    s_barrier
    v_mfma_f32_16x16x32_bf16 a[128:131], a[80:83], a[0:3], a[128:131]
    ds_read_b64_tr_b16 a[64:65], v4 offset:0
    v_mfma_f32_16x16x32_bf16 a[128:131], a[84:87], a[32:35], a[128:131]
    ds_read_b64_tr_b16 a[66:67], v4 offset:1024
    v_mfma_f32_16x16x32_bf16 a[132:135], a[80:83], a[4:7], a[132:135]
    v_mfma_f32_16x16x32_bf16 a[132:135], a[84:87], a[36:39], a[132:135]
    ds_read_b64_tr_b16 a[68:69], v4 offset:8192
    v_mfma_f32_16x16x32_bf16 a[136:139], a[80:83], a[8:11], a[136:139]
    ds_read_b64_tr_b16 a[70:71], v4 offset:9216
    v_mfma_f32_16x16x32_bf16 a[136:139], a[84:87], a[40:43], a[136:139]
    v_mfma_f32_16x16x32_bf16 a[140:143], a[80:83], a[12:15], a[140:143]
    ds_read_b64_tr_b16 a[72:73], v5 offset:0
    v_mfma_f32_16x16x32_bf16 a[140:143], a[84:87], a[44:47], a[140:143]
    ds_read_b64_tr_b16 a[74:75], v5 offset:1024
    v_mfma_f32_16x16x32_bf16 a[144:147], a[80:83], a[16:19], a[144:147]
    v_mfma_f32_16x16x32_bf16 a[144:147], a[84:87], a[48:51], a[144:147]
    ds_read_b64_tr_b16 a[76:77], v5 offset:8192
    v_mfma_f32_16x16x32_bf16 a[148:151], a[80:83], a[20:23], a[148:151]
    ds_read_b64_tr_b16 a[78:79], v5 offset:9216
    v_mfma_f32_16x16x32_bf16 a[148:151], a[84:87], a[52:55], a[148:151]
    v_mfma_f32_16x16x32_bf16 a[152:155], a[80:83], a[24:27], a[152:155]
    v_mfma_f32_16x16x32_bf16 a[152:155], a[84:87], a[56:59], a[152:155]
    v_mfma_f32_16x16x32_bf16 a[156:159], a[80:83], a[28:31], a[156:159]
    v_mfma_f32_16x16x32_bf16 a[156:159], a[84:87], a[60:63], a[156:159]
    v_mfma_f32_16x16x32_bf16 a[160:163], a[88:91], a[0:3], a[160:163]
    ds_read_b128 a[0:3], v60 offset:0
    v_mfma_f32_16x16x32_bf16 a[160:163], a[92:95], a[32:35], a[160:163]
    ds_read_b128 a[32:35], v61 offset:0
    v_mfma_f32_16x16x32_bf16 a[164:167], a[88:91], a[4:7], a[164:167]
    ds_read_b128 a[4:7], v60 offset:2048
    v_mfma_f32_16x16x32_bf16 a[164:167], a[92:95], a[36:39], a[164:167]
    ds_read_b128 a[36:39], v61 offset:2048
    v_mfma_f32_16x16x32_bf16 a[168:171], a[88:91], a[8:11], a[168:171]
    ds_read_b128 a[8:11], v60 offset:4096
    v_mfma_f32_16x16x32_bf16 a[168:171], a[92:95], a[40:43], a[168:171]
    ds_read_b128 a[40:43], v61 offset:4096
    v_mfma_f32_16x16x32_bf16 a[172:175], a[88:91], a[12:15], a[172:175]
    ds_read_b128 a[12:15], v60 offset:6144
    v_mfma_f32_16x16x32_bf16 a[172:175], a[92:95], a[44:47], a[172:175]
    ds_read_b128 a[44:47], v61 offset:6144
    v_mfma_f32_16x16x32_bf16 a[176:179], a[88:91], a[16:19], a[176:179]
    ds_read_b128 a[16:19], v60 offset:8192
    v_mfma_f32_16x16x32_bf16 a[176:179], a[92:95], a[48:51], a[176:179]
    ds_read_b128 a[48:51], v61 offset:8192
    v_mfma_f32_16x16x32_bf16 a[180:183], a[88:91], a[20:23], a[180:183]
    ds_read_b128 a[20:23], v60 offset:10240
    v_mfma_f32_16x16x32_bf16 a[180:183], a[92:95], a[52:55], a[180:183]
    ds_read_b128 a[52:55], v61 offset:10240
    v_mfma_f32_16x16x32_bf16 a[184:187], a[88:91], a[24:27], a[184:187]
    ds_read_b128 a[24:27], v60 offset:12288
    v_mfma_f32_16x16x32_bf16 a[184:187], a[92:95], a[56:59], a[184:187]
    ds_read_b128 a[56:59], v61 offset:12288
    v_mfma_f32_16x16x32_bf16 a[188:191], a[88:91], a[28:31], a[188:191]
    ds_read_b128 a[28:31], v60 offset:14336
    v_mfma_f32_16x16x32_bf16 a[188:191], a[92:95], a[60:63], a[188:191]
    ds_read_b128 a[60:63], v61 offset:14336
    s_waitcnt lgkmcnt(10)
    v_mfma_f32_16x16x32_bf16 v[64:67], a[64:67], a[0:3], v[64:67]
    ds_read_b64_tr_b16 a[80:81], v6 offset:0
    v_mfma_f32_16x16x32_bf16 v[64:67], a[68:71], a[32:35], v[64:67]
    v_mfma_f32_16x16x32_bf16 v[68:71], a[64:67], a[4:7], v[68:71]
    ds_read_b64_tr_b16 a[82:83], v6 offset:1024
    v_mfma_f32_16x16x32_bf16 v[68:71], a[68:71], a[36:39], v[68:71]
    v_mfma_f32_16x16x32_bf16 v[72:75], a[64:67], a[8:11], v[72:75]
    ds_read_b64_tr_b16 a[84:85], v6 offset:8192
    v_mfma_f32_16x16x32_bf16 v[72:75], a[68:71], a[40:43], v[72:75]
    s_waitcnt lgkmcnt(7)
    v_mfma_f32_16x16x32_bf16 v[76:79], a[64:67], a[12:15], v[76:79]
    ds_read_b64_tr_b16 a[86:87], v6 offset:9216
    v_mfma_f32_16x16x32_bf16 v[76:79], a[68:71], a[44:47], v[76:79]
    s_add_u32 m0, s37, 49152
    v_mfma_f32_16x16x32_bf16 v[80:83], a[64:67], a[16:19], v[80:83]
    buffer_load_dwordx4 v9, s[16:19], s32 offen lds
    v_mfma_f32_16x16x32_bf16 v[80:83], a[68:71], a[48:51], v[80:83]
    s_add_u32 s32, s32, 458752
    v_mfma_f32_16x16x32_bf16 v[84:87], a[64:67], a[20:23], v[84:87]
    v_mfma_f32_16x16x32_bf16 v[84:87], a[68:71], a[52:55], v[84:87]
    s_add_u32 m0, s37, 53248
    s_waitcnt lgkmcnt(2)
    v_mfma_f32_16x16x32_bf16 v[88:91], a[64:67], a[24:27], v[88:91]
    buffer_load_dwordx4 v9, s[16:19], s33 offen lds
    v_mfma_f32_16x16x32_bf16 v[88:91], a[68:71], a[56:59], v[88:91]
    s_add_u32 s33, s33, 458752
    v_mfma_f32_16x16x32_bf16 v[92:95], a[64:67], a[28:31], v[92:95]
    v_mfma_f32_16x16x32_bf16 v[92:95], a[68:71], a[60:63], v[92:95]
    v_mfma_f32_16x16x32_bf16 v[96:99], a[72:75], a[0:3], v[96:99]
    ds_read_b64_tr_b16 a[88:89], v7 offset:0
    v_mfma_f32_16x16x32_bf16 v[96:99], a[76:79], a[32:35], v[96:99]
    v_mfma_f32_16x16x32_bf16 v[100:103], a[72:75], a[4:7], v[100:103]
    ds_read_b64_tr_b16 a[90:91], v7 offset:1024
    v_mfma_f32_16x16x32_bf16 v[100:103], a[76:79], a[36:39], v[100:103]
    v_mfma_f32_16x16x32_bf16 v[104:107], a[72:75], a[8:11], v[104:107]
    ds_read_b64_tr_b16 a[92:93], v7 offset:8192
    v_mfma_f32_16x16x32_bf16 v[104:107], a[76:79], a[40:43], v[104:107]
    v_mfma_f32_16x16x32_bf16 v[108:111], a[72:75], a[12:15], v[108:111]
    ds_read_b64_tr_b16 a[94:95], v7 offset:9216
    v_mfma_f32_16x16x32_bf16 v[108:111], a[76:79], a[44:47], v[108:111]
    s_add_u32 m0, s37, 57344
    v_mfma_f32_16x16x32_bf16 v[112:115], a[72:75], a[16:19], v[112:115]
    buffer_load_dwordx4 v9, s[16:19], s34 offen lds
    v_mfma_f32_16x16x32_bf16 v[112:115], a[76:79], a[48:51], v[112:115]
    s_add_u32 s34, s34, 458752
    v_mfma_f32_16x16x32_bf16 v[116:119], a[72:75], a[20:23], v[116:119]
    v_mfma_f32_16x16x32_bf16 v[116:119], a[76:79], a[52:55], v[116:119]
    s_add_u32 m0, s37, 61440
    v_mfma_f32_16x16x32_bf16 v[120:123], a[72:75], a[24:27], v[120:123]
    buffer_load_dwordx4 v9, s[16:19], s35 offen lds
    v_mfma_f32_16x16x32_bf16 v[120:123], a[76:79], a[56:59], v[120:123]
    s_add_u32 s35, s35, 458752
    v_mfma_f32_16x16x32_bf16 v[124:127], a[72:75], a[28:31], v[124:127]
    v_mfma_f32_16x16x32_bf16 v[124:127], a[76:79], a[60:63], v[124:127]
    s_waitcnt vmcnt(19) lgkmcnt(0)
    s_barrier
    v_mfma_f32_16x16x32_bf16 v[128:131], a[80:83], a[0:3], v[128:131]
    ds_read_b64_tr_b16 a[64:65], v4 offset:16384
    v_mfma_f32_16x16x32_bf16 v[128:131], a[84:87], a[32:35], v[128:131]
    v_mfma_f32_16x16x32_bf16 v[132:135], a[80:83], a[4:7], v[132:135]
    ds_read_b64_tr_b16 a[66:67], v4 offset:17408
    s_mov_b32 s37, s3
    v_and_b32 v32, 31, v11
    v_mfma_f32_16x16x32_bf16 v[132:135], a[84:87], a[36:39], v[132:135]
    v_lshlrev_b32 v32, 6, v32
    v_mfma_f32_16x16x32_bf16 v[136:139], a[80:83], a[8:11], v[136:139]
    ds_read_b64_tr_b16 a[68:69], v4 offset:24576
    s_mov_b32 s95, 47251456
    v_mfma_f32_16x16x32_bf16 v[136:139], a[84:87], a[40:43], v[136:139]
    s_add_u32 s41, s37, 3
    v_mfma_f32_16x16x32_bf16 v[140:143], a[80:83], a[12:15], v[140:143]
    ds_read_b64_tr_b16 a[70:71], v4 offset:25600
    v_mov_b32 v33, s41
    v_mfma_f32_16x16x32_bf16 v[140:143], a[84:87], a[44:47], v[140:143]
    s_lshl_b32 s58, s2, 6
    s_add_u32 s58, s58, 47251456
    v_mfma_f32_16x16x32_bf16 v[144:147], a[80:83], a[16:19], v[144:147]
    s_lshl_b32 s42, s38, 2
    v_mfma_f32_16x16x32_bf16 v[144:147], a[84:87], a[48:51], v[144:147]
    s_add_u32 s59, s59, s42
    v_mfma_f32_16x16x32_bf16 v[148:151], a[80:83], a[20:23], v[148:151]
    s_add_u32 s59, s59, 16
    v_mfma_f32_16x16x32_bf16 v[148:151], a[84:87], a[52:55], v[148:151]
    s_add_u32 s42, s37, 1
    v_mfma_f32_16x16x32_bf16 v[152:155], a[80:83], a[24:27], v[152:155]
    v_mov_b32 v57, s42
    v_lshlrev_b32 v56, 26, v11
    v_mfma_f32_16x16x32_bf16 v[152:155], a[84:87], a[56:59], v[152:155]
    s_mov_b32 s8, s82
    v_mfma_f32_16x16x32_bf16 v[156:159], a[80:83], a[28:31], v[156:159]
    s_mov_b32 s9, s83
    v_mfma_f32_16x16x32_bf16 v[156:159], a[84:87], a[60:63], v[156:159]
    s_mov_b32 s10, 0x400000
    v_mfma_f32_16x16x32_bf16 v[160:163], a[88:91], a[0:3], v[160:163]
    ds_read_b64_tr_b16 a[72:73], v5 offset:16384
    s_mov_b32 s11, 0x20000
    v_mfma_f32_16x16x32_bf16 v[160:163], a[92:95], a[32:35], v[160:163]
    s_and_b32 s76, s2, 7
    s_lshr_b32 s77, s2, 3
    v_mfma_f32_16x16x32_bf16 v[164:167], a[88:91], a[4:7], v[164:167]
    ds_read_b64_tr_b16 a[74:75], v5 offset:17408
    s_lshr_b32 s14, s76, 2
    v_mfma_f32_16x16x32_bf16 v[164:167], a[92:95], a[36:39], v[164:167]
    s_and_b32 s12, s76, 3
    v_mfma_f32_16x16x32_bf16 v[168:171], a[88:91], a[8:11], v[168:171]
    ds_read_b64_tr_b16 a[76:77], v5 offset:24576
    s_lshl_b32 s12, s12, 2
    v_mfma_f32_16x16x32_bf16 v[168:171], a[92:95], a[40:43], v[168:171]
    s_lshr_b32 s78, s77, 3
    v_mfma_f32_16x16x32_bf16 v[172:175], a[88:91], a[12:15], v[172:175]
    ds_read_b64_tr_b16 a[78:79], v5 offset:25600
    s_add_u32 s12, s12, s78
    s_and_b32 s13, s77, 7
    v_mfma_f32_16x16x32_bf16 v[172:175], a[92:95], a[44:47], v[172:175]
    s_lshl_b32 s76, s12, 2
    v_mfma_f32_16x16x32_bf16 v[176:179], a[88:91], a[16:19], v[176:179]
    s_add_u32 s76, s76, s38
    v_mfma_f32_16x16x32_bf16 v[176:179], a[92:95], a[48:51], v[176:179]
    s_mul_i32 s76, s76, 112
    v_mfma_f32_16x16x32_bf16 v[180:183], a[88:91], a[20:23], v[180:183]
    s_mul_i32 s77, s14, 110
    v_mfma_f32_16x16x32_bf16 v[180:183], a[92:95], a[52:55], v[180:183]
    s_add_u32 s76, s76, s77
    s_lshl_b32 s15, s76, 11
    v_mfma_f32_16x16x32_bf16 v[184:187], a[88:91], a[24:27], v[184:187]
    s_mul_i32 s76, s14, 3520
    v_mfma_f32_16x16x32_bf16 v[184:187], a[92:95], a[56:59], v[184:187]
    s_lshl_b32 s77, s38, 4
    v_mfma_f32_16x16x32_bf16 v[188:191], a[88:91], a[28:31], v[188:191]
    s_add_u32 s76, s76, s77
    v_mfma_f32_16x16x32_bf16 v[188:191], a[92:95], a[60:63], v[188:191]
    s_lshl_b32 s76, s76, 11
    s_waitcnt lgkmcnt(1)
    v_mfma_f32_16x16x32_bf16 v[192:195], a[64:67], a[0:3], v[192:195]
    ds_read_b64_tr_b16 a[80:81], v6 offset:16384
    s_lshl_b32 s77, s13, 8
    s_add_u32 s16, s76, s77
    v_mfma_f32_16x16x32_bf16 v[192:195], a[68:71], a[32:35], v[192:195]
    s_lshl_b32 s24, s38, 12
    v_mfma_f32_16x16x32_bf16 v[196:199], a[64:67], a[4:7], v[196:199]
    ds_read_b64_tr_b16 a[82:83], v6 offset:17408
    s_mul_i32 s31, s14, -262144
    v_mfma_f32_16x16x32_bf16 v[196:199], a[68:71], a[36:39], v[196:199]
    s_add_u32 s31, s31, 131072
    v_mfma_f32_16x16x32_bf16 v[200:203], a[64:67], a[8:11], v[200:203]
    ds_read_b64_tr_b16 a[84:85], v6 offset:24576
    v_lshrrev_b32 v35, 4, v11
    v_mfma_f32_16x16x32_bf16 v[200:203], a[68:71], a[40:43], v[200:203]
    v_lshlrev_b32 v9, 1, v35
    v_and_b32 v8, 15, v11
    v_mfma_f32_16x16x32_bf16 v[204:207], a[64:67], a[12:15], v[204:207]
    ds_read_b64_tr_b16 a[86:87], v6 offset:25600
    v_xor_b32 v9, v9, v8
    v_mfma_f32_16x16x32_bf16 v[204:207], a[68:71], a[44:47], v[204:207]
    v_lshlrev_b32 v9, 4, v9
    v_mfma_f32_16x16x32_bf16 v[208:211], a[64:67], a[16:19], v[208:211]
    v_lshl_add_u32 v8, v35, 11, v9
    v_mfma_f32_16x16x32_bf16 v[208:211], a[68:71], a[48:51], v[208:211]
    v_xor_b32 v58, 128, v8
    v_mfma_f32_16x16x32_bf16 v[212:215], a[64:67], a[20:23], v[212:215]
    v_add_u32 v58, 7168, v58
    v_add_u32 v59, 14336, v8
    v_mfma_f32_16x16x32_bf16 v[212:215], a[68:71], a[52:55], v[212:215]
    v_add_u32 v1, 14336, v58
    v_mfma_f32_16x16x32_bf16 v[216:219], a[64:67], a[24:27], v[216:219]
    s_bfe_u32 s76, s12, 0x20001
    v_mfma_f32_16x16x32_bf16 v[216:219], a[68:71], a[56:59], v[216:219]
    s_mul_i32 s76, s76, 56
    v_mfma_f32_16x16x32_bf16 v[220:223], a[64:67], a[28:31], v[220:223]
    s_lshr_b32 s77, s12, 3
    v_mfma_f32_16x16x32_bf16 v[220:223], a[68:71], a[60:63], v[220:223]
    s_lshl_b32 s77, s77, 2
    s_add_u32 s76, s76, s77
    v_mfma_f32_16x16x32_bf16 v[224:227], a[72:75], a[0:3], v[224:227]
    ds_read_b64_tr_b16 a[88:89], v7 offset:16384
    s_add_u32 s76, s76, 32
    s_waitcnt lgkmcnt(5)
    v_mfma_f32_16x16x32_bf16 v[224:227], a[76:79], a[32:35], v[224:227]
    s_lshl_b32 s76, s76, 6
    v_mfma_f32_16x16x32_bf16 v[228:231], a[72:75], a[4:7], v[228:231]
    ds_read_b64_tr_b16 a[90:91], v7 offset:17408
    s_and_b32 s77, s12, 1
    v_mfma_f32_16x16x32_bf16 v[228:231], a[76:79], a[36:39], v[228:231]
    s_lshl_b32 s77, s77, 3
    v_mfma_f32_16x16x32_bf16 v[232:235], a[72:75], a[8:11], v[232:235]
    ds_read_b64_tr_b16 a[92:93], v7 offset:24576
    s_add_u32 s76, s76, s77
    s_add_u32 s39, s76, 47251472
    v_mfma_f32_16x16x32_bf16 v[232:235], a[76:79], a[40:43], v[232:235]
    v_bfe_u32 v35, v11, 1, 3
    v_mfma_f32_16x16x32_bf16 v[236:239], a[72:75], a[12:15], v[236:239]
    ds_read_b64_tr_b16 a[94:95], v7 offset:25600
    v_min_u32 v35, 6, v35
    v_mfma_f32_16x16x32_bf16 v[236:239], a[76:79], a[44:47], v[236:239]
    s_mul_i32 s76, s14, 3
    v_mfma_f32_16x16x32_bf16 v[240:243], a[72:75], a[16:19], v[240:243]
    v_lshrrev_b32 v9, 4, v11
    v_mfma_f32_16x16x32_bf16 v[240:243], a[76:79], a[48:51], v[240:243]
    v_min_u32 v9, 2, v9
    v_xor_b32 v9, s76, v9
    v_mfma_f32_16x16x32_bf16 v[244:247], a[72:75], a[20:23], v[244:247]
    v_lshl_add_u32 v35, v35, 3, v9
    v_mfma_f32_16x16x32_bf16 v[244:247], a[76:79], a[52:55], v[244:247]
    v_lshlrev_b32 v35, 6, v35
    v_mfma_f32_16x16x32_bf16 v[248:251], a[72:75], a[24:27], v[248:251]
    v_and_b32 v9, 1, v11
    v_mfma_f32_16x16x32_bf16 v[248:251], a[76:79], a[56:59], v[248:251]
    v_lshl_add_u32 v9, v9, 2, v35
    v_mfma_f32_16x16x32_bf16 v[252:255], a[72:75], a[28:31], v[252:255]
    s_add_u32 s40, s37, 1
    v_mfma_f32_16x16x32_bf16 v[252:255], a[76:79], a[60:63], v[252:255]
    s_waitcnt vmcnt(6) lgkmcnt(0)
    s_barrier
    v_mfma_f32_16x16x32_bf16 a[128:131], a[80:83], a[0:3], a[128:131]
    ds_read_b64_tr_b16 a[64:65], v4 offset:32768
    v_mfma_f32_16x16x32_bf16 a[128:131], a[84:87], a[32:35], a[128:131]
    ds_read_b64_tr_b16 a[66:67], v4 offset:33792
    v_mfma_f32_16x16x32_bf16 a[132:135], a[80:83], a[4:7], a[132:135]
    v_mfma_f32_16x16x32_bf16 a[132:135], a[84:87], a[36:39], a[132:135]
    ds_read_b64_tr_b16 a[68:69], v4 offset:40960
    v_mfma_f32_16x16x32_bf16 a[136:139], a[80:83], a[8:11], a[136:139]
    ds_read_b64_tr_b16 a[70:71], v4 offset:41984
    v_mfma_f32_16x16x32_bf16 a[136:139], a[84:87], a[40:43], a[136:139]
    v_mfma_f32_16x16x32_bf16 a[140:143], a[80:83], a[12:15], a[140:143]
    ds_read_b64_tr_b16 a[72:73], v5 offset:32768
    v_mfma_f32_16x16x32_bf16 a[140:143], a[84:87], a[44:47], a[140:143]
    ds_read_b64_tr_b16 a[74:75], v5 offset:33792
    v_mfma_f32_16x16x32_bf16 a[144:147], a[80:83], a[16:19], a[144:147]
    v_mfma_f32_16x16x32_bf16 a[144:147], a[84:87], a[48:51], a[144:147]
    ds_read_b64_tr_b16 a[76:77], v5 offset:40960
    v_mfma_f32_16x16x32_bf16 a[148:151], a[80:83], a[20:23], a[148:151]
    ds_read_b64_tr_b16 a[78:79], v5 offset:41984
    v_mfma_f32_16x16x32_bf16 a[148:151], a[84:87], a[52:55], a[148:151]
    v_mfma_f32_16x16x32_bf16 a[152:155], a[80:83], a[24:27], a[152:155]
    v_mfma_f32_16x16x32_bf16 a[152:155], a[84:87], a[56:59], a[152:155]
    v_mfma_f32_16x16x32_bf16 a[156:159], a[80:83], a[28:31], a[156:159]
    v_mfma_f32_16x16x32_bf16 a[156:159], a[84:87], a[60:63], a[156:159]
    v_mfma_f32_16x16x32_bf16 a[160:163], a[88:91], a[0:3], a[160:163]
    ds_read_b128 a[0:3], v2 offset:0
    v_mfma_f32_16x16x32_bf16 a[160:163], a[92:95], a[32:35], a[160:163]
    ds_read_b128 a[32:35], v3 offset:0
    v_mfma_f32_16x16x32_bf16 a[164:167], a[88:91], a[4:7], a[164:167]
    ds_read_b128 a[4:7], v2 offset:2048
    v_mfma_f32_16x16x32_bf16 a[164:167], a[92:95], a[36:39], a[164:167]
    ds_read_b128 a[36:39], v3 offset:2048
    v_mfma_f32_16x16x32_bf16 a[168:171], a[88:91], a[8:11], a[168:171]
    ds_read_b128 a[8:11], v2 offset:4096
    v_mfma_f32_16x16x32_bf16 a[168:171], a[92:95], a[40:43], a[168:171]
    ds_read_b128 a[40:43], v3 offset:4096
    v_mfma_f32_16x16x32_bf16 a[172:175], a[88:91], a[12:15], a[172:175]
    ds_read_b128 a[12:15], v2 offset:6144
    v_mfma_f32_16x16x32_bf16 a[172:175], a[92:95], a[44:47], a[172:175]
    ds_read_b128 a[44:47], v3 offset:6144
    v_mfma_f32_16x16x32_bf16 a[176:179], a[88:91], a[16:19], a[176:179]
    ds_read_b128 a[16:19], v2 offset:8192
    v_mfma_f32_16x16x32_bf16 a[176:179], a[92:95], a[48:51], a[176:179]
    ds_read_b128 a[48:51], v3 offset:8192
    v_mfma_f32_16x16x32_bf16 a[180:183], a[88:91], a[20:23], a[180:183]
    ds_read_b128 a[20:23], v2 offset:10240
    v_mfma_f32_16x16x32_bf16 a[180:183], a[92:95], a[52:55], a[180:183]
    ds_read_b128 a[52:55], v3 offset:10240
    v_mfma_f32_16x16x32_bf16 a[184:187], a[88:91], a[24:27], a[184:187]
    ds_read_b128 a[24:27], v2 offset:12288
    v_mfma_f32_16x16x32_bf16 a[184:187], a[92:95], a[56:59], a[184:187]
    ds_read_b128 a[56:59], v3 offset:12288
    v_mfma_f32_16x16x32_bf16 a[188:191], a[88:91], a[28:31], a[188:191]
    ds_read_b128 a[28:31], v2 offset:14336
    v_mfma_f32_16x16x32_bf16 a[188:191], a[92:95], a[60:63], a[188:191]
    ds_read_b128 a[60:63], v3 offset:14336
    s_waitcnt lgkmcnt(10)
    v_mfma_f32_16x16x32_bf16 v[64:67], a[64:67], a[0:3], v[64:67]
    ds_read_b64_tr_b16 a[80:81], v6 offset:32768
    v_mfma_f32_16x16x32_bf16 v[64:67], a[68:71], a[32:35], v[64:67]
    v_mfma_f32_16x16x32_bf16 v[68:71], a[64:67], a[4:7], v[68:71]
    ds_read_b64_tr_b16 a[82:83], v6 offset:33792
    v_mfma_f32_16x16x32_bf16 v[68:71], a[68:71], a[36:39], v[68:71]
    v_mfma_f32_16x16x32_bf16 v[72:75], a[64:67], a[8:11], v[72:75]
    ds_read_b64_tr_b16 a[84:85], v6 offset:40960
    v_mfma_f32_16x16x32_bf16 v[72:75], a[68:71], a[40:43], v[72:75]
    s_waitcnt lgkmcnt(7)
    v_mfma_f32_16x16x32_bf16 v[76:79], a[64:67], a[12:15], v[76:79]
    ds_read_b64_tr_b16 a[86:87], v6 offset:41984
    v_mfma_f32_16x16x32_bf16 v[76:79], a[68:71], a[44:47], v[76:79]
    v_mfma_f32_16x16x32_bf16 v[80:83], a[64:67], a[16:19], v[80:83]
    v_mfma_f32_16x16x32_bf16 v[80:83], a[68:71], a[48:51], v[80:83]
    v_mfma_f32_16x16x32_bf16 v[84:87], a[64:67], a[20:23], v[84:87]
    v_mfma_f32_16x16x32_bf16 v[84:87], a[68:71], a[52:55], v[84:87]
    s_waitcnt lgkmcnt(2)
    v_mfma_f32_16x16x32_bf16 v[88:91], a[64:67], a[24:27], v[88:91]
    v_mfma_f32_16x16x32_bf16 v[88:91], a[68:71], a[56:59], v[88:91]
    v_mfma_f32_16x16x32_bf16 v[92:95], a[64:67], a[28:31], v[92:95]
    v_mfma_f32_16x16x32_bf16 v[92:95], a[68:71], a[60:63], v[92:95]
    v_mfma_f32_16x16x32_bf16 v[96:99], a[72:75], a[0:3], v[96:99]
    ds_read_b64_tr_b16 a[88:89], v7 offset:32768
    v_mfma_f32_16x16x32_bf16 v[96:99], a[76:79], a[32:35], v[96:99]
    v_mfma_f32_16x16x32_bf16 v[100:103], a[72:75], a[4:7], v[100:103]
    ds_read_b64_tr_b16 a[90:91], v7 offset:33792
    v_mfma_f32_16x16x32_bf16 v[100:103], a[76:79], a[36:39], v[100:103]
    v_mfma_f32_16x16x32_bf16 v[104:107], a[72:75], a[8:11], v[104:107]
    ds_read_b64_tr_b16 a[92:93], v7 offset:40960
    v_mfma_f32_16x16x32_bf16 v[104:107], a[76:79], a[40:43], v[104:107]
    v_mfma_f32_16x16x32_bf16 v[108:111], a[72:75], a[12:15], v[108:111]
    ds_read_b64_tr_b16 a[94:95], v7 offset:41984
    v_mfma_f32_16x16x32_bf16 v[108:111], a[76:79], a[44:47], v[108:111]
    v_mfma_f32_16x16x32_bf16 v[112:115], a[72:75], a[16:19], v[112:115]
    v_mfma_f32_16x16x32_bf16 v[112:115], a[76:79], a[48:51], v[112:115]
    v_mfma_f32_16x16x32_bf16 v[116:119], a[72:75], a[20:23], v[116:119]
    v_mfma_f32_16x16x32_bf16 v[116:119], a[76:79], a[52:55], v[116:119]
    v_mfma_f32_16x16x32_bf16 v[120:123], a[72:75], a[24:27], v[120:123]
    v_mfma_f32_16x16x32_bf16 v[120:123], a[76:79], a[56:59], v[120:123]
    v_mfma_f32_16x16x32_bf16 v[124:127], a[72:75], a[28:31], v[124:127]
    v_mfma_f32_16x16x32_bf16 v[124:127], a[76:79], a[60:63], v[124:127]
    s_waitcnt vmcnt(0) lgkmcnt(0)
    s_barrier
    v_mfma_f32_16x16x32_bf16 v[128:131], a[80:83], a[0:3], v[128:131]
    ds_read_b64_tr_b16 a[64:65], v4 offset:49152
    v_mfma_f32_16x16x32_bf16 v[128:131], a[84:87], a[32:35], v[128:131]
    v_mfma_f32_16x16x32_bf16 v[132:135], a[80:83], a[4:7], v[132:135]
    ds_read_b64_tr_b16 a[66:67], v4 offset:50176
    v_mfma_f32_16x16x32_bf16 v[132:135], a[84:87], a[36:39], v[132:135]
    v_mfma_f32_16x16x32_bf16 v[136:139], a[80:83], a[8:11], v[136:139]
    ds_read_b64_tr_b16 a[68:69], v4 offset:57344
    v_mfma_f32_16x16x32_bf16 v[136:139], a[84:87], a[40:43], v[136:139]
    v_mfma_f32_16x16x32_bf16 v[140:143], a[80:83], a[12:15], v[140:143]
    ds_read_b64_tr_b16 a[70:71], v4 offset:58368
    v_mfma_f32_16x16x32_bf16 v[140:143], a[84:87], a[44:47], v[140:143]
    v_mfma_f32_16x16x32_bf16 v[144:147], a[80:83], a[16:19], v[144:147]
    v_mfma_f32_16x16x32_bf16 v[144:147], a[84:87], a[48:51], v[144:147]
    v_mfma_f32_16x16x32_bf16 v[148:151], a[80:83], a[20:23], v[148:151]
    v_mfma_f32_16x16x32_bf16 v[148:151], a[84:87], a[52:55], v[148:151]
    v_mfma_f32_16x16x32_bf16 v[152:155], a[80:83], a[24:27], v[152:155]
    v_mfma_f32_16x16x32_bf16 v[152:155], a[84:87], a[56:59], v[152:155]
    v_mfma_f32_16x16x32_bf16 v[156:159], a[80:83], a[28:31], v[156:159]
    v_mfma_f32_16x16x32_bf16 v[156:159], a[84:87], a[60:63], v[156:159]
    v_mfma_f32_16x16x32_bf16 v[160:163], a[88:91], a[0:3], v[160:163]
    ds_read_b64_tr_b16 a[72:73], v5 offset:49152
    v_mfma_f32_16x16x32_bf16 v[160:163], a[92:95], a[32:35], v[160:163]
    v_mfma_f32_16x16x32_bf16 v[164:167], a[88:91], a[4:7], v[164:167]
    ds_read_b64_tr_b16 a[74:75], v5 offset:50176
    v_mfma_f32_16x16x32_bf16 v[164:167], a[92:95], a[36:39], v[164:167]
    v_mfma_f32_16x16x32_bf16 v[168:171], a[88:91], a[8:11], v[168:171]
    ds_read_b64_tr_b16 a[76:77], v5 offset:57344
    v_mfma_f32_16x16x32_bf16 v[168:171], a[92:95], a[40:43], v[168:171]
    v_mfma_f32_16x16x32_bf16 v[172:175], a[88:91], a[12:15], v[172:175]
    ds_read_b64_tr_b16 a[78:79], v5 offset:58368
    v_mfma_f32_16x16x32_bf16 v[172:175], a[92:95], a[44:47], v[172:175]
    v_mfma_f32_16x16x32_bf16 v[176:179], a[88:91], a[16:19], v[176:179]
    v_mfma_f32_16x16x32_bf16 v[176:179], a[92:95], a[48:51], v[176:179]
    v_mfma_f32_16x16x32_bf16 v[180:183], a[88:91], a[20:23], v[180:183]
    v_mfma_f32_16x16x32_bf16 v[180:183], a[92:95], a[52:55], v[180:183]
    v_mfma_f32_16x16x32_bf16 v[184:187], a[88:91], a[24:27], v[184:187]
    v_mfma_f32_16x16x32_bf16 v[184:187], a[92:95], a[56:59], v[184:187]
    v_mfma_f32_16x16x32_bf16 v[188:191], a[88:91], a[28:31], v[188:191]
    v_mfma_f32_16x16x32_bf16 v[188:191], a[92:95], a[60:63], v[188:191]
    s_waitcnt lgkmcnt(1)
    v_mfma_f32_16x16x32_bf16 v[192:195], a[64:67], a[0:3], v[192:195]
    ds_read_b64_tr_b16 a[80:81], v6 offset:49152
    v_mfma_f32_16x16x32_bf16 v[192:195], a[68:71], a[32:35], v[192:195]
    v_mfma_f32_16x16x32_bf16 v[196:199], a[64:67], a[4:7], v[196:199]
    ds_read_b64_tr_b16 a[82:83], v6 offset:50176
    v_mfma_f32_16x16x32_bf16 v[196:199], a[68:71], a[36:39], v[196:199]
    v_mfma_f32_16x16x32_bf16 v[200:203], a[64:67], a[8:11], v[200:203]
    ds_read_b64_tr_b16 a[84:85], v6 offset:57344
    v_mfma_f32_16x16x32_bf16 v[200:203], a[68:71], a[40:43], v[200:203]
    v_mfma_f32_16x16x32_bf16 v[204:207], a[64:67], a[12:15], v[204:207]
    ds_read_b64_tr_b16 a[86:87], v6 offset:58368
    v_mfma_f32_16x16x32_bf16 v[204:207], a[68:71], a[44:47], v[204:207]
    v_mfma_f32_16x16x32_bf16 v[208:211], a[64:67], a[16:19], v[208:211]
    s_waitcnt vmcnt(4)
    v_cmp_ne_u32 vcc, s45, v17
    s_mov_b32 s41, 100000
    s_nop 3
Lpc2_33:
    s_cbranch_vccz Lpcd_34
    s_sleep 4
    buffer_load_dwordx2 v[16:17], v18, s[68:71], 0 offen offset:40 sc1
    s_waitcnt vmcnt(0)
    v_cmp_ne_u32 vcc, s45, v17
    s_sub_u32 s41, s41, 1
    s_nop 2
    s_cbranch_scc0 Lpc2_33
Lpcd_34:
    v_readlane_b32 s41, v16, 0
    v_readlane_b32 s42, v16, 1
    v_mfma_f32_16x16x32_bf16 v[208:211], a[68:71], a[48:51], v[208:211]
    v_mfma_f32_16x16x32_bf16 v[212:215], a[64:67], a[20:23], v[212:215]
    v_mfma_f32_16x16x32_bf16 v[212:215], a[68:71], a[52:55], v[212:215]
    s_sub_u32 s41, s41, s42
    s_mov_b32 s19, 4
    v_mfma_f32_16x16x32_bf16 v[216:219], a[64:67], a[24:27], v[216:219]
    v_mfma_f32_16x16x32_bf16 v[216:219], a[68:71], a[56:59], v[216:219]
    s_cmp_gt_i32 s41, 100000
    s_cselect_b32 s19, 6, s19
    v_mfma_f32_16x16x32_bf16 v[220:223], a[64:67], a[28:31], v[220:223]
    v_mfma_f32_16x16x32_bf16 v[220:223], a[68:71], a[60:63], v[220:223]
    s_cmp_gt_i32 s41, 200000
    s_cselect_b32 s19, 8, s19
    v_mfma_f32_16x16x32_bf16 v[224:227], a[72:75], a[0:3], v[224:227]
    ds_read_b64_tr_b16 a[88:89], v7 offset:49152
    s_waitcnt lgkmcnt(5)
    v_mfma_f32_16x16x32_bf16 v[224:227], a[76:79], a[32:35], v[224:227]
    s_cmp_lt_i32 s41, -100000
    s_cselect_b32 s19, 2, s19
    v_mfma_f32_16x16x32_bf16 v[228:231], a[72:75], a[4:7], v[228:231]
    ds_read_b64_tr_b16 a[90:91], v7 offset:50176
    v_mfma_f32_16x16x32_bf16 v[228:231], a[76:79], a[36:39], v[228:231]
    s_cmp_lt_i32 s41, -200000
    s_cselect_b32 s19, 0, s19
    v_mfma_f32_16x16x32_bf16 v[232:235], a[72:75], a[8:11], v[232:235]
    ds_read_b64_tr_b16 a[92:93], v7 offset:57344
    v_mfma_f32_16x16x32_bf16 v[232:235], a[76:79], a[40:43], v[232:235]
    s_lshl_b32 s18, s19, 14
    v_mfma_f32_16x16x32_bf16 v[236:239], a[72:75], a[12:15], v[236:239]
    ds_read_b64_tr_b16 a[94:95], v7 offset:58368
    v_mfma_f32_16x16x32_bf16 v[236:239], a[76:79], a[44:47], v[236:239]
    v_mfma_f32_16x16x32_bf16 v[240:243], a[72:75], a[16:19], v[240:243]
    v_mfma_f32_16x16x32_bf16 v[240:243], a[76:79], a[48:51], v[240:243]
    v_mfma_f32_16x16x32_bf16 v[244:247], a[72:75], a[20:23], v[244:247]
    v_mfma_f32_16x16x32_bf16 v[244:247], a[76:79], a[52:55], v[244:247]
    v_mfma_f32_16x16x32_bf16 v[248:251], a[72:75], a[24:27], v[248:251]
    v_mfma_f32_16x16x32_bf16 v[248:251], a[76:79], a[56:59], v[248:251]
    v_mfma_f32_16x16x32_bf16 v[252:255], a[72:75], a[28:31], v[252:255]
    v_mfma_f32_16x16x32_bf16 v[252:255], a[76:79], a[60:63], v[252:255]
    s_waitcnt lgkmcnt(0)
    s_barrier
    v_mfma_f32_16x16x32_bf16 a[128:131], a[80:83], a[0:3], a[128:131]
    v_mfma_f32_16x16x32_bf16 a[128:131], a[84:87], a[32:35], a[128:131]
    s_add_u32 s79, s18, 0
    s_and_b32 s79, s79, 131071
    s_add_u32 m0, s24, s79
    s_nop 0
    buffer_load_dwordx4 v8, s[60:63], s16 offen offset:0 lds
    v_mfma_f32_16x16x32_bf16 a[132:135], a[80:83], a[4:7], a[132:135]
    v_mfma_f32_16x16x32_bf16 a[132:135], a[84:87], a[36:39], a[132:135]
    buffer_load_dwordx4 v58, s[60:63], s16 offen offset:1024 lds
    v_mfma_f32_16x16x32_bf16 a[136:139], a[80:83], a[8:11], a[136:139]
    v_mfma_f32_16x16x32_bf16 a[136:139], a[84:87], a[40:43], a[136:139]
    v_mfma_f32_16x16x32_bf16 a[140:143], a[80:83], a[12:15], a[140:143]
    buffer_load_dwordx4 v59, s[60:63], s16 offen offset:2048 lds
    v_mfma_f32_16x16x32_bf16 a[140:143], a[84:87], a[44:47], a[140:143]
    v_mfma_f32_16x16x32_bf16 a[144:147], a[80:83], a[16:19], a[144:147]
    buffer_load_dwordx4 v1, s[60:63], s16 offen offset:3072 lds
    s_add_u32 s16, s16, s31
    v_mfma_f32_16x16x32_bf16 a[144:147], a[84:87], a[48:51], a[144:147]
    v_mfma_f32_16x16x32_bf16 a[148:151], a[80:83], a[20:23], a[148:151]
    v_mfma_f32_16x16x32_bf16 a[148:151], a[84:87], a[52:55], a[148:151]
    s_add_u32 s79, s18, 16384
    s_and_b32 s79, s79, 131071
    s_add_u32 m0, s24, s79
    s_nop 0
    buffer_load_dwordx4 v8, s[60:63], s16 offen offset:0 lds
    v_mfma_f32_16x16x32_bf16 a[152:155], a[80:83], a[24:27], a[152:155]
    v_mfma_f32_16x16x32_bf16 a[152:155], a[84:87], a[56:59], a[152:155]
    buffer_load_dwordx4 v58, s[60:63], s16 offen offset:1024 lds
    v_mfma_f32_16x16x32_bf16 a[156:159], a[80:83], a[28:31], a[156:159]
    v_mfma_f32_16x16x32_bf16 a[156:159], a[84:87], a[60:63], a[156:159]
    v_mfma_f32_16x16x32_bf16 a[160:163], a[88:91], a[0:3], a[160:163]
    buffer_load_dwordx4 v59, s[60:63], s16 offen offset:2048 lds
    v_mfma_f32_16x16x32_bf16 a[160:163], a[92:95], a[32:35], a[160:163]
    v_mfma_f32_16x16x32_bf16 a[164:167], a[88:91], a[4:7], a[164:167]
    buffer_load_dwordx4 v1, s[60:63], s16 offen offset:3072 lds
    s_add_u32 s16, s16, s31
    v_mfma_f32_16x16x32_bf16 a[164:167], a[92:95], a[36:39], a[164:167]
    v_mfma_f32_16x16x32_bf16 a[168:171], a[88:91], a[8:11], a[168:171]
    v_mfma_f32_16x16x32_bf16 a[168:171], a[92:95], a[40:43], a[168:171]
    s_add_u32 s79, s18, 32768
    s_and_b32 s79, s79, 131071
    s_add_u32 m0, s24, s79
    s_nop 0
    buffer_load_dwordx4 v8, s[60:63], s16 offen offset:0 lds
    v_mfma_f32_16x16x32_bf16 a[172:175], a[88:91], a[12:15], a[172:175]
    v_mfma_f32_16x16x32_bf16 a[172:175], a[92:95], a[44:47], a[172:175]
    buffer_load_dwordx4 v58, s[60:63], s16 offen offset:1024 lds
    v_mfma_f32_16x16x32_bf16 a[176:179], a[88:91], a[16:19], a[176:179]
    v_mfma_f32_16x16x32_bf16 a[176:179], a[92:95], a[48:51], a[176:179]
    v_mfma_f32_16x16x32_bf16 a[180:183], a[88:91], a[20:23], a[180:183]
    buffer_load_dwordx4 v59, s[60:63], s16 offen offset:2048 lds
    v_mfma_f32_16x16x32_bf16 a[180:183], a[92:95], a[52:55], a[180:183]
    v_mfma_f32_16x16x32_bf16 a[184:187], a[88:91], a[24:27], a[184:187]
    buffer_load_dwordx4 v1, s[60:63], s16 offen offset:3072 lds
    s_add_u32 s16, s16, s31
    v_mfma_f32_16x16x32_bf16 a[184:187], a[92:95], a[56:59], a[184:187]
    v_mfma_f32_16x16x32_bf16 a[188:191], a[88:91], a[28:31], a[188:191]
    v_mfma_f32_16x16x32_bf16 a[188:191], a[92:95], a[60:63], a[188:191]
    s_nop 7
    s_add_u32 s42, s50, 0
    s_add_u32 s41, s50, 2048
    v_pk_mul_f32 v[36:37], v[64:65], s[48:49]
    v_pk_mul_f32 v[64:65], v[64:65], v[192:193]
    v_pk_mul_f32 v[38:39], v[66:67], s[48:49]
    v_pk_mul_f32 v[66:67], v[66:67], v[194:195]
    v_pk_mul_f32 v[40:41], v[96:97], s[48:49]
    v_pk_mul_f32 v[96:97], v[96:97], v[224:225]
    v_pk_mul_f32 v[42:43], v[98:99], s[48:49]
    v_pk_mul_f32 v[98:99], v[98:99], v[226:227]
    v_exp_f32 v36, v36
    v_exp_f32 v37, v37
    v_exp_f32 v38, v38
    v_pk_add_f32 v[36:37], v[36:37], 1.0 op_sel_hi:[1,0]
    v_rcp_f32 v36, v36
    v_rcp_f32 v37, v37
    v_exp_f32 v39, v39
    v_pk_mul_f32 v[64:65], v[64:65], v[36:37]
    v_cvt_pk_bf16_f32 v12, v64, v65
    v_pk_add_f32 v[38:39], v[38:39], 1.0 op_sel_hi:[1,0]
    v_rcp_f32 v38, v38
    v_rcp_f32 v39, v39
    v_exp_f32 v40, v40
    v_pk_mul_f32 v[66:67], v[66:67], v[38:39]
    v_cvt_pk_bf16_f32 v13, v66, v67
    v_exp_f32 v41, v41
    v_exp_f32 v42, v42
    v_pk_add_f32 v[40:41], v[40:41], 1.0 op_sel_hi:[1,0]
    v_rcp_f32 v40, v40
    v_rcp_f32 v41, v41
    v_exp_f32 v43, v43
    v_pk_mul_f32 v[96:97], v[96:97], v[40:41]
    v_cvt_pk_bf16_f32 v14, v96, v97
    v_pk_add_f32 v[42:43], v[42:43], 1.0 op_sel_hi:[1,0]
    v_rcp_f32 v42, v42
    v_rcp_f32 v43, v43
    v_pk_mul_f32 v[36:37], v[68:69], s[48:49]
    v_pk_mul_f32 v[68:69], v[68:69], v[196:197]
    v_pk_mul_f32 v[98:99], v[98:99], v[42:43]
    v_cvt_pk_bf16_f32 v15, v98, v99
    buffer_load_dword v34, v32, s[68:71], s95 offen sc1
    buffer_store_dwordx4 v[12:15], v10, s[20:23], s42 offen sc1
    v_pk_mul_f32 v[38:39], v[70:71], s[48:49]
    v_pk_mul_f32 v[70:71], v[70:71], v[198:199]
    s_add_u32 s42, s50, 1024
    v_pk_mul_f32 v[40:41], v[100:101], s[48:49]
    v_pk_mul_f32 v[100:101], v[100:101], v[228:229]
    v_pk_mul_f32 v[42:43], v[102:103], s[48:49]
    v_pk_mul_f32 v[102:103], v[102:103], v[230:231]
    v_exp_f32 v36, v36
    v_exp_f32 v37, v37
    v_exp_f32 v38, v38
    v_pk_add_f32 v[36:37], v[36:37], 1.0 op_sel_hi:[1,0]
    v_rcp_f32 v36, v36
    v_rcp_f32 v37, v37
    v_exp_f32 v39, v39
    v_pk_mul_f32 v[68:69], v[68:69], v[36:37]
    v_cvt_pk_bf16_f32 v20, v68, v69
    v_pk_add_f32 v[38:39], v[38:39], 1.0 op_sel_hi:[1,0]
    v_rcp_f32 v38, v38
    v_rcp_f32 v39, v39
    v_exp_f32 v40, v40
    v_pk_mul_f32 v[70:71], v[70:71], v[38:39]
    v_cvt_pk_bf16_f32 v21, v70, v71
    v_exp_f32 v41, v41
    v_exp_f32 v42, v42
    v_pk_add_f32 v[40:41], v[40:41], 1.0 op_sel_hi:[1,0]
    v_rcp_f32 v40, v40
    v_rcp_f32 v41, v41
    v_exp_f32 v43, v43
    v_pk_mul_f32 v[100:101], v[100:101], v[40:41]
    v_cvt_pk_bf16_f32 v22, v100, v101
    v_pk_add_f32 v[42:43], v[42:43], 1.0 op_sel_hi:[1,0]
    v_rcp_f32 v42, v42
    v_rcp_f32 v43, v43
    v_accvgpr_read_b32 v196, a132
    v_pk_mul_f32 v[102:103], v[102:103], v[42:43]
    v_cvt_pk_bf16_f32 v23, v102, v103
    buffer_store_dwordx4 v[20:23], v10, s[20:23], s42 offen sc1
    v_accvgpr_read_b32 v197, a133
    v_accvgpr_read_b32 v198, a134
    v_accvgpr_read_b32 v199, a135
    v_accvgpr_read_b32 v228, a164
    v_accvgpr_read_b32 v229, a165
    v_accvgpr_read_b32 v230, a166
    v_accvgpr_read_b32 v231, a167
    v_pk_mul_f32 v[44:45], v[128:129], s[48:49]
    v_pk_mul_f32 v[46:47], v[130:131], s[48:49]
    v_accvgpr_read_b32 v192, a128
    v_accvgpr_read_b32 v193, a129
    v_pk_mul_f32 v[128:129], v[128:129], v[192:193]
    v_pk_mul_f32 v[48:49], v[160:161], s[48:49]
    v_accvgpr_read_b32 v194, a130
    v_accvgpr_read_b32 v195, a131
    v_pk_mul_f32 v[130:131], v[130:131], v[194:195]
    v_pk_mul_f32 v[50:51], v[162:163], s[48:49]
    v_accvgpr_read_b32 v224, a160
    v_accvgpr_read_b32 v225, a161
    v_pk_mul_f32 v[160:161], v[160:161], v[224:225]
    v_accvgpr_read_b32 v226, a162
    v_accvgpr_read_b32 v227, a163
    v_pk_mul_f32 v[162:163], v[162:163], v[226:227]
    v_exp_f32 v44, v44
    v_exp_f32 v45, v45
    v_exp_f32 v46, v46
    v_pk_add_f32 v[44:45], v[44:45], 1.0 op_sel_hi:[1,0]
    v_rcp_f32 v44, v44
    v_rcp_f32 v45, v45
    v_exp_f32 v47, v47
    v_pk_mul_f32 v[128:129], v[128:129], v[44:45]
    v_cvt_pk_bf16_f32 v16, v128, v129
    v_pk_mul_f32 v[44:45], v[132:133], s[48:49]
    v_pk_mul_f32 v[132:133], v[132:133], v[196:197]
    v_pk_add_f32 v[46:47], v[46:47], 1.0 op_sel_hi:[1,0]
    v_rcp_f32 v46, v46
    v_rcp_f32 v47, v47
    v_exp_f32 v44, v44
    v_pk_mul_f32 v[130:131], v[130:131], v[46:47]
    v_cvt_pk_bf16_f32 v17, v130, v131
    v_pk_mul_f32 v[46:47], v[134:135], s[48:49]
    v_pk_mul_f32 v[134:135], v[134:135], v[198:199]
    v_exp_f32 v45, v45
    v_exp_f32 v48, v48
    v_pk_add_f32 v[44:45], v[44:45], 1.0 op_sel_hi:[1,0]
    v_rcp_f32 v44, v44
    v_rcp_f32 v45, v45
    v_exp_f32 v49, v49
    v_pk_mul_f32 v[132:133], v[132:133], v[44:45]
    v_cvt_pk_bf16_f32 v52, v132, v133
    v_pk_add_f32 v[48:49], v[48:49], 1.0 op_sel_hi:[1,0]
    v_rcp_f32 v48, v48
    v_rcp_f32 v49, v49
    v_exp_f32 v46, v46
    v_pk_mul_f32 v[160:161], v[160:161], v[48:49]
    v_cvt_pk_bf16_f32 v18, v160, v161
    v_pk_mul_f32 v[48:49], v[164:165], s[48:49]
    v_pk_mul_f32 v[164:165], v[164:165], v[228:229]
    v_exp_f32 v47, v47
    v_exp_f32 v50, v50
    v_pk_add_f32 v[46:47], v[46:47], 1.0 op_sel_hi:[1,0]
    v_rcp_f32 v46, v46
    v_rcp_f32 v47, v47
    v_exp_f32 v51, v51
    v_pk_mul_f32 v[134:135], v[134:135], v[46:47]
    v_cvt_pk_bf16_f32 v53, v134, v135
    v_pk_add_f32 v[50:51], v[50:51], 1.0 op_sel_hi:[1,0]
    v_rcp_f32 v50, v50
    v_rcp_f32 v51, v51
    v_exp_f32 v48, v48
    v_pk_mul_f32 v[162:163], v[162:163], v[50:51]
    v_cvt_pk_bf16_f32 v19, v162, v163
    buffer_store_dwordx4 v[16:19], v10, s[20:23], s41 offen sc1
    v_pk_mul_f32 v[50:51], v[166:167], s[48:49]
    v_pk_mul_f32 v[166:167], v[166:167], v[230:231]
    s_add_u32 s41, s50, 3072
    s_add_u32 s42, s50, 229376
    v_exp_f32 v49, v49
    v_exp_f32 v50, v50
    v_pk_add_f32 v[48:49], v[48:49], 1.0 op_sel_hi:[1,0]
    v_rcp_f32 v48, v48
    v_rcp_f32 v49, v49
    v_exp_f32 v51, v51
    v_pk_mul_f32 v[164:165], v[164:165], v[48:49]
    v_cvt_pk_bf16_f32 v54, v164, v165
    v_pk_add_f32 v[50:51], v[50:51], 1.0 op_sel_hi:[1,0]
    v_rcp_f32 v50, v50
    v_rcp_f32 v51, v51
    v_pk_mul_f32 v[36:37], v[72:73], s[48:49]
    v_pk_mul_f32 v[166:167], v[166:167], v[50:51]
    v_cvt_pk_bf16_f32 v55, v166, v167
    buffer_store_dwordx4 v[52:55], v10, s[20:23], s41 offen sc1
    v_pk_mul_f32 v[72:73], v[72:73], v[200:201]
    v_pk_mul_f32 v[38:39], v[74:75], s[48:49]
    s_add_u32 s41, s50, 231424
    v_pk_mul_f32 v[74:75], v[74:75], v[202:203]
    v_pk_mul_f32 v[40:41], v[104:105], s[48:49]
    v_pk_mul_f32 v[104:105], v[104:105], v[232:233]
    v_pk_mul_f32 v[42:43], v[106:107], s[48:49]
    v_pk_mul_f32 v[106:107], v[106:107], v[234:235]
    v_exp_f32 v36, v36
    v_exp_f32 v37, v37
    v_exp_f32 v38, v38
    v_pk_add_f32 v[36:37], v[36:37], 1.0 op_sel_hi:[1,0]
    v_rcp_f32 v36, v36
    v_rcp_f32 v37, v37
    v_exp_f32 v39, v39
    v_pk_mul_f32 v[72:73], v[72:73], v[36:37]
    v_cvt_pk_bf16_f32 v12, v72, v73
    v_pk_mul_f32 v[36:37], v[76:77], s[48:49]
    v_pk_mul_f32 v[76:77], v[76:77], v[204:205]
    v_exp_f32 v36, v36
    v_exp_f32 v37, v37
    v_accvgpr_read_b32 v204, a140
    v_pk_add_f32 v[36:37], v[36:37], 1.0 op_sel_hi:[1,0]
    v_rcp_f32 v36, v36
    v_rcp_f32 v37, v37
    v_accvgpr_read_b32 v205, a141
    v_pk_mul_f32 v[76:77], v[76:77], v[36:37]
    v_cvt_pk_bf16_f32 v20, v76, v77
    v_pk_add_f32 v[38:39], v[38:39], 1.0 op_sel_hi:[1,0]
    v_rcp_f32 v38, v38
    v_rcp_f32 v39, v39
    v_exp_f32 v40, v40
    v_pk_mul_f32 v[74:75], v[74:75], v[38:39]
    v_cvt_pk_bf16_f32 v13, v74, v75
    v_pk_mul_f32 v[38:39], v[78:79], s[48:49]
    v_pk_mul_f32 v[78:79], v[78:79], v[206:207]
    v_exp_f32 v38, v38
    v_exp_f32 v39, v39
    v_accvgpr_read_b32 v206, a142
    v_pk_add_f32 v[38:39], v[38:39], 1.0 op_sel_hi:[1,0]
    v_rcp_f32 v38, v38
    v_rcp_f32 v39, v39
    v_accvgpr_read_b32 v207, a143
    v_pk_mul_f32 v[78:79], v[78:79], v[38:39]
    v_cvt_pk_bf16_f32 v21, v78, v79
    v_exp_f32 v41, v41
    v_exp_f32 v42, v42
    v_pk_add_f32 v[40:41], v[40:41], 1.0 op_sel_hi:[1,0]
    v_rcp_f32 v40, v40
    v_rcp_f32 v41, v41
    v_exp_f32 v43, v43
    v_pk_mul_f32 v[104:105], v[104:105], v[40:41]
    v_cvt_pk_bf16_f32 v14, v104, v105
    v_pk_mul_f32 v[40:41], v[108:109], s[48:49]
    v_pk_mul_f32 v[108:109], v[108:109], v[236:237]
    v_exp_f32 v40, v40
    v_exp_f32 v41, v41
    v_accvgpr_read_b32 v236, a172
    v_pk_add_f32 v[40:41], v[40:41], 1.0 op_sel_hi:[1,0]
    v_rcp_f32 v40, v40
    v_rcp_f32 v41, v41
    v_accvgpr_read_b32 v237, a173
    v_pk_mul_f32 v[108:109], v[108:109], v[40:41]
    v_cvt_pk_bf16_f32 v22, v108, v109
    v_pk_add_f32 v[42:43], v[42:43], 1.0 op_sel_hi:[1,0]
    v_rcp_f32 v42, v42
    v_rcp_f32 v43, v43
    v_pk_mul_f32 v[44:45], v[136:137], s[48:49]
    v_pk_mul_f32 v[106:107], v[106:107], v[42:43]
    v_cvt_pk_bf16_f32 v15, v106, v107
    buffer_store_dwordx4 v[12:15], v10, s[20:23], s42 offen sc1
    s_waitcnt vmcnt(5)
    v_sub_u32 v34, v34, v33
    v_cmp_lt_u32 s[56:57], 4, v34
    s_add_u32 m0, s93, 0
    s_add_u32 s94, s92, 0
    buffer_load_dwordx4 v28, s[68:71], s94 offen sc1 lds
    s_add_u32 m0, s93, 1024
    s_add_u32 s94, s92, 8192
    buffer_load_dwordx4 v29, s[68:71], s94 offen sc1 lds
    s_add_u32 m0, s93, 2048
    s_add_u32 s94, s92, 16384
    buffer_load_dwordx4 v30, s[68:71], s94 offen sc1 lds
    s_add_u32 m0, s93, 3072
    s_add_u32 s94, s92, 24576
    buffer_load_dwordx4 v31, s[68:71], s94 offen sc1 lds
    v_pk_mul_f32 v[42:43], v[110:111], s[48:49]
    v_pk_mul_f32 v[110:111], v[110:111], v[238:239]
    s_add_u32 s42, s50, 230400
    v_exp_f32 v42, v42
    v_exp_f32 v43, v43
    v_accvgpr_read_b32 v238, a174
    v_pk_add_f32 v[42:43], v[42:43], 1.0 op_sel_hi:[1,0]
    v_rcp_f32 v42, v42
    v_rcp_f32 v43, v43
    v_accvgpr_read_b32 v239, a175
    v_pk_mul_f32 v[110:111], v[110:111], v[42:43]
    v_cvt_pk_bf16_f32 v23, v110, v111
    buffer_store_dwordx4 v[20:23], v10, s[20:23], s42 offen sc1
    v_pk_mul_f32 v[46:47], v[138:139], s[48:49]
    v_accvgpr_read_b32 v200, a136
    v_accvgpr_read_b32 v201, a137
    v_pk_mul_f32 v[136:137], v[136:137], v[200:201]
    v_pk_mul_f32 v[48:49], v[168:169], s[48:49]
    v_accvgpr_read_b32 v202, a138
    v_accvgpr_read_b32 v203, a139
    v_pk_mul_f32 v[138:139], v[138:139], v[202:203]
    v_pk_mul_f32 v[50:51], v[170:171], s[48:49]
    v_accvgpr_read_b32 v232, a168
    v_accvgpr_read_b32 v233, a169
    v_pk_mul_f32 v[168:169], v[168:169], v[232:233]
    v_accvgpr_read_b32 v234, a170
    v_accvgpr_read_b32 v235, a171
    v_pk_mul_f32 v[170:171], v[170:171], v[234:235]
    v_pk_mul_f32 v[36:37], v[80:81], s[48:49]
    v_pk_mul_f32 v[80:81], v[80:81], v[208:209]
    v_pk_mul_f32 v[38:39], v[82:83], s[48:49]
    v_pk_mul_f32 v[82:83], v[82:83], v[210:211]
    v_pk_mul_f32 v[40:41], v[112:113], s[48:49]
    v_pk_mul_f32 v[112:113], v[112:113], v[240:241]
    v_pk_mul_f32 v[42:43], v[114:115], s[48:49]
    v_pk_mul_f32 v[114:115], v[114:115], v[242:243]
    v_exp_f32 v44, v44
    v_exp_f32 v45, v45
    v_exp_f32 v46, v46
    v_pk_add_f32 v[44:45], v[44:45], 1.0 op_sel_hi:[1,0]
    v_rcp_f32 v44, v44
    v_rcp_f32 v45, v45
    v_exp_f32 v47, v47
    v_pk_mul_f32 v[136:137], v[136:137], v[44:45]
    v_cvt_pk_bf16_f32 v16, v136, v137
    v_pk_mul_f32 v[44:45], v[140:141], s[48:49]
    v_pk_mul_f32 v[140:141], v[140:141], v[204:205]
    v_exp_f32 v44, v44
    v_exp_f32 v45, v45
    v_pk_add_f32 v[46:47], v[46:47], 1.0 op_sel_hi:[1,0]
    v_pk_add_f32 v[44:45], v[44:45], 1.0 op_sel_hi:[1,0]
    v_rcp_f32 v44, v44
    v_rcp_f32 v45, v45
    v_rcp_f32 v46, v46
    v_pk_mul_f32 v[140:141], v[140:141], v[44:45]
    v_cvt_pk_bf16_f32 v52, v140, v141
    v_rcp_f32 v47, v47
    v_exp_f32 v48, v48
    v_pk_mul_f32 v[138:139], v[138:139], v[46:47]
    v_cvt_pk_bf16_f32 v17, v138, v139
    v_pk_mul_f32 v[46:47], v[142:143], s[48:49]
    v_pk_mul_f32 v[142:143], v[142:143], v[206:207]
    v_exp_f32 v46, v46
    v_exp_f32 v47, v47
    v_exp_f32 v49, v49
    v_pk_add_f32 v[46:47], v[46:47], 1.0 op_sel_hi:[1,0]
    v_rcp_f32 v46, v46
    v_rcp_f32 v47, v47
    v_pk_add_f32 v[48:49], v[48:49], 1.0 op_sel_hi:[1,0]
    v_pk_mul_f32 v[142:143], v[142:143], v[46:47]
    v_cvt_pk_bf16_f32 v53, v142, v143
    v_rcp_f32 v48, v48
    v_rcp_f32 v49, v49
    v_exp_f32 v50, v50
    v_pk_mul_f32 v[168:169], v[168:169], v[48:49]
    v_cvt_pk_bf16_f32 v18, v168, v169
    v_pk_mul_f32 v[48:49], v[172:173], s[48:49]
    v_pk_mul_f32 v[172:173], v[172:173], v[236:237]
    v_exp_f32 v48, v48
    v_exp_f32 v49, v49
    v_exp_f32 v51, v51
    v_pk_add_f32 v[48:49], v[48:49], 1.0 op_sel_hi:[1,0]
    v_rcp_f32 v48, v48
    v_rcp_f32 v49, v49
    v_pk_add_f32 v[50:51], v[50:51], 1.0 op_sel_hi:[1,0]
    v_pk_mul_f32 v[172:173], v[172:173], v[48:49]
    v_cvt_pk_bf16_f32 v54, v172, v173
    v_rcp_f32 v50, v50
    v_rcp_f32 v51, v51
    v_exp_f32 v36, v36
    v_pk_mul_f32 v[170:171], v[170:171], v[50:51]
    v_cvt_pk_bf16_f32 v19, v170, v171
    buffer_store_dwordx4 v[16:19], v10, s[20:23], s41 offen sc1
    v_pk_mul_f32 v[50:51], v[174:175], s[48:49]
    v_pk_mul_f32 v[174:175], v[174:175], v[238:239]
    s_add_u32 s41, s50, 232448
    s_add_u32 s42, s50, 458752
    v_exp_f32 v50, v50
    v_exp_f32 v51, v51
    v_exp_f32 v37, v37
    v_pk_add_f32 v[50:51], v[50:51], 1.0 op_sel_hi:[1,0]
    v_rcp_f32 v50, v50
    v_rcp_f32 v51, v51
    v_pk_add_f32 v[36:37], v[36:37], 1.0 op_sel_hi:[1,0]
    v_pk_mul_f32 v[174:175], v[174:175], v[50:51]
    v_cvt_pk_bf16_f32 v55, v174, v175
    buffer_store_dwordx4 v[52:55], v10, s[20:23], s41 offen sc1
    v_rcp_f32 v36, v36
    v_rcp_f32 v37, v37
    s_add_u32 s41, s50, 460800
    v_pk_mul_f32 v[80:81], v[80:81], v[36:37]
    v_cvt_pk_bf16_f32 v12, v80, v81
    v_pk_mul_f32 v[36:37], v[84:85], s[48:49]
    v_pk_mul_f32 v[84:85], v[84:85], v[212:213]
    v_accvgpr_read_b32 v212, a148
    v_accvgpr_read_b32 v213, a149
    v_exp_f32 v36, v36
    v_exp_f32 v37, v37
    v_exp_f32 v38, v38
    v_pk_add_f32 v[36:37], v[36:37], 1.0 op_sel_hi:[1,0]
    v_rcp_f32 v36, v36
    v_rcp_f32 v37, v37
    v_exp_f32 v39, v39
    v_pk_mul_f32 v[84:85], v[84:85], v[36:37]
    v_cvt_pk_bf16_f32 v20, v84, v85
    v_pk_add_f32 v[38:39], v[38:39], 1.0 op_sel_hi:[1,0]
    v_rcp_f32 v38, v38
    v_rcp_f32 v39, v39
    v_pk_mul_f32 v[36:37], v[88:89], s[48:49]
    v_pk_mul_f32 v[82:83], v[82:83], v[38:39]
    v_cvt_pk_bf16_f32 v13, v82, v83
    v_pk_mul_f32 v[38:39], v[86:87], s[48:49]
    v_pk_mul_f32 v[86:87], v[86:87], v[214:215]
    v_accvgpr_read_b32 v214, a150
    v_accvgpr_read_b32 v215, a151
    v_pk_mul_f32 v[88:89], v[88:89], v[216:217]
    v_exp_f32 v38, v38
    v_exp_f32 v39, v39
    v_exp_f32 v40, v40
    v_pk_add_f32 v[38:39], v[38:39], 1.0 op_sel_hi:[1,0]
    v_rcp_f32 v38, v38
    v_rcp_f32 v39, v39
    v_exp_f32 v41, v41
    v_pk_mul_f32 v[86:87], v[86:87], v[38:39]
    v_cvt_pk_bf16_f32 v21, v86, v87
    v_pk_add_f32 v[40:41], v[40:41], 1.0 op_sel_hi:[1,0]
    v_rcp_f32 v40, v40
    v_rcp_f32 v41, v41
    v_pk_mul_f32 v[38:39], v[90:91], s[48:49]
    v_pk_mul_f32 v[112:113], v[112:113], v[40:41]
    v_cvt_pk_bf16_f32 v14, v112, v113
    v_pk_mul_f32 v[40:41], v[116:117], s[48:49]
    v_pk_mul_f32 v[116:117], v[116:117], v[244:245]
    v_accvgpr_read_b32 v244, a180
    v_accvgpr_read_b32 v245, a181
    v_pk_mul_f32 v[90:91], v[90:91], v[218:219]
    v_exp_f32 v40, v40
    v_exp_f32 v41, v41
    v_exp_f32 v42, v42
    v_pk_add_f32 v[40:41], v[40:41], 1.0 op_sel_hi:[1,0]
    v_rcp_f32 v40, v40
    v_rcp_f32 v41, v41
    v_exp_f32 v43, v43
    v_pk_mul_f32 v[116:117], v[116:117], v[40:41]
    v_cvt_pk_bf16_f32 v22, v116, v117
    v_pk_add_f32 v[42:43], v[42:43], 1.0 op_sel_hi:[1,0]
    v_rcp_f32 v42, v42
    v_rcp_f32 v43, v43
    v_pk_mul_f32 v[40:41], v[120:121], s[48:49]
    v_pk_mul_f32 v[114:115], v[114:115], v[42:43]
    v_cvt_pk_bf16_f32 v15, v114, v115
    buffer_store_dwordx4 v[12:15], v10, s[20:23], s42 offen sc1
    v_pk_mul_f32 v[42:43], v[118:119], s[48:49]
    v_pk_mul_f32 v[118:119], v[118:119], v[246:247]
    s_add_u32 s42, s50, 459776
    v_accvgpr_read_b32 v246, a182
    v_accvgpr_read_b32 v247, a183
    v_pk_mul_f32 v[120:121], v[120:121], v[248:249]
    v_exp_f32 v42, v42
    v_exp_f32 v43, v43
    v_pk_mul_f32 v[44:45], v[144:145], s[48:49]
    v_pk_add_f32 v[42:43], v[42:43], 1.0 op_sel_hi:[1,0]
    v_rcp_f32 v42, v42
    v_rcp_f32 v43, v43
    v_accvgpr_read_b32 v208, a144
    v_pk_mul_f32 v[118:119], v[118:119], v[42:43]
    v_cvt_pk_bf16_f32 v23, v118, v119
    buffer_store_dwordx4 v[20:23], v10, s[20:23], s42 offen sc1
    v_pk_mul_f32 v[42:43], v[122:123], s[48:49]
    v_pk_mul_f32 v[122:123], v[122:123], v[250:251]
    v_pk_mul_f32 v[46:47], v[146:147], s[48:49]
    v_accvgpr_read_b32 v209, a145
    v_pk_mul_f32 v[144:145], v[144:145], v[208:209]
    v_pk_mul_f32 v[48:49], v[176:177], s[48:49]
    v_accvgpr_read_b32 v210, a146
    v_accvgpr_read_b32 v211, a147
    v_pk_mul_f32 v[146:147], v[146:147], v[210:211]
    v_pk_mul_f32 v[50:51], v[178:179], s[48:49]
    v_accvgpr_read_b32 v240, a176
    v_accvgpr_read_b32 v241, a177
    v_pk_mul_f32 v[176:177], v[176:177], v[240:241]
    v_accvgpr_read_b32 v242, a178
    v_accvgpr_read_b32 v243, a179
    v_pk_mul_f32 v[178:179], v[178:179], v[242:243]
    v_accvgpr_read_b32 v216, a152
    v_accvgpr_read_b32 v217, a153
    v_accvgpr_read_b32 v218, a154
    v_accvgpr_read_b32 v219, a155
    v_accvgpr_read_b32 v248, a184
    v_accvgpr_read_b32 v249, a185
    v_accvgpr_read_b32 v250, a186
    v_accvgpr_read_b32 v251, a187
    v_exp_f32 v36, v36
    v_exp_f32 v37, v37
    v_exp_f32 v38, v38
    v_pk_add_f32 v[36:37], v[36:37], 1.0 op_sel_hi:[1,0]
    v_rcp_f32 v36, v36
    v_rcp_f32 v37, v37
    v_exp_f32 v39, v39
    v_pk_mul_f32 v[88:89], v[88:89], v[36:37]
    v_cvt_pk_bf16_f32 v12, v88, v89
    v_pk_mul_f32 v[36:37], v[92:93], s[48:49]
    v_pk_mul_f32 v[92:93], v[92:93], v[220:221]
    v_accvgpr_read_b32 v220, a156
    v_accvgpr_read_b32 v221, a157
    v_exp_f32 v36, v36
    v_exp_f32 v37, v37
    v_pk_add_f32 v[38:39], v[38:39], 1.0 op_sel_hi:[1,0]
    v_pk_add_f32 v[36:37], v[36:37], 1.0 op_sel_hi:[1,0]
    v_rcp_f32 v36, v36
    v_rcp_f32 v37, v37
    v_rcp_f32 v38, v38
    v_pk_mul_f32 v[92:93], v[92:93], v[36:37]
    v_cvt_pk_bf16_f32 v20, v92, v93
    v_rcp_f32 v39, v39
    v_exp_f32 v40, v40
    v_pk_mul_f32 v[90:91], v[90:91], v[38:39]
    v_cvt_pk_bf16_f32 v13, v90, v91
    v_pk_mul_f32 v[38:39], v[94:95], s[48:49]
    v_pk_mul_f32 v[94:95], v[94:95], v[222:223]
    v_accvgpr_read_b32 v222, a158
    v_accvgpr_read_b32 v223, a159
    v_exp_f32 v38, v38
    v_exp_f32 v39, v39
    v_exp_f32 v41, v41
    v_pk_add_f32 v[38:39], v[38:39], 1.0 op_sel_hi:[1,0]
    v_rcp_f32 v38, v38
    v_rcp_f32 v39, v39
    v_pk_add_f32 v[40:41], v[40:41], 1.0 op_sel_hi:[1,0]
    v_pk_mul_f32 v[94:95], v[94:95], v[38:39]
    v_cvt_pk_bf16_f32 v21, v94, v95
    v_rcp_f32 v40, v40
    v_rcp_f32 v41, v41
    v_exp_f32 v42, v42
    v_pk_mul_f32 v[120:121], v[120:121], v[40:41]
    v_cvt_pk_bf16_f32 v14, v120, v121
    v_pk_mul_f32 v[40:41], v[124:125], s[48:49]
    v_pk_mul_f32 v[124:125], v[124:125], v[252:253]
    v_accvgpr_read_b32 v252, a188
    v_accvgpr_read_b32 v253, a189
    v_exp_f32 v40, v40
    v_exp_f32 v41, v41
    v_exp_f32 v43, v43
    v_pk_add_f32 v[40:41], v[40:41], 1.0 op_sel_hi:[1,0]
    v_rcp_f32 v40, v40
    v_rcp_f32 v41, v41
    v_pk_add_f32 v[42:43], v[42:43], 1.0 op_sel_hi:[1,0]
    v_pk_mul_f32 v[124:125], v[124:125], v[40:41]
    v_cvt_pk_bf16_f32 v22, v124, v125
    v_rcp_f32 v42, v42
    v_rcp_f32 v43, v43
    v_exp_f32 v44, v44
    v_pk_mul_f32 v[122:123], v[122:123], v[42:43]
    v_cvt_pk_bf16_f32 v15, v122, v123
    v_pk_mul_f32 v[42:43], v[126:127], s[48:49]
    v_pk_mul_f32 v[126:127], v[126:127], v[254:255]
    v_accvgpr_read_b32 v254, a190
    v_accvgpr_read_b32 v255, a191
    v_exp_f32 v42, v42
    v_exp_f32 v43, v43
    v_exp_f32 v45, v45
    v_pk_add_f32 v[42:43], v[42:43], 1.0 op_sel_hi:[1,0]
    v_rcp_f32 v42, v42
    v_rcp_f32 v43, v43
    v_pk_add_f32 v[44:45], v[44:45], 1.0 op_sel_hi:[1,0]
    v_pk_mul_f32 v[126:127], v[126:127], v[42:43]
    v_cvt_pk_bf16_f32 v23, v126, v127
    v_rcp_f32 v44, v44
    v_rcp_f32 v45, v45
    v_exp_f32 v46, v46
    v_pk_mul_f32 v[144:145], v[144:145], v[44:45]
    v_cvt_pk_bf16_f32 v16, v144, v145
    v_pk_mul_f32 v[44:45], v[148:149], s[48:49]
    v_pk_mul_f32 v[148:149], v[148:149], v[212:213]
    v_exp_f32 v44, v44
    v_exp_f32 v45, v45
    v_exp_f32 v47, v47
    v_pk_add_f32 v[44:45], v[44:45], 1.0 op_sel_hi:[1,0]
    v_rcp_f32 v44, v44
    v_rcp_f32 v45, v45
    v_pk_add_f32 v[46:47], v[46:47], 1.0 op_sel_hi:[1,0]
    v_pk_mul_f32 v[148:149], v[148:149], v[44:45]
    v_cvt_pk_bf16_f32 v52, v148, v149
    v_rcp_f32 v46, v46
    v_rcp_f32 v47, v47
    v_pk_mul_f32 v[44:45], v[152:153], s[48:49]
    v_pk_mul_f32 v[146:147], v[146:147], v[46:47]
    v_cvt_pk_bf16_f32 v17, v146, v147
    v_pk_mul_f32 v[46:47], v[150:151], s[48:49]
    v_pk_mul_f32 v[150:151], v[150:151], v[214:215]
    v_pk_mul_f32 v[152:153], v[152:153], v[216:217]
    v_exp_f32 v46, v46
    v_exp_f32 v47, v47
    v_exp_f32 v48, v48
    v_pk_add_f32 v[46:47], v[46:47], 1.0 op_sel_hi:[1,0]
    v_rcp_f32 v46, v46
    v_rcp_f32 v47, v47
    v_exp_f32 v49, v49
    v_pk_mul_f32 v[150:151], v[150:151], v[46:47]
    v_cvt_pk_bf16_f32 v53, v150, v151
    v_pk_add_f32 v[48:49], v[48:49], 1.0 op_sel_hi:[1,0]
    v_rcp_f32 v48, v48
    v_rcp_f32 v49, v49
    v_pk_mul_f32 v[46:47], v[154:155], s[48:49]
    v_pk_mul_f32 v[176:177], v[176:177], v[48:49]
    v_cvt_pk_bf16_f32 v18, v176, v177
    v_pk_mul_f32 v[48:49], v[180:181], s[48:49]
    v_pk_mul_f32 v[180:181], v[180:181], v[244:245]
    v_pk_mul_f32 v[154:155], v[154:155], v[218:219]
    v_exp_f32 v48, v48
    v_exp_f32 v49, v49
    v_exp_f32 v50, v50
    v_pk_add_f32 v[48:49], v[48:49], 1.0 op_sel_hi:[1,0]
    v_rcp_f32 v48, v48
    v_rcp_f32 v49, v49
    v_exp_f32 v51, v51
    v_pk_mul_f32 v[180:181], v[180:181], v[48:49]
    v_cvt_pk_bf16_f32 v54, v180, v181
    v_pk_add_f32 v[50:51], v[50:51], 1.0 op_sel_hi:[1,0]
    v_rcp_f32 v50, v50
    v_rcp_f32 v51, v51
    v_pk_mul_f32 v[48:49], v[184:185], s[48:49]
    v_pk_mul_f32 v[178:179], v[178:179], v[50:51]
    v_cvt_pk_bf16_f32 v19, v178, v179
    buffer_store_dwordx4 v[16:19], v10, s[20:23], s41 offen sc1
    v_pk_mul_f32 v[50:51], v[182:183], s[48:49]
    v_pk_mul_f32 v[182:183], v[182:183], v[246:247]
    s_add_u32 s41, s50, 461824
    s_add_u32 s42, s50, 688128
    buffer_store_dwordx4 v[12:15], v10, s[20:23], s42 offen sc1
    v_pk_mul_f32 v[184:185], v[184:185], v[248:249]
    v_exp_f32 v50, v50
    v_exp_f32 v51, v51
    v_exp_f32 v44, v44
    v_pk_add_f32 v[50:51], v[50:51], 1.0 op_sel_hi:[1,0]
    v_rcp_f32 v50, v50
    v_rcp_f32 v51, v51
    v_exp_f32 v45, v45
    v_pk_mul_f32 v[182:183], v[182:183], v[50:51]
    v_cvt_pk_bf16_f32 v55, v182, v183
    buffer_store_dwordx4 v[52:55], v10, s[20:23], s41 offen sc1
    v_pk_mul_f32 v[50:51], v[186:187], s[48:49]
    v_pk_mul_f32 v[186:187], v[186:187], v[250:251]
    s_add_u32 s41, s50, 690176
    s_add_u32 s42, s50, 689152
    buffer_store_dwordx4 v[20:23], v10, s[20:23], s42 offen sc1
    v_pk_add_f32 v[44:45], v[44:45], 1.0 op_sel_hi:[1,0]
    v_rcp_f32 v44, v44
    v_rcp_f32 v45, v45
    v_exp_f32 v46, v46
    v_pk_mul_f32 v[152:153], v[152:153], v[44:45]
    v_cvt_pk_bf16_f32 v16, v152, v153
    v_pk_mul_f32 v[44:45], v[156:157], s[48:49]
    v_pk_mul_f32 v[156:157], v[156:157], v[220:221]
    v_exp_f32 v44, v44
    v_exp_f32 v45, v45
    v_exp_f32 v47, v47
    v_pk_add_f32 v[44:45], v[44:45], 1.0 op_sel_hi:[1,0]
    v_rcp_f32 v44, v44
    v_rcp_f32 v45, v45
    v_pk_add_f32 v[46:47], v[46:47], 1.0 op_sel_hi:[1,0]
    v_pk_mul_f32 v[156:157], v[156:157], v[44:45]
    v_cvt_pk_bf16_f32 v52, v156, v157
    v_rcp_f32 v46, v46
    v_rcp_f32 v47, v47
    v_exp_f32 v48, v48
    v_pk_mul_f32 v[154:155], v[154:155], v[46:47]
    v_cvt_pk_bf16_f32 v17, v154, v155
    v_pk_mul_f32 v[46:47], v[158:159], s[48:49]
    v_pk_mul_f32 v[158:159], v[158:159], v[222:223]
    v_exp_f32 v46, v46
    v_exp_f32 v47, v47
    v_exp_f32 v49, v49
    v_pk_add_f32 v[46:47], v[46:47], 1.0 op_sel_hi:[1,0]
    v_rcp_f32 v46, v46
    v_rcp_f32 v47, v47
    v_pk_add_f32 v[48:49], v[48:49], 1.0 op_sel_hi:[1,0]
    v_pk_mul_f32 v[158:159], v[158:159], v[46:47]
    v_cvt_pk_bf16_f32 v53, v158, v159
    v_rcp_f32 v48, v48
    v_rcp_f32 v49, v49
    v_exp_f32 v50, v50
    v_pk_mul_f32 v[184:185], v[184:185], v[48:49]
    v_cvt_pk_bf16_f32 v18, v184, v185
    v_pk_mul_f32 v[48:49], v[188:189], s[48:49]
    v_pk_mul_f32 v[188:189], v[188:189], v[252:253]
    v_exp_f32 v48, v48
    v_exp_f32 v49, v49
    v_exp_f32 v51, v51
    v_pk_add_f32 v[48:49], v[48:49], 1.0 op_sel_hi:[1,0]
    v_rcp_f32 v48, v48
    v_rcp_f32 v49, v49
    v_pk_add_f32 v[50:51], v[50:51], 1.0 op_sel_hi:[1,0]
    v_pk_mul_f32 v[188:189], v[188:189], v[48:49]
    v_cvt_pk_bf16_f32 v54, v188, v189
    v_rcp_f32 v50, v50
    v_rcp_f32 v51, v51
    s_nop 0
    v_pk_mul_f32 v[186:187], v[186:187], v[50:51]
    v_cvt_pk_bf16_f32 v19, v186, v187
    buffer_store_dwordx4 v[16:19], v10, s[20:23], s41 offen sc1
    v_pk_mul_f32 v[50:51], v[190:191], s[48:49]
    v_pk_mul_f32 v[190:191], v[190:191], v[254:255]
    s_add_u32 s41, s50, 691200
    v_exp_f32 v50, v50
    v_exp_f32 v51, v51
    s_nop 0
    v_pk_add_f32 v[50:51], v[50:51], 1.0 op_sel_hi:[1,0]
    v_rcp_f32 v50, v50
    v_rcp_f32 v51, v51
    s_nop 0
    v_pk_mul_f32 v[190:191], v[190:191], v[50:51]
    v_cvt_pk_bf16_f32 v55, v190, v191
    buffer_store_dwordx4 v[52:55], v10, s[20:23], s41 offen sc1
    s_waitcnt vmcnt(11)
    s_mov_b32 s34, 1
    s_cmp_eq_u64 s[56:57], 0
    s_cbranch_scc1 Lzg_37
    s_waitcnt vmcnt(0)
    buffer_store_dword v57, v56, s[68:71], s59 offen sc1
    s_mov_b32 s34, 0
Ltail:
    s_mov_b32 s41, 100000
Lzp_35:
    buffer_load_dword v34, v32, s[68:71], s95 offen sc1
    s_waitcnt vmcnt(0)
    v_sub_u32 v34, v34, v33
    v_cmp_lt_u32 vcc, 4, v34
    s_sub_u32 s41, s41, 1
    s_cbranch_scc1 Lzd_36
    s_cbranch_vccz Lzd_36
    s_sleep 8
    s_branch Lzp_35
Lzd_36:
    s_add_u32 m0, s93, 0
    s_add_u32 s94, s92, 0
    buffer_load_dwordx4 v28, s[68:71], s94 offen sc1 lds
    s_add_u32 m0, s93, 1024
    s_add_u32 s94, s92, 8192
    buffer_load_dwordx4 v29, s[68:71], s94 offen sc1 lds
    s_add_u32 m0, s93, 2048
    s_add_u32 s94, s92, 16384
    buffer_load_dwordx4 v30, s[68:71], s94 offen sc1 lds
    s_add_u32 m0, s93, 3072
    s_add_u32 s94, s92, 24576
    buffer_load_dwordx4 v31, s[68:71], s94 offen sc1 lds
    s_waitcnt vmcnt(0)
Lzg_37:
    s_barrier
    s_cmp_eq_u32 s34, 0
    s_cbranch_scc1 Lhs_38
    s_waitcnt vmcnt(0)
    buffer_store_dword v57, v56, s[68:71], s59 offen sc1
Lhs_38:
    v_lshrrev_b32 v41, 5, v11
    s_lshl_b32 s85, s38, 1
    v_lshl_add_u32 v42, v41, 3, s85
    v_and_b32 v43, 15, v11
    v_and_b32 v40, 31, v11
    v_xor_b32 v42, v42, v43
    v_lshlrev_b32 v43, 9, v40
    v_lshl_add_u32 v32, v42, 4, v43
    s_mov_b32 s86, 131072
    v_add_u32 v32, s86, v32
    v_xor_b32 v33, 16, v32
    ds_read_b128 v[224:227], v32
    ds_read_b128 v[232:235], v33
    ds_read_b128 v[228:231], v32 offset:256
    ds_read_b128 v[236:239], v33 offset:256
    v_bfe_u32 v42, v11, 1, 2
    s_lshl_b32 s87, s38, 12
    v_xor_b32 v42, v42, v41
    s_add_u32 s88, s87, 147456
    v_lshlrev_b32 v42, 4, v42
    s_lshl_b32 s84, s2, 14
    v_lshl_add_u32 v42, v40, 6, v42
    s_add_u32 s84, s84, s87
    v_lshlrev_b32 v40, 31, v11
    s_add_u32 s84, s84, 25165824
    v_or_b32 v40, 1.0, v40
    v_cmp_gt_u32 vcc, 32, v11
    v_accvgpr_read_b32 v80, a224
    v_accvgpr_read_b32 v81, a225
    v_accvgpr_read_b32 v82, a226
    v_accvgpr_read_b32 v83, a227
    v_accvgpr_read_b32 v84, a228
    v_accvgpr_read_b32 v85, a229
    v_accvgpr_read_b32 v86, a230
    v_accvgpr_read_b32 v87, a231
    s_waitcnt lgkmcnt(3)
    v_mfma_f32_32x32x16_bf16 v[112:127], v[224:227], a[248:251], 0
    v_readlane_b32 s89, v224, 0
    s_waitcnt lgkmcnt(2)
    v_readlane_b32 s90, v232, 0
    s_and_b32 s89, s89, 0xffff0000
    v_accvgpr_read_b32 v88, a232
    v_accvgpr_read_b32 v89, a233
    v_mfma_f32_32x32x16_bf16 v[144:159], v[232:235], a[248:251], 0
    v_accvgpr_read_b32 v90, a234
    v_accvgpr_read_b32 v91, a235
    v_accvgpr_read_b32 v92, a236
    v_accvgpr_read_b32 v93, a237
    v_accvgpr_read_b32 v94, a238
    v_mfma_f32_32x32x16_bf16 v[96:111], v[224:227], a[240:243], 0
    v_accvgpr_read_b32 v95, a239
    v_cndmask_b32 v35, 0, v40, vcc
    s_and_b32 s90, s90, 0xffff0000
    v_accvgpr_read_b32 v64, a208
    v_accvgpr_read_b32 v65, a209
    v_mfma_f32_32x32x16_bf16 v[128:143], v[232:235], a[240:243], 0
    v_accvgpr_read_b32 v66, a210
    v_accvgpr_read_b32 v67, a211
    v_accvgpr_read_b32 v68, a212
    v_accvgpr_read_b32 v69, a213
    v_accvgpr_read_b32 v70, a214
    s_waitcnt lgkmcnt(1)
    v_mfma_f32_32x32x16_bf16 v[112:127], v[228:231], a[252:255], v[112:127]
    v_accvgpr_read_b32 v71, a215
    v_accvgpr_read_b32 v72, a216
    v_accvgpr_read_b32 v73, a217
    v_accvgpr_read_b32 v74, a218
    v_accvgpr_read_b32 v75, a219
    s_add_u32 s79, s18, 49152
    s_and_b32 s79, s79, 131071
    s_add_u32 m0, s24, s79
    s_nop 0
    buffer_load_dwordx4 v8, s[60:63], s16 offen offset:0 lds
    s_waitcnt lgkmcnt(0)
    v_mfma_f32_32x32x16_bf16 v[144:159], v[236:239], a[252:255], v[144:159]
    v_accvgpr_read_b32 v76, a220
    v_accvgpr_read_b32 v77, a221
    v_accvgpr_read_b32 v78, a222
    v_accvgpr_read_b32 v79, a223
    v_add_u32 v34, s88, v42
    v_mfma_f32_32x32x16_bf16 v[96:111], v[228:231], a[244:247], v[96:111]
    buffer_load_dwordx4 v58, s[60:63], s16 offen offset:1024 lds
    v_bfe_u32 v42, v11, 3, 2
    v_lshlrev_b32 v42, 4, v42
    v_xor_b32 v37, 32, v34
    v_xor_b32 v42, v42, v10
    v_add_u32 v36, s88, v42
    v_mfma_f32_32x32x16_bf16 v[128:143], v[236:239], a[244:247], v[128:143]
    s_nop 5
    v_fmac_f32 v96, s89, v35
    v_pk_mul_f32 v[192:193], v[112:113], v[80:81]
    buffer_load_dwordx4 v59, s[60:63], s16 offen offset:2048 lds
    v_pk_mul_f32 v[194:195], v[114:115], v[82:83]
    v_pk_mul_f32 v[196:197], v[116:117], v[84:85]
    v_pk_mul_f32 v[198:199], v[118:119], v[86:87]
    v_pk_mul_f32 v[200:201], v[120:121], v[88:89]
    v_pk_mul_f32 v[202:203], v[122:123], v[90:91]
    v_pk_mul_f32 v[204:205], v[124:125], v[92:93]
    v_pk_mul_f32 v[206:207], v[126:127], v[94:95]
    v_pk_mul_f32 v[208:209], v[144:145], v[80:81]
    v_pk_mul_f32 v[210:211], v[146:147], v[82:83]
    buffer_load_dwordx4 v1, s[60:63], s16 offen offset:3072 lds
    s_add_u32 s16, s16, s31
    v_pk_mul_f32 v[212:213], v[148:149], v[84:85]
    v_pk_mul_f32 v[214:215], v[150:151], v[86:87]
    v_pk_mul_f32 v[216:217], v[152:153], v[88:89]
    v_pk_mul_f32 v[218:219], v[154:155], v[90:91]
    v_pk_mul_f32 v[220:221], v[156:157], v[92:93]
    v_pk_mul_f32 v[222:223], v[158:159], v[94:95]
    v_pk_mul_f32 v[112:113], v[112:113], v[64:65]
    v_pk_fma_f32 v[192:193], v[96:97], v[64:65], v[192:193]
    s_add_u32 s79, s18, 65536
    s_and_b32 s79, s79, 131071
    s_add_u32 m0, s24, s79
    s_nop 0
    buffer_load_dwordx4 v8, s[60:63], s16 offen offset:0 lds
    v_pk_mul_f32 v[114:115], v[114:115], v[66:67]
    v_pk_fma_f32 v[194:195], v[98:99], v[66:67], v[194:195]
    v_pk_mul_f32 v[116:117], v[116:117], v[68:69]
    v_pk_fma_f32 v[196:197], v[100:101], v[68:69], v[196:197]
    v_pk_mul_f32 v[118:119], v[118:119], v[70:71]
    v_pk_fma_f32 v[198:199], v[102:103], v[70:71], v[198:199]
    v_pk_mul_f32 v[120:121], v[120:121], v[72:73]
    v_pk_mul_f32 v[122:123], v[122:123], v[74:75]
    v_pk_mul_f32 v[124:125], v[124:125], v[76:77]
    buffer_load_dwordx4 v58, s[60:63], s16 offen offset:1024 lds
    v_pk_mul_f32 v[126:127], v[126:127], v[78:79]
    v_pk_mul_f32 v[144:145], v[144:145], v[64:65]
    v_pk_mul_f32 v[146:147], v[146:147], v[66:67]
    v_pk_fma_f32 v[210:211], v[130:131], v[66:67], v[210:211]
    v_pk_mul_f32 v[148:149], v[148:149], v[68:69]
    v_pk_fma_f32 v[212:213], v[132:133], v[68:69], v[212:213]
    v_pk_mul_f32 v[150:151], v[150:151], v[70:71]
    v_pk_fma_f32 v[214:215], v[134:135], v[70:71], v[214:215]
    v_pk_mul_f32 v[152:153], v[152:153], v[72:73]
    buffer_load_dwordx4 v59, s[60:63], s16 offen offset:2048 lds
    v_pk_mul_f32 v[154:155], v[154:155], v[74:75]
    v_pk_mul_f32 v[156:157], v[156:157], v[76:77]
    v_pk_mul_f32 v[158:159], v[158:159], v[78:79]
    v_pk_fma_f32 v[112:113], v[96:97], v[80:81], v[112:113] neg_lo:[0,1,0] neg_hi:[0,1,0]
    v_pk_fma_f32 v[114:115], v[98:99], v[82:83], v[114:115] neg_lo:[0,1,0] neg_hi:[0,1,0]
    v_pk_fma_f32 v[116:117], v[100:101], v[84:85], v[116:117] neg_lo:[0,1,0] neg_hi:[0,1,0]
    v_pk_fma_f32 v[118:119], v[102:103], v[86:87], v[118:119] neg_lo:[0,1,0] neg_hi:[0,1,0]
    v_pk_fma_f32 v[200:201], v[104:105], v[72:73], v[200:201]
    buffer_load_dwordx4 v1, s[60:63], s16 offen offset:3072 lds
    s_add_u32 s16, s16, s31
    v_pk_fma_f32 v[120:121], v[104:105], v[88:89], v[120:121] neg_lo:[0,1,0] neg_hi:[0,1,0]
    v_pk_fma_f32 v[202:203], v[106:107], v[74:75], v[202:203]
    v_pk_fma_f32 v[122:123], v[106:107], v[90:91], v[122:123] neg_lo:[0,1,0] neg_hi:[0,1,0]
    v_pk_fma_f32 v[204:205], v[108:109], v[76:77], v[204:205]
    v_pk_fma_f32 v[124:125], v[108:109], v[92:93], v[124:125] neg_lo:[0,1,0] neg_hi:[0,1,0]
    v_pk_fma_f32 v[206:207], v[110:111], v[78:79], v[206:207]
    v_pk_fma_f32 v[126:127], v[110:111], v[94:95], v[126:127] neg_lo:[0,1,0] neg_hi:[0,1,0]
    v_pk_fma_f32 v[146:147], v[130:131], v[82:83], v[146:147] neg_lo:[0,1,0] neg_hi:[0,1,0]
    v_pk_fma_f32 v[148:149], v[132:133], v[84:85], v[148:149] neg_lo:[0,1,0] neg_hi:[0,1,0]
    s_add_u32 s79, s18, 81920
    s_and_b32 s79, s79, 131071
    s_add_u32 m0, s24, s79
    s_nop 0
    buffer_load_dwordx4 v8, s[60:63], s16 offen offset:0 lds
    v_pk_fma_f32 v[150:151], v[134:135], v[86:87], v[150:151] neg_lo:[0,1,0] neg_hi:[0,1,0]
    v_pk_fma_f32 v[216:217], v[136:137], v[72:73], v[216:217]
    v_pk_fma_f32 v[152:153], v[136:137], v[88:89], v[152:153] neg_lo:[0,1,0] neg_hi:[0,1,0]
    v_pk_fma_f32 v[218:219], v[138:139], v[74:75], v[218:219]
    v_pk_fma_f32 v[154:155], v[138:139], v[90:91], v[154:155] neg_lo:[0,1,0] neg_hi:[0,1,0]
    v_pk_fma_f32 v[220:221], v[140:141], v[76:77], v[220:221]
    v_pk_fma_f32 v[156:157], v[140:141], v[92:93], v[156:157] neg_lo:[0,1,0] neg_hi:[0,1,0]
    v_pk_fma_f32 v[222:223], v[142:143], v[78:79], v[222:223]
    v_pk_fma_f32 v[158:159], v[142:143], v[94:95], v[158:159] neg_lo:[0,1,0] neg_hi:[0,1,0]
    buffer_load_dwordx4 v58, s[60:63], s16 offen offset:1024 lds
    v_fmac_f32 v128, s90, v35
    v_pk_fma_f32 v[208:209], v[128:129], v[64:65], v[208:209]
    v_pk_fma_f32 v[144:145], v[128:129], v[80:81], v[144:145] neg_lo:[0,1,0] neg_hi:[0,1,0]
    v_cvt_pk_bf16_f32 v160, v192, v193
    v_cvt_pk_bf16_f32 v161, v194, v195
    v_cvt_pk_bf16_f32 v162, v196, v197
    v_cvt_pk_bf16_f32 v163, v198, v199
    v_cvt_pk_bf16_f32 v176, v208, v209
    v_cvt_pk_bf16_f32 v177, v210, v211
    buffer_load_dwordx4 v59, s[60:63], s16 offen offset:2048 lds
    v_mfma_f32_32x32x16_bf16 v[96:111], v[160:163], a[192:195], 0
    v_cvt_pk_bf16_f32 v178, v212, v213
    v_cvt_pk_bf16_f32 v179, v214, v215
    v_cvt_pk_bf16_f32 v164, v200, v201
    v_cvt_pk_bf16_f32 v165, v202, v203
    v_cvt_pk_bf16_f32 v166, v204, v205
    v_mfma_f32_32x32x16_bf16 v[128:143], v[176:179], a[192:195], 0
    v_cvt_pk_bf16_f32 v167, v206, v207
    buffer_load_dwordx4 v1, s[60:63], s16 offen offset:3072 lds
    s_add_u32 s16, s16, s31
    v_cvt_pk_bf16_f32 v180, v216, v217
    v_cvt_pk_bf16_f32 v181, v218, v219
    v_cvt_pk_bf16_f32 v182, v220, v221
    v_cvt_pk_bf16_f32 v183, v222, v223
    v_mfma_f32_32x32x16_bf16 v[96:111], v[164:167], a[196:199], v[96:111]
    v_cvt_pk_bf16_f32 v168, v112, v113
    v_cvt_pk_bf16_f32 v169, v114, v115
    v_cvt_pk_bf16_f32 v170, v116, v117
    v_cvt_pk_bf16_f32 v171, v118, v119
    s_add_u32 s79, s18, 98304
    s_and_b32 s79, s79, 131071
    s_add_u32 m0, s24, s79
    s_nop 0
    buffer_load_dwordx4 v8, s[60:63], s16 offen offset:0 lds
    v_cvt_pk_bf16_f32 v184, v144, v145
    v_mfma_f32_32x32x16_bf16 v[128:143], v[180:183], a[196:199], v[128:143]
    v_cvt_pk_bf16_f32 v185, v146, v147
    v_cvt_pk_bf16_f32 v186, v148, v149
    v_cvt_pk_bf16_f32 v187, v150, v151
    v_cvt_pk_bf16_f32 v172, v120, v121
    v_cvt_pk_bf16_f32 v173, v122, v123
    v_mfma_f32_32x32x16_bf16 v[96:111], v[168:171], a[200:203], v[96:111]
    v_cvt_pk_bf16_f32 v174, v124, v125
    buffer_load_dwordx4 v58, s[60:63], s16 offen offset:1024 lds
    v_cvt_pk_bf16_f32 v175, v126, v127
    v_cvt_pk_bf16_f32 v188, v152, v153
    v_cvt_pk_bf16_f32 v189, v154, v155
    v_cvt_pk_bf16_f32 v190, v156, v157
    v_mfma_f32_32x32x16_bf16 v[128:143], v[184:187], a[200:203], v[128:143]
    v_cvt_pk_bf16_f32 v191, v158, v159
    v_mfma_f32_32x32x16_bf16 v[96:111], v[172:175], a[204:207], v[96:111]
    s_nop 0
    buffer_load_dwordx4 v59, s[60:63], s16 offen offset:2048 lds
    v_mfma_f32_32x32x16_bf16 v[128:143], v[188:191], a[204:207], v[128:143]
    s_nop 9
    v_cvt_pk_bf16_f32 v192, v96, v97
    v_cvt_pk_bf16_f32 v193, v98, v99
    v_cvt_pk_bf16_f32 v194, v104, v105
    v_cvt_pk_bf16_f32 v195, v106, v107
    v_cvt_pk_bf16_f32 v196, v100, v101
    v_cvt_pk_bf16_f32 v197, v102, v103
    v_cvt_pk_bf16_f32 v198, v108, v109
    buffer_load_dwordx4 v1, s[60:63], s16 offen offset:3072 lds
    s_add_u32 s16, s16, s31
    v_cvt_pk_bf16_f32 v199, v110, v111
    v_cvt_pk_bf16_f32 v208, v128, v129
    v_cvt_pk_bf16_f32 v209, v130, v131
    v_cvt_pk_bf16_f32 v210, v136, v137
    v_cvt_pk_bf16_f32 v211, v138, v139
    v_cvt_pk_bf16_f32 v212, v132, v133
    v_cvt_pk_bf16_f32 v213, v134, v135
    v_cvt_pk_bf16_f32 v214, v140, v141
    v_cvt_pk_bf16_f32 v215, v142, v143
    buffer_load_dword v13, v9, s[68:71], s39 offen sc1
    ds_write_b128 v34, v[192:195] offset:0
    ds_write_b128 v37, v[196:199] offset:0
    ds_write_b128 v34, v[208:211] offset:2048
    ds_write_b128 v37, v[212:215] offset:2048
    ds_read_b128 v[112:115], v36 offset:0
    ds_read_b128 v[116:119], v36 offset:1024
    ds_read_b128 v[144:147], v36 offset:2048
    ds_read_b128 v[148:151], v36 offset:3072
    s_waitcnt lgkmcnt(3)
    buffer_store_dwordx4 v[112:115], v10, s[68:71], s84 offen offset:0 sc1
    s_waitcnt lgkmcnt(2)
    buffer_store_dwordx4 v[116:119], v10, s[68:71], s84 offen offset:1024 sc1
    s_waitcnt lgkmcnt(1)
    buffer_store_dwordx4 v[144:147], v10, s[68:71], s84 offen offset:2048 sc1
    s_waitcnt lgkmcnt(0)
    buffer_store_dwordx4 v[148:151], v10, s[68:71], s84 offen offset:3072 sc1
    s_nop 1
    s_mov_b32 s44, -1
    s_mov_b32 s45, -1
    v_lshrrev_b32 v24, 2, v11
    v_and_b32 v25, 3, v11
    v_lshlrev_b32 v25, 3, v25
    v_lshl_add_u32 v25, v24, 8, v25
    v_and_b32 v24, 7, v24
    s_lshl_b32 s76, s14, 2
    v_xor_b32 v24, s76, v24
    v_xor_b32 v26, 0, v24
    v_lshl_add_u32 v196, v26, 5, v25
    v_add_u32 v204, 0x10000, v196
    v_xor_b32 v26, 1, v24
    v_lshl_add_u32 v197, v26, 5, v25
    v_add_u32 v205, 0x10000, v197
    v_xor_b32 v26, 2, v24
    v_lshl_add_u32 v198, v26, 5, v25
    v_add_u32 v206, 0x10000, v198
    v_xor_b32 v26, 3, v24
    v_lshl_add_u32 v199, v26, 5, v25
    v_add_u32 v207, 0x10000, v199
    v_xor_b32 v26, 4, v24
    v_lshl_add_u32 v200, v26, 5, v25
    v_add_u32 v208, 0x10000, v200
    v_xor_b32 v26, 5, v24
    v_lshl_add_u32 v201, v26, 5, v25
    v_add_u32 v209, 0x10000, v201
    v_xor_b32 v26, 6, v24
    v_lshl_add_u32 v202, v26, 5, v25
    v_add_u32 v210, 0x10000, v202
    v_xor_b32 v26, 7, v24
    v_lshl_add_u32 v203, v26, 5, v25
    v_add_u32 v211, 0x10000, v203
    s_lshl_b32 s76, s12, 3
    s_add_u32 s76, s76, s13
    s_lshl_b32 s76, s76, 1
    s_add_u32 s77, s76, s14
    s_xor_b32 s76, s77, 1
    s_lshl_b32 s78, s38, 13
    s_lshl_b32 s25, s76, 15
    s_add_u32 s78, s78, 16777216
    s_add_u32 s25, s25, s78
    s_lshl_b32 s26, s77, 15
    s_add_u32 s26, s26, s78
    s_lshl_b32 s76, s12, 2
    s_add_u32 s76, s76, s38
    s_lshl_b32 s29, s76, 8
    s_add_u32 s29, s29, 29360128
    s_lshl_b32 s27, s76, 16
    s_lshl_b32 s76, s13, 8
    s_add_u32 s27, s27, s76
    s_lshl_b32 s76, s14, 7
    s_add_u32 s27, s27, s76
    s_add_u32 s28, s27, 32768
    s_add_u32 s30, s27, 25165824
    s_add_u32 s42, s28, 25165824
    v_and_b32 v24, 15, v11
    v_lshrrev_b32 v25, 4, v11
    v_lshlrev_b32 v26, 4, v25
    v_lshl_add_u32 v21, v24, 11, v26
    v_and_b32 v26, 1, v25
    v_lshlrev_b32 v26, 5, v26
    v_lshrrev_b32 v25, 1, v25
    v_lshl_add_u32 v26, v25, 4, v26
    v_lshl_add_u32 v20, v24, 11, v26
    v_lshlrev_b32 v22, 3, v24
    v_lshrrev_b32 v24, 2, v11
    v_and_b32 v25, 3, v11
    v_lshlrev_b32 v25, 3, v25
    v_lshl_add_u32 v25, v24, 7, v25
    v_bfe_u32 v24, v11, 3, 2
    v_xor_b32 v26, 0, v24
    v_lshl_add_u32 v182, v26, 5, v25
    v_add_u32 v186, 0x10000, v182
    v_xor_b32 v26, 1, v24
    v_lshl_add_u32 v183, v26, 5, v25
    v_add_u32 v187, 0x10000, v183
    v_xor_b32 v26, 2, v24
    v_lshl_add_u32 v184, v26, 5, v25
    v_add_u32 v188, 0x10000, v184
    v_xor_b32 v26, 3, v24
    v_lshl_add_u32 v185, v26, 5, v25
    v_add_u32 v189, 0x10000, v185
    v_bfe_u32 v24, v11, 1, 2
    v_lshrrev_b32 v25, 4, v11
    v_xor_b32 v24, v24, v25
    v_lshlrev_b32 v24, 5, v24
    v_and_b32 v25, 1, v11
    v_lshl_add_u32 v24, v25, 4, v24
    v_lshrrev_b32 v25, 3, v11
    v_lshl_add_u32 v24, v25, 11, v24
    s_lshl_b32 s76, s14, 7
    v_add_u32 v214, s76, v24
    v_add_u32 v215, 15360, v214
    s_lshl_b32 s33, s38, 11
    s_lshl_b32 s76, s38, 15
    s_lshl_b32 s77, s13, 8
    s_add_u32 s76, s76, s77
    s_sub_u32 s77, 30, s19
    s_sub_u32 s78, 55, s77
    s_cmp_eq_u32 s14, 0
    s_cselect_b32 s77, s77, s78
    s_lshl_b32 s77, s77, 17
    s_add_u32 s32, s76, s77
    s_ashr_i32 s34, s31, 5
    s_add_u32 s35, s25, 4096
    s_add_u32 s36, s26, 4096
    s_add_u32 s76, s37, 1
    v_mov_b32 v191, s76
    v_mov_b32 v24, 0x7ffffff0
    s_lshl_b32 s76, s12, 10
    s_add_u32 s76, s76, 47251456
    v_and_b32 v25, 15, v11
    v_lshlrev_b32 v25, 6, v25
    v_add_u32 v212, s76, v25
    s_add_u32 s76, s37, 4
    v_mov_b32 v213, s76
    v_cmp_eq_u32 vcc, 0, v0
    s_nop 1
    v_cndmask_b32 v192, v24, 0, vcc
    v_mov_b32 v27, v191
    v_mov_b32 v31, v191
    v_mov_b32 v35, v191
    v_mov_b32 v39, v191
    v_mov_b32 v43, v191
    v_mov_b32 v47, v191
    s_waitcnt vmcnt(4)
    v_cmp_ne_u32 vcc, s40, v13
    s_nop 4
    s_and_b64 vcc, vcc, s[44:45]
    s_cbranch_scc0 Lhd_40
    s_mov_b32 s78, 100000
Lhp_39:
    buffer_load_dword v13, v9, s[68:71], s39 offen sc1
    s_waitcnt vmcnt(0)
    v_cmp_ne_u32 vcc, s40, v13
    s_sub_u32 s78, s78, 1
    s_cbranch_scc1 Lhd_40
    s_nop 2
    s_and_b64 vcc, vcc, s[44:45]
    s_cbranch_scc0 Lhd_40
    s_sleep 4
    s_branch Lhp_39
Lhd_40:
    v_mov_b32 v12, 0x7ffffff0
    s_cmp_eq_u32 s19, 2
    s_cbranch_scc1 Lpro_48
    s_cmp_eq_u32 s19, 4
    s_cbranch_scc1 Lpro_49
    s_cmp_eq_u32 s19, 6
    s_cbranch_scc1 Lpro_50
    s_cmp_eq_u32 s19, 8
    s_cbranch_scc1 Lpro_51
Lpro_47:
    buffer_load_dwordx4 a[0:3], v10, s[20:23], s15 offen offset:0 sc1
    buffer_load_dwordx4 a[4:7], v10, s[20:23], s15 offen offset:1024 sc1
    buffer_load_dwordx4 a[8:11], v10, s[20:23], s15 offen offset:2048 sc1
    buffer_load_dwordx4 a[12:15], v10, s[20:23], s15 offen offset:3072 sc1
    s_add_u32 s15, s15, s34
    buffer_load_dword v13, v12, s[68:71], 0 offen
    buffer_load_dword v13, v12, s[68:71], 0 offen
    buffer_load_dword v13, v12, s[68:71], 0 offen
    buffer_load_dword v13, v12, s[68:71], 0 offen
    buffer_load_dwordx4 a[16:19], v10, s[20:23], s15 offen offset:0 sc1
    buffer_load_dwordx4 a[20:23], v10, s[20:23], s15 offen offset:1024 sc1
    buffer_load_dwordx4 a[24:27], v10, s[20:23], s15 offen offset:2048 sc1
    buffer_load_dwordx4 a[28:31], v10, s[20:23], s15 offen offset:3072 sc1
    s_add_u32 s15, s15, s34
    buffer_load_dword v13, v12, s[68:71], 0 offen
    buffer_load_dword v13, v12, s[68:71], 0 offen
    buffer_load_dword v13, v12, s[68:71], 0 offen
    buffer_load_dword v13, v12, s[68:71], 0 offen
    buffer_load_dwordx4 a[32:35], v10, s[20:23], s15 offen offset:0 sc1
    buffer_load_dwordx4 a[36:39], v10, s[20:23], s15 offen offset:1024 sc1
    buffer_load_dwordx4 a[40:43], v10, s[20:23], s15 offen offset:2048 sc1
    buffer_load_dwordx4 a[44:47], v10, s[20:23], s15 offen offset:3072 sc1
    s_add_u32 s15, s15, s34
    buffer_load_dword v13, v12, s[68:71], 0 offen
    buffer_load_dword v13, v12, s[68:71], 0 offen
    buffer_load_dword v13, v12, s[68:71], 0 offen
    buffer_load_dword v13, v12, s[68:71], 0 offen
    v_mov_b32 v64, 0
    v_mov_b32 v65, 0
    v_mov_b32 v66, 0
    v_mov_b32 v67, 0
    v_mov_b32 v68, 0
    v_mov_b32 v69, 0
    v_mov_b32 v70, 0
    v_mov_b32 v71, 0
    v_mov_b32 v72, 0
    v_mov_b32 v73, 0
    v_mov_b32 v74, 0
    v_mov_b32 v75, 0
    v_mov_b32 v76, 0
    v_mov_b32 v77, 0
    v_mov_b32 v78, 0
    v_mov_b32 v79, 0
    v_mov_b32 v80, 0
    v_mov_b32 v81, 0
    v_mov_b32 v82, 0
    v_mov_b32 v83, 0
    v_mov_b32 v84, 0
    v_mov_b32 v85, 0
    v_mov_b32 v86, 0
    v_mov_b32 v87, 0
    v_mov_b32 v88, 0
    v_mov_b32 v89, 0
    v_mov_b32 v90, 0
    v_mov_b32 v91, 0
    v_mov_b32 v92, 0
    v_mov_b32 v93, 0
    v_mov_b32 v94, 0
    v_mov_b32 v95, 0
    v_mov_b32 v96, 0
    v_mov_b32 v97, 0
    v_mov_b32 v98, 0
    v_mov_b32 v99, 0
    v_mov_b32 v100, 0
    v_mov_b32 v101, 0
    v_mov_b32 v102, 0
    v_mov_b32 v103, 0
    v_mov_b32 v104, 0
    v_mov_b32 v105, 0
    v_mov_b32 v106, 0
    v_mov_b32 v107, 0
    v_mov_b32 v108, 0
    v_mov_b32 v109, 0
    v_mov_b32 v110, 0
    v_mov_b32 v111, 0
    v_mov_b32 v112, 0
    v_mov_b32 v113, 0
    v_mov_b32 v114, 0
    v_mov_b32 v115, 0
    v_mov_b32 v116, 0
    v_mov_b32 v117, 0
    v_mov_b32 v118, 0
    v_mov_b32 v119, 0
    v_mov_b32 v120, 0
    v_mov_b32 v121, 0
    v_mov_b32 v122, 0
    v_mov_b32 v123, 0
    v_mov_b32 v124, 0
    v_mov_b32 v125, 0
    v_mov_b32 v126, 0
    v_mov_b32 v127, 0
    s_waitcnt vmcnt(20)
    s_barrier
    ds_read_b64_tr_b16 a[128:129], v196 offset:0
    ds_read_b64_tr_b16 a[130:131], v196 offset:4096
    ds_read_b64_tr_b16 a[132:133], v197 offset:0
    ds_read_b64_tr_b16 a[134:135], v197 offset:4096
    ds_read_b64_tr_b16 a[136:137], v198 offset:0
    ds_read_b64_tr_b16 a[138:139], v198 offset:4096
    ds_read_b64_tr_b16 a[140:141], v199 offset:0
    ds_read_b64_tr_b16 a[142:143], v199 offset:4096
    ds_read_b64_tr_b16 a[144:145], v200 offset:0
    ds_read_b64_tr_b16 a[146:147], v200 offset:4096
    ds_read_b64_tr_b16 a[148:149], v201 offset:0
    ds_read_b64_tr_b16 a[150:151], v201 offset:4096
    ds_read_b64_tr_b16 a[152:153], v202 offset:0
    ds_read_b64_tr_b16 a[154:155], v202 offset:4096
    ds_read_b64_tr_b16 a[156:157], v203 offset:0
    ds_read_b64_tr_b16 a[158:159], v203 offset:4096
    s_branch Lent_42
Lpro_48:
    buffer_load_dwordx4 a[32:35], v10, s[20:23], s15 offen offset:0 sc1
    buffer_load_dwordx4 a[36:39], v10, s[20:23], s15 offen offset:1024 sc1
    buffer_load_dwordx4 a[40:43], v10, s[20:23], s15 offen offset:2048 sc1
    buffer_load_dwordx4 a[44:47], v10, s[20:23], s15 offen offset:3072 sc1
    s_add_u32 s15, s15, s34
    buffer_load_dword v13, v12, s[68:71], 0 offen
    buffer_load_dword v13, v12, s[68:71], 0 offen
    buffer_load_dword v13, v12, s[68:71], 0 offen
    buffer_load_dword v13, v12, s[68:71], 0 offen
    buffer_load_dwordx4 a[48:51], v10, s[20:23], s15 offen offset:0 sc1
    buffer_load_dwordx4 a[52:55], v10, s[20:23], s15 offen offset:1024 sc1
    buffer_load_dwordx4 a[56:59], v10, s[20:23], s15 offen offset:2048 sc1
    buffer_load_dwordx4 a[60:63], v10, s[20:23], s15 offen offset:3072 sc1
    s_add_u32 s15, s15, s34
    buffer_load_dword v13, v12, s[68:71], 0 offen
    buffer_load_dword v13, v12, s[68:71], 0 offen
    buffer_load_dword v13, v12, s[68:71], 0 offen
    buffer_load_dword v13, v12, s[68:71], 0 offen
    buffer_load_dwordx4 a[64:67], v10, s[20:23], s15 offen offset:0 sc1
    buffer_load_dwordx4 a[68:71], v10, s[20:23], s15 offen offset:1024 sc1
    buffer_load_dwordx4 a[72:75], v10, s[20:23], s15 offen offset:2048 sc1
    buffer_load_dwordx4 a[76:79], v10, s[20:23], s15 offen offset:3072 sc1
    s_add_u32 s15, s15, s34
    buffer_load_dword v13, v12, s[68:71], 0 offen
    buffer_load_dword v13, v12, s[68:71], 0 offen
    buffer_load_dword v13, v12, s[68:71], 0 offen
    buffer_load_dword v13, v12, s[68:71], 0 offen
    v_mov_b32 v64, 0
    v_mov_b32 v65, 0
    v_mov_b32 v66, 0
    v_mov_b32 v67, 0
    v_mov_b32 v68, 0
    v_mov_b32 v69, 0
    v_mov_b32 v70, 0
    v_mov_b32 v71, 0
    v_mov_b32 v72, 0
    v_mov_b32 v73, 0
    v_mov_b32 v74, 0
    v_mov_b32 v75, 0
    v_mov_b32 v76, 0
    v_mov_b32 v77, 0
    v_mov_b32 v78, 0
    v_mov_b32 v79, 0
    v_mov_b32 v80, 0
    v_mov_b32 v81, 0
    v_mov_b32 v82, 0
    v_mov_b32 v83, 0
    v_mov_b32 v84, 0
    v_mov_b32 v85, 0
    v_mov_b32 v86, 0
    v_mov_b32 v87, 0
    v_mov_b32 v88, 0
    v_mov_b32 v89, 0
    v_mov_b32 v90, 0
    v_mov_b32 v91, 0
    v_mov_b32 v92, 0
    v_mov_b32 v93, 0
    v_mov_b32 v94, 0
    v_mov_b32 v95, 0
    v_mov_b32 v96, 0
    v_mov_b32 v97, 0
    v_mov_b32 v98, 0
    v_mov_b32 v99, 0
    v_mov_b32 v100, 0
    v_mov_b32 v101, 0
    v_mov_b32 v102, 0
    v_mov_b32 v103, 0
    v_mov_b32 v104, 0
    v_mov_b32 v105, 0
    v_mov_b32 v106, 0
    v_mov_b32 v107, 0
    v_mov_b32 v108, 0
    v_mov_b32 v109, 0
    v_mov_b32 v110, 0
    v_mov_b32 v111, 0
    v_mov_b32 v112, 0
    v_mov_b32 v113, 0
    v_mov_b32 v114, 0
    v_mov_b32 v115, 0
    v_mov_b32 v116, 0
    v_mov_b32 v117, 0
    v_mov_b32 v118, 0
    v_mov_b32 v119, 0
    v_mov_b32 v120, 0
    v_mov_b32 v121, 0
    v_mov_b32 v122, 0
    v_mov_b32 v123, 0
    v_mov_b32 v124, 0
    v_mov_b32 v125, 0
    v_mov_b32 v126, 0
    v_mov_b32 v127, 0
    s_waitcnt vmcnt(20)
    s_barrier
    ds_read_b64_tr_b16 a[128:129], v196 offset:32768
    ds_read_b64_tr_b16 a[130:131], v196 offset:36864
    ds_read_b64_tr_b16 a[132:133], v197 offset:32768
    ds_read_b64_tr_b16 a[134:135], v197 offset:36864
    ds_read_b64_tr_b16 a[136:137], v198 offset:32768
    ds_read_b64_tr_b16 a[138:139], v198 offset:36864
    ds_read_b64_tr_b16 a[140:141], v199 offset:32768
    ds_read_b64_tr_b16 a[142:143], v199 offset:36864
    ds_read_b64_tr_b16 a[144:145], v200 offset:32768
    ds_read_b64_tr_b16 a[146:147], v200 offset:36864
    ds_read_b64_tr_b16 a[148:149], v201 offset:32768
    ds_read_b64_tr_b16 a[150:151], v201 offset:36864
    ds_read_b64_tr_b16 a[152:153], v202 offset:32768
    ds_read_b64_tr_b16 a[154:155], v202 offset:36864
    ds_read_b64_tr_b16 a[156:157], v203 offset:32768
    ds_read_b64_tr_b16 a[158:159], v203 offset:36864
    s_branch Lent_43
Lpro_49:
    buffer_load_dwordx4 a[64:67], v10, s[20:23], s15 offen offset:0 sc1
    buffer_load_dwordx4 a[68:71], v10, s[20:23], s15 offen offset:1024 sc1
    buffer_load_dwordx4 a[72:75], v10, s[20:23], s15 offen offset:2048 sc1
    buffer_load_dwordx4 a[76:79], v10, s[20:23], s15 offen offset:3072 sc1
    s_add_u32 s15, s15, s34
    buffer_load_dword v13, v12, s[68:71], 0 offen
    buffer_load_dword v13, v12, s[68:71], 0 offen
    buffer_load_dword v13, v12, s[68:71], 0 offen
    buffer_load_dword v13, v12, s[68:71], 0 offen
    buffer_load_dwordx4 a[80:83], v10, s[20:23], s15 offen offset:0 sc1
    buffer_load_dwordx4 a[84:87], v10, s[20:23], s15 offen offset:1024 sc1
    buffer_load_dwordx4 a[88:91], v10, s[20:23], s15 offen offset:2048 sc1
    buffer_load_dwordx4 a[92:95], v10, s[20:23], s15 offen offset:3072 sc1
    s_add_u32 s15, s15, s34
    buffer_load_dword v13, v12, s[68:71], 0 offen
    buffer_load_dword v13, v12, s[68:71], 0 offen
    buffer_load_dword v13, v12, s[68:71], 0 offen
    buffer_load_dword v13, v12, s[68:71], 0 offen
    buffer_load_dwordx4 a[96:99], v10, s[20:23], s15 offen offset:0 sc1
    buffer_load_dwordx4 a[100:103], v10, s[20:23], s15 offen offset:1024 sc1
    buffer_load_dwordx4 a[104:107], v10, s[20:23], s15 offen offset:2048 sc1
    buffer_load_dwordx4 a[108:111], v10, s[20:23], s15 offen offset:3072 sc1
    s_add_u32 s15, s15, s34
    buffer_load_dword v13, v12, s[68:71], 0 offen
    buffer_load_dword v13, v12, s[68:71], 0 offen
    buffer_load_dword v13, v12, s[68:71], 0 offen
    buffer_load_dword v13, v12, s[68:71], 0 offen
    v_mov_b32 v64, 0
    v_mov_b32 v65, 0
    v_mov_b32 v66, 0
    v_mov_b32 v67, 0
    v_mov_b32 v68, 0
    v_mov_b32 v69, 0
    v_mov_b32 v70, 0
    v_mov_b32 v71, 0
    v_mov_b32 v72, 0
    v_mov_b32 v73, 0
    v_mov_b32 v74, 0
    v_mov_b32 v75, 0
    v_mov_b32 v76, 0
    v_mov_b32 v77, 0
    v_mov_b32 v78, 0
    v_mov_b32 v79, 0
    v_mov_b32 v80, 0
    v_mov_b32 v81, 0
    v_mov_b32 v82, 0
    v_mov_b32 v83, 0
    v_mov_b32 v84, 0
    v_mov_b32 v85, 0
    v_mov_b32 v86, 0
    v_mov_b32 v87, 0
    v_mov_b32 v88, 0
    v_mov_b32 v89, 0
    v_mov_b32 v90, 0
    v_mov_b32 v91, 0
    v_mov_b32 v92, 0
    v_mov_b32 v93, 0
    v_mov_b32 v94, 0
    v_mov_b32 v95, 0
    v_mov_b32 v96, 0
    v_mov_b32 v97, 0
    v_mov_b32 v98, 0
    v_mov_b32 v99, 0
    v_mov_b32 v100, 0
    v_mov_b32 v101, 0
    v_mov_b32 v102, 0
    v_mov_b32 v103, 0
    v_mov_b32 v104, 0
    v_mov_b32 v105, 0
    v_mov_b32 v106, 0
    v_mov_b32 v107, 0
    v_mov_b32 v108, 0
    v_mov_b32 v109, 0
    v_mov_b32 v110, 0
    v_mov_b32 v111, 0
    v_mov_b32 v112, 0
    v_mov_b32 v113, 0
    v_mov_b32 v114, 0
    v_mov_b32 v115, 0
    v_mov_b32 v116, 0
    v_mov_b32 v117, 0
    v_mov_b32 v118, 0
    v_mov_b32 v119, 0
    v_mov_b32 v120, 0
    v_mov_b32 v121, 0
    v_mov_b32 v122, 0
    v_mov_b32 v123, 0
    v_mov_b32 v124, 0
    v_mov_b32 v125, 0
    v_mov_b32 v126, 0
    v_mov_b32 v127, 0
    s_waitcnt vmcnt(20)
    s_barrier
    ds_read_b64_tr_b16 a[128:129], v204 offset:0
    ds_read_b64_tr_b16 a[130:131], v204 offset:4096
    ds_read_b64_tr_b16 a[132:133], v205 offset:0
    ds_read_b64_tr_b16 a[134:135], v205 offset:4096
    ds_read_b64_tr_b16 a[136:137], v206 offset:0
    ds_read_b64_tr_b16 a[138:139], v206 offset:4096
    ds_read_b64_tr_b16 a[140:141], v207 offset:0
    ds_read_b64_tr_b16 a[142:143], v207 offset:4096
    ds_read_b64_tr_b16 a[144:145], v208 offset:0
    ds_read_b64_tr_b16 a[146:147], v208 offset:4096
    ds_read_b64_tr_b16 a[148:149], v209 offset:0
    ds_read_b64_tr_b16 a[150:151], v209 offset:4096
    ds_read_b64_tr_b16 a[152:153], v210 offset:0
    ds_read_b64_tr_b16 a[154:155], v210 offset:4096
    ds_read_b64_tr_b16 a[156:157], v211 offset:0
    ds_read_b64_tr_b16 a[158:159], v211 offset:4096
    s_branch Lent_44
Lpro_50:
    buffer_load_dwordx4 a[96:99], v10, s[20:23], s15 offen offset:0 sc1
    buffer_load_dwordx4 a[100:103], v10, s[20:23], s15 offen offset:1024 sc1
    buffer_load_dwordx4 a[104:107], v10, s[20:23], s15 offen offset:2048 sc1
    buffer_load_dwordx4 a[108:111], v10, s[20:23], s15 offen offset:3072 sc1
    s_add_u32 s15, s15, s34
    buffer_load_dword v13, v12, s[68:71], 0 offen
    buffer_load_dword v13, v12, s[68:71], 0 offen
    buffer_load_dword v13, v12, s[68:71], 0 offen
    buffer_load_dword v13, v12, s[68:71], 0 offen
    buffer_load_dwordx4 a[112:115], v10, s[20:23], s15 offen offset:0 sc1
    buffer_load_dwordx4 a[116:119], v10, s[20:23], s15 offen offset:1024 sc1
    buffer_load_dwordx4 a[120:123], v10, s[20:23], s15 offen offset:2048 sc1
    buffer_load_dwordx4 a[124:127], v10, s[20:23], s15 offen offset:3072 sc1
    s_add_u32 s15, s15, s34
    buffer_load_dword v13, v12, s[68:71], 0 offen
    buffer_load_dword v13, v12, s[68:71], 0 offen
    buffer_load_dword v13, v12, s[68:71], 0 offen
    buffer_load_dword v13, v12, s[68:71], 0 offen
    buffer_load_dwordx4 a[0:3], v10, s[20:23], s15 offen offset:0 sc1
    buffer_load_dwordx4 a[4:7], v10, s[20:23], s15 offen offset:1024 sc1
    buffer_load_dwordx4 a[8:11], v10, s[20:23], s15 offen offset:2048 sc1
    buffer_load_dwordx4 a[12:15], v10, s[20:23], s15 offen offset:3072 sc1
    s_add_u32 s15, s15, s34
    buffer_load_dword v13, v12, s[68:71], 0 offen
    buffer_load_dword v13, v12, s[68:71], 0 offen
    buffer_load_dword v13, v12, s[68:71], 0 offen
    buffer_load_dword v13, v12, s[68:71], 0 offen
    v_mov_b32 v64, 0
    v_mov_b32 v65, 0
    v_mov_b32 v66, 0
    v_mov_b32 v67, 0
    v_mov_b32 v68, 0
    v_mov_b32 v69, 0
    v_mov_b32 v70, 0
    v_mov_b32 v71, 0
    v_mov_b32 v72, 0
    v_mov_b32 v73, 0
    v_mov_b32 v74, 0
    v_mov_b32 v75, 0
    v_mov_b32 v76, 0
    v_mov_b32 v77, 0
    v_mov_b32 v78, 0
    v_mov_b32 v79, 0
    v_mov_b32 v80, 0
    v_mov_b32 v81, 0
    v_mov_b32 v82, 0
    v_mov_b32 v83, 0
    v_mov_b32 v84, 0
    v_mov_b32 v85, 0
    v_mov_b32 v86, 0
    v_mov_b32 v87, 0
    v_mov_b32 v88, 0
    v_mov_b32 v89, 0
    v_mov_b32 v90, 0
    v_mov_b32 v91, 0
    v_mov_b32 v92, 0
    v_mov_b32 v93, 0
    v_mov_b32 v94, 0
    v_mov_b32 v95, 0
    v_mov_b32 v96, 0
    v_mov_b32 v97, 0
    v_mov_b32 v98, 0
    v_mov_b32 v99, 0
    v_mov_b32 v100, 0
    v_mov_b32 v101, 0
    v_mov_b32 v102, 0
    v_mov_b32 v103, 0
    v_mov_b32 v104, 0
    v_mov_b32 v105, 0
    v_mov_b32 v106, 0
    v_mov_b32 v107, 0
    v_mov_b32 v108, 0
    v_mov_b32 v109, 0
    v_mov_b32 v110, 0
    v_mov_b32 v111, 0
    v_mov_b32 v112, 0
    v_mov_b32 v113, 0
    v_mov_b32 v114, 0
    v_mov_b32 v115, 0
    v_mov_b32 v116, 0
    v_mov_b32 v117, 0
    v_mov_b32 v118, 0
    v_mov_b32 v119, 0
    v_mov_b32 v120, 0
    v_mov_b32 v121, 0
    v_mov_b32 v122, 0
    v_mov_b32 v123, 0
    v_mov_b32 v124, 0
    v_mov_b32 v125, 0
    v_mov_b32 v126, 0
    v_mov_b32 v127, 0
    s_waitcnt vmcnt(20)
    s_barrier
    ds_read_b64_tr_b16 a[128:129], v204 offset:32768
    ds_read_b64_tr_b16 a[130:131], v204 offset:36864
    ds_read_b64_tr_b16 a[132:133], v205 offset:32768
    ds_read_b64_tr_b16 a[134:135], v205 offset:36864
    ds_read_b64_tr_b16 a[136:137], v206 offset:32768
    ds_read_b64_tr_b16 a[138:139], v206 offset:36864
    ds_read_b64_tr_b16 a[140:141], v207 offset:32768
    ds_read_b64_tr_b16 a[142:143], v207 offset:36864
    ds_read_b64_tr_b16 a[144:145], v208 offset:32768
    ds_read_b64_tr_b16 a[146:147], v208 offset:36864
    ds_read_b64_tr_b16 a[148:149], v209 offset:32768
    ds_read_b64_tr_b16 a[150:151], v209 offset:36864
    ds_read_b64_tr_b16 a[152:153], v210 offset:32768
    ds_read_b64_tr_b16 a[154:155], v210 offset:36864
    ds_read_b64_tr_b16 a[156:157], v211 offset:32768
    ds_read_b64_tr_b16 a[158:159], v211 offset:36864
    s_branch Lent_45
Lpro_51:
    buffer_load_dwordx4 a[0:3], v10, s[20:23], s15 offen offset:0 sc1
    buffer_load_dwordx4 a[4:7], v10, s[20:23], s15 offen offset:1024 sc1
    buffer_load_dwordx4 a[8:11], v10, s[20:23], s15 offen offset:2048 sc1
    buffer_load_dwordx4 a[12:15], v10, s[20:23], s15 offen offset:3072 sc1
    s_add_u32 s15, s15, s34
    buffer_load_dword v13, v12, s[68:71], 0 offen
    buffer_load_dword v13, v12, s[68:71], 0 offen
    buffer_load_dword v13, v12, s[68:71], 0 offen
    buffer_load_dword v13, v12, s[68:71], 0 offen
    buffer_load_dwordx4 a[16:19], v10, s[20:23], s15 offen offset:0 sc1
    buffer_load_dwordx4 a[20:23], v10, s[20:23], s15 offen offset:1024 sc1
    buffer_load_dwordx4 a[24:27], v10, s[20:23], s15 offen offset:2048 sc1
    buffer_load_dwordx4 a[28:31], v10, s[20:23], s15 offen offset:3072 sc1
    s_add_u32 s15, s15, s34
    buffer_load_dword v13, v12, s[68:71], 0 offen
    buffer_load_dword v13, v12, s[68:71], 0 offen
    buffer_load_dword v13, v12, s[68:71], 0 offen
    buffer_load_dword v13, v12, s[68:71], 0 offen
    buffer_load_dwordx4 a[32:35], v10, s[20:23], s15 offen offset:0 sc1
    buffer_load_dwordx4 a[36:39], v10, s[20:23], s15 offen offset:1024 sc1
    buffer_load_dwordx4 a[40:43], v10, s[20:23], s15 offen offset:2048 sc1
    buffer_load_dwordx4 a[44:47], v10, s[20:23], s15 offen offset:3072 sc1
    s_add_u32 s15, s15, s34
    buffer_load_dword v13, v12, s[68:71], 0 offen
    buffer_load_dword v13, v12, s[68:71], 0 offen
    buffer_load_dword v13, v12, s[68:71], 0 offen
    buffer_load_dword v13, v12, s[68:71], 0 offen
    v_mov_b32 v64, 0
    v_mov_b32 v65, 0
    v_mov_b32 v66, 0
    v_mov_b32 v67, 0
    v_mov_b32 v68, 0
    v_mov_b32 v69, 0
    v_mov_b32 v70, 0
    v_mov_b32 v71, 0
    v_mov_b32 v72, 0
    v_mov_b32 v73, 0
    v_mov_b32 v74, 0
    v_mov_b32 v75, 0
    v_mov_b32 v76, 0
    v_mov_b32 v77, 0
    v_mov_b32 v78, 0
    v_mov_b32 v79, 0
    v_mov_b32 v80, 0
    v_mov_b32 v81, 0
    v_mov_b32 v82, 0
    v_mov_b32 v83, 0
    v_mov_b32 v84, 0
    v_mov_b32 v85, 0
    v_mov_b32 v86, 0
    v_mov_b32 v87, 0
    v_mov_b32 v88, 0
    v_mov_b32 v89, 0
    v_mov_b32 v90, 0
    v_mov_b32 v91, 0
    v_mov_b32 v92, 0
    v_mov_b32 v93, 0
    v_mov_b32 v94, 0
    v_mov_b32 v95, 0
    v_mov_b32 v96, 0
    v_mov_b32 v97, 0
    v_mov_b32 v98, 0
    v_mov_b32 v99, 0
    v_mov_b32 v100, 0
    v_mov_b32 v101, 0
    v_mov_b32 v102, 0
    v_mov_b32 v103, 0
    v_mov_b32 v104, 0
    v_mov_b32 v105, 0
    v_mov_b32 v106, 0
    v_mov_b32 v107, 0
    v_mov_b32 v108, 0
    v_mov_b32 v109, 0
    v_mov_b32 v110, 0
    v_mov_b32 v111, 0
    v_mov_b32 v112, 0
    v_mov_b32 v113, 0
    v_mov_b32 v114, 0
    v_mov_b32 v115, 0
    v_mov_b32 v116, 0
    v_mov_b32 v117, 0
    v_mov_b32 v118, 0
    v_mov_b32 v119, 0
    v_mov_b32 v120, 0
    v_mov_b32 v121, 0
    v_mov_b32 v122, 0
    v_mov_b32 v123, 0
    v_mov_b32 v124, 0
    v_mov_b32 v125, 0
    v_mov_b32 v126, 0
    v_mov_b32 v127, 0
    s_waitcnt vmcnt(20)
    s_barrier
    ds_read_b64_tr_b16 a[128:129], v196 offset:0
    ds_read_b64_tr_b16 a[130:131], v196 offset:4096
    ds_read_b64_tr_b16 a[132:133], v197 offset:0
    ds_read_b64_tr_b16 a[134:135], v197 offset:4096
    ds_read_b64_tr_b16 a[136:137], v198 offset:0
    ds_read_b64_tr_b16 a[138:139], v198 offset:4096
    ds_read_b64_tr_b16 a[140:141], v199 offset:0
    ds_read_b64_tr_b16 a[142:143], v199 offset:4096
    ds_read_b64_tr_b16 a[144:145], v200 offset:0
    ds_read_b64_tr_b16 a[146:147], v200 offset:4096
    ds_read_b64_tr_b16 a[148:149], v201 offset:0
    ds_read_b64_tr_b16 a[150:151], v201 offset:4096
    ds_read_b64_tr_b16 a[152:153], v202 offset:0
    ds_read_b64_tr_b16 a[154:155], v202 offset:4096
    ds_read_b64_tr_b16 a[156:157], v203 offset:0
    ds_read_b64_tr_b16 a[158:159], v203 offset:4096
    s_branch Lent_46
Lent_42:
    s_waitcnt lgkmcnt(12)
    v_mfma_f32_16x16x32_bf16 v[64:67], a[128:131], a[0:3], v[64:67]
    ds_read_b64_tr_b16 a[160:161], v196 offset:8192
    v_mfma_f32_16x16x32_bf16 v[68:71], a[128:131], a[4:7], v[68:71]
    ds_read_b64_tr_b16 a[162:163], v196 offset:12288
    buffer_load_dwordx4 a[48:51], v10, s[20:23], s15 offen offset:0 sc1
    v_mfma_f32_16x16x32_bf16 v[76:79], a[132:135], a[4:7], v[76:79]
    ds_read_b64_tr_b16 a[164:165], v197 offset:8192
    v_mfma_f32_16x16x32_bf16 v[72:75], a[132:135], a[0:3], v[72:75]
    ds_read_b64_tr_b16 a[166:167], v197 offset:12288
    s_waitcnt lgkmcnt(12)
    v_mfma_f32_16x16x32_bf16 v[80:83], a[136:139], a[0:3], v[80:83]
    ds_read_b64_tr_b16 a[168:169], v198 offset:8192
    buffer_load_dwordx4 a[52:55], v10, s[20:23], s15 offen offset:1024 sc1
    v_mfma_f32_16x16x32_bf16 v[84:87], a[136:139], a[4:7], v[84:87]
    ds_read_b64_tr_b16 a[170:171], v198 offset:12288
    v_mfma_f32_16x16x32_bf16 v[92:95], a[140:143], a[4:7], v[92:95]
    ds_read_b64_tr_b16 a[172:173], v199 offset:8192
    v_mfma_f32_16x16x32_bf16 v[88:91], a[140:143], a[0:3], v[88:91]
    ds_read_b64_tr_b16 a[174:175], v199 offset:12288
    s_waitcnt lgkmcnt(12)
    v_mfma_f32_16x16x32_bf16 v[96:99], a[144:147], a[0:3], v[96:99]
    ds_read_b64_tr_b16 a[176:177], v200 offset:8192
    buffer_load_dwordx4 a[56:59], v10, s[20:23], s15 offen offset:2048 sc1
    v_mfma_f32_16x16x32_bf16 v[100:103], a[144:147], a[4:7], v[100:103]
    ds_read_b64_tr_b16 a[178:179], v200 offset:12288
    v_mfma_f32_16x16x32_bf16 v[108:111], a[148:151], a[4:7], v[108:111]
    ds_read_b64_tr_b16 a[180:181], v201 offset:8192
    v_mfma_f32_16x16x32_bf16 v[104:107], a[148:151], a[0:3], v[104:107]
    ds_read_b64_tr_b16 a[182:183], v201 offset:12288
    s_waitcnt lgkmcnt(12)
    v_mfma_f32_16x16x32_bf16 v[112:115], a[152:155], a[0:3], v[112:115]
    ds_read_b64_tr_b16 a[184:185], v202 offset:8192
    buffer_load_dwordx4 a[60:63], v10, s[20:23], s15 offen offset:3072 sc1
    s_add_u32 s15, s15, s34
    v_mfma_f32_16x16x32_bf16 v[116:119], a[152:155], a[4:7], v[116:119]
    ds_read_b64_tr_b16 a[186:187], v202 offset:12288
    v_mfma_f32_16x16x32_bf16 v[124:127], a[156:159], a[4:7], v[124:127]
    ds_read_b64_tr_b16 a[188:189], v203 offset:8192
    v_mfma_f32_16x16x32_bf16 v[120:123], a[156:159], a[0:3], v[120:123]
    ds_read_b64_tr_b16 a[190:191], v203 offset:12288
    s_waitcnt vmcnt(16)
    s_barrier
    s_waitcnt lgkmcnt(12)
    v_mfma_f32_16x16x32_bf16 v[64:67], a[160:163], a[8:11], v[64:67]
    ds_read_b64_tr_b16 a[128:129], v196 offset:16384
    s_add_u32 m0, s24, 114688
    v_mfma_f32_16x16x32_bf16 v[68:71], a[160:163], a[12:15], v[68:71]
    ds_read_b64_tr_b16 a[130:131], v196 offset:20480
    buffer_load_dwordx4 v8, s[60:63], s16 offen offset:0 lds
    v_mfma_f32_16x16x32_bf16 v[76:79], a[164:167], a[12:15], v[76:79]
    ds_read_b64_tr_b16 a[132:133], v197 offset:16384
    v_mfma_f32_16x16x32_bf16 v[72:75], a[164:167], a[8:11], v[72:75]
    ds_read_b64_tr_b16 a[134:135], v197 offset:20480
    s_waitcnt lgkmcnt(12)
    v_mfma_f32_16x16x32_bf16 v[80:83], a[168:171], a[8:11], v[80:83]
    ds_read_b64_tr_b16 a[136:137], v198 offset:16384
    buffer_load_dwordx4 v58, s[60:63], s16 offen offset:1024 lds
    v_mfma_f32_16x16x32_bf16 v[84:87], a[168:171], a[12:15], v[84:87]
    ds_read_b64_tr_b16 a[138:139], v198 offset:20480
    v_mfma_f32_16x16x32_bf16 v[92:95], a[172:175], a[12:15], v[92:95]
    ds_read_b64_tr_b16 a[140:141], v199 offset:16384
    v_mfma_f32_16x16x32_bf16 v[88:91], a[172:175], a[8:11], v[88:91]
    ds_read_b64_tr_b16 a[142:143], v199 offset:20480
    s_waitcnt lgkmcnt(12)
    v_mfma_f32_16x16x32_bf16 v[96:99], a[176:179], a[8:11], v[96:99]
    ds_read_b64_tr_b16 a[144:145], v200 offset:16384
    buffer_load_dwordx4 v59, s[60:63], s16 offen offset:2048 lds
    v_mfma_f32_16x16x32_bf16 v[100:103], a[176:179], a[12:15], v[100:103]
    ds_read_b64_tr_b16 a[146:147], v200 offset:20480
    v_mfma_f32_16x16x32_bf16 v[108:111], a[180:183], a[12:15], v[108:111]
    ds_read_b64_tr_b16 a[148:149], v201 offset:16384
    v_mfma_f32_16x16x32_bf16 v[104:107], a[180:183], a[8:11], v[104:107]
    ds_read_b64_tr_b16 a[150:151], v201 offset:20480
    s_waitcnt lgkmcnt(12)
    v_mfma_f32_16x16x32_bf16 v[112:115], a[184:187], a[8:11], v[112:115]
    ds_read_b64_tr_b16 a[152:153], v202 offset:16384
    buffer_load_dwordx4 v1, s[60:63], s16 offen offset:3072 lds
    s_add_u32 s16, s16, s31
    v_mfma_f32_16x16x32_bf16 v[116:119], a[184:187], a[12:15], v[116:119]
    ds_read_b64_tr_b16 a[154:155], v202 offset:20480
    v_mfma_f32_16x16x32_bf16 v[124:127], a[188:191], a[12:15], v[124:127]
    ds_read_b64_tr_b16 a[156:157], v203 offset:16384
    v_mfma_f32_16x16x32_bf16 v[120:123], a[188:191], a[8:11], v[120:123]
    ds_read_b64_tr_b16 a[158:159], v203 offset:20480
    s_waitcnt lgkmcnt(12)
    v_mfma_f32_16x16x32_bf16 v[64:67], a[128:131], a[16:19], v[64:67]
    ds_read_b64_tr_b16 a[160:161], v196 offset:24576
    v_mfma_f32_16x16x32_bf16 v[68:71], a[128:131], a[20:23], v[68:71]
    ds_read_b64_tr_b16 a[162:163], v196 offset:28672
    buffer_load_dwordx4 a[64:67], v10, s[20:23], s15 offen offset:0 sc1
    v_mfma_f32_16x16x32_bf16 v[76:79], a[132:135], a[20:23], v[76:79]
    ds_read_b64_tr_b16 a[164:165], v197 offset:24576
    v_mfma_f32_16x16x32_bf16 v[72:75], a[132:135], a[16:19], v[72:75]
    ds_read_b64_tr_b16 a[166:167], v197 offset:28672
    s_waitcnt lgkmcnt(12)
    v_mfma_f32_16x16x32_bf16 v[80:83], a[136:139], a[16:19], v[80:83]
    ds_read_b64_tr_b16 a[168:169], v198 offset:24576
    buffer_load_dwordx4 a[68:71], v10, s[20:23], s15 offen offset:1024 sc1
    v_mfma_f32_16x16x32_bf16 v[84:87], a[136:139], a[20:23], v[84:87]
    ds_read_b64_tr_b16 a[170:171], v198 offset:28672
    v_mfma_f32_16x16x32_bf16 v[92:95], a[140:143], a[20:23], v[92:95]
    ds_read_b64_tr_b16 a[172:173], v199 offset:24576
    v_mfma_f32_16x16x32_bf16 v[88:91], a[140:143], a[16:19], v[88:91]
    ds_read_b64_tr_b16 a[174:175], v199 offset:28672
    s_waitcnt lgkmcnt(12)
    v_mfma_f32_16x16x32_bf16 v[96:99], a[144:147], a[16:19], v[96:99]
    ds_read_b64_tr_b16 a[176:177], v200 offset:24576
    buffer_load_dwordx4 a[72:75], v10, s[20:23], s15 offen offset:2048 sc1
    v_mfma_f32_16x16x32_bf16 v[100:103], a[144:147], a[20:23], v[100:103]
    ds_read_b64_tr_b16 a[178:179], v200 offset:28672
    v_mfma_f32_16x16x32_bf16 v[108:111], a[148:151], a[20:23], v[108:111]
    ds_read_b64_tr_b16 a[180:181], v201 offset:24576
    v_mfma_f32_16x16x32_bf16 v[104:107], a[148:151], a[16:19], v[104:107]
    ds_read_b64_tr_b16 a[182:183], v201 offset:28672
    s_waitcnt lgkmcnt(12)
    v_mfma_f32_16x16x32_bf16 v[112:115], a[152:155], a[16:19], v[112:115]
    ds_read_b64_tr_b16 a[184:185], v202 offset:24576
    buffer_load_dwordx4 a[76:79], v10, s[20:23], s15 offen offset:3072 sc1
    s_add_u32 s15, s15, s34
    v_mfma_f32_16x16x32_bf16 v[116:119], a[152:155], a[20:23], v[116:119]
    ds_read_b64_tr_b16 a[186:187], v202 offset:28672
    v_mfma_f32_16x16x32_bf16 v[124:127], a[156:159], a[20:23], v[124:127]
    ds_read_b64_tr_b16 a[188:189], v203 offset:24576
    v_mfma_f32_16x16x32_bf16 v[120:123], a[156:159], a[16:19], v[120:123]
    ds_read_b64_tr_b16 a[190:191], v203 offset:28672
    s_waitcnt vmcnt(16)
    s_barrier
    s_waitcnt lgkmcnt(12)
    v_mfma_f32_16x16x32_bf16 v[64:67], a[160:163], a[24:27], v[64:67]
    ds_read_b64_tr_b16 a[128:129], v196 offset:32768
    s_add_u32 m0, s24, 0
    v_mfma_f32_16x16x32_bf16 v[68:71], a[160:163], a[28:31], v[68:71]
    ds_read_b64_tr_b16 a[130:131], v196 offset:36864
    buffer_load_dwordx4 v8, s[60:63], s16 offen offset:0 lds
    v_mfma_f32_16x16x32_bf16 v[76:79], a[164:167], a[28:31], v[76:79]
    ds_read_b64_tr_b16 a[132:133], v197 offset:32768
    v_mfma_f32_16x16x32_bf16 v[72:75], a[164:167], a[24:27], v[72:75]
    ds_read_b64_tr_b16 a[134:135], v197 offset:36864
    s_waitcnt lgkmcnt(12)
    v_mfma_f32_16x16x32_bf16 v[80:83], a[168:171], a[24:27], v[80:83]
    ds_read_b64_tr_b16 a[136:137], v198 offset:32768
    buffer_load_dwordx4 v58, s[60:63], s16 offen offset:1024 lds
    v_mfma_f32_16x16x32_bf16 v[84:87], a[168:171], a[28:31], v[84:87]
    ds_read_b64_tr_b16 a[138:139], v198 offset:36864
    v_mfma_f32_16x16x32_bf16 v[92:95], a[172:175], a[28:31], v[92:95]
    ds_read_b64_tr_b16 a[140:141], v199 offset:32768
    v_mfma_f32_16x16x32_bf16 v[88:91], a[172:175], a[24:27], v[88:91]
    ds_read_b64_tr_b16 a[142:143], v199 offset:36864
    s_waitcnt lgkmcnt(12)
    v_mfma_f32_16x16x32_bf16 v[96:99], a[176:179], a[24:27], v[96:99]
    ds_read_b64_tr_b16 a[144:145], v200 offset:32768
    buffer_load_dwordx4 v59, s[60:63], s16 offen offset:2048 lds
    v_mfma_f32_16x16x32_bf16 v[100:103], a[176:179], a[28:31], v[100:103]
    ds_read_b64_tr_b16 a[146:147], v200 offset:36864
    v_mfma_f32_16x16x32_bf16 v[108:111], a[180:183], a[28:31], v[108:111]
    ds_read_b64_tr_b16 a[148:149], v201 offset:32768
    v_mfma_f32_16x16x32_bf16 v[104:107], a[180:183], a[24:27], v[104:107]
    ds_read_b64_tr_b16 a[150:151], v201 offset:36864
    s_waitcnt lgkmcnt(12)
    v_mfma_f32_16x16x32_bf16 v[112:115], a[184:187], a[24:27], v[112:115]
    ds_read_b64_tr_b16 a[152:153], v202 offset:32768
    buffer_load_dwordx4 v1, s[60:63], s16 offen offset:3072 lds
    s_add_u32 s16, s16, s31
    v_mfma_f32_16x16x32_bf16 v[116:119], a[184:187], a[28:31], v[116:119]
    ds_read_b64_tr_b16 a[154:155], v202 offset:36864
    v_mfma_f32_16x16x32_bf16 v[124:127], a[188:191], a[28:31], v[124:127]
    ds_read_b64_tr_b16 a[156:157], v203 offset:32768
    v_mfma_f32_16x16x32_bf16 v[120:123], a[188:191], a[24:27], v[120:123]
    ds_read_b64_tr_b16 a[158:159], v203 offset:36864
Lent_43:
    s_waitcnt lgkmcnt(12)
    v_mfma_f32_16x16x32_bf16 v[64:67], a[128:131], a[32:35], v[64:67]
    ds_read_b64_tr_b16 a[160:161], v196 offset:40960
    v_mfma_f32_16x16x32_bf16 v[68:71], a[128:131], a[36:39], v[68:71]
    ds_read_b64_tr_b16 a[162:163], v196 offset:45056
    buffer_load_dwordx4 a[80:83], v10, s[20:23], s15 offen offset:0 sc1
    v_mfma_f32_16x16x32_bf16 v[76:79], a[132:135], a[36:39], v[76:79]
    ds_read_b64_tr_b16 a[164:165], v197 offset:40960
    v_mfma_f32_16x16x32_bf16 v[72:75], a[132:135], a[32:35], v[72:75]
    ds_read_b64_tr_b16 a[166:167], v197 offset:45056
    s_waitcnt lgkmcnt(12)
    v_mfma_f32_16x16x32_bf16 v[80:83], a[136:139], a[32:35], v[80:83]
    ds_read_b64_tr_b16 a[168:169], v198 offset:40960
    buffer_load_dwordx4 a[84:87], v10, s[20:23], s15 offen offset:1024 sc1
    v_mfma_f32_16x16x32_bf16 v[84:87], a[136:139], a[36:39], v[84:87]
    ds_read_b64_tr_b16 a[170:171], v198 offset:45056
    v_mfma_f32_16x16x32_bf16 v[92:95], a[140:143], a[36:39], v[92:95]
    ds_read_b64_tr_b16 a[172:173], v199 offset:40960
    v_mfma_f32_16x16x32_bf16 v[88:91], a[140:143], a[32:35], v[88:91]
    ds_read_b64_tr_b16 a[174:175], v199 offset:45056
    s_waitcnt lgkmcnt(12)
    v_mfma_f32_16x16x32_bf16 v[96:99], a[144:147], a[32:35], v[96:99]
    ds_read_b64_tr_b16 a[176:177], v200 offset:40960
    buffer_load_dwordx4 a[88:91], v10, s[20:23], s15 offen offset:2048 sc1
    v_mfma_f32_16x16x32_bf16 v[100:103], a[144:147], a[36:39], v[100:103]
    ds_read_b64_tr_b16 a[178:179], v200 offset:45056
    v_mfma_f32_16x16x32_bf16 v[108:111], a[148:151], a[36:39], v[108:111]
    ds_read_b64_tr_b16 a[180:181], v201 offset:40960
    v_mfma_f32_16x16x32_bf16 v[104:107], a[148:151], a[32:35], v[104:107]
    ds_read_b64_tr_b16 a[182:183], v201 offset:45056
    s_waitcnt lgkmcnt(12)
    v_mfma_f32_16x16x32_bf16 v[112:115], a[152:155], a[32:35], v[112:115]
    ds_read_b64_tr_b16 a[184:185], v202 offset:40960
    buffer_load_dwordx4 a[92:95], v10, s[20:23], s15 offen offset:3072 sc1
    s_add_u32 s15, s15, s34
    v_mfma_f32_16x16x32_bf16 v[116:119], a[152:155], a[36:39], v[116:119]
    ds_read_b64_tr_b16 a[186:187], v202 offset:45056
    v_mfma_f32_16x16x32_bf16 v[124:127], a[156:159], a[36:39], v[124:127]
    ds_read_b64_tr_b16 a[188:189], v203 offset:40960
    v_mfma_f32_16x16x32_bf16 v[120:123], a[156:159], a[32:35], v[120:123]
    ds_read_b64_tr_b16 a[190:191], v203 offset:45056
    s_waitcnt vmcnt(16)
    s_barrier
    s_waitcnt lgkmcnt(12)
    v_mfma_f32_16x16x32_bf16 v[64:67], a[160:163], a[40:43], v[64:67]
    ds_read_b64_tr_b16 a[128:129], v196 offset:49152
    s_add_u32 m0, s24, 16384
    v_mfma_f32_16x16x32_bf16 v[68:71], a[160:163], a[44:47], v[68:71]
    ds_read_b64_tr_b16 a[130:131], v196 offset:53248
    buffer_load_dwordx4 v8, s[60:63], s16 offen offset:0 lds
    v_mfma_f32_16x16x32_bf16 v[76:79], a[164:167], a[44:47], v[76:79]
    ds_read_b64_tr_b16 a[132:133], v197 offset:49152
    v_mfma_f32_16x16x32_bf16 v[72:75], a[164:167], a[40:43], v[72:75]
    ds_read_b64_tr_b16 a[134:135], v197 offset:53248
    s_waitcnt lgkmcnt(12)
    v_mfma_f32_16x16x32_bf16 v[80:83], a[168:171], a[40:43], v[80:83]
    ds_read_b64_tr_b16 a[136:137], v198 offset:49152
    buffer_load_dwordx4 v58, s[60:63], s16 offen offset:1024 lds
    v_mfma_f32_16x16x32_bf16 v[84:87], a[168:171], a[44:47], v[84:87]
    ds_read_b64_tr_b16 a[138:139], v198 offset:53248
    v_mfma_f32_16x16x32_bf16 v[92:95], a[172:175], a[44:47], v[92:95]
    ds_read_b64_tr_b16 a[140:141], v199 offset:49152
    v_mfma_f32_16x16x32_bf16 v[88:91], a[172:175], a[40:43], v[88:91]
    ds_read_b64_tr_b16 a[142:143], v199 offset:53248
    s_waitcnt lgkmcnt(12)
    v_mfma_f32_16x16x32_bf16 v[96:99], a[176:179], a[40:43], v[96:99]
    ds_read_b64_tr_b16 a[144:145], v200 offset:49152
    buffer_load_dwordx4 v59, s[60:63], s16 offen offset:2048 lds
    v_mfma_f32_16x16x32_bf16 v[100:103], a[176:179], a[44:47], v[100:103]
    ds_read_b64_tr_b16 a[146:147], v200 offset:53248
    v_mfma_f32_16x16x32_bf16 v[108:111], a[180:183], a[44:47], v[108:111]
    ds_read_b64_tr_b16 a[148:149], v201 offset:49152
    v_mfma_f32_16x16x32_bf16 v[104:107], a[180:183], a[40:43], v[104:107]
    ds_read_b64_tr_b16 a[150:151], v201 offset:53248
    s_waitcnt lgkmcnt(12)
    v_mfma_f32_16x16x32_bf16 v[112:115], a[184:187], a[40:43], v[112:115]
    ds_read_b64_tr_b16 a[152:153], v202 offset:49152
    buffer_load_dwordx4 v1, s[60:63], s16 offen offset:3072 lds
    s_add_u32 s16, s16, s31
    v_mfma_f32_16x16x32_bf16 v[116:119], a[184:187], a[44:47], v[116:119]
    ds_read_b64_tr_b16 a[154:155], v202 offset:53248
    v_mfma_f32_16x16x32_bf16 v[124:127], a[188:191], a[44:47], v[124:127]
    ds_read_b64_tr_b16 a[156:157], v203 offset:49152
    v_mfma_f32_16x16x32_bf16 v[120:123], a[188:191], a[40:43], v[120:123]
    ds_read_b64_tr_b16 a[158:159], v203 offset:53248
    s_waitcnt lgkmcnt(12)
    v_mfma_f32_16x16x32_bf16 v[64:67], a[128:131], a[48:51], v[64:67]
    ds_read_b64_tr_b16 a[160:161], v196 offset:57344
    v_mfma_f32_16x16x32_bf16 v[68:71], a[128:131], a[52:55], v[68:71]
    ds_read_b64_tr_b16 a[162:163], v196 offset:61440
    buffer_load_dwordx4 a[96:99], v10, s[20:23], s15 offen offset:0 sc1
    v_mfma_f32_16x16x32_bf16 v[76:79], a[132:135], a[52:55], v[76:79]
    ds_read_b64_tr_b16 a[164:165], v197 offset:57344
    v_mfma_f32_16x16x32_bf16 v[72:75], a[132:135], a[48:51], v[72:75]
    ds_read_b64_tr_b16 a[166:167], v197 offset:61440
    s_waitcnt lgkmcnt(12)
    v_mfma_f32_16x16x32_bf16 v[80:83], a[136:139], a[48:51], v[80:83]
    ds_read_b64_tr_b16 a[168:169], v198 offset:57344
    buffer_load_dwordx4 a[100:103], v10, s[20:23], s15 offen offset:1024 sc1
    v_mfma_f32_16x16x32_bf16 v[84:87], a[136:139], a[52:55], v[84:87]
    ds_read_b64_tr_b16 a[170:171], v198 offset:61440
    v_mfma_f32_16x16x32_bf16 v[92:95], a[140:143], a[52:55], v[92:95]
    ds_read_b64_tr_b16 a[172:173], v199 offset:57344
    v_mfma_f32_16x16x32_bf16 v[88:91], a[140:143], a[48:51], v[88:91]
    ds_read_b64_tr_b16 a[174:175], v199 offset:61440
    s_waitcnt lgkmcnt(12)
    v_mfma_f32_16x16x32_bf16 v[96:99], a[144:147], a[48:51], v[96:99]
    ds_read_b64_tr_b16 a[176:177], v200 offset:57344
    buffer_load_dwordx4 a[104:107], v10, s[20:23], s15 offen offset:2048 sc1
    v_mfma_f32_16x16x32_bf16 v[100:103], a[144:147], a[52:55], v[100:103]
    ds_read_b64_tr_b16 a[178:179], v200 offset:61440
    v_mfma_f32_16x16x32_bf16 v[108:111], a[148:151], a[52:55], v[108:111]
    ds_read_b64_tr_b16 a[180:181], v201 offset:57344
    v_mfma_f32_16x16x32_bf16 v[104:107], a[148:151], a[48:51], v[104:107]
    ds_read_b64_tr_b16 a[182:183], v201 offset:61440
    s_waitcnt lgkmcnt(12)
    v_mfma_f32_16x16x32_bf16 v[112:115], a[152:155], a[48:51], v[112:115]
    ds_read_b64_tr_b16 a[184:185], v202 offset:57344
    buffer_load_dwordx4 a[108:111], v10, s[20:23], s15 offen offset:3072 sc1
    s_add_u32 s15, s15, s34
    v_mfma_f32_16x16x32_bf16 v[116:119], a[152:155], a[52:55], v[116:119]
    ds_read_b64_tr_b16 a[186:187], v202 offset:61440
    v_mfma_f32_16x16x32_bf16 v[124:127], a[156:159], a[52:55], v[124:127]
    ds_read_b64_tr_b16 a[188:189], v203 offset:57344
    v_mfma_f32_16x16x32_bf16 v[120:123], a[156:159], a[48:51], v[120:123]
    ds_read_b64_tr_b16 a[190:191], v203 offset:61440
    s_waitcnt vmcnt(16)
    s_barrier
    s_waitcnt lgkmcnt(12)
    v_mfma_f32_16x16x32_bf16 v[64:67], a[160:163], a[56:59], v[64:67]
    ds_read_b64_tr_b16 a[128:129], v204 offset:0
    s_add_u32 m0, s24, 32768
    v_mfma_f32_16x16x32_bf16 v[68:71], a[160:163], a[60:63], v[68:71]
    ds_read_b64_tr_b16 a[130:131], v204 offset:4096
    buffer_load_dwordx4 v8, s[60:63], s16 offen offset:0 lds
    v_mfma_f32_16x16x32_bf16 v[76:79], a[164:167], a[60:63], v[76:79]
    ds_read_b64_tr_b16 a[132:133], v205 offset:0
    v_mfma_f32_16x16x32_bf16 v[72:75], a[164:167], a[56:59], v[72:75]
    ds_read_b64_tr_b16 a[134:135], v205 offset:4096
    s_waitcnt lgkmcnt(12)
    v_mfma_f32_16x16x32_bf16 v[80:83], a[168:171], a[56:59], v[80:83]
    ds_read_b64_tr_b16 a[136:137], v206 offset:0
    buffer_load_dwordx4 v58, s[60:63], s16 offen offset:1024 lds
    v_mfma_f32_16x16x32_bf16 v[84:87], a[168:171], a[60:63], v[84:87]
    ds_read_b64_tr_b16 a[138:139], v206 offset:4096
    v_mfma_f32_16x16x32_bf16 v[92:95], a[172:175], a[60:63], v[92:95]
    ds_read_b64_tr_b16 a[140:141], v207 offset:0
    v_mfma_f32_16x16x32_bf16 v[88:91], a[172:175], a[56:59], v[88:91]
    ds_read_b64_tr_b16 a[142:143], v207 offset:4096
    s_waitcnt lgkmcnt(12)
    v_mfma_f32_16x16x32_bf16 v[96:99], a[176:179], a[56:59], v[96:99]
    ds_read_b64_tr_b16 a[144:145], v208 offset:0
    buffer_load_dwordx4 v59, s[60:63], s16 offen offset:2048 lds
    v_mfma_f32_16x16x32_bf16 v[100:103], a[176:179], a[60:63], v[100:103]
    ds_read_b64_tr_b16 a[146:147], v208 offset:4096
    v_mfma_f32_16x16x32_bf16 v[108:111], a[180:183], a[60:63], v[108:111]
    ds_read_b64_tr_b16 a[148:149], v209 offset:0
    v_mfma_f32_16x16x32_bf16 v[104:107], a[180:183], a[56:59], v[104:107]
    ds_read_b64_tr_b16 a[150:151], v209 offset:4096
    s_waitcnt lgkmcnt(12)
    v_mfma_f32_16x16x32_bf16 v[112:115], a[184:187], a[56:59], v[112:115]
    ds_read_b64_tr_b16 a[152:153], v210 offset:0
    buffer_load_dwordx4 v1, s[60:63], s16 offen offset:3072 lds
    s_add_u32 s16, s16, s31
    v_mfma_f32_16x16x32_bf16 v[116:119], a[184:187], a[60:63], v[116:119]
    ds_read_b64_tr_b16 a[154:155], v210 offset:4096
    v_mfma_f32_16x16x32_bf16 v[124:127], a[188:191], a[60:63], v[124:127]
    ds_read_b64_tr_b16 a[156:157], v211 offset:0
    v_mfma_f32_16x16x32_bf16 v[120:123], a[188:191], a[56:59], v[120:123]
    ds_read_b64_tr_b16 a[158:159], v211 offset:4096
Lent_44:
    s_waitcnt lgkmcnt(12)
    v_mfma_f32_16x16x32_bf16 v[64:67], a[128:131], a[64:67], v[64:67]
    ds_read_b64_tr_b16 a[160:161], v204 offset:8192
    v_mfma_f32_16x16x32_bf16 v[68:71], a[128:131], a[68:71], v[68:71]
    ds_read_b64_tr_b16 a[162:163], v204 offset:12288
    buffer_load_dwordx4 a[112:115], v10, s[20:23], s15 offen offset:0 sc1
    v_mfma_f32_16x16x32_bf16 v[76:79], a[132:135], a[68:71], v[76:79]
    ds_read_b64_tr_b16 a[164:165], v205 offset:8192
    v_mfma_f32_16x16x32_bf16 v[72:75], a[132:135], a[64:67], v[72:75]
    ds_read_b64_tr_b16 a[166:167], v205 offset:12288
    s_waitcnt lgkmcnt(12)
    v_mfma_f32_16x16x32_bf16 v[80:83], a[136:139], a[64:67], v[80:83]
    ds_read_b64_tr_b16 a[168:169], v206 offset:8192
    buffer_load_dwordx4 a[116:119], v10, s[20:23], s15 offen offset:1024 sc1
    v_mfma_f32_16x16x32_bf16 v[84:87], a[136:139], a[68:71], v[84:87]
    ds_read_b64_tr_b16 a[170:171], v206 offset:12288
    v_mfma_f32_16x16x32_bf16 v[92:95], a[140:143], a[68:71], v[92:95]
    ds_read_b64_tr_b16 a[172:173], v207 offset:8192
    v_mfma_f32_16x16x32_bf16 v[88:91], a[140:143], a[64:67], v[88:91]
    ds_read_b64_tr_b16 a[174:175], v207 offset:12288
    s_waitcnt lgkmcnt(12)
    v_mfma_f32_16x16x32_bf16 v[96:99], a[144:147], a[64:67], v[96:99]
    ds_read_b64_tr_b16 a[176:177], v208 offset:8192
    buffer_load_dwordx4 a[120:123], v10, s[20:23], s15 offen offset:2048 sc1
    v_mfma_f32_16x16x32_bf16 v[100:103], a[144:147], a[68:71], v[100:103]
    ds_read_b64_tr_b16 a[178:179], v208 offset:12288
    v_mfma_f32_16x16x32_bf16 v[108:111], a[148:151], a[68:71], v[108:111]
    ds_read_b64_tr_b16 a[180:181], v209 offset:8192
    v_mfma_f32_16x16x32_bf16 v[104:107], a[148:151], a[64:67], v[104:107]
    ds_read_b64_tr_b16 a[182:183], v209 offset:12288
    s_waitcnt lgkmcnt(12)
    v_mfma_f32_16x16x32_bf16 v[112:115], a[152:155], a[64:67], v[112:115]
    ds_read_b64_tr_b16 a[184:185], v210 offset:8192
    buffer_load_dwordx4 a[124:127], v10, s[20:23], s15 offen offset:3072 sc1
    s_add_u32 s15, s15, s34
    v_mfma_f32_16x16x32_bf16 v[116:119], a[152:155], a[68:71], v[116:119]
    ds_read_b64_tr_b16 a[186:187], v210 offset:12288
    v_mfma_f32_16x16x32_bf16 v[124:127], a[156:159], a[68:71], v[124:127]
    ds_read_b64_tr_b16 a[188:189], v211 offset:8192
    v_mfma_f32_16x16x32_bf16 v[120:123], a[156:159], a[64:67], v[120:123]
    ds_read_b64_tr_b16 a[190:191], v211 offset:12288
    s_waitcnt vmcnt(16)
    s_barrier
    s_waitcnt lgkmcnt(12)
    v_mfma_f32_16x16x32_bf16 v[64:67], a[160:163], a[72:75], v[64:67]
    ds_read_b64_tr_b16 a[128:129], v204 offset:16384
    s_add_u32 m0, s24, 49152
    v_mfma_f32_16x16x32_bf16 v[68:71], a[160:163], a[76:79], v[68:71]
    ds_read_b64_tr_b16 a[130:131], v204 offset:20480
    buffer_load_dwordx4 v8, s[60:63], s16 offen offset:0 lds
    v_mfma_f32_16x16x32_bf16 v[76:79], a[164:167], a[76:79], v[76:79]
    ds_read_b64_tr_b16 a[132:133], v205 offset:16384
    v_mfma_f32_16x16x32_bf16 v[72:75], a[164:167], a[72:75], v[72:75]
    ds_read_b64_tr_b16 a[134:135], v205 offset:20480
    s_waitcnt lgkmcnt(12)
    v_mfma_f32_16x16x32_bf16 v[80:83], a[168:171], a[72:75], v[80:83]
    ds_read_b64_tr_b16 a[136:137], v206 offset:16384
    buffer_load_dwordx4 v58, s[60:63], s16 offen offset:1024 lds
    v_mfma_f32_16x16x32_bf16 v[84:87], a[168:171], a[76:79], v[84:87]
    ds_read_b64_tr_b16 a[138:139], v206 offset:20480
    v_mfma_f32_16x16x32_bf16 v[92:95], a[172:175], a[76:79], v[92:95]
    ds_read_b64_tr_b16 a[140:141], v207 offset:16384
    v_mfma_f32_16x16x32_bf16 v[88:91], a[172:175], a[72:75], v[88:91]
    ds_read_b64_tr_b16 a[142:143], v207 offset:20480
    s_waitcnt lgkmcnt(12)
    v_mfma_f32_16x16x32_bf16 v[96:99], a[176:179], a[72:75], v[96:99]
    ds_read_b64_tr_b16 a[144:145], v208 offset:16384
    buffer_load_dwordx4 v59, s[60:63], s16 offen offset:2048 lds
    v_mfma_f32_16x16x32_bf16 v[100:103], a[176:179], a[76:79], v[100:103]
    ds_read_b64_tr_b16 a[146:147], v208 offset:20480
    v_mfma_f32_16x16x32_bf16 v[108:111], a[180:183], a[76:79], v[108:111]
    ds_read_b64_tr_b16 a[148:149], v209 offset:16384
    v_mfma_f32_16x16x32_bf16 v[104:107], a[180:183], a[72:75], v[104:107]
    ds_read_b64_tr_b16 a[150:151], v209 offset:20480
    s_waitcnt lgkmcnt(12)
    v_mfma_f32_16x16x32_bf16 v[112:115], a[184:187], a[72:75], v[112:115]
    ds_read_b64_tr_b16 a[152:153], v210 offset:16384
    buffer_load_dwordx4 v1, s[60:63], s16 offen offset:3072 lds
    s_add_u32 s16, s16, s31
    v_mfma_f32_16x16x32_bf16 v[116:119], a[184:187], a[76:79], v[116:119]
    ds_read_b64_tr_b16 a[154:155], v210 offset:20480
    v_mfma_f32_16x16x32_bf16 v[124:127], a[188:191], a[76:79], v[124:127]
    ds_read_b64_tr_b16 a[156:157], v211 offset:16384
    v_mfma_f32_16x16x32_bf16 v[120:123], a[188:191], a[72:75], v[120:123]
    ds_read_b64_tr_b16 a[158:159], v211 offset:20480
    s_waitcnt lgkmcnt(12)
    v_mfma_f32_16x16x32_bf16 v[64:67], a[128:131], a[80:83], v[64:67]
    ds_read_b64_tr_b16 a[160:161], v204 offset:24576
    v_mfma_f32_16x16x32_bf16 v[68:71], a[128:131], a[84:87], v[68:71]
    ds_read_b64_tr_b16 a[162:163], v204 offset:28672
    buffer_load_dwordx4 a[0:3], v10, s[20:23], s15 offen offset:0 sc1
    v_mfma_f32_16x16x32_bf16 v[76:79], a[132:135], a[84:87], v[76:79]
    ds_read_b64_tr_b16 a[164:165], v205 offset:24576
    v_mfma_f32_16x16x32_bf16 v[72:75], a[132:135], a[80:83], v[72:75]
    ds_read_b64_tr_b16 a[166:167], v205 offset:28672
    s_waitcnt lgkmcnt(12)
    v_mfma_f32_16x16x32_bf16 v[80:83], a[136:139], a[80:83], v[80:83]
    ds_read_b64_tr_b16 a[168:169], v206 offset:24576
    buffer_load_dwordx4 a[4:7], v10, s[20:23], s15 offen offset:1024 sc1
    v_mfma_f32_16x16x32_bf16 v[84:87], a[136:139], a[84:87], v[84:87]
    ds_read_b64_tr_b16 a[170:171], v206 offset:28672
    v_mfma_f32_16x16x32_bf16 v[92:95], a[140:143], a[84:87], v[92:95]
    ds_read_b64_tr_b16 a[172:173], v207 offset:24576
    v_mfma_f32_16x16x32_bf16 v[88:91], a[140:143], a[80:83], v[88:91]
    ds_read_b64_tr_b16 a[174:175], v207 offset:28672
    s_waitcnt lgkmcnt(12)
    v_mfma_f32_16x16x32_bf16 v[96:99], a[144:147], a[80:83], v[96:99]
    ds_read_b64_tr_b16 a[176:177], v208 offset:24576
    buffer_load_dwordx4 a[8:11], v10, s[20:23], s15 offen offset:2048 sc1
    v_mfma_f32_16x16x32_bf16 v[100:103], a[144:147], a[84:87], v[100:103]
    ds_read_b64_tr_b16 a[178:179], v208 offset:28672
    v_mfma_f32_16x16x32_bf16 v[108:111], a[148:151], a[84:87], v[108:111]
    ds_read_b64_tr_b16 a[180:181], v209 offset:24576
    v_mfma_f32_16x16x32_bf16 v[104:107], a[148:151], a[80:83], v[104:107]
    ds_read_b64_tr_b16 a[182:183], v209 offset:28672
    s_waitcnt lgkmcnt(12)
    v_mfma_f32_16x16x32_bf16 v[112:115], a[152:155], a[80:83], v[112:115]
    ds_read_b64_tr_b16 a[184:185], v210 offset:24576
    buffer_load_dwordx4 a[12:15], v10, s[20:23], s15 offen offset:3072 sc1
    s_add_u32 s15, s15, s34
    v_mfma_f32_16x16x32_bf16 v[116:119], a[152:155], a[84:87], v[116:119]
    ds_read_b64_tr_b16 a[186:187], v210 offset:28672
    v_mfma_f32_16x16x32_bf16 v[124:127], a[156:159], a[84:87], v[124:127]
    ds_read_b64_tr_b16 a[188:189], v211 offset:24576
    v_mfma_f32_16x16x32_bf16 v[120:123], a[156:159], a[80:83], v[120:123]
    ds_read_b64_tr_b16 a[190:191], v211 offset:28672
    s_waitcnt vmcnt(16)
    s_barrier
    s_waitcnt lgkmcnt(12)
    v_mfma_f32_16x16x32_bf16 v[64:67], a[160:163], a[88:91], v[64:67]
    ds_read_b64_tr_b16 a[128:129], v204 offset:32768
    s_add_u32 m0, s24, 65536
    v_mfma_f32_16x16x32_bf16 v[68:71], a[160:163], a[92:95], v[68:71]
    ds_read_b64_tr_b16 a[130:131], v204 offset:36864
    buffer_load_dwordx4 v8, s[60:63], s16 offen offset:0 lds
    v_mfma_f32_16x16x32_bf16 v[76:79], a[164:167], a[92:95], v[76:79]
    ds_read_b64_tr_b16 a[132:133], v205 offset:32768
    v_mfma_f32_16x16x32_bf16 v[72:75], a[164:167], a[88:91], v[72:75]
    ds_read_b64_tr_b16 a[134:135], v205 offset:36864
    s_waitcnt lgkmcnt(12)
    v_mfma_f32_16x16x32_bf16 v[80:83], a[168:171], a[88:91], v[80:83]
    ds_read_b64_tr_b16 a[136:137], v206 offset:32768
    buffer_load_dwordx4 v58, s[60:63], s16 offen offset:1024 lds
    v_mfma_f32_16x16x32_bf16 v[84:87], a[168:171], a[92:95], v[84:87]
    ds_read_b64_tr_b16 a[138:139], v206 offset:36864
    v_mfma_f32_16x16x32_bf16 v[92:95], a[172:175], a[92:95], v[92:95]
    ds_read_b64_tr_b16 a[140:141], v207 offset:32768
    v_mfma_f32_16x16x32_bf16 v[88:91], a[172:175], a[88:91], v[88:91]
    ds_read_b64_tr_b16 a[142:143], v207 offset:36864
    s_waitcnt lgkmcnt(12)
    v_mfma_f32_16x16x32_bf16 v[96:99], a[176:179], a[88:91], v[96:99]
    ds_read_b64_tr_b16 a[144:145], v208 offset:32768
    buffer_load_dwordx4 v59, s[60:63], s16 offen offset:2048 lds
    v_mfma_f32_16x16x32_bf16 v[100:103], a[176:179], a[92:95], v[100:103]
    ds_read_b64_tr_b16 a[146:147], v208 offset:36864
    v_mfma_f32_16x16x32_bf16 v[108:111], a[180:183], a[92:95], v[108:111]
    ds_read_b64_tr_b16 a[148:149], v209 offset:32768
    v_mfma_f32_16x16x32_bf16 v[104:107], a[180:183], a[88:91], v[104:107]
    ds_read_b64_tr_b16 a[150:151], v209 offset:36864
    s_waitcnt lgkmcnt(12)
    v_mfma_f32_16x16x32_bf16 v[112:115], a[184:187], a[88:91], v[112:115]
    ds_read_b64_tr_b16 a[152:153], v210 offset:32768
    buffer_load_dwordx4 v1, s[60:63], s16 offen offset:3072 lds
    s_add_u32 s16, s16, s31
    v_mfma_f32_16x16x32_bf16 v[116:119], a[184:187], a[92:95], v[116:119]
    ds_read_b64_tr_b16 a[154:155], v210 offset:36864
    v_mfma_f32_16x16x32_bf16 v[124:127], a[188:191], a[92:95], v[124:127]
    ds_read_b64_tr_b16 a[156:157], v211 offset:32768
    v_mfma_f32_16x16x32_bf16 v[120:123], a[188:191], a[88:91], v[120:123]
    ds_read_b64_tr_b16 a[158:159], v211 offset:36864
Lent_45:
    s_waitcnt lgkmcnt(12)
    v_mfma_f32_16x16x32_bf16 v[64:67], a[128:131], a[96:99], v[64:67]
    ds_read_b64_tr_b16 a[160:161], v204 offset:40960
    v_mfma_f32_16x16x32_bf16 v[68:71], a[128:131], a[100:103], v[68:71]
    ds_read_b64_tr_b16 a[162:163], v204 offset:45056
    buffer_load_dwordx4 a[16:19], v10, s[20:23], s15 offen offset:0 sc1
    v_mfma_f32_16x16x32_bf16 v[76:79], a[132:135], a[100:103], v[76:79]
    ds_read_b64_tr_b16 a[164:165], v205 offset:40960
    v_mfma_f32_16x16x32_bf16 v[72:75], a[132:135], a[96:99], v[72:75]
    ds_read_b64_tr_b16 a[166:167], v205 offset:45056
    s_waitcnt lgkmcnt(12)
    v_mfma_f32_16x16x32_bf16 v[80:83], a[136:139], a[96:99], v[80:83]
    ds_read_b64_tr_b16 a[168:169], v206 offset:40960
    buffer_load_dwordx4 a[20:23], v10, s[20:23], s15 offen offset:1024 sc1
    v_mfma_f32_16x16x32_bf16 v[84:87], a[136:139], a[100:103], v[84:87]
    ds_read_b64_tr_b16 a[170:171], v206 offset:45056
    v_mfma_f32_16x16x32_bf16 v[92:95], a[140:143], a[100:103], v[92:95]
    ds_read_b64_tr_b16 a[172:173], v207 offset:40960
    v_mfma_f32_16x16x32_bf16 v[88:91], a[140:143], a[96:99], v[88:91]
    ds_read_b64_tr_b16 a[174:175], v207 offset:45056
    s_waitcnt lgkmcnt(12)
    v_mfma_f32_16x16x32_bf16 v[96:99], a[144:147], a[96:99], v[96:99]
    ds_read_b64_tr_b16 a[176:177], v208 offset:40960
    buffer_load_dwordx4 a[24:27], v10, s[20:23], s15 offen offset:2048 sc1
    v_mfma_f32_16x16x32_bf16 v[100:103], a[144:147], a[100:103], v[100:103]
    ds_read_b64_tr_b16 a[178:179], v208 offset:45056
    v_mfma_f32_16x16x32_bf16 v[108:111], a[148:151], a[100:103], v[108:111]
    ds_read_b64_tr_b16 a[180:181], v209 offset:40960
    v_mfma_f32_16x16x32_bf16 v[104:107], a[148:151], a[96:99], v[104:107]
    ds_read_b64_tr_b16 a[182:183], v209 offset:45056
    s_waitcnt lgkmcnt(12)
    v_mfma_f32_16x16x32_bf16 v[112:115], a[152:155], a[96:99], v[112:115]
    ds_read_b64_tr_b16 a[184:185], v210 offset:40960
    buffer_load_dwordx4 a[28:31], v10, s[20:23], s15 offen offset:3072 sc1
    s_add_u32 s15, s15, s34
    v_mfma_f32_16x16x32_bf16 v[116:119], a[152:155], a[100:103], v[116:119]
    ds_read_b64_tr_b16 a[186:187], v210 offset:45056
    v_mfma_f32_16x16x32_bf16 v[124:127], a[156:159], a[100:103], v[124:127]
    ds_read_b64_tr_b16 a[188:189], v211 offset:40960
    v_mfma_f32_16x16x32_bf16 v[120:123], a[156:159], a[96:99], v[120:123]
    ds_read_b64_tr_b16 a[190:191], v211 offset:45056
    s_waitcnt vmcnt(16)
    s_barrier
    s_waitcnt lgkmcnt(12)
    v_mfma_f32_16x16x32_bf16 v[64:67], a[160:163], a[104:107], v[64:67]
    ds_read_b64_tr_b16 a[128:129], v204 offset:49152
    s_add_u32 m0, s24, 81920
    v_mfma_f32_16x16x32_bf16 v[68:71], a[160:163], a[108:111], v[68:71]
    ds_read_b64_tr_b16 a[130:131], v204 offset:53248
    buffer_load_dwordx4 v8, s[60:63], s16 offen offset:0 lds
    v_mfma_f32_16x16x32_bf16 v[76:79], a[164:167], a[108:111], v[76:79]
    ds_read_b64_tr_b16 a[132:133], v205 offset:49152
    v_mfma_f32_16x16x32_bf16 v[72:75], a[164:167], a[104:107], v[72:75]
    ds_read_b64_tr_b16 a[134:135], v205 offset:53248
    s_waitcnt lgkmcnt(12)
    v_mfma_f32_16x16x32_bf16 v[80:83], a[168:171], a[104:107], v[80:83]
    ds_read_b64_tr_b16 a[136:137], v206 offset:49152
    buffer_load_dwordx4 v58, s[60:63], s16 offen offset:1024 lds
    v_mfma_f32_16x16x32_bf16 v[84:87], a[168:171], a[108:111], v[84:87]
    ds_read_b64_tr_b16 a[138:139], v206 offset:53248
    v_mfma_f32_16x16x32_bf16 v[92:95], a[172:175], a[108:111], v[92:95]
    ds_read_b64_tr_b16 a[140:141], v207 offset:49152
    v_mfma_f32_16x16x32_bf16 v[88:91], a[172:175], a[104:107], v[88:91]
    ds_read_b64_tr_b16 a[142:143], v207 offset:53248
    s_waitcnt lgkmcnt(12)
    v_mfma_f32_16x16x32_bf16 v[96:99], a[176:179], a[104:107], v[96:99]
    ds_read_b64_tr_b16 a[144:145], v208 offset:49152
    buffer_load_dwordx4 v59, s[60:63], s16 offen offset:2048 lds
    v_mfma_f32_16x16x32_bf16 v[100:103], a[176:179], a[108:111], v[100:103]
    ds_read_b64_tr_b16 a[146:147], v208 offset:53248
    v_mfma_f32_16x16x32_bf16 v[108:111], a[180:183], a[108:111], v[108:111]
    ds_read_b64_tr_b16 a[148:149], v209 offset:49152
    v_mfma_f32_16x16x32_bf16 v[104:107], a[180:183], a[104:107], v[104:107]
    ds_read_b64_tr_b16 a[150:151], v209 offset:53248
    s_waitcnt lgkmcnt(12)
    v_mfma_f32_16x16x32_bf16 v[112:115], a[184:187], a[104:107], v[112:115]
    ds_read_b64_tr_b16 a[152:153], v210 offset:49152
    buffer_load_dwordx4 v1, s[60:63], s16 offen offset:3072 lds
    s_add_u32 s16, s16, s31
    v_mfma_f32_16x16x32_bf16 v[116:119], a[184:187], a[108:111], v[116:119]
    ds_read_b64_tr_b16 a[154:155], v210 offset:53248
    v_mfma_f32_16x16x32_bf16 v[124:127], a[188:191], a[108:111], v[124:127]
    ds_read_b64_tr_b16 a[156:157], v211 offset:49152
    v_mfma_f32_16x16x32_bf16 v[120:123], a[188:191], a[104:107], v[120:123]
    ds_read_b64_tr_b16 a[158:159], v211 offset:53248
    s_waitcnt lgkmcnt(12)
    v_mfma_f32_16x16x32_bf16 v[64:67], a[128:131], a[112:115], v[64:67]
    ds_read_b64_tr_b16 a[160:161], v204 offset:57344
    v_mfma_f32_16x16x32_bf16 v[68:71], a[128:131], a[116:119], v[68:71]
    ds_read_b64_tr_b16 a[162:163], v204 offset:61440
    buffer_load_dwordx4 a[32:35], v10, s[20:23], s15 offen offset:0 sc1
    v_mfma_f32_16x16x32_bf16 v[76:79], a[132:135], a[116:119], v[76:79]
    ds_read_b64_tr_b16 a[164:165], v205 offset:57344
    v_mfma_f32_16x16x32_bf16 v[72:75], a[132:135], a[112:115], v[72:75]
    ds_read_b64_tr_b16 a[166:167], v205 offset:61440
    s_waitcnt lgkmcnt(12)
    v_mfma_f32_16x16x32_bf16 v[80:83], a[136:139], a[112:115], v[80:83]
    ds_read_b64_tr_b16 a[168:169], v206 offset:57344
    buffer_load_dwordx4 a[36:39], v10, s[20:23], s15 offen offset:1024 sc1
    v_mfma_f32_16x16x32_bf16 v[84:87], a[136:139], a[116:119], v[84:87]
    ds_read_b64_tr_b16 a[170:171], v206 offset:61440
    v_mfma_f32_16x16x32_bf16 v[92:95], a[140:143], a[116:119], v[92:95]
    ds_read_b64_tr_b16 a[172:173], v207 offset:57344
    v_mfma_f32_16x16x32_bf16 v[88:91], a[140:143], a[112:115], v[88:91]
    ds_read_b64_tr_b16 a[174:175], v207 offset:61440
    s_waitcnt lgkmcnt(12)
    v_mfma_f32_16x16x32_bf16 v[96:99], a[144:147], a[112:115], v[96:99]
    ds_read_b64_tr_b16 a[176:177], v208 offset:57344
    buffer_load_dwordx4 a[40:43], v10, s[20:23], s15 offen offset:2048 sc1
    v_mfma_f32_16x16x32_bf16 v[100:103], a[144:147], a[116:119], v[100:103]
    ds_read_b64_tr_b16 a[178:179], v208 offset:61440
    v_mfma_f32_16x16x32_bf16 v[108:111], a[148:151], a[116:119], v[108:111]
    ds_read_b64_tr_b16 a[180:181], v209 offset:57344
    v_mfma_f32_16x16x32_bf16 v[104:107], a[148:151], a[112:115], v[104:107]
    ds_read_b64_tr_b16 a[182:183], v209 offset:61440
    s_waitcnt lgkmcnt(12)
    v_mfma_f32_16x16x32_bf16 v[112:115], a[152:155], a[112:115], v[112:115]
    ds_read_b64_tr_b16 a[184:185], v210 offset:57344
    buffer_load_dwordx4 a[44:47], v10, s[20:23], s15 offen offset:3072 sc1
    s_add_u32 s15, s15, s34
    v_mfma_f32_16x16x32_bf16 v[116:119], a[152:155], a[116:119], v[116:119]
    ds_read_b64_tr_b16 a[186:187], v210 offset:61440
    v_mfma_f32_16x16x32_bf16 v[124:127], a[156:159], a[116:119], v[124:127]
    ds_read_b64_tr_b16 a[188:189], v211 offset:57344
    v_mfma_f32_16x16x32_bf16 v[120:123], a[156:159], a[112:115], v[120:123]
    ds_read_b64_tr_b16 a[190:191], v211 offset:61440
    s_waitcnt vmcnt(16)
    s_barrier
    s_waitcnt lgkmcnt(12)
    v_mfma_f32_16x16x32_bf16 v[64:67], a[160:163], a[120:123], v[64:67]
    ds_read_b64_tr_b16 a[128:129], v196 offset:0
    s_add_u32 m0, s24, 98304
    v_mfma_f32_16x16x32_bf16 v[68:71], a[160:163], a[124:127], v[68:71]
    ds_read_b64_tr_b16 a[130:131], v196 offset:4096
    buffer_load_dwordx4 v8, s[60:63], s16 offen offset:0 lds
    v_mfma_f32_16x16x32_bf16 v[76:79], a[164:167], a[124:127], v[76:79]
    ds_read_b64_tr_b16 a[132:133], v197 offset:0
    v_mfma_f32_16x16x32_bf16 v[72:75], a[164:167], a[120:123], v[72:75]
    ds_read_b64_tr_b16 a[134:135], v197 offset:4096
    s_waitcnt lgkmcnt(12)
    v_mfma_f32_16x16x32_bf16 v[80:83], a[168:171], a[120:123], v[80:83]
    ds_read_b64_tr_b16 a[136:137], v198 offset:0
    buffer_load_dwordx4 v58, s[60:63], s16 offen offset:1024 lds
    v_mfma_f32_16x16x32_bf16 v[84:87], a[168:171], a[124:127], v[84:87]
    ds_read_b64_tr_b16 a[138:139], v198 offset:4096
    v_mfma_f32_16x16x32_bf16 v[92:95], a[172:175], a[124:127], v[92:95]
    ds_read_b64_tr_b16 a[140:141], v199 offset:0
    v_mfma_f32_16x16x32_bf16 v[88:91], a[172:175], a[120:123], v[88:91]
    ds_read_b64_tr_b16 a[142:143], v199 offset:4096
    s_waitcnt lgkmcnt(12)
    v_mfma_f32_16x16x32_bf16 v[96:99], a[176:179], a[120:123], v[96:99]
    ds_read_b64_tr_b16 a[144:145], v200 offset:0
    buffer_load_dwordx4 v59, s[60:63], s16 offen offset:2048 lds
    v_mfma_f32_16x16x32_bf16 v[100:103], a[176:179], a[124:127], v[100:103]
    ds_read_b64_tr_b16 a[146:147], v200 offset:4096
    v_mfma_f32_16x16x32_bf16 v[108:111], a[180:183], a[124:127], v[108:111]
    ds_read_b64_tr_b16 a[148:149], v201 offset:0
    v_mfma_f32_16x16x32_bf16 v[104:107], a[180:183], a[120:123], v[104:107]
    ds_read_b64_tr_b16 a[150:151], v201 offset:4096
    s_waitcnt lgkmcnt(12)
    v_mfma_f32_16x16x32_bf16 v[112:115], a[184:187], a[120:123], v[112:115]
    ds_read_b64_tr_b16 a[152:153], v202 offset:0
    buffer_load_dwordx4 v1, s[60:63], s16 offen offset:3072 lds
    s_add_u32 s16, s16, s31
    v_mfma_f32_16x16x32_bf16 v[116:119], a[184:187], a[124:127], v[116:119]
    ds_read_b64_tr_b16 a[154:155], v202 offset:4096
    v_mfma_f32_16x16x32_bf16 v[124:127], a[188:191], a[124:127], v[124:127]
    ds_read_b64_tr_b16 a[156:157], v203 offset:0
    v_mfma_f32_16x16x32_bf16 v[120:123], a[188:191], a[120:123], v[120:123]
    ds_read_b64_tr_b16 a[158:159], v203 offset:4096
Lent_46:
    s_waitcnt lgkmcnt(12)
    v_mfma_f32_16x16x32_bf16 v[64:67], a[128:131], a[0:3], v[64:67]
    ds_read_b64_tr_b16 a[160:161], v196 offset:8192
    v_mfma_f32_16x16x32_bf16 v[68:71], a[128:131], a[4:7], v[68:71]
    ds_read_b64_tr_b16 a[162:163], v196 offset:12288
    buffer_load_dwordx4 a[48:51], v10, s[20:23], s15 offen offset:0 sc1
    v_mfma_f32_16x16x32_bf16 v[76:79], a[132:135], a[4:7], v[76:79]
    ds_read_b64_tr_b16 a[164:165], v197 offset:8192
    v_mfma_f32_16x16x32_bf16 v[72:75], a[132:135], a[0:3], v[72:75]
    ds_read_b64_tr_b16 a[166:167], v197 offset:12288
    s_waitcnt lgkmcnt(12)
    v_mfma_f32_16x16x32_bf16 v[80:83], a[136:139], a[0:3], v[80:83]
    ds_read_b64_tr_b16 a[168:169], v198 offset:8192
    buffer_load_dwordx4 a[52:55], v10, s[20:23], s15 offen offset:1024 sc1
    v_mfma_f32_16x16x32_bf16 v[84:87], a[136:139], a[4:7], v[84:87]
    ds_read_b64_tr_b16 a[170:171], v198 offset:12288
    v_mfma_f32_16x16x32_bf16 v[92:95], a[140:143], a[4:7], v[92:95]
    ds_read_b64_tr_b16 a[172:173], v199 offset:8192
    v_mfma_f32_16x16x32_bf16 v[88:91], a[140:143], a[0:3], v[88:91]
    ds_read_b64_tr_b16 a[174:175], v199 offset:12288
    s_waitcnt lgkmcnt(12)
    v_mfma_f32_16x16x32_bf16 v[96:99], a[144:147], a[0:3], v[96:99]
    ds_read_b64_tr_b16 a[176:177], v200 offset:8192
    buffer_load_dwordx4 a[56:59], v10, s[20:23], s15 offen offset:2048 sc1
    v_mfma_f32_16x16x32_bf16 v[100:103], a[144:147], a[4:7], v[100:103]
    ds_read_b64_tr_b16 a[178:179], v200 offset:12288
    v_mfma_f32_16x16x32_bf16 v[108:111], a[148:151], a[4:7], v[108:111]
    ds_read_b64_tr_b16 a[180:181], v201 offset:8192
    v_mfma_f32_16x16x32_bf16 v[104:107], a[148:151], a[0:3], v[104:107]
    ds_read_b64_tr_b16 a[182:183], v201 offset:12288
    s_waitcnt lgkmcnt(12)
    v_mfma_f32_16x16x32_bf16 v[112:115], a[152:155], a[0:3], v[112:115]
    ds_read_b64_tr_b16 a[184:185], v202 offset:8192
    buffer_load_dwordx4 a[60:63], v10, s[20:23], s15 offen offset:3072 sc1
    s_add_u32 s15, s15, s34
    v_mfma_f32_16x16x32_bf16 v[116:119], a[152:155], a[4:7], v[116:119]
    ds_read_b64_tr_b16 a[186:187], v202 offset:12288
    v_mfma_f32_16x16x32_bf16 v[124:127], a[156:159], a[4:7], v[124:127]
    ds_read_b64_tr_b16 a[188:189], v203 offset:8192
    v_mfma_f32_16x16x32_bf16 v[120:123], a[156:159], a[0:3], v[120:123]
    ds_read_b64_tr_b16 a[190:191], v203 offset:12288
    s_waitcnt vmcnt(16)
    s_barrier
    s_waitcnt lgkmcnt(12)
    v_mfma_f32_16x16x32_bf16 v[64:67], a[160:163], a[8:11], v[64:67]
    ds_read_b64_tr_b16 a[128:129], v196 offset:16384
    v_mfma_f32_16x16x32_bf16 v[68:71], a[160:163], a[12:15], v[68:71]
    ds_read_b64_tr_b16 a[130:131], v196 offset:20480
    buffer_store_dword v213, v192, s[68:71], s58 offen sc1
    v_mfma_f32_16x16x32_bf16 v[76:79], a[164:167], a[12:15], v[76:79]
    ds_read_b64_tr_b16 a[132:133], v197 offset:16384
    v_mfma_f32_16x16x32_bf16 v[72:75], a[164:167], a[8:11], v[72:75]
    ds_read_b64_tr_b16 a[134:135], v197 offset:20480
    s_add_u32 m0, s24, 114688
    s_waitcnt lgkmcnt(12)
    v_mfma_f32_16x16x32_bf16 v[80:83], a[168:171], a[8:11], v[80:83]
    ds_read_b64_tr_b16 a[136:137], v198 offset:16384
    buffer_load_dwordx4 v8, s[60:63], s16 offen offset:0 lds
    v_mfma_f32_16x16x32_bf16 v[84:87], a[168:171], a[12:15], v[84:87]
    ds_read_b64_tr_b16 a[138:139], v198 offset:20480
    v_mfma_f32_16x16x32_bf16 v[92:95], a[172:175], a[12:15], v[92:95]
    ds_read_b64_tr_b16 a[140:141], v199 offset:16384
    v_mfma_f32_16x16x32_bf16 v[88:91], a[172:175], a[8:11], v[88:91]
    ds_read_b64_tr_b16 a[142:143], v199 offset:20480
    buffer_load_dwordx4 v58, s[60:63], s16 offen offset:1024 lds
    s_waitcnt lgkmcnt(12)
    v_mfma_f32_16x16x32_bf16 v[96:99], a[176:179], a[8:11], v[96:99]
    ds_read_b64_tr_b16 a[144:145], v200 offset:16384
    v_mfma_f32_16x16x32_bf16 v[100:103], a[176:179], a[12:15], v[100:103]
    ds_read_b64_tr_b16 a[146:147], v200 offset:20480
    v_mfma_f32_16x16x32_bf16 v[108:111], a[180:183], a[12:15], v[108:111]
    ds_read_b64_tr_b16 a[148:149], v201 offset:16384
    buffer_load_dwordx4 v59, s[60:63], s16 offen offset:2048 lds
    v_mfma_f32_16x16x32_bf16 v[104:107], a[180:183], a[8:11], v[104:107]
    ds_read_b64_tr_b16 a[150:151], v201 offset:20480
    s_waitcnt lgkmcnt(12)
    v_mfma_f32_16x16x32_bf16 v[112:115], a[184:187], a[8:11], v[112:115]
    ds_read_b64_tr_b16 a[152:153], v202 offset:16384
    v_mfma_f32_16x16x32_bf16 v[116:119], a[184:187], a[12:15], v[116:119]
    ds_read_b64_tr_b16 a[154:155], v202 offset:20480
    buffer_load_dwordx4 v1, s[60:63], s16 offen offset:3072 lds
    s_add_u32 s16, s16, s31
    v_mfma_f32_16x16x32_bf16 v[124:127], a[188:191], a[12:15], v[124:127]
    ds_read_b64_tr_b16 a[156:157], v203 offset:16384
    v_mfma_f32_16x16x32_bf16 v[120:123], a[188:191], a[8:11], v[120:123]
    ds_read_b64_tr_b16 a[158:159], v203 offset:20480
    s_waitcnt lgkmcnt(12)
    v_mfma_f32_16x16x32_bf16 v[64:67], a[128:131], a[16:19], v[64:67]
    ds_read_b64_tr_b16 a[160:161], v196 offset:24576
    v_mfma_f32_16x16x32_bf16 v[68:71], a[128:131], a[20:23], v[68:71]
    ds_read_b64_tr_b16 a[162:163], v196 offset:28672
    buffer_load_dwordx4 a[64:67], v10, s[20:23], s15 offen offset:0 sc1
    v_mfma_f32_16x16x32_bf16 v[76:79], a[132:135], a[20:23], v[76:79]
    ds_read_b64_tr_b16 a[164:165], v197 offset:24576
    v_mfma_f32_16x16x32_bf16 v[72:75], a[132:135], a[16:19], v[72:75]
    ds_read_b64_tr_b16 a[166:167], v197 offset:28672
    s_waitcnt lgkmcnt(12)
    v_mfma_f32_16x16x32_bf16 v[80:83], a[136:139], a[16:19], v[80:83]
    ds_read_b64_tr_b16 a[168:169], v198 offset:24576
    buffer_load_dwordx4 a[68:71], v10, s[20:23], s15 offen offset:1024 sc1
    v_mfma_f32_16x16x32_bf16 v[84:87], a[136:139], a[20:23], v[84:87]
    ds_read_b64_tr_b16 a[170:171], v198 offset:28672
    v_mfma_f32_16x16x32_bf16 v[92:95], a[140:143], a[20:23], v[92:95]
    ds_read_b64_tr_b16 a[172:173], v199 offset:24576
    v_mfma_f32_16x16x32_bf16 v[88:91], a[140:143], a[16:19], v[88:91]
    ds_read_b64_tr_b16 a[174:175], v199 offset:28672
    s_waitcnt lgkmcnt(12)
    v_mfma_f32_16x16x32_bf16 v[96:99], a[144:147], a[16:19], v[96:99]
    ds_read_b64_tr_b16 a[176:177], v200 offset:24576
    buffer_load_dwordx4 a[72:75], v10, s[20:23], s15 offen offset:2048 sc1
    v_mfma_f32_16x16x32_bf16 v[100:103], a[144:147], a[20:23], v[100:103]
    ds_read_b64_tr_b16 a[178:179], v200 offset:28672
    v_mfma_f32_16x16x32_bf16 v[108:111], a[148:151], a[20:23], v[108:111]
    ds_read_b64_tr_b16 a[180:181], v201 offset:24576
    v_mfma_f32_16x16x32_bf16 v[104:107], a[148:151], a[16:19], v[104:107]
    ds_read_b64_tr_b16 a[182:183], v201 offset:28672
    s_waitcnt lgkmcnt(12)
    v_mfma_f32_16x16x32_bf16 v[112:115], a[152:155], a[16:19], v[112:115]
    ds_read_b64_tr_b16 a[184:185], v202 offset:24576
    buffer_load_dwordx4 a[76:79], v10, s[20:23], s15 offen offset:3072 sc1
    s_add_u32 s15, s15, s34
    v_mfma_f32_16x16x32_bf16 v[116:119], a[152:155], a[20:23], v[116:119]
    ds_read_b64_tr_b16 a[186:187], v202 offset:28672
    v_mfma_f32_16x16x32_bf16 v[124:127], a[156:159], a[20:23], v[124:127]
    ds_read_b64_tr_b16 a[188:189], v203 offset:24576
    v_mfma_f32_16x16x32_bf16 v[120:123], a[156:159], a[16:19], v[120:123]
    ds_read_b64_tr_b16 a[190:191], v203 offset:28672
    s_waitcnt vmcnt(17)
    s_barrier
    s_waitcnt lgkmcnt(12)
    v_mfma_f32_16x16x32_bf16 v[64:67], a[160:163], a[24:27], v[64:67]
    ds_read_b64_tr_b16 a[128:129], v196 offset:32768
    s_add_u32 m0, s24, 0
    v_mfma_f32_16x16x32_bf16 v[68:71], a[160:163], a[28:31], v[68:71]
    ds_read_b64_tr_b16 a[130:131], v196 offset:36864
    buffer_load_dwordx4 v8, s[60:63], s16 offen offset:0 lds
    v_mfma_f32_16x16x32_bf16 v[76:79], a[164:167], a[28:31], v[76:79]
    ds_read_b64_tr_b16 a[132:133], v197 offset:32768
    v_mfma_f32_16x16x32_bf16 v[72:75], a[164:167], a[24:27], v[72:75]
    ds_read_b64_tr_b16 a[134:135], v197 offset:36864
    s_waitcnt lgkmcnt(12)
    v_mfma_f32_16x16x32_bf16 v[80:83], a[168:171], a[24:27], v[80:83]
    ds_read_b64_tr_b16 a[136:137], v198 offset:32768
    buffer_load_dwordx4 v58, s[60:63], s16 offen offset:1024 lds
    v_mfma_f32_16x16x32_bf16 v[84:87], a[168:171], a[28:31], v[84:87]
    ds_read_b64_tr_b16 a[138:139], v198 offset:36864
    v_mfma_f32_16x16x32_bf16 v[92:95], a[172:175], a[28:31], v[92:95]
    ds_read_b64_tr_b16 a[140:141], v199 offset:32768
    v_mfma_f32_16x16x32_bf16 v[88:91], a[172:175], a[24:27], v[88:91]
    ds_read_b64_tr_b16 a[142:143], v199 offset:36864
    s_waitcnt lgkmcnt(12)
    v_mfma_f32_16x16x32_bf16 v[96:99], a[176:179], a[24:27], v[96:99]
    ds_read_b64_tr_b16 a[144:145], v200 offset:32768
    buffer_load_dwordx4 v59, s[60:63], s16 offen offset:2048 lds
    v_mfma_f32_16x16x32_bf16 v[100:103], a[176:179], a[28:31], v[100:103]
    ds_read_b64_tr_b16 a[146:147], v200 offset:36864
    v_mfma_f32_16x16x32_bf16 v[108:111], a[180:183], a[28:31], v[108:111]
    ds_read_b64_tr_b16 a[148:149], v201 offset:32768
    v_mfma_f32_16x16x32_bf16 v[104:107], a[180:183], a[24:27], v[104:107]
    ds_read_b64_tr_b16 a[150:151], v201 offset:36864
    s_waitcnt lgkmcnt(12)
    v_mfma_f32_16x16x32_bf16 v[112:115], a[184:187], a[24:27], v[112:115]
    ds_read_b64_tr_b16 a[152:153], v202 offset:32768
    buffer_load_dwordx4 v1, s[60:63], s16 offen offset:3072 lds
    s_add_u32 s16, s16, s31
    v_mfma_f32_16x16x32_bf16 v[116:119], a[184:187], a[28:31], v[116:119]
    ds_read_b64_tr_b16 a[154:155], v202 offset:36864
    v_mfma_f32_16x16x32_bf16 v[124:127], a[188:191], a[28:31], v[124:127]
    ds_read_b64_tr_b16 a[156:157], v203 offset:32768
    v_mfma_f32_16x16x32_bf16 v[120:123], a[188:191], a[24:27], v[120:123]
    ds_read_b64_tr_b16 a[158:159], v203 offset:36864
    s_waitcnt lgkmcnt(12)
    v_mfma_f32_16x16x32_bf16 v[64:67], a[128:131], a[32:35], v[64:67]
    ds_read_b64_tr_b16 a[160:161], v196 offset:40960
    v_mfma_f32_16x16x32_bf16 v[68:71], a[128:131], a[36:39], v[68:71]
    ds_read_b64_tr_b16 a[162:163], v196 offset:45056
    buffer_load_dwordx4 a[80:83], v10, s[20:23], s15 offen offset:0 sc1
    v_mfma_f32_16x16x32_bf16 v[76:79], a[132:135], a[36:39], v[76:79]
    ds_read_b64_tr_b16 a[164:165], v197 offset:40960
    v_mfma_f32_16x16x32_bf16 v[72:75], a[132:135], a[32:35], v[72:75]
    ds_read_b64_tr_b16 a[166:167], v197 offset:45056
    s_waitcnt lgkmcnt(12)
    v_mfma_f32_16x16x32_bf16 v[80:83], a[136:139], a[32:35], v[80:83]
    ds_read_b64_tr_b16 a[168:169], v198 offset:40960
    buffer_load_dwordx4 a[84:87], v10, s[20:23], s15 offen offset:1024 sc1
    v_mfma_f32_16x16x32_bf16 v[84:87], a[136:139], a[36:39], v[84:87]
    ds_read_b64_tr_b16 a[170:171], v198 offset:45056
    v_mfma_f32_16x16x32_bf16 v[92:95], a[140:143], a[36:39], v[92:95]
    ds_read_b64_tr_b16 a[172:173], v199 offset:40960
    v_mfma_f32_16x16x32_bf16 v[88:91], a[140:143], a[32:35], v[88:91]
    ds_read_b64_tr_b16 a[174:175], v199 offset:45056
    s_waitcnt lgkmcnt(12)
    v_mfma_f32_16x16x32_bf16 v[96:99], a[144:147], a[32:35], v[96:99]
    ds_read_b64_tr_b16 a[176:177], v200 offset:40960
    buffer_load_dwordx4 a[88:91], v10, s[20:23], s15 offen offset:2048 sc1
    v_mfma_f32_16x16x32_bf16 v[100:103], a[144:147], a[36:39], v[100:103]
    ds_read_b64_tr_b16 a[178:179], v200 offset:45056
    v_mfma_f32_16x16x32_bf16 v[108:111], a[148:151], a[36:39], v[108:111]
    ds_read_b64_tr_b16 a[180:181], v201 offset:40960
    v_mfma_f32_16x16x32_bf16 v[104:107], a[148:151], a[32:35], v[104:107]
    ds_read_b64_tr_b16 a[182:183], v201 offset:45056
    s_waitcnt lgkmcnt(12)
    v_mfma_f32_16x16x32_bf16 v[112:115], a[152:155], a[32:35], v[112:115]
    ds_read_b64_tr_b16 a[184:185], v202 offset:40960
    buffer_load_dwordx4 a[92:95], v10, s[20:23], s15 offen offset:3072 sc1
    s_add_u32 s15, s15, s34
    v_mfma_f32_16x16x32_bf16 v[116:119], a[152:155], a[36:39], v[116:119]
    ds_read_b64_tr_b16 a[186:187], v202 offset:45056
    v_mfma_f32_16x16x32_bf16 v[124:127], a[156:159], a[36:39], v[124:127]
    ds_read_b64_tr_b16 a[188:189], v203 offset:40960
    v_mfma_f32_16x16x32_bf16 v[120:123], a[156:159], a[32:35], v[120:123]
    ds_read_b64_tr_b16 a[190:191], v203 offset:45056
    s_waitcnt vmcnt(17)
    s_barrier
    s_waitcnt lgkmcnt(12)
    v_mfma_f32_16x16x32_bf16 v[64:67], a[160:163], a[40:43], v[64:67]
    ds_read_b64_tr_b16 a[128:129], v196 offset:49152
    s_add_u32 m0, s24, 16384
    v_mfma_f32_16x16x32_bf16 v[68:71], a[160:163], a[44:47], v[68:71]
    ds_read_b64_tr_b16 a[130:131], v196 offset:53248
    buffer_load_dwordx4 v8, s[60:63], s16 offen offset:0 lds
    v_mfma_f32_16x16x32_bf16 v[76:79], a[164:167], a[44:47], v[76:79]
    ds_read_b64_tr_b16 a[132:133], v197 offset:49152
    v_mfma_f32_16x16x32_bf16 v[72:75], a[164:167], a[40:43], v[72:75]
    ds_read_b64_tr_b16 a[134:135], v197 offset:53248
    s_waitcnt lgkmcnt(12)
    v_mfma_f32_16x16x32_bf16 v[80:83], a[168:171], a[40:43], v[80:83]
    ds_read_b64_tr_b16 a[136:137], v198 offset:49152
    buffer_load_dwordx4 v58, s[60:63], s16 offen offset:1024 lds
    v_mfma_f32_16x16x32_bf16 v[84:87], a[168:171], a[44:47], v[84:87]
    ds_read_b64_tr_b16 a[138:139], v198 offset:53248
    v_mfma_f32_16x16x32_bf16 v[92:95], a[172:175], a[44:47], v[92:95]
    ds_read_b64_tr_b16 a[140:141], v199 offset:49152
    v_mfma_f32_16x16x32_bf16 v[88:91], a[172:175], a[40:43], v[88:91]
    ds_read_b64_tr_b16 a[142:143], v199 offset:53248
    s_waitcnt lgkmcnt(12)
    v_mfma_f32_16x16x32_bf16 v[96:99], a[176:179], a[40:43], v[96:99]
    ds_read_b64_tr_b16 a[144:145], v200 offset:49152
    buffer_load_dwordx4 v59, s[60:63], s16 offen offset:2048 lds
    v_mfma_f32_16x16x32_bf16 v[100:103], a[176:179], a[44:47], v[100:103]
    ds_read_b64_tr_b16 a[146:147], v200 offset:53248
    v_mfma_f32_16x16x32_bf16 v[108:111], a[180:183], a[44:47], v[108:111]
    ds_read_b64_tr_b16 a[148:149], v201 offset:49152
    v_mfma_f32_16x16x32_bf16 v[104:107], a[180:183], a[40:43], v[104:107]
    ds_read_b64_tr_b16 a[150:151], v201 offset:53248
    s_waitcnt lgkmcnt(12)
    v_mfma_f32_16x16x32_bf16 v[112:115], a[184:187], a[40:43], v[112:115]
    ds_read_b64_tr_b16 a[152:153], v202 offset:49152
    buffer_load_dwordx4 v1, s[60:63], s16 offen offset:3072 lds
    s_add_u32 s16, s16, s31
    v_mfma_f32_16x16x32_bf16 v[116:119], a[184:187], a[44:47], v[116:119]
    ds_read_b64_tr_b16 a[154:155], v202 offset:53248
    v_mfma_f32_16x16x32_bf16 v[124:127], a[188:191], a[44:47], v[124:127]
    ds_read_b64_tr_b16 a[156:157], v203 offset:49152
    v_mfma_f32_16x16x32_bf16 v[120:123], a[188:191], a[40:43], v[120:123]
    ds_read_b64_tr_b16 a[158:159], v203 offset:53248
    s_waitcnt lgkmcnt(12)
    v_mfma_f32_16x16x32_bf16 v[64:67], a[128:131], a[48:51], v[64:67]
    ds_read_b64_tr_b16 a[160:161], v196 offset:57344
    v_mfma_f32_16x16x32_bf16 v[68:71], a[128:131], a[52:55], v[68:71]
    ds_read_b64_tr_b16 a[162:163], v196 offset:61440
    buffer_load_dwordx4 a[96:99], v10, s[20:23], s15 offen offset:0 sc1
    v_mfma_f32_16x16x32_bf16 v[76:79], a[132:135], a[52:55], v[76:79]
    ds_read_b64_tr_b16 a[164:165], v197 offset:57344
    v_mfma_f32_16x16x32_bf16 v[72:75], a[132:135], a[48:51], v[72:75]
    ds_read_b64_tr_b16 a[166:167], v197 offset:61440
    s_waitcnt lgkmcnt(12)
    v_mfma_f32_16x16x32_bf16 v[80:83], a[136:139], a[48:51], v[80:83]
    ds_read_b64_tr_b16 a[168:169], v198 offset:57344
    buffer_load_dwordx4 a[100:103], v10, s[20:23], s15 offen offset:1024 sc1
    v_mfma_f32_16x16x32_bf16 v[84:87], a[136:139], a[52:55], v[84:87]
    ds_read_b64_tr_b16 a[170:171], v198 offset:61440
    v_mfma_f32_16x16x32_bf16 v[92:95], a[140:143], a[52:55], v[92:95]
    ds_read_b64_tr_b16 a[172:173], v199 offset:57344
    v_mfma_f32_16x16x32_bf16 v[88:91], a[140:143], a[48:51], v[88:91]
    ds_read_b64_tr_b16 a[174:175], v199 offset:61440
    s_waitcnt lgkmcnt(12)
    v_mfma_f32_16x16x32_bf16 v[96:99], a[144:147], a[48:51], v[96:99]
    ds_read_b64_tr_b16 a[176:177], v200 offset:57344
    buffer_load_dwordx4 a[104:107], v10, s[20:23], s15 offen offset:2048 sc1
    v_mfma_f32_16x16x32_bf16 v[100:103], a[144:147], a[52:55], v[100:103]
    ds_read_b64_tr_b16 a[178:179], v200 offset:61440
    v_mfma_f32_16x16x32_bf16 v[108:111], a[148:151], a[52:55], v[108:111]
    ds_read_b64_tr_b16 a[180:181], v201 offset:57344
    v_mfma_f32_16x16x32_bf16 v[104:107], a[148:151], a[48:51], v[104:107]
    ds_read_b64_tr_b16 a[182:183], v201 offset:61440
    s_waitcnt lgkmcnt(12)
    v_mfma_f32_16x16x32_bf16 v[112:115], a[152:155], a[48:51], v[112:115]
    ds_read_b64_tr_b16 a[184:185], v202 offset:57344
    buffer_load_dwordx4 a[108:111], v10, s[20:23], s15 offen offset:3072 sc1
    s_add_u32 s15, s15, s34
    v_mfma_f32_16x16x32_bf16 v[116:119], a[152:155], a[52:55], v[116:119]
    ds_read_b64_tr_b16 a[186:187], v202 offset:61440
    v_mfma_f32_16x16x32_bf16 v[124:127], a[156:159], a[52:55], v[124:127]
    ds_read_b64_tr_b16 a[188:189], v203 offset:57344
    v_mfma_f32_16x16x32_bf16 v[120:123], a[156:159], a[48:51], v[120:123]
    ds_read_b64_tr_b16 a[190:191], v203 offset:61440
    s_waitcnt vmcnt(16)
    s_barrier
    s_waitcnt lgkmcnt(12)
    v_mfma_f32_16x16x32_bf16 v[64:67], a[160:163], a[56:59], v[64:67]
    ds_read_b64_tr_b16 a[128:129], v204 offset:0
    s_add_u32 m0, s24, 32768
    v_mfma_f32_16x16x32_bf16 v[68:71], a[160:163], a[60:63], v[68:71]
    ds_read_b64_tr_b16 a[130:131], v204 offset:4096
    buffer_load_dwordx4 v8, s[60:63], s16 offen offset:0 lds
    v_mfma_f32_16x16x32_bf16 v[76:79], a[164:167], a[60:63], v[76:79]
    ds_read_b64_tr_b16 a[132:133], v205 offset:0
    v_mfma_f32_16x16x32_bf16 v[72:75], a[164:167], a[56:59], v[72:75]
    ds_read_b64_tr_b16 a[134:135], v205 offset:4096
    s_waitcnt lgkmcnt(12)
    v_mfma_f32_16x16x32_bf16 v[80:83], a[168:171], a[56:59], v[80:83]
    ds_read_b64_tr_b16 a[136:137], v206 offset:0
    buffer_load_dwordx4 v58, s[60:63], s16 offen offset:1024 lds
    v_mfma_f32_16x16x32_bf16 v[84:87], a[168:171], a[60:63], v[84:87]
    ds_read_b64_tr_b16 a[138:139], v206 offset:4096
    v_mfma_f32_16x16x32_bf16 v[92:95], a[172:175], a[60:63], v[92:95]
    ds_read_b64_tr_b16 a[140:141], v207 offset:0
    v_mfma_f32_16x16x32_bf16 v[88:91], a[172:175], a[56:59], v[88:91]
    ds_read_b64_tr_b16 a[142:143], v207 offset:4096
    s_waitcnt lgkmcnt(12)
    v_mfma_f32_16x16x32_bf16 v[96:99], a[176:179], a[56:59], v[96:99]
    ds_read_b64_tr_b16 a[144:145], v208 offset:0
    buffer_load_dwordx4 v59, s[60:63], s16 offen offset:2048 lds
    v_mfma_f32_16x16x32_bf16 v[100:103], a[176:179], a[60:63], v[100:103]
    ds_read_b64_tr_b16 a[146:147], v208 offset:4096
    v_mfma_f32_16x16x32_bf16 v[108:111], a[180:183], a[60:63], v[108:111]
    ds_read_b64_tr_b16 a[148:149], v209 offset:0
    v_mfma_f32_16x16x32_bf16 v[104:107], a[180:183], a[56:59], v[104:107]
    ds_read_b64_tr_b16 a[150:151], v209 offset:4096
    s_waitcnt lgkmcnt(12)
    v_mfma_f32_16x16x32_bf16 v[112:115], a[184:187], a[56:59], v[112:115]
    ds_read_b64_tr_b16 a[152:153], v210 offset:0
    buffer_load_dwordx4 v1, s[60:63], s16 offen offset:3072 lds
    s_add_u32 s16, s16, s31
    v_mfma_f32_16x16x32_bf16 v[116:119], a[184:187], a[60:63], v[116:119]
    ds_read_b64_tr_b16 a[154:155], v210 offset:4096
    v_mfma_f32_16x16x32_bf16 v[124:127], a[188:191], a[60:63], v[124:127]
    ds_read_b64_tr_b16 a[156:157], v211 offset:0
    v_mfma_f32_16x16x32_bf16 v[120:123], a[188:191], a[56:59], v[120:123]
    ds_read_b64_tr_b16 a[158:159], v211 offset:4096
    s_waitcnt lgkmcnt(12)
    v_mfma_f32_16x16x32_bf16 v[64:67], a[128:131], a[64:67], v[64:67]
    ds_read_b64_tr_b16 a[160:161], v204 offset:8192
    v_mfma_f32_16x16x32_bf16 v[68:71], a[128:131], a[68:71], v[68:71]
    ds_read_b64_tr_b16 a[162:163], v204 offset:12288
    buffer_load_dwordx4 a[112:115], v10, s[20:23], s15 offen offset:0 sc1
    v_mfma_f32_16x16x32_bf16 v[76:79], a[132:135], a[68:71], v[76:79]
    ds_read_b64_tr_b16 a[164:165], v205 offset:8192
    v_mfma_f32_16x16x32_bf16 v[72:75], a[132:135], a[64:67], v[72:75]
    ds_read_b64_tr_b16 a[166:167], v205 offset:12288
    s_waitcnt lgkmcnt(12)
    v_mfma_f32_16x16x32_bf16 v[80:83], a[136:139], a[64:67], v[80:83]
    ds_read_b64_tr_b16 a[168:169], v206 offset:8192
    buffer_load_dwordx4 a[116:119], v10, s[20:23], s15 offen offset:1024 sc1
    v_mfma_f32_16x16x32_bf16 v[84:87], a[136:139], a[68:71], v[84:87]
    ds_read_b64_tr_b16 a[170:171], v206 offset:12288
    v_mfma_f32_16x16x32_bf16 v[92:95], a[140:143], a[68:71], v[92:95]
    ds_read_b64_tr_b16 a[172:173], v207 offset:8192
    v_mfma_f32_16x16x32_bf16 v[88:91], a[140:143], a[64:67], v[88:91]
    ds_read_b64_tr_b16 a[174:175], v207 offset:12288
    s_waitcnt lgkmcnt(12)
    v_mfma_f32_16x16x32_bf16 v[96:99], a[144:147], a[64:67], v[96:99]
    ds_read_b64_tr_b16 a[176:177], v208 offset:8192
    buffer_load_dwordx4 a[120:123], v10, s[20:23], s15 offen offset:2048 sc1
    v_mfma_f32_16x16x32_bf16 v[100:103], a[144:147], a[68:71], v[100:103]
    ds_read_b64_tr_b16 a[178:179], v208 offset:12288
    v_mfma_f32_16x16x32_bf16 v[108:111], a[148:151], a[68:71], v[108:111]
    ds_read_b64_tr_b16 a[180:181], v209 offset:8192
    v_mfma_f32_16x16x32_bf16 v[104:107], a[148:151], a[64:67], v[104:107]
    ds_read_b64_tr_b16 a[182:183], v209 offset:12288
    s_waitcnt lgkmcnt(12)
    v_mfma_f32_16x16x32_bf16 v[112:115], a[152:155], a[64:67], v[112:115]
    ds_read_b64_tr_b16 a[184:185], v210 offset:8192
    buffer_load_dwordx4 a[124:127], v10, s[20:23], s15 offen offset:3072 sc1
    s_add_u32 s15, s15, s34
    v_mfma_f32_16x16x32_bf16 v[116:119], a[152:155], a[68:71], v[116:119]
    ds_read_b64_tr_b16 a[186:187], v210 offset:12288
    v_mfma_f32_16x16x32_bf16 v[124:127], a[156:159], a[68:71], v[124:127]
    ds_read_b64_tr_b16 a[188:189], v211 offset:8192
    v_mfma_f32_16x16x32_bf16 v[120:123], a[156:159], a[64:67], v[120:123]
    ds_read_b64_tr_b16 a[190:191], v211 offset:12288
    s_waitcnt vmcnt(16)
    s_barrier
    s_waitcnt lgkmcnt(12)
    v_mfma_f32_16x16x32_bf16 v[64:67], a[160:163], a[72:75], v[64:67]
    ds_read_b64_tr_b16 a[128:129], v204 offset:16384
    s_add_u32 m0, s24, 49152
    v_mfma_f32_16x16x32_bf16 v[68:71], a[160:163], a[76:79], v[68:71]
    ds_read_b64_tr_b16 a[130:131], v204 offset:20480
    buffer_load_dwordx4 v8, s[60:63], s16 offen offset:0 lds
    v_mfma_f32_16x16x32_bf16 v[76:79], a[164:167], a[76:79], v[76:79]
    ds_read_b64_tr_b16 a[132:133], v205 offset:16384
    v_mfma_f32_16x16x32_bf16 v[72:75], a[164:167], a[72:75], v[72:75]
    ds_read_b64_tr_b16 a[134:135], v205 offset:20480
    s_waitcnt lgkmcnt(12)
    v_mfma_f32_16x16x32_bf16 v[80:83], a[168:171], a[72:75], v[80:83]
    ds_read_b64_tr_b16 a[136:137], v206 offset:16384
    buffer_load_dwordx4 v58, s[60:63], s16 offen offset:1024 lds
    v_mfma_f32_16x16x32_bf16 v[84:87], a[168:171], a[76:79], v[84:87]
    ds_read_b64_tr_b16 a[138:139], v206 offset:20480
    v_mfma_f32_16x16x32_bf16 v[92:95], a[172:175], a[76:79], v[92:95]
    ds_read_b64_tr_b16 a[140:141], v207 offset:16384
    v_mfma_f32_16x16x32_bf16 v[88:91], a[172:175], a[72:75], v[88:91]
    ds_read_b64_tr_b16 a[142:143], v207 offset:20480
    s_waitcnt lgkmcnt(12)
    v_mfma_f32_16x16x32_bf16 v[96:99], a[176:179], a[72:75], v[96:99]
    ds_read_b64_tr_b16 a[144:145], v208 offset:16384
    buffer_load_dwordx4 v59, s[60:63], s16 offen offset:2048 lds
    v_mfma_f32_16x16x32_bf16 v[100:103], a[176:179], a[76:79], v[100:103]
    ds_read_b64_tr_b16 a[146:147], v208 offset:20480
    v_mfma_f32_16x16x32_bf16 v[108:111], a[180:183], a[76:79], v[108:111]
    ds_read_b64_tr_b16 a[148:149], v209 offset:16384
    v_mfma_f32_16x16x32_bf16 v[104:107], a[180:183], a[72:75], v[104:107]
    ds_read_b64_tr_b16 a[150:151], v209 offset:20480
    s_waitcnt lgkmcnt(12)
    v_mfma_f32_16x16x32_bf16 v[112:115], a[184:187], a[72:75], v[112:115]
    ds_read_b64_tr_b16 a[152:153], v210 offset:16384
    buffer_load_dwordx4 v1, s[60:63], s16 offen offset:3072 lds
    s_add_u32 s16, s16, s31
    v_mfma_f32_16x16x32_bf16 v[116:119], a[184:187], a[76:79], v[116:119]
    ds_read_b64_tr_b16 a[154:155], v210 offset:20480
    v_mfma_f32_16x16x32_bf16 v[124:127], a[188:191], a[76:79], v[124:127]
    ds_read_b64_tr_b16 a[156:157], v211 offset:16384
    v_mfma_f32_16x16x32_bf16 v[120:123], a[188:191], a[72:75], v[120:123]
    ds_read_b64_tr_b16 a[158:159], v211 offset:20480
    s_waitcnt lgkmcnt(12)
    v_mfma_f32_16x16x32_bf16 v[64:67], a[128:131], a[80:83], v[64:67]
    ds_read_b64_tr_b16 a[160:161], v204 offset:24576
    v_mfma_f32_16x16x32_bf16 v[68:71], a[128:131], a[84:87], v[68:71]
    ds_read_b64_tr_b16 a[162:163], v204 offset:28672
    buffer_load_dwordx4 a[0:3], v10, s[20:23], s15 offen offset:0 sc1
    v_mfma_f32_16x16x32_bf16 v[76:79], a[132:135], a[84:87], v[76:79]
    ds_read_b64_tr_b16 a[164:165], v205 offset:24576
    v_mfma_f32_16x16x32_bf16 v[72:75], a[132:135], a[80:83], v[72:75]
    ds_read_b64_tr_b16 a[166:167], v205 offset:28672
    s_waitcnt lgkmcnt(12)
    v_mfma_f32_16x16x32_bf16 v[80:83], a[136:139], a[80:83], v[80:83]
    ds_read_b64_tr_b16 a[168:169], v206 offset:24576
    buffer_load_dwordx4 a[4:7], v10, s[20:23], s15 offen offset:1024 sc1
    v_mfma_f32_16x16x32_bf16 v[84:87], a[136:139], a[84:87], v[84:87]
    ds_read_b64_tr_b16 a[170:171], v206 offset:28672
    v_mfma_f32_16x16x32_bf16 v[92:95], a[140:143], a[84:87], v[92:95]
    ds_read_b64_tr_b16 a[172:173], v207 offset:24576
    v_mfma_f32_16x16x32_bf16 v[88:91], a[140:143], a[80:83], v[88:91]
    ds_read_b64_tr_b16 a[174:175], v207 offset:28672
    s_waitcnt lgkmcnt(12)
    v_mfma_f32_16x16x32_bf16 v[96:99], a[144:147], a[80:83], v[96:99]
    ds_read_b64_tr_b16 a[176:177], v208 offset:24576
    buffer_load_dwordx4 a[8:11], v10, s[20:23], s15 offen offset:2048 sc1
    v_mfma_f32_16x16x32_bf16 v[100:103], a[144:147], a[84:87], v[100:103]
    ds_read_b64_tr_b16 a[178:179], v208 offset:28672
    v_mfma_f32_16x16x32_bf16 v[108:111], a[148:151], a[84:87], v[108:111]
    ds_read_b64_tr_b16 a[180:181], v209 offset:24576
    v_mfma_f32_16x16x32_bf16 v[104:107], a[148:151], a[80:83], v[104:107]
    ds_read_b64_tr_b16 a[182:183], v209 offset:28672
    s_waitcnt lgkmcnt(12)
    v_mfma_f32_16x16x32_bf16 v[112:115], a[152:155], a[80:83], v[112:115]
    ds_read_b64_tr_b16 a[184:185], v210 offset:24576
    buffer_load_dwordx4 a[12:15], v10, s[20:23], s15 offen offset:3072 sc1
    s_add_u32 s15, s15, s34
    v_mfma_f32_16x16x32_bf16 v[116:119], a[152:155], a[84:87], v[116:119]
    ds_read_b64_tr_b16 a[186:187], v210 offset:28672
    v_mfma_f32_16x16x32_bf16 v[124:127], a[156:159], a[84:87], v[124:127]
    ds_read_b64_tr_b16 a[188:189], v211 offset:24576
    v_mfma_f32_16x16x32_bf16 v[120:123], a[156:159], a[80:83], v[120:123]
    ds_read_b64_tr_b16 a[190:191], v211 offset:28672
    s_waitcnt vmcnt(16)
    s_barrier
    s_waitcnt lgkmcnt(12)
    v_mfma_f32_16x16x32_bf16 v[64:67], a[160:163], a[88:91], v[64:67]
    ds_read_b64_tr_b16 a[128:129], v204 offset:32768
    s_add_u32 m0, s24, 65536
    v_mfma_f32_16x16x32_bf16 v[68:71], a[160:163], a[92:95], v[68:71]
    ds_read_b64_tr_b16 a[130:131], v204 offset:36864
    buffer_load_dwordx4 v8, s[60:63], s16 offen offset:0 lds
    v_mfma_f32_16x16x32_bf16 v[76:79], a[164:167], a[92:95], v[76:79]
    ds_read_b64_tr_b16 a[132:133], v205 offset:32768
    v_mfma_f32_16x16x32_bf16 v[72:75], a[164:167], a[88:91], v[72:75]
    ds_read_b64_tr_b16 a[134:135], v205 offset:36864
    s_waitcnt lgkmcnt(12)
    v_mfma_f32_16x16x32_bf16 v[80:83], a[168:171], a[88:91], v[80:83]
    ds_read_b64_tr_b16 a[136:137], v206 offset:32768
    buffer_load_dwordx4 v58, s[60:63], s16 offen offset:1024 lds
    v_mfma_f32_16x16x32_bf16 v[84:87], a[168:171], a[92:95], v[84:87]
    ds_read_b64_tr_b16 a[138:139], v206 offset:36864
    v_mfma_f32_16x16x32_bf16 v[92:95], a[172:175], a[92:95], v[92:95]
    ds_read_b64_tr_b16 a[140:141], v207 offset:32768
    v_mfma_f32_16x16x32_bf16 v[88:91], a[172:175], a[88:91], v[88:91]
    ds_read_b64_tr_b16 a[142:143], v207 offset:36864
    s_waitcnt lgkmcnt(12)
    v_mfma_f32_16x16x32_bf16 v[96:99], a[176:179], a[88:91], v[96:99]
    ds_read_b64_tr_b16 a[144:145], v208 offset:32768
    buffer_load_dwordx4 v59, s[60:63], s16 offen offset:2048 lds
    v_mfma_f32_16x16x32_bf16 v[100:103], a[176:179], a[92:95], v[100:103]
    ds_read_b64_tr_b16 a[146:147], v208 offset:36864
    v_mfma_f32_16x16x32_bf16 v[108:111], a[180:183], a[92:95], v[108:111]
    ds_read_b64_tr_b16 a[148:149], v209 offset:32768
    v_mfma_f32_16x16x32_bf16 v[104:107], a[180:183], a[88:91], v[104:107]
    ds_read_b64_tr_b16 a[150:151], v209 offset:36864
    s_waitcnt lgkmcnt(12)
    v_mfma_f32_16x16x32_bf16 v[112:115], a[184:187], a[88:91], v[112:115]
    ds_read_b64_tr_b16 a[152:153], v210 offset:32768
    buffer_load_dwordx4 v1, s[60:63], s16 offen offset:3072 lds
    s_add_u32 s16, s16, s31
    v_mfma_f32_16x16x32_bf16 v[116:119], a[184:187], a[92:95], v[116:119]
    ds_read_b64_tr_b16 a[154:155], v210 offset:36864
    v_mfma_f32_16x16x32_bf16 v[124:127], a[188:191], a[92:95], v[124:127]
    ds_read_b64_tr_b16 a[156:157], v211 offset:32768
    v_mfma_f32_16x16x32_bf16 v[120:123], a[188:191], a[88:91], v[120:123]
    ds_read_b64_tr_b16 a[158:159], v211 offset:36864
    s_waitcnt lgkmcnt(12)
    v_mfma_f32_16x16x32_bf16 v[64:67], a[128:131], a[96:99], v[64:67]
    ds_read_b64_tr_b16 a[160:161], v204 offset:40960
    v_mfma_f32_16x16x32_bf16 v[68:71], a[128:131], a[100:103], v[68:71]
    ds_read_b64_tr_b16 a[162:163], v204 offset:45056
    buffer_load_dwordx4 a[16:19], v10, s[20:23], s15 offen offset:0 sc1
    v_mfma_f32_16x16x32_bf16 v[76:79], a[132:135], a[100:103], v[76:79]
    ds_read_b64_tr_b16 a[164:165], v205 offset:40960
    v_mfma_f32_16x16x32_bf16 v[72:75], a[132:135], a[96:99], v[72:75]
    ds_read_b64_tr_b16 a[166:167], v205 offset:45056
    s_waitcnt lgkmcnt(12)
    v_mfma_f32_16x16x32_bf16 v[80:83], a[136:139], a[96:99], v[80:83]
    ds_read_b64_tr_b16 a[168:169], v206 offset:40960
    buffer_load_dwordx4 a[20:23], v10, s[20:23], s15 offen offset:1024 sc1
    v_mfma_f32_16x16x32_bf16 v[84:87], a[136:139], a[100:103], v[84:87]
    ds_read_b64_tr_b16 a[170:171], v206 offset:45056
    v_mfma_f32_16x16x32_bf16 v[92:95], a[140:143], a[100:103], v[92:95]
    ds_read_b64_tr_b16 a[172:173], v207 offset:40960
    v_mfma_f32_16x16x32_bf16 v[88:91], a[140:143], a[96:99], v[88:91]
    ds_read_b64_tr_b16 a[174:175], v207 offset:45056
    s_waitcnt lgkmcnt(12)
    v_mfma_f32_16x16x32_bf16 v[96:99], a[144:147], a[96:99], v[96:99]
    ds_read_b64_tr_b16 a[176:177], v208 offset:40960
    buffer_load_dwordx4 a[24:27], v10, s[20:23], s15 offen offset:2048 sc1
    v_mfma_f32_16x16x32_bf16 v[100:103], a[144:147], a[100:103], v[100:103]
    ds_read_b64_tr_b16 a[178:179], v208 offset:45056
    v_mfma_f32_16x16x32_bf16 v[108:111], a[148:151], a[100:103], v[108:111]
    ds_read_b64_tr_b16 a[180:181], v209 offset:40960
    v_mfma_f32_16x16x32_bf16 v[104:107], a[148:151], a[96:99], v[104:107]
    ds_read_b64_tr_b16 a[182:183], v209 offset:45056
    s_waitcnt lgkmcnt(12)
    v_mfma_f32_16x16x32_bf16 v[112:115], a[152:155], a[96:99], v[112:115]
    ds_read_b64_tr_b16 a[184:185], v210 offset:40960
    buffer_load_dwordx4 a[28:31], v10, s[20:23], s15 offen offset:3072 sc1
    s_add_u32 s15, s15, s34
    v_mfma_f32_16x16x32_bf16 v[116:119], a[152:155], a[100:103], v[116:119]
    ds_read_b64_tr_b16 a[186:187], v210 offset:45056
    v_mfma_f32_16x16x32_bf16 v[124:127], a[156:159], a[100:103], v[124:127]
    ds_read_b64_tr_b16 a[188:189], v211 offset:40960
    v_mfma_f32_16x16x32_bf16 v[120:123], a[156:159], a[96:99], v[120:123]
    ds_read_b64_tr_b16 a[190:191], v211 offset:45056
    s_waitcnt vmcnt(16)
    s_barrier
    s_waitcnt lgkmcnt(12)
    v_mfma_f32_16x16x32_bf16 v[64:67], a[160:163], a[104:107], v[64:67]
    ds_read_b64_tr_b16 a[128:129], v204 offset:49152
    s_add_u32 m0, s24, 81920
    v_mfma_f32_16x16x32_bf16 v[68:71], a[160:163], a[108:111], v[68:71]
    ds_read_b64_tr_b16 a[130:131], v204 offset:53248
    buffer_load_dwordx4 v8, s[60:63], s16 offen offset:0 lds
    v_mfma_f32_16x16x32_bf16 v[76:79], a[164:167], a[108:111], v[76:79]
    ds_read_b64_tr_b16 a[132:133], v205 offset:49152
    v_mfma_f32_16x16x32_bf16 v[72:75], a[164:167], a[104:107], v[72:75]
    ds_read_b64_tr_b16 a[134:135], v205 offset:53248
    s_waitcnt lgkmcnt(12)
    v_mfma_f32_16x16x32_bf16 v[80:83], a[168:171], a[104:107], v[80:83]
    ds_read_b64_tr_b16 a[136:137], v206 offset:49152
    buffer_load_dwordx4 v58, s[60:63], s16 offen offset:1024 lds
    v_mfma_f32_16x16x32_bf16 v[84:87], a[168:171], a[108:111], v[84:87]
    ds_read_b64_tr_b16 a[138:139], v206 offset:53248
    v_mfma_f32_16x16x32_bf16 v[92:95], a[172:175], a[108:111], v[92:95]
    ds_read_b64_tr_b16 a[140:141], v207 offset:49152
    v_mfma_f32_16x16x32_bf16 v[88:91], a[172:175], a[104:107], v[88:91]
    ds_read_b64_tr_b16 a[142:143], v207 offset:53248
    s_waitcnt lgkmcnt(12)
    v_mfma_f32_16x16x32_bf16 v[96:99], a[176:179], a[104:107], v[96:99]
    ds_read_b64_tr_b16 a[144:145], v208 offset:49152
    buffer_load_dwordx4 v59, s[60:63], s16 offen offset:2048 lds
    v_mfma_f32_16x16x32_bf16 v[100:103], a[176:179], a[108:111], v[100:103]
    ds_read_b64_tr_b16 a[146:147], v208 offset:53248
    v_mfma_f32_16x16x32_bf16 v[108:111], a[180:183], a[108:111], v[108:111]
    ds_read_b64_tr_b16 a[148:149], v209 offset:49152
    v_mfma_f32_16x16x32_bf16 v[104:107], a[180:183], a[104:107], v[104:107]
    ds_read_b64_tr_b16 a[150:151], v209 offset:53248
    s_waitcnt lgkmcnt(12)
    v_mfma_f32_16x16x32_bf16 v[112:115], a[184:187], a[104:107], v[112:115]
    ds_read_b64_tr_b16 a[152:153], v210 offset:49152
    buffer_load_dwordx4 v1, s[60:63], s16 offen offset:3072 lds
    s_add_u32 s16, s16, s31
    v_mfma_f32_16x16x32_bf16 v[116:119], a[184:187], a[108:111], v[116:119]
    ds_read_b64_tr_b16 a[154:155], v210 offset:53248
    v_mfma_f32_16x16x32_bf16 v[124:127], a[188:191], a[108:111], v[124:127]
    ds_read_b64_tr_b16 a[156:157], v211 offset:49152
    v_mfma_f32_16x16x32_bf16 v[120:123], a[188:191], a[104:107], v[120:123]
    ds_read_b64_tr_b16 a[158:159], v211 offset:53248
    s_waitcnt lgkmcnt(12)
    v_mfma_f32_16x16x32_bf16 v[64:67], a[128:131], a[112:115], v[64:67]
    ds_read_b64_tr_b16 a[160:161], v204 offset:57344
    v_mfma_f32_16x16x32_bf16 v[68:71], a[128:131], a[116:119], v[68:71]
    ds_read_b64_tr_b16 a[162:163], v204 offset:61440
    buffer_load_dwordx4 a[32:35], v10, s[20:23], s15 offen offset:0 sc1
    v_mfma_f32_16x16x32_bf16 v[76:79], a[132:135], a[116:119], v[76:79]
    ds_read_b64_tr_b16 a[164:165], v205 offset:57344
    v_mfma_f32_16x16x32_bf16 v[72:75], a[132:135], a[112:115], v[72:75]
    ds_read_b64_tr_b16 a[166:167], v205 offset:61440
    s_waitcnt lgkmcnt(12)
    v_mfma_f32_16x16x32_bf16 v[80:83], a[136:139], a[112:115], v[80:83]
    ds_read_b64_tr_b16 a[168:169], v206 offset:57344
    buffer_load_dwordx4 a[36:39], v10, s[20:23], s15 offen offset:1024 sc1
    v_mfma_f32_16x16x32_bf16 v[84:87], a[136:139], a[116:119], v[84:87]
    ds_read_b64_tr_b16 a[170:171], v206 offset:61440
    v_mfma_f32_16x16x32_bf16 v[92:95], a[140:143], a[116:119], v[92:95]
    ds_read_b64_tr_b16 a[172:173], v207 offset:57344
    v_mfma_f32_16x16x32_bf16 v[88:91], a[140:143], a[112:115], v[88:91]
    ds_read_b64_tr_b16 a[174:175], v207 offset:61440
    s_waitcnt lgkmcnt(12)
    v_mfma_f32_16x16x32_bf16 v[96:99], a[144:147], a[112:115], v[96:99]
    ds_read_b64_tr_b16 a[176:177], v208 offset:57344
    buffer_load_dwordx4 a[40:43], v10, s[20:23], s15 offen offset:2048 sc1
    v_mfma_f32_16x16x32_bf16 v[100:103], a[144:147], a[116:119], v[100:103]
    ds_read_b64_tr_b16 a[178:179], v208 offset:61440
    v_mfma_f32_16x16x32_bf16 v[108:111], a[148:151], a[116:119], v[108:111]
    ds_read_b64_tr_b16 a[180:181], v209 offset:57344
    v_mfma_f32_16x16x32_bf16 v[104:107], a[148:151], a[112:115], v[104:107]
    ds_read_b64_tr_b16 a[182:183], v209 offset:61440
    s_waitcnt lgkmcnt(12)
    v_mfma_f32_16x16x32_bf16 v[112:115], a[152:155], a[112:115], v[112:115]
    ds_read_b64_tr_b16 a[184:185], v210 offset:57344
    buffer_load_dwordx4 a[44:47], v10, s[20:23], s15 offen offset:3072 sc1
    s_add_u32 s15, s15, s34
    v_mfma_f32_16x16x32_bf16 v[116:119], a[152:155], a[116:119], v[116:119]
    ds_read_b64_tr_b16 a[186:187], v210 offset:61440
    v_mfma_f32_16x16x32_bf16 v[124:127], a[156:159], a[116:119], v[124:127]
    ds_read_b64_tr_b16 a[188:189], v211 offset:57344
    v_mfma_f32_16x16x32_bf16 v[120:123], a[156:159], a[112:115], v[120:123]
    ds_read_b64_tr_b16 a[190:191], v211 offset:61440
    s_waitcnt vmcnt(16)
    s_barrier
    s_waitcnt lgkmcnt(12)
    v_mfma_f32_16x16x32_bf16 v[64:67], a[160:163], a[120:123], v[64:67]
    ds_read_b64_tr_b16 a[128:129], v196 offset:0
    s_add_u32 m0, s24, 98304
    v_mfma_f32_16x16x32_bf16 v[68:71], a[160:163], a[124:127], v[68:71]
    ds_read_b64_tr_b16 a[130:131], v196 offset:4096
    buffer_load_dwordx4 v8, s[60:63], s16 offen offset:0 lds
    v_mfma_f32_16x16x32_bf16 v[76:79], a[164:167], a[124:127], v[76:79]
    ds_read_b64_tr_b16 a[132:133], v197 offset:0
    v_mfma_f32_16x16x32_bf16 v[72:75], a[164:167], a[120:123], v[72:75]
    ds_read_b64_tr_b16 a[134:135], v197 offset:4096
    s_waitcnt lgkmcnt(12)
    v_mfma_f32_16x16x32_bf16 v[80:83], a[168:171], a[120:123], v[80:83]
    ds_read_b64_tr_b16 a[136:137], v198 offset:0
    buffer_load_dwordx4 v58, s[60:63], s16 offen offset:1024 lds
    v_mfma_f32_16x16x32_bf16 v[84:87], a[168:171], a[124:127], v[84:87]
    ds_read_b64_tr_b16 a[138:139], v198 offset:4096
    v_mfma_f32_16x16x32_bf16 v[92:95], a[172:175], a[124:127], v[92:95]
    ds_read_b64_tr_b16 a[140:141], v199 offset:0
    v_mfma_f32_16x16x32_bf16 v[88:91], a[172:175], a[120:123], v[88:91]
    ds_read_b64_tr_b16 a[142:143], v199 offset:4096
    s_waitcnt lgkmcnt(12)
    v_mfma_f32_16x16x32_bf16 v[96:99], a[176:179], a[120:123], v[96:99]
    ds_read_b64_tr_b16 a[144:145], v200 offset:0
    buffer_load_dwordx4 v59, s[60:63], s16 offen offset:2048 lds
    v_mfma_f32_16x16x32_bf16 v[100:103], a[176:179], a[124:127], v[100:103]
    ds_read_b64_tr_b16 a[146:147], v200 offset:4096
    v_mfma_f32_16x16x32_bf16 v[108:111], a[180:183], a[124:127], v[108:111]
    ds_read_b64_tr_b16 a[148:149], v201 offset:0
    v_mfma_f32_16x16x32_bf16 v[104:107], a[180:183], a[120:123], v[104:107]
    ds_read_b64_tr_b16 a[150:151], v201 offset:4096
    s_waitcnt lgkmcnt(12)
    v_mfma_f32_16x16x32_bf16 v[112:115], a[184:187], a[120:123], v[112:115]
    ds_read_b64_tr_b16 a[152:153], v202 offset:0
    buffer_load_dwordx4 v1, s[60:63], s16 offen offset:3072 lds
    s_add_u32 s16, s16, s31
    v_mfma_f32_16x16x32_bf16 v[116:119], a[184:187], a[124:127], v[116:119]
    ds_read_b64_tr_b16 a[154:155], v202 offset:4096
    v_mfma_f32_16x16x32_bf16 v[124:127], a[188:191], a[124:127], v[124:127]
    ds_read_b64_tr_b16 a[156:157], v203 offset:0
    v_mfma_f32_16x16x32_bf16 v[120:123], a[188:191], a[120:123], v[120:123]
    ds_read_b64_tr_b16 a[158:159], v203 offset:4096
    s_waitcnt lgkmcnt(12)
    v_mfma_f32_16x16x32_bf16 v[64:67], a[128:131], a[0:3], v[64:67]
    ds_read_b64_tr_b16 a[160:161], v196 offset:8192
    v_mfma_f32_16x16x32_bf16 v[68:71], a[128:131], a[4:7], v[68:71]
    ds_read_b64_tr_b16 a[162:163], v196 offset:12288
    buffer_load_dwordx4 a[48:51], v10, s[20:23], s15 offen offset:0 sc1
    v_mfma_f32_16x16x32_bf16 v[76:79], a[132:135], a[4:7], v[76:79]
    ds_read_b64_tr_b16 a[164:165], v197 offset:8192
    v_mfma_f32_16x16x32_bf16 v[72:75], a[132:135], a[0:3], v[72:75]
    ds_read_b64_tr_b16 a[166:167], v197 offset:12288
    s_waitcnt lgkmcnt(12)
    v_mfma_f32_16x16x32_bf16 v[80:83], a[136:139], a[0:3], v[80:83]
    ds_read_b64_tr_b16 a[168:169], v198 offset:8192
    buffer_load_dwordx4 a[52:55], v10, s[20:23], s15 offen offset:1024 sc1
    v_mfma_f32_16x16x32_bf16 v[84:87], a[136:139], a[4:7], v[84:87]
    ds_read_b64_tr_b16 a[170:171], v198 offset:12288
    v_mfma_f32_16x16x32_bf16 v[92:95], a[140:143], a[4:7], v[92:95]
    ds_read_b64_tr_b16 a[172:173], v199 offset:8192
    v_mfma_f32_16x16x32_bf16 v[88:91], a[140:143], a[0:3], v[88:91]
    ds_read_b64_tr_b16 a[174:175], v199 offset:12288
    s_waitcnt lgkmcnt(12)
    v_mfma_f32_16x16x32_bf16 v[96:99], a[144:147], a[0:3], v[96:99]
    ds_read_b64_tr_b16 a[176:177], v200 offset:8192
    buffer_load_dwordx4 a[56:59], v10, s[20:23], s15 offen offset:2048 sc1
    v_mfma_f32_16x16x32_bf16 v[100:103], a[144:147], a[4:7], v[100:103]
    ds_read_b64_tr_b16 a[178:179], v200 offset:12288
    v_mfma_f32_16x16x32_bf16 v[108:111], a[148:151], a[4:7], v[108:111]
    ds_read_b64_tr_b16 a[180:181], v201 offset:8192
    v_mfma_f32_16x16x32_bf16 v[104:107], a[148:151], a[0:3], v[104:107]
    ds_read_b64_tr_b16 a[182:183], v201 offset:12288
    s_waitcnt lgkmcnt(12)
    v_mfma_f32_16x16x32_bf16 v[112:115], a[152:155], a[0:3], v[112:115]
    ds_read_b64_tr_b16 a[184:185], v202 offset:8192
    buffer_load_dwordx4 a[60:63], v10, s[20:23], s15 offen offset:3072 sc1
    s_add_u32 s15, s15, s34
    v_mfma_f32_16x16x32_bf16 v[116:119], a[152:155], a[4:7], v[116:119]
    ds_read_b64_tr_b16 a[186:187], v202 offset:12288
    v_mfma_f32_16x16x32_bf16 v[124:127], a[156:159], a[4:7], v[124:127]
    ds_read_b64_tr_b16 a[188:189], v203 offset:8192
    v_mfma_f32_16x16x32_bf16 v[120:123], a[156:159], a[0:3], v[120:123]
    ds_read_b64_tr_b16 a[190:191], v203 offset:12288
    s_waitcnt vmcnt(16)
    s_barrier
    s_waitcnt lgkmcnt(12)
    v_mfma_f32_16x16x32_bf16 v[64:67], a[160:163], a[8:11], v[64:67]
    ds_read_b64_tr_b16 a[128:129], v196 offset:16384
    s_add_u32 m0, s24, 114688
    v_mfma_f32_16x16x32_bf16 v[68:71], a[160:163], a[12:15], v[68:71]
    ds_read_b64_tr_b16 a[130:131], v196 offset:20480
    buffer_load_dwordx4 v8, s[60:63], s16 offen offset:0 lds
    v_mfma_f32_16x16x32_bf16 v[76:79], a[164:167], a[12:15], v[76:79]
    ds_read_b64_tr_b16 a[132:133], v197 offset:16384
    v_mfma_f32_16x16x32_bf16 v[72:75], a[164:167], a[8:11], v[72:75]
    ds_read_b64_tr_b16 a[134:135], v197 offset:20480
    s_waitcnt lgkmcnt(12)
    v_mfma_f32_16x16x32_bf16 v[80:83], a[168:171], a[8:11], v[80:83]
    ds_read_b64_tr_b16 a[136:137], v198 offset:16384
    buffer_load_dwordx4 v58, s[60:63], s16 offen offset:1024 lds
    v_mfma_f32_16x16x32_bf16 v[84:87], a[168:171], a[12:15], v[84:87]
    ds_read_b64_tr_b16 a[138:139], v198 offset:20480
    v_mfma_f32_16x16x32_bf16 v[92:95], a[172:175], a[12:15], v[92:95]
    ds_read_b64_tr_b16 a[140:141], v199 offset:16384
    v_mfma_f32_16x16x32_bf16 v[88:91], a[172:175], a[8:11], v[88:91]
    ds_read_b64_tr_b16 a[142:143], v199 offset:20480
    s_waitcnt lgkmcnt(12)
    v_mfma_f32_16x16x32_bf16 v[96:99], a[176:179], a[8:11], v[96:99]
    ds_read_b64_tr_b16 a[144:145], v200 offset:16384
    buffer_load_dwordx4 v59, s[60:63], s16 offen offset:2048 lds
    v_mfma_f32_16x16x32_bf16 v[100:103], a[176:179], a[12:15], v[100:103]
    ds_read_b64_tr_b16 a[146:147], v200 offset:20480
    v_mfma_f32_16x16x32_bf16 v[108:111], a[180:183], a[12:15], v[108:111]
    ds_read_b64_tr_b16 a[148:149], v201 offset:16384
    v_mfma_f32_16x16x32_bf16 v[104:107], a[180:183], a[8:11], v[104:107]
    ds_read_b64_tr_b16 a[150:151], v201 offset:20480
    s_waitcnt lgkmcnt(12)
    v_mfma_f32_16x16x32_bf16 v[112:115], a[184:187], a[8:11], v[112:115]
    ds_read_b64_tr_b16 a[152:153], v202 offset:16384
    buffer_load_dwordx4 v1, s[60:63], s16 offen offset:3072 lds
    s_add_u32 s16, s16, s31
    v_mfma_f32_16x16x32_bf16 v[116:119], a[184:187], a[12:15], v[116:119]
    ds_read_b64_tr_b16 a[154:155], v202 offset:20480
    v_mfma_f32_16x16x32_bf16 v[124:127], a[188:191], a[12:15], v[124:127]
    ds_read_b64_tr_b16 a[156:157], v203 offset:16384
    v_mfma_f32_16x16x32_bf16 v[120:123], a[188:191], a[8:11], v[120:123]
    ds_read_b64_tr_b16 a[158:159], v203 offset:20480
    s_waitcnt lgkmcnt(12)
    v_mfma_f32_16x16x32_bf16 v[64:67], a[128:131], a[16:19], v[64:67]
    ds_read_b64_tr_b16 a[160:161], v196 offset:24576
    v_mfma_f32_16x16x32_bf16 v[68:71], a[128:131], a[20:23], v[68:71]
    ds_read_b64_tr_b16 a[162:163], v196 offset:28672
    buffer_load_dwordx4 a[64:67], v10, s[20:23], s15 offen offset:0 sc1
    v_mfma_f32_16x16x32_bf16 v[76:79], a[132:135], a[20:23], v[76:79]
    ds_read_b64_tr_b16 a[164:165], v197 offset:24576
    v_mfma_f32_16x16x32_bf16 v[72:75], a[132:135], a[16:19], v[72:75]
    ds_read_b64_tr_b16 a[166:167], v197 offset:28672
    s_waitcnt lgkmcnt(12)
    v_mfma_f32_16x16x32_bf16 v[80:83], a[136:139], a[16:19], v[80:83]
    ds_read_b64_tr_b16 a[168:169], v198 offset:24576
    buffer_load_dwordx4 a[68:71], v10, s[20:23], s15 offen offset:1024 sc1
    v_mfma_f32_16x16x32_bf16 v[84:87], a[136:139], a[20:23], v[84:87]
    ds_read_b64_tr_b16 a[170:171], v198 offset:28672
    v_mfma_f32_16x16x32_bf16 v[92:95], a[140:143], a[20:23], v[92:95]
    ds_read_b64_tr_b16 a[172:173], v199 offset:24576
    v_mfma_f32_16x16x32_bf16 v[88:91], a[140:143], a[16:19], v[88:91]
    ds_read_b64_tr_b16 a[174:175], v199 offset:28672
    s_waitcnt lgkmcnt(12)
    v_mfma_f32_16x16x32_bf16 v[96:99], a[144:147], a[16:19], v[96:99]
    ds_read_b64_tr_b16 a[176:177], v200 offset:24576
    buffer_load_dwordx4 a[72:75], v10, s[20:23], s15 offen offset:2048 sc1
    v_mfma_f32_16x16x32_bf16 v[100:103], a[144:147], a[20:23], v[100:103]
    ds_read_b64_tr_b16 a[178:179], v200 offset:28672
    v_mfma_f32_16x16x32_bf16 v[108:111], a[148:151], a[20:23], v[108:111]
    ds_read_b64_tr_b16 a[180:181], v201 offset:24576
    v_mfma_f32_16x16x32_bf16 v[104:107], a[148:151], a[16:19], v[104:107]
    ds_read_b64_tr_b16 a[182:183], v201 offset:28672
    s_waitcnt lgkmcnt(12)
    v_mfma_f32_16x16x32_bf16 v[112:115], a[152:155], a[16:19], v[112:115]
    ds_read_b64_tr_b16 a[184:185], v202 offset:24576
    buffer_load_dwordx4 a[76:79], v10, s[20:23], s15 offen offset:3072 sc1
    s_add_u32 s15, s15, s34
    v_mfma_f32_16x16x32_bf16 v[116:119], a[152:155], a[20:23], v[116:119]
    ds_read_b64_tr_b16 a[186:187], v202 offset:28672
    v_mfma_f32_16x16x32_bf16 v[124:127], a[156:159], a[20:23], v[124:127]
    ds_read_b64_tr_b16 a[188:189], v203 offset:24576
    v_mfma_f32_16x16x32_bf16 v[120:123], a[156:159], a[16:19], v[120:123]
    ds_read_b64_tr_b16 a[190:191], v203 offset:28672
    s_waitcnt vmcnt(16)
    s_barrier
    s_waitcnt lgkmcnt(12)
    v_mfma_f32_16x16x32_bf16 v[64:67], a[160:163], a[24:27], v[64:67]
    ds_read_b64_tr_b16 a[128:129], v196 offset:32768
    s_add_u32 m0, s24, 0
    v_mfma_f32_16x16x32_bf16 v[68:71], a[160:163], a[28:31], v[68:71]
    ds_read_b64_tr_b16 a[130:131], v196 offset:36864
    buffer_load_dwordx4 v8, s[60:63], s16 offen offset:0 lds
    v_mfma_f32_16x16x32_bf16 v[76:79], a[164:167], a[28:31], v[76:79]
    ds_read_b64_tr_b16 a[132:133], v197 offset:32768
    v_mfma_f32_16x16x32_bf16 v[72:75], a[164:167], a[24:27], v[72:75]
    ds_read_b64_tr_b16 a[134:135], v197 offset:36864
    s_waitcnt lgkmcnt(12)
    v_mfma_f32_16x16x32_bf16 v[80:83], a[168:171], a[24:27], v[80:83]
    ds_read_b64_tr_b16 a[136:137], v198 offset:32768
    buffer_load_dwordx4 v58, s[60:63], s16 offen offset:1024 lds
    v_mfma_f32_16x16x32_bf16 v[84:87], a[168:171], a[28:31], v[84:87]
    ds_read_b64_tr_b16 a[138:139], v198 offset:36864
    v_mfma_f32_16x16x32_bf16 v[92:95], a[172:175], a[28:31], v[92:95]
    ds_read_b64_tr_b16 a[140:141], v199 offset:32768
    v_mfma_f32_16x16x32_bf16 v[88:91], a[172:175], a[24:27], v[88:91]
    ds_read_b64_tr_b16 a[142:143], v199 offset:36864
    s_waitcnt lgkmcnt(12)
    v_mfma_f32_16x16x32_bf16 v[96:99], a[176:179], a[24:27], v[96:99]
    ds_read_b64_tr_b16 a[144:145], v200 offset:32768
    buffer_load_dwordx4 v59, s[60:63], s16 offen offset:2048 lds
    v_mfma_f32_16x16x32_bf16 v[100:103], a[176:179], a[28:31], v[100:103]
    ds_read_b64_tr_b16 a[146:147], v200 offset:36864
    v_mfma_f32_16x16x32_bf16 v[108:111], a[180:183], a[28:31], v[108:111]
    ds_read_b64_tr_b16 a[148:149], v201 offset:32768
    v_mfma_f32_16x16x32_bf16 v[104:107], a[180:183], a[24:27], v[104:107]
    ds_read_b64_tr_b16 a[150:151], v201 offset:36864
    s_waitcnt lgkmcnt(12)
    v_mfma_f32_16x16x32_bf16 v[112:115], a[184:187], a[24:27], v[112:115]
    ds_read_b64_tr_b16 a[152:153], v202 offset:32768
    buffer_load_dwordx4 v1, s[60:63], s16 offen offset:3072 lds
    s_add_u32 s16, s16, s31
    v_mfma_f32_16x16x32_bf16 v[116:119], a[184:187], a[28:31], v[116:119]
    ds_read_b64_tr_b16 a[154:155], v202 offset:36864
    v_mfma_f32_16x16x32_bf16 v[124:127], a[188:191], a[28:31], v[124:127]
    ds_read_b64_tr_b16 a[156:157], v203 offset:32768
    v_mfma_f32_16x16x32_bf16 v[120:123], a[188:191], a[24:27], v[120:123]
    ds_read_b64_tr_b16 a[158:159], v203 offset:36864
    s_waitcnt lgkmcnt(12)
    v_mfma_f32_16x16x32_bf16 v[64:67], a[128:131], a[32:35], v[64:67]
    ds_read_b64_tr_b16 a[160:161], v196 offset:40960
    v_mfma_f32_16x16x32_bf16 v[68:71], a[128:131], a[36:39], v[68:71]
    ds_read_b64_tr_b16 a[162:163], v196 offset:45056
    buffer_load_dwordx4 a[80:83], v10, s[20:23], s15 offen offset:0 sc1
    v_mfma_f32_16x16x32_bf16 v[76:79], a[132:135], a[36:39], v[76:79]
    ds_read_b64_tr_b16 a[164:165], v197 offset:40960
    v_mfma_f32_16x16x32_bf16 v[72:75], a[132:135], a[32:35], v[72:75]
    ds_read_b64_tr_b16 a[166:167], v197 offset:45056
    s_waitcnt lgkmcnt(12)
    v_mfma_f32_16x16x32_bf16 v[80:83], a[136:139], a[32:35], v[80:83]
    ds_read_b64_tr_b16 a[168:169], v198 offset:40960
    buffer_load_dwordx4 a[84:87], v10, s[20:23], s15 offen offset:1024 sc1
    v_mfma_f32_16x16x32_bf16 v[84:87], a[136:139], a[36:39], v[84:87]
    ds_read_b64_tr_b16 a[170:171], v198 offset:45056
    v_mfma_f32_16x16x32_bf16 v[92:95], a[140:143], a[36:39], v[92:95]
    ds_read_b64_tr_b16 a[172:173], v199 offset:40960
    v_mfma_f32_16x16x32_bf16 v[88:91], a[140:143], a[32:35], v[88:91]
    ds_read_b64_tr_b16 a[174:175], v199 offset:45056
    buffer_load_dwordx4 a[88:91], v10, s[20:23], s15 offen offset:2048 sc1
    s_waitcnt lgkmcnt(12)
    v_mfma_f32_16x16x32_bf16 v[96:99], a[144:147], a[32:35], v[96:99]
    ds_read_b64_tr_b16 a[176:177], v200 offset:40960
    v_mfma_f32_16x16x32_bf16 v[100:103], a[144:147], a[36:39], v[100:103]
    ds_read_b64_tr_b16 a[178:179], v200 offset:45056
    v_mfma_f32_16x16x32_bf16 v[108:111], a[148:151], a[36:39], v[108:111]
    ds_read_b64_tr_b16 a[180:181], v201 offset:40960
    buffer_load_dwordx4 a[92:95], v10, s[20:23], s15 offen offset:3072 sc1
    s_add_u32 s15, s15, s34
    v_mfma_f32_16x16x32_bf16 v[104:107], a[148:151], a[32:35], v[104:107]
    ds_read_b64_tr_b16 a[182:183], v201 offset:45056
    s_waitcnt lgkmcnt(12)
    v_mfma_f32_16x16x32_bf16 v[112:115], a[152:155], a[32:35], v[112:115]
    ds_read_b64_tr_b16 a[184:185], v202 offset:40960
    v_mfma_f32_16x16x32_bf16 v[116:119], a[152:155], a[36:39], v[116:119]
    ds_read_b64_tr_b16 a[186:187], v202 offset:45056
    buffer_load_dword v194, v212, s[68:71], 0 offen sc1
    v_mfma_f32_16x16x32_bf16 v[124:127], a[156:159], a[36:39], v[124:127]
    ds_read_b64_tr_b16 a[188:189], v203 offset:40960
    v_mfma_f32_16x16x32_bf16 v[120:123], a[156:159], a[32:35], v[120:123]
    ds_read_b64_tr_b16 a[190:191], v203 offset:45056
    s_waitcnt vmcnt(17)
    s_barrier
    s_waitcnt lgkmcnt(12)
    v_mfma_f32_16x16x32_bf16 v[64:67], a[160:163], a[40:43], v[64:67]
    ds_read_b64_tr_b16 a[128:129], v196 offset:49152
    s_add_u32 m0, s24, 16384
    v_mfma_f32_16x16x32_bf16 v[68:71], a[160:163], a[44:47], v[68:71]
    ds_read_b64_tr_b16 a[130:131], v196 offset:53248
    buffer_load_dwordx4 v8, s[60:63], s16 offen offset:0 lds
    v_mfma_f32_16x16x32_bf16 v[76:79], a[164:167], a[44:47], v[76:79]
    ds_read_b64_tr_b16 a[132:133], v197 offset:49152
    v_mfma_f32_16x16x32_bf16 v[72:75], a[164:167], a[40:43], v[72:75]
    ds_read_b64_tr_b16 a[134:135], v197 offset:53248
    s_waitcnt lgkmcnt(12)
    v_mfma_f32_16x16x32_bf16 v[80:83], a[168:171], a[40:43], v[80:83]
    ds_read_b64_tr_b16 a[136:137], v198 offset:49152
    buffer_load_dwordx4 v58, s[60:63], s16 offen offset:1024 lds
    v_mfma_f32_16x16x32_bf16 v[84:87], a[168:171], a[44:47], v[84:87]
    ds_read_b64_tr_b16 a[138:139], v198 offset:53248
    v_mfma_f32_16x16x32_bf16 v[92:95], a[172:175], a[44:47], v[92:95]
    ds_read_b64_tr_b16 a[140:141], v199 offset:49152
    v_mfma_f32_16x16x32_bf16 v[88:91], a[172:175], a[40:43], v[88:91]
    ds_read_b64_tr_b16 a[142:143], v199 offset:53248
    s_waitcnt lgkmcnt(12)
    v_mfma_f32_16x16x32_bf16 v[96:99], a[176:179], a[40:43], v[96:99]
    ds_read_b64_tr_b16 a[144:145], v200 offset:49152
    buffer_load_dwordx4 v59, s[60:63], s16 offen offset:2048 lds
    v_mfma_f32_16x16x32_bf16 v[100:103], a[176:179], a[44:47], v[100:103]
    ds_read_b64_tr_b16 a[146:147], v200 offset:53248
    v_mfma_f32_16x16x32_bf16 v[108:111], a[180:183], a[44:47], v[108:111]
    ds_read_b64_tr_b16 a[148:149], v201 offset:49152
    v_mfma_f32_16x16x32_bf16 v[104:107], a[180:183], a[40:43], v[104:107]
    ds_read_b64_tr_b16 a[150:151], v201 offset:53248
    s_waitcnt lgkmcnt(12)
    v_mfma_f32_16x16x32_bf16 v[112:115], a[184:187], a[40:43], v[112:115]
    ds_read_b64_tr_b16 a[152:153], v202 offset:49152
    buffer_load_dwordx4 v1, s[60:63], s16 offen offset:3072 lds
    s_add_u32 s16, s16, s31
    v_mfma_f32_16x16x32_bf16 v[116:119], a[184:187], a[44:47], v[116:119]
    ds_read_b64_tr_b16 a[154:155], v202 offset:53248
    v_mfma_f32_16x16x32_bf16 v[124:127], a[188:191], a[44:47], v[124:127]
    ds_read_b64_tr_b16 a[156:157], v203 offset:49152
    v_mfma_f32_16x16x32_bf16 v[120:123], a[188:191], a[40:43], v[120:123]
    ds_read_b64_tr_b16 a[158:159], v203 offset:53248
    s_waitcnt lgkmcnt(12)
    v_mfma_f32_16x16x32_bf16 v[64:67], a[128:131], a[48:51], v[64:67]
    ds_read_b64_tr_b16 a[160:161], v196 offset:57344
    v_mfma_f32_16x16x32_bf16 v[68:71], a[128:131], a[52:55], v[68:71]
    ds_read_b64_tr_b16 a[162:163], v196 offset:61440
    buffer_load_dwordx4 a[96:99], v10, s[20:23], s15 offen offset:0 sc1
    v_mfma_f32_16x16x32_bf16 v[76:79], a[132:135], a[52:55], v[76:79]
    ds_read_b64_tr_b16 a[164:165], v197 offset:57344
    v_mfma_f32_16x16x32_bf16 v[72:75], a[132:135], a[48:51], v[72:75]
    ds_read_b64_tr_b16 a[166:167], v197 offset:61440
    s_waitcnt lgkmcnt(12)
    v_mfma_f32_16x16x32_bf16 v[80:83], a[136:139], a[48:51], v[80:83]
    ds_read_b64_tr_b16 a[168:169], v198 offset:57344
    buffer_load_dwordx4 a[100:103], v10, s[20:23], s15 offen offset:1024 sc1
    v_mfma_f32_16x16x32_bf16 v[84:87], a[136:139], a[52:55], v[84:87]
    ds_read_b64_tr_b16 a[170:171], v198 offset:61440
    v_mfma_f32_16x16x32_bf16 v[92:95], a[140:143], a[52:55], v[92:95]
    ds_read_b64_tr_b16 a[172:173], v199 offset:57344
    v_mfma_f32_16x16x32_bf16 v[88:91], a[140:143], a[48:51], v[88:91]
    ds_read_b64_tr_b16 a[174:175], v199 offset:61440
    s_waitcnt lgkmcnt(12)
    v_mfma_f32_16x16x32_bf16 v[96:99], a[144:147], a[48:51], v[96:99]
    ds_read_b64_tr_b16 a[176:177], v200 offset:57344
    buffer_load_dwordx4 a[104:107], v10, s[20:23], s15 offen offset:2048 sc1
    v_mfma_f32_16x16x32_bf16 v[100:103], a[144:147], a[52:55], v[100:103]
    ds_read_b64_tr_b16 a[178:179], v200 offset:61440
    v_mfma_f32_16x16x32_bf16 v[108:111], a[148:151], a[52:55], v[108:111]
    ds_read_b64_tr_b16 a[180:181], v201 offset:57344
    v_mfma_f32_16x16x32_bf16 v[104:107], a[148:151], a[48:51], v[104:107]
    ds_read_b64_tr_b16 a[182:183], v201 offset:61440
    s_waitcnt lgkmcnt(12)
    v_mfma_f32_16x16x32_bf16 v[112:115], a[152:155], a[48:51], v[112:115]
    ds_read_b64_tr_b16 a[184:185], v202 offset:57344
    buffer_load_dwordx4 a[108:111], v10, s[20:23], s15 offen offset:3072 sc1
    s_add_u32 s15, s15, s34
    v_mfma_f32_16x16x32_bf16 v[116:119], a[152:155], a[52:55], v[116:119]
    ds_read_b64_tr_b16 a[186:187], v202 offset:61440
    v_mfma_f32_16x16x32_bf16 v[124:127], a[156:159], a[52:55], v[124:127]
    ds_read_b64_tr_b16 a[188:189], v203 offset:57344
    v_mfma_f32_16x16x32_bf16 v[120:123], a[156:159], a[48:51], v[120:123]
    ds_read_b64_tr_b16 a[190:191], v203 offset:61440
    s_waitcnt vmcnt(17)
    s_barrier
    s_waitcnt lgkmcnt(12)
    v_mfma_f32_16x16x32_bf16 v[64:67], a[160:163], a[56:59], v[64:67]
    ds_read_b64_tr_b16 a[128:129], v204 offset:0
    s_add_u32 m0, s24, 32768
    v_mfma_f32_16x16x32_bf16 v[68:71], a[160:163], a[60:63], v[68:71]
    ds_read_b64_tr_b16 a[130:131], v204 offset:4096
    buffer_load_dwordx4 v8, s[60:63], s16 offen offset:0 lds
    v_mfma_f32_16x16x32_bf16 v[76:79], a[164:167], a[60:63], v[76:79]
    ds_read_b64_tr_b16 a[132:133], v205 offset:0
    v_mfma_f32_16x16x32_bf16 v[72:75], a[164:167], a[56:59], v[72:75]
    ds_read_b64_tr_b16 a[134:135], v205 offset:4096
    s_waitcnt lgkmcnt(12)
    v_mfma_f32_16x16x32_bf16 v[80:83], a[168:171], a[56:59], v[80:83]
    ds_read_b64_tr_b16 a[136:137], v206 offset:0
    buffer_load_dwordx4 v58, s[60:63], s16 offen offset:1024 lds
    v_mfma_f32_16x16x32_bf16 v[84:87], a[168:171], a[60:63], v[84:87]
    ds_read_b64_tr_b16 a[138:139], v206 offset:4096
    v_mfma_f32_16x16x32_bf16 v[92:95], a[172:175], a[60:63], v[92:95]
    ds_read_b64_tr_b16 a[140:141], v207 offset:0
    v_mfma_f32_16x16x32_bf16 v[88:91], a[172:175], a[56:59], v[88:91]
    ds_read_b64_tr_b16 a[142:143], v207 offset:4096
    s_waitcnt lgkmcnt(12)
    v_mfma_f32_16x16x32_bf16 v[96:99], a[176:179], a[56:59], v[96:99]
    ds_read_b64_tr_b16 a[144:145], v208 offset:0
    buffer_load_dwordx4 v59, s[60:63], s16 offen offset:2048 lds
    v_mfma_f32_16x16x32_bf16 v[100:103], a[176:179], a[60:63], v[100:103]
    ds_read_b64_tr_b16 a[146:147], v208 offset:4096
    v_mfma_f32_16x16x32_bf16 v[108:111], a[180:183], a[60:63], v[108:111]
    ds_read_b64_tr_b16 a[148:149], v209 offset:0
    v_mfma_f32_16x16x32_bf16 v[104:107], a[180:183], a[56:59], v[104:107]
    ds_read_b64_tr_b16 a[150:151], v209 offset:4096
    s_waitcnt lgkmcnt(12)
    v_mfma_f32_16x16x32_bf16 v[112:115], a[184:187], a[56:59], v[112:115]
    ds_read_b64_tr_b16 a[152:153], v210 offset:0
    buffer_load_dwordx4 v1, s[60:63], s16 offen offset:3072 lds
    s_add_u32 s16, s16, s31
    v_mfma_f32_16x16x32_bf16 v[116:119], a[184:187], a[60:63], v[116:119]
    ds_read_b64_tr_b16 a[154:155], v210 offset:4096
    v_mfma_f32_16x16x32_bf16 v[124:127], a[188:191], a[60:63], v[124:127]
    ds_read_b64_tr_b16 a[156:157], v211 offset:0
    v_mfma_f32_16x16x32_bf16 v[120:123], a[188:191], a[56:59], v[120:123]
    ds_read_b64_tr_b16 a[158:159], v211 offset:4096
    s_waitcnt lgkmcnt(12)
    v_mfma_f32_16x16x32_bf16 v[64:67], a[128:131], a[64:67], v[64:67]
    ds_read_b64_tr_b16 a[160:161], v204 offset:8192
    v_mfma_f32_16x16x32_bf16 v[68:71], a[128:131], a[68:71], v[68:71]
    ds_read_b64_tr_b16 a[162:163], v204 offset:12288
    buffer_load_dwordx4 a[112:115], v10, s[20:23], s15 offen offset:0 sc1
    v_mfma_f32_16x16x32_bf16 v[76:79], a[132:135], a[68:71], v[76:79]
    ds_read_b64_tr_b16 a[164:165], v205 offset:8192
    v_mfma_f32_16x16x32_bf16 v[72:75], a[132:135], a[64:67], v[72:75]
    ds_read_b64_tr_b16 a[166:167], v205 offset:12288
    s_waitcnt lgkmcnt(12)
    v_mfma_f32_16x16x32_bf16 v[80:83], a[136:139], a[64:67], v[80:83]
    ds_read_b64_tr_b16 a[168:169], v206 offset:8192
    buffer_load_dwordx4 a[116:119], v10, s[20:23], s15 offen offset:1024 sc1
    v_mfma_f32_16x16x32_bf16 v[84:87], a[136:139], a[68:71], v[84:87]
    ds_read_b64_tr_b16 a[170:171], v206 offset:12288
    v_mfma_f32_16x16x32_bf16 v[92:95], a[140:143], a[68:71], v[92:95]
    ds_read_b64_tr_b16 a[172:173], v207 offset:8192
    v_mfma_f32_16x16x32_bf16 v[88:91], a[140:143], a[64:67], v[88:91]
    ds_read_b64_tr_b16 a[174:175], v207 offset:12288
    s_waitcnt lgkmcnt(12)
    v_mfma_f32_16x16x32_bf16 v[96:99], a[144:147], a[64:67], v[96:99]
    ds_read_b64_tr_b16 a[176:177], v208 offset:8192
    buffer_load_dwordx4 a[120:123], v10, s[20:23], s15 offen offset:2048 sc1
    v_mfma_f32_16x16x32_bf16 v[100:103], a[144:147], a[68:71], v[100:103]
    ds_read_b64_tr_b16 a[178:179], v208 offset:12288
    v_mfma_f32_16x16x32_bf16 v[108:111], a[148:151], a[68:71], v[108:111]
    ds_read_b64_tr_b16 a[180:181], v209 offset:8192
    v_mfma_f32_16x16x32_bf16 v[104:107], a[148:151], a[64:67], v[104:107]
    ds_read_b64_tr_b16 a[182:183], v209 offset:12288
    s_waitcnt lgkmcnt(12)
    v_mfma_f32_16x16x32_bf16 v[112:115], a[152:155], a[64:67], v[112:115]
    ds_read_b64_tr_b16 a[184:185], v210 offset:8192
    buffer_load_dwordx4 a[124:127], v10, s[20:23], s15 offen offset:3072 sc1
    s_add_u32 s15, s15, s34
    v_mfma_f32_16x16x32_bf16 v[116:119], a[152:155], a[68:71], v[116:119]
    ds_read_b64_tr_b16 a[186:187], v210 offset:12288
    v_mfma_f32_16x16x32_bf16 v[124:127], a[156:159], a[68:71], v[124:127]
    ds_read_b64_tr_b16 a[188:189], v211 offset:8192
    v_mfma_f32_16x16x32_bf16 v[120:123], a[156:159], a[64:67], v[120:123]
    ds_read_b64_tr_b16 a[190:191], v211 offset:12288
    s_waitcnt vmcnt(17)
    s_barrier
    s_waitcnt lgkmcnt(12)
    v_mfma_f32_16x16x32_bf16 v[64:67], a[160:163], a[72:75], v[64:67]
    ds_read_b64_tr_b16 a[128:129], v204 offset:16384
    s_add_u32 m0, s24, 49152
    v_mfma_f32_16x16x32_bf16 v[68:71], a[160:163], a[76:79], v[68:71]
    ds_read_b64_tr_b16 a[130:131], v204 offset:20480
    buffer_load_dwordx4 v8, s[60:63], s16 offen offset:0 lds
    v_mfma_f32_16x16x32_bf16 v[76:79], a[164:167], a[76:79], v[76:79]
    ds_read_b64_tr_b16 a[132:133], v205 offset:16384
    v_mfma_f32_16x16x32_bf16 v[72:75], a[164:167], a[72:75], v[72:75]
    ds_read_b64_tr_b16 a[134:135], v205 offset:20480
    s_waitcnt lgkmcnt(12)
    v_mfma_f32_16x16x32_bf16 v[80:83], a[168:171], a[72:75], v[80:83]
    ds_read_b64_tr_b16 a[136:137], v206 offset:16384
    buffer_load_dwordx4 v58, s[60:63], s16 offen offset:1024 lds
    v_mfma_f32_16x16x32_bf16 v[84:87], a[168:171], a[76:79], v[84:87]
    ds_read_b64_tr_b16 a[138:139], v206 offset:20480
    v_mfma_f32_16x16x32_bf16 v[92:95], a[172:175], a[76:79], v[92:95]
    ds_read_b64_tr_b16 a[140:141], v207 offset:16384
    v_mfma_f32_16x16x32_bf16 v[88:91], a[172:175], a[72:75], v[88:91]
    ds_read_b64_tr_b16 a[142:143], v207 offset:20480
    s_waitcnt lgkmcnt(12)
    v_mfma_f32_16x16x32_bf16 v[96:99], a[176:179], a[72:75], v[96:99]
    ds_read_b64_tr_b16 a[144:145], v208 offset:16384
    buffer_load_dwordx4 v59, s[60:63], s16 offen offset:2048 lds
    v_mfma_f32_16x16x32_bf16 v[100:103], a[176:179], a[76:79], v[100:103]
    ds_read_b64_tr_b16 a[146:147], v208 offset:20480
    v_mfma_f32_16x16x32_bf16 v[108:111], a[180:183], a[76:79], v[108:111]
    ds_read_b64_tr_b16 a[148:149], v209 offset:16384
    v_mfma_f32_16x16x32_bf16 v[104:107], a[180:183], a[72:75], v[104:107]
    ds_read_b64_tr_b16 a[150:151], v209 offset:20480
    s_waitcnt lgkmcnt(12)
    v_mfma_f32_16x16x32_bf16 v[112:115], a[184:187], a[72:75], v[112:115]
    ds_read_b64_tr_b16 a[152:153], v210 offset:16384
    buffer_load_dwordx4 v1, s[60:63], s16 offen offset:3072 lds
    s_add_u32 s16, s16, s31
    v_mfma_f32_16x16x32_bf16 v[116:119], a[184:187], a[76:79], v[116:119]
    ds_read_b64_tr_b16 a[154:155], v210 offset:20480
    v_mfma_f32_16x16x32_bf16 v[124:127], a[188:191], a[76:79], v[124:127]
    ds_read_b64_tr_b16 a[156:157], v211 offset:16384
    v_mfma_f32_16x16x32_bf16 v[120:123], a[188:191], a[72:75], v[120:123]
    ds_read_b64_tr_b16 a[158:159], v211 offset:20480
    s_waitcnt lgkmcnt(12)
    v_mfma_f32_16x16x32_bf16 v[64:67], a[128:131], a[80:83], v[64:67]
    ds_read_b64_tr_b16 a[160:161], v204 offset:24576
    v_mfma_f32_16x16x32_bf16 v[68:71], a[128:131], a[84:87], v[68:71]
    ds_read_b64_tr_b16 a[162:163], v204 offset:28672
    buffer_load_dwordx4 a[0:3], v10, s[20:23], s15 offen offset:0 sc1
    v_mfma_f32_16x16x32_bf16 v[76:79], a[132:135], a[84:87], v[76:79]
    ds_read_b64_tr_b16 a[164:165], v205 offset:24576
    v_mfma_f32_16x16x32_bf16 v[72:75], a[132:135], a[80:83], v[72:75]
    ds_read_b64_tr_b16 a[166:167], v205 offset:28672
    s_waitcnt lgkmcnt(12)
    v_mfma_f32_16x16x32_bf16 v[80:83], a[136:139], a[80:83], v[80:83]
    ds_read_b64_tr_b16 a[168:169], v206 offset:24576
    buffer_load_dwordx4 a[4:7], v10, s[20:23], s15 offen offset:1024 sc1
    v_mfma_f32_16x16x32_bf16 v[84:87], a[136:139], a[84:87], v[84:87]
    ds_read_b64_tr_b16 a[170:171], v206 offset:28672
    v_mfma_f32_16x16x32_bf16 v[92:95], a[140:143], a[84:87], v[92:95]
    ds_read_b64_tr_b16 a[172:173], v207 offset:24576
    v_mfma_f32_16x16x32_bf16 v[88:91], a[140:143], a[80:83], v[88:91]
    ds_read_b64_tr_b16 a[174:175], v207 offset:28672
    s_waitcnt lgkmcnt(12)
    v_mfma_f32_16x16x32_bf16 v[96:99], a[144:147], a[80:83], v[96:99]
    ds_read_b64_tr_b16 a[176:177], v208 offset:24576
    buffer_load_dwordx4 a[8:11], v10, s[20:23], s15 offen offset:2048 sc1
    v_mfma_f32_16x16x32_bf16 v[100:103], a[144:147], a[84:87], v[100:103]
    ds_read_b64_tr_b16 a[178:179], v208 offset:28672
    v_mfma_f32_16x16x32_bf16 v[108:111], a[148:151], a[84:87], v[108:111]
    ds_read_b64_tr_b16 a[180:181], v209 offset:24576
    v_mfma_f32_16x16x32_bf16 v[104:107], a[148:151], a[80:83], v[104:107]
    ds_read_b64_tr_b16 a[182:183], v209 offset:28672
    s_waitcnt lgkmcnt(12)
    v_mfma_f32_16x16x32_bf16 v[112:115], a[152:155], a[80:83], v[112:115]
    ds_read_b64_tr_b16 a[184:185], v210 offset:24576
    buffer_load_dwordx4 a[12:15], v10, s[20:23], s15 offen offset:3072 sc1
    s_add_u32 s15, s15, s34
    v_mfma_f32_16x16x32_bf16 v[116:119], a[152:155], a[84:87], v[116:119]
    ds_read_b64_tr_b16 a[186:187], v210 offset:28672
    v_mfma_f32_16x16x32_bf16 v[124:127], a[156:159], a[84:87], v[124:127]
    ds_read_b64_tr_b16 a[188:189], v211 offset:24576
    v_mfma_f32_16x16x32_bf16 v[120:123], a[156:159], a[80:83], v[120:123]
    ds_read_b64_tr_b16 a[190:191], v211 offset:28672
    s_waitcnt vmcnt(16)
    s_barrier
    s_waitcnt lgkmcnt(12)
    v_mfma_f32_16x16x32_bf16 v[64:67], a[160:163], a[88:91], v[64:67]
    v_sub_u32 v194, v194, v213
    v_cmp_lt_u32 s[56:57], 3, v194
    ds_read_b64_tr_b16 a[128:129], v204 offset:32768
    s_add_u32 m0, s24, 65536
    v_mfma_f32_16x16x32_bf16 v[68:71], a[160:163], a[92:95], v[68:71]
    ds_read_b64_tr_b16 a[130:131], v204 offset:36864
    buffer_load_dwordx4 v8, s[60:63], s16 offen offset:0 lds
    v_mfma_f32_16x16x32_bf16 v[76:79], a[164:167], a[92:95], v[76:79]
    ds_read_b64_tr_b16 a[132:133], v205 offset:32768
    v_mfma_f32_16x16x32_bf16 v[72:75], a[164:167], a[88:91], v[72:75]
    ds_read_b64_tr_b16 a[134:135], v205 offset:36864
    s_waitcnt lgkmcnt(12)
    v_mfma_f32_16x16x32_bf16 v[80:83], a[168:171], a[88:91], v[80:83]
    ds_read_b64_tr_b16 a[136:137], v206 offset:32768
    buffer_load_dwordx4 v58, s[60:63], s16 offen offset:1024 lds
    v_mfma_f32_16x16x32_bf16 v[84:87], a[168:171], a[92:95], v[84:87]
    ds_read_b64_tr_b16 a[138:139], v206 offset:36864
    v_mfma_f32_16x16x32_bf16 v[92:95], a[172:175], a[92:95], v[92:95]
    ds_read_b64_tr_b16 a[140:141], v207 offset:32768
    v_mfma_f32_16x16x32_bf16 v[88:91], a[172:175], a[88:91], v[88:91]
    ds_read_b64_tr_b16 a[142:143], v207 offset:36864
    s_waitcnt lgkmcnt(12)
    v_mfma_f32_16x16x32_bf16 v[96:99], a[176:179], a[88:91], v[96:99]
    ds_read_b64_tr_b16 a[144:145], v208 offset:32768
    buffer_load_dwordx4 v59, s[60:63], s16 offen offset:2048 lds
    v_mfma_f32_16x16x32_bf16 v[100:103], a[176:179], a[92:95], v[100:103]
    ds_read_b64_tr_b16 a[146:147], v208 offset:36864
    v_mfma_f32_16x16x32_bf16 v[108:111], a[180:183], a[92:95], v[108:111]
    ds_read_b64_tr_b16 a[148:149], v209 offset:32768
    v_mfma_f32_16x16x32_bf16 v[104:107], a[180:183], a[88:91], v[104:107]
    ds_read_b64_tr_b16 a[150:151], v209 offset:36864
    s_waitcnt lgkmcnt(12)
    v_mfma_f32_16x16x32_bf16 v[112:115], a[184:187], a[88:91], v[112:115]
    ds_read_b64_tr_b16 a[152:153], v210 offset:32768
    buffer_load_dwordx4 v1, s[60:63], s16 offen offset:3072 lds
    s_add_u32 s16, s16, s31
    v_mfma_f32_16x16x32_bf16 v[116:119], a[184:187], a[92:95], v[116:119]
    ds_read_b64_tr_b16 a[154:155], v210 offset:36864
    v_mfma_f32_16x16x32_bf16 v[124:127], a[188:191], a[92:95], v[124:127]
    ds_read_b64_tr_b16 a[156:157], v211 offset:32768
    v_mfma_f32_16x16x32_bf16 v[120:123], a[188:191], a[88:91], v[120:123]
    ds_read_b64_tr_b16 a[158:159], v211 offset:36864
    s_waitcnt lgkmcnt(12)
    v_mfma_f32_16x16x32_bf16 v[64:67], a[128:131], a[96:99], v[64:67]
    ds_read_b64_tr_b16 a[160:161], v204 offset:40960
    v_mfma_f32_16x16x32_bf16 v[68:71], a[128:131], a[100:103], v[68:71]
    ds_read_b64_tr_b16 a[162:163], v204 offset:45056
    buffer_load_dwordx4 a[16:19], v10, s[20:23], s15 offen offset:0 sc1
    v_mfma_f32_16x16x32_bf16 v[76:79], a[132:135], a[100:103], v[76:79]
    ds_read_b64_tr_b16 a[164:165], v205 offset:40960
    v_mfma_f32_16x16x32_bf16 v[72:75], a[132:135], a[96:99], v[72:75]
    ds_read_b64_tr_b16 a[166:167], v205 offset:45056
    s_waitcnt lgkmcnt(12)
    v_mfma_f32_16x16x32_bf16 v[80:83], a[136:139], a[96:99], v[80:83]
    ds_read_b64_tr_b16 a[168:169], v206 offset:40960
    buffer_load_dwordx4 a[20:23], v10, s[20:23], s15 offen offset:1024 sc1
    v_mfma_f32_16x16x32_bf16 v[84:87], a[136:139], a[100:103], v[84:87]
    ds_read_b64_tr_b16 a[170:171], v206 offset:45056
    v_mfma_f32_16x16x32_bf16 v[92:95], a[140:143], a[100:103], v[92:95]
    ds_read_b64_tr_b16 a[172:173], v207 offset:40960
    v_mfma_f32_16x16x32_bf16 v[88:91], a[140:143], a[96:99], v[88:91]
    ds_read_b64_tr_b16 a[174:175], v207 offset:45056
    s_waitcnt lgkmcnt(12)
    v_mfma_f32_16x16x32_bf16 v[96:99], a[144:147], a[96:99], v[96:99]
    ds_read_b64_tr_b16 a[176:177], v208 offset:40960
    buffer_load_dwordx4 a[24:27], v10, s[20:23], s15 offen offset:2048 sc1
    v_mfma_f32_16x16x32_bf16 v[100:103], a[144:147], a[100:103], v[100:103]
    ds_read_b64_tr_b16 a[178:179], v208 offset:45056
    v_mfma_f32_16x16x32_bf16 v[108:111], a[148:151], a[100:103], v[108:111]
    ds_read_b64_tr_b16 a[180:181], v209 offset:40960
    v_mfma_f32_16x16x32_bf16 v[104:107], a[148:151], a[96:99], v[104:107]
    ds_read_b64_tr_b16 a[182:183], v209 offset:45056
    s_waitcnt lgkmcnt(12)
    v_mfma_f32_16x16x32_bf16 v[112:115], a[152:155], a[96:99], v[112:115]
    ds_read_b64_tr_b16 a[184:185], v210 offset:40960
    buffer_load_dwordx4 a[28:31], v10, s[20:23], s15 offen offset:3072 sc1
    s_add_u32 s15, s15, s34
    v_mfma_f32_16x16x32_bf16 v[116:119], a[152:155], a[100:103], v[116:119]
    ds_read_b64_tr_b16 a[186:187], v210 offset:45056
    v_mfma_f32_16x16x32_bf16 v[124:127], a[156:159], a[100:103], v[124:127]
    ds_read_b64_tr_b16 a[188:189], v211 offset:40960
    v_mfma_f32_16x16x32_bf16 v[120:123], a[156:159], a[96:99], v[120:123]
    ds_read_b64_tr_b16 a[190:191], v211 offset:45056
    s_waitcnt vmcnt(16)
    s_barrier
    s_waitcnt lgkmcnt(12)
    v_mfma_f32_16x16x32_bf16 v[64:67], a[160:163], a[104:107], v[64:67]
    ds_read_b64_tr_b16 a[128:129], v204 offset:49152
    s_add_u32 m0, s24, 81920
    v_mfma_f32_16x16x32_bf16 v[68:71], a[160:163], a[108:111], v[68:71]
    ds_read_b64_tr_b16 a[130:131], v204 offset:53248
    buffer_load_dwordx4 v8, s[60:63], s16 offen offset:0 lds
    v_mfma_f32_16x16x32_bf16 v[76:79], a[164:167], a[108:111], v[76:79]
    ds_read_b64_tr_b16 a[132:133], v205 offset:49152
    v_mfma_f32_16x16x32_bf16 v[72:75], a[164:167], a[104:107], v[72:75]
    ds_read_b64_tr_b16 a[134:135], v205 offset:53248
    s_waitcnt lgkmcnt(12)
    v_mfma_f32_16x16x32_bf16 v[80:83], a[168:171], a[104:107], v[80:83]
    ds_read_b64_tr_b16 a[136:137], v206 offset:49152
    buffer_load_dwordx4 v58, s[60:63], s16 offen offset:1024 lds
    v_mfma_f32_16x16x32_bf16 v[84:87], a[168:171], a[108:111], v[84:87]
    ds_read_b64_tr_b16 a[138:139], v206 offset:53248
    v_mfma_f32_16x16x32_bf16 v[92:95], a[172:175], a[108:111], v[92:95]
    ds_read_b64_tr_b16 a[140:141], v207 offset:49152
    v_mfma_f32_16x16x32_bf16 v[88:91], a[172:175], a[104:107], v[88:91]
    ds_read_b64_tr_b16 a[142:143], v207 offset:53248
    s_waitcnt lgkmcnt(12)
    v_mfma_f32_16x16x32_bf16 v[96:99], a[176:179], a[104:107], v[96:99]
    ds_read_b64_tr_b16 a[144:145], v208 offset:49152
    buffer_load_dwordx4 v59, s[60:63], s16 offen offset:2048 lds
    v_mfma_f32_16x16x32_bf16 v[100:103], a[176:179], a[108:111], v[100:103]
    ds_read_b64_tr_b16 a[146:147], v208 offset:53248
    v_mfma_f32_16x16x32_bf16 v[108:111], a[180:183], a[108:111], v[108:111]
    ds_read_b64_tr_b16 a[148:149], v209 offset:49152
    v_mfma_f32_16x16x32_bf16 v[104:107], a[180:183], a[104:107], v[104:107]
    ds_read_b64_tr_b16 a[150:151], v209 offset:53248
    s_waitcnt lgkmcnt(12)
    v_mfma_f32_16x16x32_bf16 v[112:115], a[184:187], a[104:107], v[112:115]
    ds_read_b64_tr_b16 a[152:153], v210 offset:49152
    buffer_load_dwordx4 v1, s[60:63], s16 offen offset:3072 lds
    s_add_u32 s16, s16, s31
    v_mfma_f32_16x16x32_bf16 v[116:119], a[184:187], a[108:111], v[116:119]
    ds_read_b64_tr_b16 a[154:155], v210 offset:53248
    v_mfma_f32_16x16x32_bf16 v[124:127], a[188:191], a[108:111], v[124:127]
    ds_read_b64_tr_b16 a[156:157], v211 offset:49152
    v_mfma_f32_16x16x32_bf16 v[120:123], a[188:191], a[104:107], v[120:123]
    ds_read_b64_tr_b16 a[158:159], v211 offset:53248
    s_waitcnt lgkmcnt(12)
    v_mfma_f32_16x16x32_bf16 v[64:67], a[128:131], a[112:115], v[64:67]
    ds_read_b64_tr_b16 a[160:161], v204 offset:57344
    v_mfma_f32_16x16x32_bf16 v[68:71], a[128:131], a[116:119], v[68:71]
    ds_read_b64_tr_b16 a[162:163], v204 offset:61440
    buffer_load_dwordx4 a[32:35], v10, s[20:23], s15 offen offset:0 sc1
    v_mfma_f32_16x16x32_bf16 v[76:79], a[132:135], a[116:119], v[76:79]
    ds_read_b64_tr_b16 a[164:165], v205 offset:57344
    v_mfma_f32_16x16x32_bf16 v[72:75], a[132:135], a[112:115], v[72:75]
    ds_read_b64_tr_b16 a[166:167], v205 offset:61440
    s_waitcnt lgkmcnt(12)
    v_mfma_f32_16x16x32_bf16 v[80:83], a[136:139], a[112:115], v[80:83]
    ds_read_b64_tr_b16 a[168:169], v206 offset:57344
    buffer_load_dwordx4 a[36:39], v10, s[20:23], s15 offen offset:1024 sc1
    v_mfma_f32_16x16x32_bf16 v[84:87], a[136:139], a[116:119], v[84:87]
    ds_read_b64_tr_b16 a[170:171], v206 offset:61440
    v_mfma_f32_16x16x32_bf16 v[92:95], a[140:143], a[116:119], v[92:95]
    ds_read_b64_tr_b16 a[172:173], v207 offset:57344
    v_mfma_f32_16x16x32_bf16 v[88:91], a[140:143], a[112:115], v[88:91]
    ds_read_b64_tr_b16 a[174:175], v207 offset:61440
    s_waitcnt lgkmcnt(12)
    v_mfma_f32_16x16x32_bf16 v[96:99], a[144:147], a[112:115], v[96:99]
    ds_read_b64_tr_b16 a[176:177], v208 offset:57344
    buffer_load_dwordx4 a[40:43], v10, s[20:23], s15 offen offset:2048 sc1
    v_mfma_f32_16x16x32_bf16 v[100:103], a[144:147], a[116:119], v[100:103]
    ds_read_b64_tr_b16 a[178:179], v208 offset:61440
    v_mfma_f32_16x16x32_bf16 v[108:111], a[148:151], a[116:119], v[108:111]
    ds_read_b64_tr_b16 a[180:181], v209 offset:57344
    v_mfma_f32_16x16x32_bf16 v[104:107], a[148:151], a[112:115], v[104:107]
    ds_read_b64_tr_b16 a[182:183], v209 offset:61440
    s_waitcnt lgkmcnt(12)
    v_mfma_f32_16x16x32_bf16 v[112:115], a[152:155], a[112:115], v[112:115]
    ds_read_b64_tr_b16 a[184:185], v210 offset:57344
    buffer_load_dwordx4 a[44:47], v10, s[20:23], s15 offen offset:3072 sc1
    s_add_u32 s15, s15, s34
    v_mfma_f32_16x16x32_bf16 v[116:119], a[152:155], a[116:119], v[116:119]
    ds_read_b64_tr_b16 a[186:187], v210 offset:61440
    v_mfma_f32_16x16x32_bf16 v[124:127], a[156:159], a[116:119], v[124:127]
    ds_read_b64_tr_b16 a[188:189], v211 offset:57344
    v_mfma_f32_16x16x32_bf16 v[120:123], a[156:159], a[112:115], v[120:123]
    ds_read_b64_tr_b16 a[190:191], v211 offset:61440
    s_waitcnt vmcnt(16)
    s_barrier
    s_waitcnt lgkmcnt(12)
    v_mfma_f32_16x16x32_bf16 v[64:67], a[160:163], a[120:123], v[64:67]
    ds_read_b64_tr_b16 a[128:129], v196 offset:0
    s_add_u32 m0, s33, 98304
    v_mfma_f32_16x16x32_bf16 v[68:71], a[160:163], a[124:127], v[68:71]
    ds_read_b64_tr_b16 a[130:131], v196 offset:4096
    buffer_load_dwordx4 v214, s[60:63], s32 offen offset:0 lds
    v_mfma_f32_16x16x32_bf16 v[76:79], a[164:167], a[124:127], v[76:79]
    ds_read_b64_tr_b16 a[132:133], v197 offset:0
    v_mfma_f32_16x16x32_bf16 v[72:75], a[164:167], a[120:123], v[72:75]
    ds_read_b64_tr_b16 a[134:135], v197 offset:4096
    s_waitcnt lgkmcnt(12)
    v_mfma_f32_16x16x32_bf16 v[80:83], a[168:171], a[120:123], v[80:83]
    ds_read_b64_tr_b16 a[136:137], v198 offset:0
    v_mfma_f32_16x16x32_bf16 v[84:87], a[168:171], a[124:127], v[84:87]
    ds_read_b64_tr_b16 a[138:139], v198 offset:4096
    v_mfma_f32_16x16x32_bf16 v[92:95], a[172:175], a[124:127], v[92:95]
    ds_read_b64_tr_b16 a[140:141], v199 offset:0
    v_mfma_f32_16x16x32_bf16 v[88:91], a[172:175], a[120:123], v[88:91]
    ds_read_b64_tr_b16 a[142:143], v199 offset:4096
    s_waitcnt lgkmcnt(12)
    v_mfma_f32_16x16x32_bf16 v[96:99], a[176:179], a[120:123], v[96:99]
    ds_read_b64_tr_b16 a[144:145], v200 offset:0
    buffer_load_dwordx4 v215, s[60:63], s32 offen offset:1024 lds
    s_add_u32 s32, s32, s31
    v_mfma_f32_16x16x32_bf16 v[100:103], a[176:179], a[124:127], v[100:103]
    ds_read_b64_tr_b16 a[146:147], v200 offset:4096
    v_mfma_f32_16x16x32_bf16 v[108:111], a[180:183], a[124:127], v[108:111]
    ds_read_b64_tr_b16 a[148:149], v201 offset:0
    v_mfma_f32_16x16x32_bf16 v[104:107], a[180:183], a[120:123], v[104:107]
    ds_read_b64_tr_b16 a[150:151], v201 offset:4096
    s_waitcnt lgkmcnt(12)
    v_mfma_f32_16x16x32_bf16 v[112:115], a[184:187], a[120:123], v[112:115]
    ds_read_b64_tr_b16 a[152:153], v202 offset:0
    v_mfma_f32_16x16x32_bf16 v[116:119], a[184:187], a[124:127], v[116:119]
    ds_read_b64_tr_b16 a[154:155], v202 offset:4096
    v_mfma_f32_16x16x32_bf16 v[124:127], a[188:191], a[124:127], v[124:127]
    ds_read_b64_tr_b16 a[156:157], v203 offset:0
    v_mfma_f32_16x16x32_bf16 v[120:123], a[188:191], a[120:123], v[120:123]
    ds_read_b64_tr_b16 a[158:159], v203 offset:4096
    s_waitcnt lgkmcnt(12)
    v_mfma_f32_16x16x32_bf16 v[64:67], a[128:131], a[0:3], v[64:67]
    ds_read_b64_tr_b16 a[160:161], v196 offset:8192
    v_mfma_f32_16x16x32_bf16 v[68:71], a[128:131], a[4:7], v[68:71]
    ds_read_b64_tr_b16 a[162:163], v196 offset:12288
    buffer_load_dwordx4 a[48:51], v10, s[20:23], s15 offen offset:0 sc1
    v_mfma_f32_16x16x32_bf16 v[76:79], a[132:135], a[4:7], v[76:79]
    ds_read_b64_tr_b16 a[164:165], v197 offset:8192
    v_mfma_f32_16x16x32_bf16 v[72:75], a[132:135], a[0:3], v[72:75]
    ds_read_b64_tr_b16 a[166:167], v197 offset:12288
    s_waitcnt lgkmcnt(12)
    v_mfma_f32_16x16x32_bf16 v[80:83], a[136:139], a[0:3], v[80:83]
    ds_read_b64_tr_b16 a[168:169], v198 offset:8192
    buffer_load_dwordx4 a[52:55], v10, s[20:23], s15 offen offset:1024 sc1
    v_mfma_f32_16x16x32_bf16 v[84:87], a[136:139], a[4:7], v[84:87]
    ds_read_b64_tr_b16 a[170:171], v198 offset:12288
    v_mfma_f32_16x16x32_bf16 v[92:95], a[140:143], a[4:7], v[92:95]
    ds_read_b64_tr_b16 a[172:173], v199 offset:8192
    v_mfma_f32_16x16x32_bf16 v[88:91], a[140:143], a[0:3], v[88:91]
    ds_read_b64_tr_b16 a[174:175], v199 offset:12288
    s_waitcnt lgkmcnt(12)
    v_mfma_f32_16x16x32_bf16 v[96:99], a[144:147], a[0:3], v[96:99]
    ds_read_b64_tr_b16 a[176:177], v200 offset:8192
    buffer_load_dwordx4 a[56:59], v10, s[20:23], s15 offen offset:2048 sc1
    v_mfma_f32_16x16x32_bf16 v[100:103], a[144:147], a[4:7], v[100:103]
    ds_read_b64_tr_b16 a[178:179], v200 offset:12288
    v_mfma_f32_16x16x32_bf16 v[108:111], a[148:151], a[4:7], v[108:111]
    ds_read_b64_tr_b16 a[180:181], v201 offset:8192
    v_mfma_f32_16x16x32_bf16 v[104:107], a[148:151], a[0:3], v[104:107]
    ds_read_b64_tr_b16 a[182:183], v201 offset:12288
    s_waitcnt lgkmcnt(12)
    v_mfma_f32_16x16x32_bf16 v[112:115], a[152:155], a[0:3], v[112:115]
    ds_read_b64_tr_b16 a[184:185], v202 offset:8192
    buffer_load_dwordx4 a[60:63], v10, s[20:23], s15 offen offset:3072 sc1
    s_add_u32 s15, s15, s34
    v_mfma_f32_16x16x32_bf16 v[116:119], a[152:155], a[4:7], v[116:119]
    ds_read_b64_tr_b16 a[186:187], v202 offset:12288
    v_mfma_f32_16x16x32_bf16 v[124:127], a[156:159], a[4:7], v[124:127]
    ds_read_b64_tr_b16 a[188:189], v203 offset:8192
    v_mfma_f32_16x16x32_bf16 v[120:123], a[156:159], a[0:3], v[120:123]
    ds_read_b64_tr_b16 a[190:191], v203 offset:12288
    s_waitcnt vmcnt(14)
    s_barrier
    s_waitcnt lgkmcnt(12)
    v_mfma_f32_16x16x32_bf16 v[64:67], a[160:163], a[8:11], v[64:67]
    ds_read_b64_tr_b16 a[128:129], v196 offset:16384
    s_add_u32 m0, s33, 114688
    v_mfma_f32_16x16x32_bf16 v[68:71], a[160:163], a[12:15], v[68:71]
    ds_read_b64_tr_b16 a[130:131], v196 offset:20480
    buffer_load_dwordx4 v214, s[60:63], s32 offen offset:0 lds
    v_mfma_f32_16x16x32_bf16 v[76:79], a[164:167], a[12:15], v[76:79]
    ds_read_b64_tr_b16 a[132:133], v197 offset:16384
    v_mfma_f32_16x16x32_bf16 v[72:75], a[164:167], a[8:11], v[72:75]
    ds_read_b64_tr_b16 a[134:135], v197 offset:20480
    s_waitcnt lgkmcnt(12)
    v_mfma_f32_16x16x32_bf16 v[80:83], a[168:171], a[8:11], v[80:83]
    ds_read_b64_tr_b16 a[136:137], v198 offset:16384
    v_mfma_f32_16x16x32_bf16 v[84:87], a[168:171], a[12:15], v[84:87]
    ds_read_b64_tr_b16 a[138:139], v198 offset:20480
    v_mfma_f32_16x16x32_bf16 v[92:95], a[172:175], a[12:15], v[92:95]
    ds_read_b64_tr_b16 a[140:141], v199 offset:16384
    v_mfma_f32_16x16x32_bf16 v[88:91], a[172:175], a[8:11], v[88:91]
    ds_read_b64_tr_b16 a[142:143], v199 offset:20480
    s_waitcnt lgkmcnt(12)
    v_mfma_f32_16x16x32_bf16 v[96:99], a[176:179], a[8:11], v[96:99]
    ds_read_b64_tr_b16 a[144:145], v200 offset:16384
    buffer_load_dwordx4 v215, s[60:63], s32 offen offset:1024 lds
    s_add_u32 s32, s32, s31
    v_mfma_f32_16x16x32_bf16 v[100:103], a[176:179], a[12:15], v[100:103]
    ds_read_b64_tr_b16 a[146:147], v200 offset:20480
    v_mfma_f32_16x16x32_bf16 v[108:111], a[180:183], a[12:15], v[108:111]
    ds_read_b64_tr_b16 a[148:149], v201 offset:16384
    v_mfma_f32_16x16x32_bf16 v[104:107], a[180:183], a[8:11], v[104:107]
    ds_read_b64_tr_b16 a[150:151], v201 offset:20480
    s_waitcnt lgkmcnt(12)
    v_mfma_f32_16x16x32_bf16 v[112:115], a[184:187], a[8:11], v[112:115]
    ds_read_b64_tr_b16 a[152:153], v202 offset:16384
    v_mfma_f32_16x16x32_bf16 v[116:119], a[184:187], a[12:15], v[116:119]
    ds_read_b64_tr_b16 a[154:155], v202 offset:20480
    v_mfma_f32_16x16x32_bf16 v[124:127], a[188:191], a[12:15], v[124:127]
    ds_read_b64_tr_b16 a[156:157], v203 offset:16384
    v_mfma_f32_16x16x32_bf16 v[120:123], a[188:191], a[8:11], v[120:123]
    ds_read_b64_tr_b16 a[158:159], v203 offset:20480
    s_waitcnt lgkmcnt(12)
    v_mfma_f32_16x16x32_bf16 v[64:67], a[128:131], a[16:19], v[64:67]
    ds_read_b64_tr_b16 a[160:161], v196 offset:24576
    v_mfma_f32_16x16x32_bf16 v[68:71], a[128:131], a[20:23], v[68:71]
    ds_read_b64_tr_b16 a[162:163], v196 offset:28672
    buffer_load_dwordx4 a[64:67], v10, s[20:23], s15 offen offset:0 sc1
    v_mfma_f32_16x16x32_bf16 v[76:79], a[132:135], a[20:23], v[76:79]
    ds_read_b64_tr_b16 a[164:165], v197 offset:24576
    v_mfma_f32_16x16x32_bf16 v[72:75], a[132:135], a[16:19], v[72:75]
    ds_read_b64_tr_b16 a[166:167], v197 offset:28672
    s_waitcnt lgkmcnt(12)
    v_mfma_f32_16x16x32_bf16 v[80:83], a[136:139], a[16:19], v[80:83]
    ds_read_b64_tr_b16 a[168:169], v198 offset:24576
    buffer_load_dwordx4 a[68:71], v10, s[20:23], s15 offen offset:1024 sc1
    v_mfma_f32_16x16x32_bf16 v[84:87], a[136:139], a[20:23], v[84:87]
    ds_read_b64_tr_b16 a[170:171], v198 offset:28672
    v_mfma_f32_16x16x32_bf16 v[92:95], a[140:143], a[20:23], v[92:95]
    ds_read_b64_tr_b16 a[172:173], v199 offset:24576
    v_mfma_f32_16x16x32_bf16 v[88:91], a[140:143], a[16:19], v[88:91]
    ds_read_b64_tr_b16 a[174:175], v199 offset:28672
    s_waitcnt lgkmcnt(12)
    v_mfma_f32_16x16x32_bf16 v[96:99], a[144:147], a[16:19], v[96:99]
    ds_read_b64_tr_b16 a[176:177], v200 offset:24576
    buffer_load_dwordx4 a[72:75], v10, s[20:23], s15 offen offset:2048 sc1
    v_mfma_f32_16x16x32_bf16 v[100:103], a[144:147], a[20:23], v[100:103]
    ds_read_b64_tr_b16 a[178:179], v200 offset:28672
    v_mfma_f32_16x16x32_bf16 v[108:111], a[148:151], a[20:23], v[108:111]
    ds_read_b64_tr_b16 a[180:181], v201 offset:24576
    v_mfma_f32_16x16x32_bf16 v[104:107], a[148:151], a[16:19], v[104:107]
    ds_read_b64_tr_b16 a[182:183], v201 offset:28672
    s_waitcnt lgkmcnt(12)
    v_mfma_f32_16x16x32_bf16 v[112:115], a[152:155], a[16:19], v[112:115]
    ds_read_b64_tr_b16 a[184:185], v202 offset:24576
    buffer_load_dwordx4 a[76:79], v10, s[20:23], s15 offen offset:3072 sc1
    s_add_u32 s15, s15, s34
    v_mfma_f32_16x16x32_bf16 v[116:119], a[152:155], a[20:23], v[116:119]
    ds_read_b64_tr_b16 a[186:187], v202 offset:28672
    v_mfma_f32_16x16x32_bf16 v[124:127], a[156:159], a[20:23], v[124:127]
    ds_read_b64_tr_b16 a[188:189], v203 offset:24576
    v_mfma_f32_16x16x32_bf16 v[120:123], a[156:159], a[16:19], v[120:123]
    ds_read_b64_tr_b16 a[190:191], v203 offset:28672
    s_waitcnt vmcnt(12)
    s_barrier
    s_waitcnt lgkmcnt(12)
    v_mfma_f32_16x16x32_bf16 v[64:67], a[160:163], a[24:27], v[64:67]
    ds_read_b64_tr_b16 a[128:129], v196 offset:32768
    s_add_u32 m0, s33, 0
    v_mfma_f32_16x16x32_bf16 v[68:71], a[160:163], a[28:31], v[68:71]
    ds_read_b64_tr_b16 a[130:131], v196 offset:36864
    buffer_load_dwordx4 v214, s[60:63], s32 offen offset:0 lds
    v_mfma_f32_16x16x32_bf16 v[76:79], a[164:167], a[28:31], v[76:79]
    ds_read_b64_tr_b16 a[132:133], v197 offset:32768
    v_mfma_f32_16x16x32_bf16 v[72:75], a[164:167], a[24:27], v[72:75]
    ds_read_b64_tr_b16 a[134:135], v197 offset:36864
    s_waitcnt lgkmcnt(12)
    v_mfma_f32_16x16x32_bf16 v[80:83], a[168:171], a[24:27], v[80:83]
    ds_read_b64_tr_b16 a[136:137], v198 offset:32768
    v_mfma_f32_16x16x32_bf16 v[84:87], a[168:171], a[28:31], v[84:87]
    ds_read_b64_tr_b16 a[138:139], v198 offset:36864
    v_mfma_f32_16x16x32_bf16 v[92:95], a[172:175], a[28:31], v[92:95]
    ds_read_b64_tr_b16 a[140:141], v199 offset:32768
    v_mfma_f32_16x16x32_bf16 v[88:91], a[172:175], a[24:27], v[88:91]
    ds_read_b64_tr_b16 a[142:143], v199 offset:36864
    s_waitcnt lgkmcnt(12)
    v_mfma_f32_16x16x32_bf16 v[96:99], a[176:179], a[24:27], v[96:99]
    ds_read_b64_tr_b16 a[144:145], v200 offset:32768
    buffer_load_dwordx4 v215, s[60:63], s32 offen offset:1024 lds
    s_add_u32 s32, s32, s31
    v_mfma_f32_16x16x32_bf16 v[100:103], a[176:179], a[28:31], v[100:103]
    ds_read_b64_tr_b16 a[146:147], v200 offset:36864
    v_mfma_f32_16x16x32_bf16 v[108:111], a[180:183], a[28:31], v[108:111]
    ds_read_b64_tr_b16 a[148:149], v201 offset:32768
    v_mfma_f32_16x16x32_bf16 v[104:107], a[180:183], a[24:27], v[104:107]
    ds_read_b64_tr_b16 a[150:151], v201 offset:36864
    s_waitcnt lgkmcnt(12)
    v_mfma_f32_16x16x32_bf16 v[112:115], a[184:187], a[24:27], v[112:115]
    ds_read_b64_tr_b16 a[152:153], v202 offset:32768
    v_mfma_f32_16x16x32_bf16 v[116:119], a[184:187], a[28:31], v[116:119]
    ds_read_b64_tr_b16 a[154:155], v202 offset:36864
    v_mfma_f32_16x16x32_bf16 v[124:127], a[188:191], a[28:31], v[124:127]
    ds_read_b64_tr_b16 a[156:157], v203 offset:32768
    v_mfma_f32_16x16x32_bf16 v[120:123], a[188:191], a[24:27], v[120:123]
    ds_read_b64_tr_b16 a[158:159], v203 offset:36864
    s_waitcnt lgkmcnt(12)
    v_mfma_f32_16x16x32_bf16 v[64:67], a[128:131], a[32:35], v[64:67]
    ds_read_b64_tr_b16 a[160:161], v196 offset:40960
    v_mfma_f32_16x16x32_bf16 v[68:71], a[128:131], a[36:39], v[68:71]
    ds_read_b64_tr_b16 a[162:163], v196 offset:45056
    buffer_load_dwordx4 a[80:83], v10, s[20:23], s15 offen offset:0 sc1
    v_mfma_f32_16x16x32_bf16 v[76:79], a[132:135], a[36:39], v[76:79]
    ds_read_b64_tr_b16 a[164:165], v197 offset:40960
    v_mfma_f32_16x16x32_bf16 v[72:75], a[132:135], a[32:35], v[72:75]
    ds_read_b64_tr_b16 a[166:167], v197 offset:45056
    s_waitcnt lgkmcnt(12)
    v_mfma_f32_16x16x32_bf16 v[80:83], a[136:139], a[32:35], v[80:83]
    ds_read_b64_tr_b16 a[168:169], v198 offset:40960
    buffer_load_dwordx4 a[84:87], v10, s[20:23], s15 offen offset:1024 sc1
    v_mfma_f32_16x16x32_bf16 v[84:87], a[136:139], a[36:39], v[84:87]
    ds_read_b64_tr_b16 a[170:171], v198 offset:45056
    v_mfma_f32_16x16x32_bf16 v[92:95], a[140:143], a[36:39], v[92:95]
    ds_read_b64_tr_b16 a[172:173], v199 offset:40960
    v_mfma_f32_16x16x32_bf16 v[88:91], a[140:143], a[32:35], v[88:91]
    ds_read_b64_tr_b16 a[174:175], v199 offset:45056
    s_waitcnt lgkmcnt(12)
    v_mfma_f32_16x16x32_bf16 v[96:99], a[144:147], a[32:35], v[96:99]
    ds_read_b64_tr_b16 a[176:177], v200 offset:40960
    buffer_load_dwordx4 a[88:91], v10, s[20:23], s15 offen offset:2048 sc1
    v_mfma_f32_16x16x32_bf16 v[100:103], a[144:147], a[36:39], v[100:103]
    ds_read_b64_tr_b16 a[178:179], v200 offset:45056
    v_mfma_f32_16x16x32_bf16 v[108:111], a[148:151], a[36:39], v[108:111]
    ds_read_b64_tr_b16 a[180:181], v201 offset:40960
    v_mfma_f32_16x16x32_bf16 v[104:107], a[148:151], a[32:35], v[104:107]
    ds_read_b64_tr_b16 a[182:183], v201 offset:45056
    s_waitcnt lgkmcnt(12)
    v_mfma_f32_16x16x32_bf16 v[112:115], a[152:155], a[32:35], v[112:115]
    ds_read_b64_tr_b16 a[184:185], v202 offset:40960
    buffer_load_dwordx4 a[92:95], v10, s[20:23], s15 offen offset:3072 sc1
    s_add_u32 s15, s15, s34
    v_mfma_f32_16x16x32_bf16 v[116:119], a[152:155], a[36:39], v[116:119]
    ds_read_b64_tr_b16 a[186:187], v202 offset:45056
    v_mfma_f32_16x16x32_bf16 v[124:127], a[156:159], a[36:39], v[124:127]
    ds_read_b64_tr_b16 a[188:189], v203 offset:40960
    v_mfma_f32_16x16x32_bf16 v[120:123], a[156:159], a[32:35], v[120:123]
    ds_read_b64_tr_b16 a[190:191], v203 offset:45056
    s_waitcnt vmcnt(12)
    s_barrier
    s_waitcnt lgkmcnt(12)
    v_mfma_f32_16x16x32_bf16 v[64:67], a[160:163], a[40:43], v[64:67]
    ds_read_b64_tr_b16 a[128:129], v196 offset:49152
    s_add_u32 m0, s33, 16384
    v_mfma_f32_16x16x32_bf16 v[68:71], a[160:163], a[44:47], v[68:71]
    ds_read_b64_tr_b16 a[130:131], v196 offset:53248
    buffer_load_dwordx4 v214, s[60:63], s32 offen offset:0 lds
    v_mfma_f32_16x16x32_bf16 v[76:79], a[164:167], a[44:47], v[76:79]
    ds_read_b64_tr_b16 a[132:133], v197 offset:49152
    v_mfma_f32_16x16x32_bf16 v[72:75], a[164:167], a[40:43], v[72:75]
    ds_read_b64_tr_b16 a[134:135], v197 offset:53248
    s_waitcnt lgkmcnt(12)
    v_mfma_f32_16x16x32_bf16 v[80:83], a[168:171], a[40:43], v[80:83]
    ds_read_b64_tr_b16 a[136:137], v198 offset:49152
    v_mfma_f32_16x16x32_bf16 v[84:87], a[168:171], a[44:47], v[84:87]
    ds_read_b64_tr_b16 a[138:139], v198 offset:53248
    v_mfma_f32_16x16x32_bf16 v[92:95], a[172:175], a[44:47], v[92:95]
    ds_read_b64_tr_b16 a[140:141], v199 offset:49152
    v_mfma_f32_16x16x32_bf16 v[88:91], a[172:175], a[40:43], v[88:91]
    ds_read_b64_tr_b16 a[142:143], v199 offset:53248
    s_waitcnt lgkmcnt(12)
    v_mfma_f32_16x16x32_bf16 v[96:99], a[176:179], a[40:43], v[96:99]
    ds_read_b64_tr_b16 a[144:145], v200 offset:49152
    buffer_load_dwordx4 v215, s[60:63], s32 offen offset:1024 lds
    s_add_u32 s32, s32, s31
    v_mfma_f32_16x16x32_bf16 v[100:103], a[176:179], a[44:47], v[100:103]
    ds_read_b64_tr_b16 a[146:147], v200 offset:53248
    v_mfma_f32_16x16x32_bf16 v[108:111], a[180:183], a[44:47], v[108:111]
    ds_read_b64_tr_b16 a[148:149], v201 offset:49152
    v_mfma_f32_16x16x32_bf16 v[104:107], a[180:183], a[40:43], v[104:107]
    ds_read_b64_tr_b16 a[150:151], v201 offset:53248
    s_waitcnt lgkmcnt(12)
    v_mfma_f32_16x16x32_bf16 v[112:115], a[184:187], a[40:43], v[112:115]
    ds_read_b64_tr_b16 a[152:153], v202 offset:49152
    v_mfma_f32_16x16x32_bf16 v[116:119], a[184:187], a[44:47], v[116:119]
    ds_read_b64_tr_b16 a[154:155], v202 offset:53248
    v_mfma_f32_16x16x32_bf16 v[124:127], a[188:191], a[44:47], v[124:127]
    ds_read_b64_tr_b16 a[156:157], v203 offset:49152
    v_mfma_f32_16x16x32_bf16 v[120:123], a[188:191], a[40:43], v[120:123]
    ds_read_b64_tr_b16 a[158:159], v203 offset:53248
    s_waitcnt lgkmcnt(12)
    v_mfma_f32_16x16x32_bf16 v[64:67], a[128:131], a[48:51], v[64:67]
    ds_read_b64_tr_b16 a[160:161], v196 offset:57344
    v_mfma_f32_16x16x32_bf16 v[68:71], a[128:131], a[52:55], v[68:71]
    ds_read_b64_tr_b16 a[162:163], v196 offset:61440
    buffer_load_dwordx4 a[96:99], v10, s[20:23], s15 offen offset:0 sc1
    v_mfma_f32_16x16x32_bf16 v[76:79], a[132:135], a[52:55], v[76:79]
    ds_read_b64_tr_b16 a[164:165], v197 offset:57344
    v_mfma_f32_16x16x32_bf16 v[72:75], a[132:135], a[48:51], v[72:75]
    ds_read_b64_tr_b16 a[166:167], v197 offset:61440
    s_waitcnt lgkmcnt(12)
    v_mfma_f32_16x16x32_bf16 v[80:83], a[136:139], a[48:51], v[80:83]
    ds_read_b64_tr_b16 a[168:169], v198 offset:57344
    buffer_load_dwordx4 a[100:103], v10, s[20:23], s15 offen offset:1024 sc1
    v_mfma_f32_16x16x32_bf16 v[84:87], a[136:139], a[52:55], v[84:87]
    ds_read_b64_tr_b16 a[170:171], v198 offset:61440
    v_mfma_f32_16x16x32_bf16 v[92:95], a[140:143], a[52:55], v[92:95]
    ds_read_b64_tr_b16 a[172:173], v199 offset:57344
    v_mfma_f32_16x16x32_bf16 v[88:91], a[140:143], a[48:51], v[88:91]
    ds_read_b64_tr_b16 a[174:175], v199 offset:61440
    s_waitcnt lgkmcnt(12)
    v_mfma_f32_16x16x32_bf16 v[96:99], a[144:147], a[48:51], v[96:99]
    ds_read_b64_tr_b16 a[176:177], v200 offset:57344
    buffer_load_dwordx4 a[104:107], v10, s[20:23], s15 offen offset:2048 sc1
    v_mfma_f32_16x16x32_bf16 v[100:103], a[144:147], a[52:55], v[100:103]
    ds_read_b64_tr_b16 a[178:179], v200 offset:61440
    v_mfma_f32_16x16x32_bf16 v[108:111], a[148:151], a[52:55], v[108:111]
    ds_read_b64_tr_b16 a[180:181], v201 offset:57344
    v_mfma_f32_16x16x32_bf16 v[104:107], a[148:151], a[48:51], v[104:107]
    ds_read_b64_tr_b16 a[182:183], v201 offset:61440
    s_waitcnt lgkmcnt(12)
    v_mfma_f32_16x16x32_bf16 v[112:115], a[152:155], a[48:51], v[112:115]
    ds_read_b64_tr_b16 a[184:185], v202 offset:57344
    buffer_load_dwordx4 a[108:111], v10, s[20:23], s15 offen offset:3072 sc1
    s_add_u32 s15, s15, s34
    v_mfma_f32_16x16x32_bf16 v[116:119], a[152:155], a[52:55], v[116:119]
    ds_read_b64_tr_b16 a[186:187], v202 offset:61440
    v_mfma_f32_16x16x32_bf16 v[124:127], a[156:159], a[52:55], v[124:127]
    ds_read_b64_tr_b16 a[188:189], v203 offset:57344
    v_mfma_f32_16x16x32_bf16 v[120:123], a[156:159], a[48:51], v[120:123]
    ds_read_b64_tr_b16 a[190:191], v203 offset:61440
    s_waitcnt vmcnt(12)
    s_barrier
    s_waitcnt lgkmcnt(12)
    v_mfma_f32_16x16x32_bf16 v[64:67], a[160:163], a[56:59], v[64:67]
    ds_read_b64_tr_b16 a[128:129], v204 offset:0
    v_mfma_f32_16x16x32_bf16 v[68:71], a[160:163], a[60:63], v[68:71]
    ds_read_b64_tr_b16 a[130:131], v204 offset:4096
    v_mfma_f32_16x16x32_bf16 v[76:79], a[164:167], a[60:63], v[76:79]
    ds_read_b64_tr_b16 a[132:133], v205 offset:0
    v_mfma_f32_16x16x32_bf16 v[72:75], a[164:167], a[56:59], v[72:75]
    ds_read_b64_tr_b16 a[134:135], v205 offset:4096
    s_waitcnt lgkmcnt(12)
    v_mfma_f32_16x16x32_bf16 v[80:83], a[168:171], a[56:59], v[80:83]
    ds_read_b64_tr_b16 a[136:137], v206 offset:0
    v_mfma_f32_16x16x32_bf16 v[84:87], a[168:171], a[60:63], v[84:87]
    ds_read_b64_tr_b16 a[138:139], v206 offset:4096
    v_mfma_f32_16x16x32_bf16 v[92:95], a[172:175], a[60:63], v[92:95]
    ds_read_b64_tr_b16 a[140:141], v207 offset:0
    v_mfma_f32_16x16x32_bf16 v[88:91], a[172:175], a[56:59], v[88:91]
    ds_read_b64_tr_b16 a[142:143], v207 offset:4096
    s_waitcnt lgkmcnt(12)
    v_mfma_f32_16x16x32_bf16 v[96:99], a[176:179], a[56:59], v[96:99]
    ds_read_b64_tr_b16 a[144:145], v208 offset:0
    v_mfma_f32_16x16x32_bf16 v[100:103], a[176:179], a[60:63], v[100:103]
    ds_read_b64_tr_b16 a[146:147], v208 offset:4096
    v_mfma_f32_16x16x32_bf16 v[108:111], a[180:183], a[60:63], v[108:111]
    ds_read_b64_tr_b16 a[148:149], v209 offset:0
    v_mfma_f32_16x16x32_bf16 v[104:107], a[180:183], a[56:59], v[104:107]
    ds_read_b64_tr_b16 a[150:151], v209 offset:4096
    s_waitcnt lgkmcnt(12)
    v_mfma_f32_16x16x32_bf16 v[112:115], a[184:187], a[56:59], v[112:115]
    ds_read_b64_tr_b16 a[152:153], v210 offset:0
    v_mfma_f32_16x16x32_bf16 v[116:119], a[184:187], a[60:63], v[116:119]
    ds_read_b64_tr_b16 a[154:155], v210 offset:4096
    v_mfma_f32_16x16x32_bf16 v[124:127], a[188:191], a[60:63], v[124:127]
    ds_read_b64_tr_b16 a[156:157], v211 offset:0
    v_mfma_f32_16x16x32_bf16 v[120:123], a[188:191], a[56:59], v[120:123]
    ds_read_b64_tr_b16 a[158:159], v211 offset:4096
    s_waitcnt lgkmcnt(12)
    v_mfma_f32_16x16x32_bf16 v[64:67], a[128:131], a[64:67], v[64:67]
    ds_read_b64_tr_b16 a[160:161], v204 offset:8192
    v_mfma_f32_16x16x32_bf16 v[68:71], a[128:131], a[68:71], v[68:71]
    ds_read_b64_tr_b16 a[162:163], v204 offset:12288
    buffer_load_dwordx4 a[112:115], v10, s[20:23], s15 offen offset:0 sc1
    v_mfma_f32_16x16x32_bf16 v[76:79], a[132:135], a[68:71], v[76:79]
    ds_read_b64_tr_b16 a[164:165], v205 offset:8192
    v_mfma_f32_16x16x32_bf16 v[72:75], a[132:135], a[64:67], v[72:75]
    ds_read_b64_tr_b16 a[166:167], v205 offset:12288
    s_waitcnt lgkmcnt(12)
    v_mfma_f32_16x16x32_bf16 v[80:83], a[136:139], a[64:67], v[80:83]
    ds_read_b64_tr_b16 a[168:169], v206 offset:8192
    buffer_load_dwordx4 a[116:119], v10, s[20:23], s15 offen offset:1024 sc1
    v_mfma_f32_16x16x32_bf16 v[84:87], a[136:139], a[68:71], v[84:87]
    ds_read_b64_tr_b16 a[170:171], v206 offset:12288
    v_mfma_f32_16x16x32_bf16 v[92:95], a[140:143], a[68:71], v[92:95]
    ds_read_b64_tr_b16 a[172:173], v207 offset:8192
    v_mfma_f32_16x16x32_bf16 v[88:91], a[140:143], a[64:67], v[88:91]
    ds_read_b64_tr_b16 a[174:175], v207 offset:12288
    s_waitcnt lgkmcnt(12)
    v_mfma_f32_16x16x32_bf16 v[96:99], a[144:147], a[64:67], v[96:99]
    ds_read_b64_tr_b16 a[176:177], v208 offset:8192
    buffer_load_dwordx4 a[120:123], v10, s[20:23], s15 offen offset:2048 sc1
    v_mfma_f32_16x16x32_bf16 v[100:103], a[144:147], a[68:71], v[100:103]
    ds_read_b64_tr_b16 a[178:179], v208 offset:12288
    v_mfma_f32_16x16x32_bf16 v[108:111], a[148:151], a[68:71], v[108:111]
    ds_read_b64_tr_b16 a[180:181], v209 offset:8192
    v_mfma_f32_16x16x32_bf16 v[104:107], a[148:151], a[64:67], v[104:107]
    ds_read_b64_tr_b16 a[182:183], v209 offset:12288
    s_waitcnt lgkmcnt(12)
    v_mfma_f32_16x16x32_bf16 v[112:115], a[152:155], a[64:67], v[112:115]
    ds_read_b64_tr_b16 a[184:185], v210 offset:8192
    buffer_load_dwordx4 a[124:127], v10, s[20:23], s15 offen offset:3072 sc1
    s_add_u32 s15, s15, s34
    v_mfma_f32_16x16x32_bf16 v[116:119], a[152:155], a[68:71], v[116:119]
    ds_read_b64_tr_b16 a[186:187], v210 offset:12288
    v_mfma_f32_16x16x32_bf16 v[124:127], a[156:159], a[68:71], v[124:127]
    ds_read_b64_tr_b16 a[188:189], v211 offset:8192
    v_mfma_f32_16x16x32_bf16 v[120:123], a[156:159], a[64:67], v[120:123]
    ds_read_b64_tr_b16 a[190:191], v211 offset:12288
    s_waitcnt vmcnt(10)
    s_barrier
    s_waitcnt lgkmcnt(12)
    v_mfma_f32_16x16x32_bf16 v[64:67], a[160:163], a[72:75], v[64:67]
    ds_read_b64_tr_b16 a[128:129], v204 offset:16384
    v_mfma_f32_16x16x32_bf16 v[68:71], a[160:163], a[76:79], v[68:71]
    ds_read_b64_tr_b16 a[130:131], v204 offset:20480
    v_mfma_f32_16x16x32_bf16 v[76:79], a[164:167], a[76:79], v[76:79]
    ds_read_b64_tr_b16 a[132:133], v205 offset:16384
    v_mfma_f32_16x16x32_bf16 v[72:75], a[164:167], a[72:75], v[72:75]
    ds_read_b64_tr_b16 a[134:135], v205 offset:20480
    s_waitcnt lgkmcnt(12)
    v_mfma_f32_16x16x32_bf16 v[80:83], a[168:171], a[72:75], v[80:83]
    ds_read_b64_tr_b16 a[136:137], v206 offset:16384
    v_mfma_f32_16x16x32_bf16 v[84:87], a[168:171], a[76:79], v[84:87]
    ds_read_b64_tr_b16 a[138:139], v206 offset:20480
    v_mfma_f32_16x16x32_bf16 v[92:95], a[172:175], a[76:79], v[92:95]
    ds_read_b64_tr_b16 a[140:141], v207 offset:16384
    v_mfma_f32_16x16x32_bf16 v[88:91], a[172:175], a[72:75], v[88:91]
    ds_read_b64_tr_b16 a[142:143], v207 offset:20480
    s_waitcnt lgkmcnt(12)
    v_mfma_f32_16x16x32_bf16 v[96:99], a[176:179], a[72:75], v[96:99]
    ds_read_b64_tr_b16 a[144:145], v208 offset:16384
    v_mfma_f32_16x16x32_bf16 v[100:103], a[176:179], a[76:79], v[100:103]
    ds_read_b64_tr_b16 a[146:147], v208 offset:20480
    v_mfma_f32_16x16x32_bf16 v[108:111], a[180:183], a[76:79], v[108:111]
    ds_read_b64_tr_b16 a[148:149], v209 offset:16384
    v_mfma_f32_16x16x32_bf16 v[104:107], a[180:183], a[72:75], v[104:107]
    ds_read_b64_tr_b16 a[150:151], v209 offset:20480
    s_waitcnt lgkmcnt(12)
    v_mfma_f32_16x16x32_bf16 v[112:115], a[184:187], a[72:75], v[112:115]
    ds_read_b64_tr_b16 a[152:153], v210 offset:16384
    v_mfma_f32_16x16x32_bf16 v[116:119], a[184:187], a[76:79], v[116:119]
    ds_read_b64_tr_b16 a[154:155], v210 offset:20480
    v_mfma_f32_16x16x32_bf16 v[124:127], a[188:191], a[76:79], v[124:127]
    ds_read_b64_tr_b16 a[156:157], v211 offset:16384
    v_mfma_f32_16x16x32_bf16 v[120:123], a[188:191], a[72:75], v[120:123]
    ds_read_b64_tr_b16 a[158:159], v211 offset:20480
    s_waitcnt lgkmcnt(12)
    v_mfma_f32_16x16x32_bf16 v[64:67], a[128:131], a[80:83], v[64:67]
    ds_read_b64_tr_b16 a[160:161], v204 offset:24576
    v_mfma_f32_16x16x32_bf16 v[68:71], a[128:131], a[84:87], v[68:71]
    ds_read_b64_tr_b16 a[162:163], v204 offset:28672
    buffer_load_dwordx4 a[0:3], v10, s[20:23], s15 offen offset:0 sc1
    v_mfma_f32_16x16x32_bf16 v[76:79], a[132:135], a[84:87], v[76:79]
    ds_read_b64_tr_b16 a[164:165], v205 offset:24576
    v_mfma_f32_16x16x32_bf16 v[72:75], a[132:135], a[80:83], v[72:75]
    ds_read_b64_tr_b16 a[166:167], v205 offset:28672
    s_waitcnt lgkmcnt(12)
    v_mfma_f32_16x16x32_bf16 v[80:83], a[136:139], a[80:83], v[80:83]
    ds_read_b64_tr_b16 a[168:169], v206 offset:24576
    buffer_load_dwordx4 a[4:7], v10, s[20:23], s15 offen offset:1024 sc1
    v_mfma_f32_16x16x32_bf16 v[84:87], a[136:139], a[84:87], v[84:87]
    ds_read_b64_tr_b16 a[170:171], v206 offset:28672
    v_mfma_f32_16x16x32_bf16 v[92:95], a[140:143], a[84:87], v[92:95]
    ds_read_b64_tr_b16 a[172:173], v207 offset:24576
    v_mfma_f32_16x16x32_bf16 v[88:91], a[140:143], a[80:83], v[88:91]
    ds_read_b64_tr_b16 a[174:175], v207 offset:28672
    s_waitcnt lgkmcnt(12)
    v_mfma_f32_16x16x32_bf16 v[96:99], a[144:147], a[80:83], v[96:99]
    ds_read_b64_tr_b16 a[176:177], v208 offset:24576
    buffer_load_dwordx4 a[8:11], v10, s[20:23], s15 offen offset:2048 sc1
    v_mfma_f32_16x16x32_bf16 v[100:103], a[144:147], a[84:87], v[100:103]
    ds_read_b64_tr_b16 a[178:179], v208 offset:28672
    v_mfma_f32_16x16x32_bf16 v[108:111], a[148:151], a[84:87], v[108:111]
    ds_read_b64_tr_b16 a[180:181], v209 offset:24576
    v_mfma_f32_16x16x32_bf16 v[104:107], a[148:151], a[80:83], v[104:107]
    ds_read_b64_tr_b16 a[182:183], v209 offset:28672
    s_waitcnt lgkmcnt(12)
    v_mfma_f32_16x16x32_bf16 v[112:115], a[152:155], a[80:83], v[112:115]
    ds_read_b64_tr_b16 a[184:185], v210 offset:24576
    buffer_load_dwordx4 a[12:15], v10, s[20:23], s15 offen offset:3072 sc1
    s_add_u32 s15, s15, s34
    v_mfma_f32_16x16x32_bf16 v[116:119], a[152:155], a[84:87], v[116:119]
    ds_read_b64_tr_b16 a[186:187], v210 offset:28672
    v_mfma_f32_16x16x32_bf16 v[124:127], a[156:159], a[84:87], v[124:127]
    ds_read_b64_tr_b16 a[188:189], v211 offset:24576
    v_mfma_f32_16x16x32_bf16 v[120:123], a[156:159], a[80:83], v[120:123]
    ds_read_b64_tr_b16 a[190:191], v211 offset:28672
    s_waitcnt vmcnt(8)
    s_barrier
    s_waitcnt lgkmcnt(12)
    v_mfma_f32_16x16x32_bf16 v[64:67], a[160:163], a[88:91], v[64:67]
    ds_read_b64_tr_b16 a[128:129], v186 offset:32768
    v_mfma_f32_16x16x32_bf16 v[68:71], a[160:163], a[92:95], v[68:71]
    v_mfma_f32_16x16x32_bf16 v[76:79], a[164:167], a[92:95], v[76:79]
    ds_read_b64_tr_b16 a[130:131], v186 offset:34816
    v_mfma_f32_16x16x32_bf16 v[72:75], a[164:167], a[88:91], v[72:75]
    s_waitcnt lgkmcnt(10)
    v_mfma_f32_16x16x32_bf16 v[80:83], a[168:171], a[88:91], v[80:83]
    ds_read_b64_tr_b16 a[132:133], v187 offset:32768
    v_mfma_f32_16x16x32_bf16 v[84:87], a[168:171], a[92:95], v[84:87]
    v_mfma_f32_16x16x32_bf16 v[92:95], a[172:175], a[92:95], v[92:95]
    ds_read_b64_tr_b16 a[134:135], v187 offset:34816
    v_mfma_f32_16x16x32_bf16 v[88:91], a[172:175], a[88:91], v[88:91]
    s_waitcnt lgkmcnt(8)
    v_mfma_f32_16x16x32_bf16 v[96:99], a[176:179], a[88:91], v[96:99]
    ds_read_b64_tr_b16 a[136:137], v188 offset:32768
    v_mfma_f32_16x16x32_bf16 v[100:103], a[176:179], a[92:95], v[100:103]
    v_mfma_f32_16x16x32_bf16 v[108:111], a[180:183], a[92:95], v[108:111]
    ds_read_b64_tr_b16 a[138:139], v188 offset:34816
    v_mfma_f32_16x16x32_bf16 v[104:107], a[180:183], a[88:91], v[104:107]
    s_waitcnt lgkmcnt(6)
    v_mfma_f32_16x16x32_bf16 v[112:115], a[184:187], a[88:91], v[112:115]
    ds_read_b64_tr_b16 a[140:141], v189 offset:32768
    v_mfma_f32_16x16x32_bf16 v[116:119], a[184:187], a[92:95], v[116:119]
    v_mfma_f32_16x16x32_bf16 v[124:127], a[188:191], a[92:95], v[124:127]
    ds_read_b64_tr_b16 a[142:143], v189 offset:34816
    v_mfma_f32_16x16x32_bf16 v[120:123], a[188:191], a[88:91], v[120:123]
    s_waitcnt lgkmcnt(4)
    v_mfma_f32_16x16x32_bf16 v[64:67], a[128:131], a[96:99], v[64:67]
    ds_read_b64_tr_b16 a[160:161], v186 offset:36864
    v_mfma_f32_16x16x32_bf16 v[68:71], a[128:131], a[100:103], v[68:71]
    ds_read_b64_tr_b16 a[162:163], v186 offset:38912
    v_mfma_f32_16x16x32_bf16 v[76:79], a[132:135], a[100:103], v[76:79]
    ds_read_b64_tr_b16 a[164:165], v187 offset:36864
    v_mfma_f32_16x16x32_bf16 v[72:75], a[132:135], a[96:99], v[72:75]
    ds_read_b64_tr_b16 a[166:167], v187 offset:38912
    s_waitcnt lgkmcnt(4)
    v_mfma_f32_16x16x32_bf16 v[80:83], a[136:139], a[96:99], v[80:83]
    ds_read_b64_tr_b16 a[168:169], v188 offset:36864
    v_cvt_pk_bf16_f32 v24, v96, v97
    v_cvt_pk_bf16_f32 v25, v98, v99
    v_cvt_pk_bf16_f32 v26, v100, v101
    buffer_store_dwordx4 v[24:27], v10, s[68:71], s25 offen offset:0 sc1
    v_cvt_pk_bf16_f32 v28, v102, v103
    v_cvt_pk_bf16_f32 v29, v104, v105
    v_cvt_pk_bf16_f32 v30, v106, v107
    buffer_store_dwordx4 v[28:31], v10, s[68:71], s25 offen offset:1024 sc1
    v_cvt_pk_bf16_f32 v32, v108, v109
    v_cvt_pk_bf16_f32 v33, v110, v111
    v_cvt_pk_bf16_f32 v34, v112, v113
    buffer_store_dwordx4 v[32:35], v10, s[68:71], s25 offen offset:2048 sc1
    v_mfma_f32_16x16x32_bf16 v[84:87], a[136:139], a[100:103], v[84:87]
    ds_read_b64_tr_b16 a[170:171], v188 offset:38912
    v_cvt_pk_bf16_f32 v36, v114, v115
    v_cvt_pk_bf16_f32 v37, v116, v117
    v_cvt_pk_bf16_f32 v38, v118, v119
    buffer_store_dwordx4 v[36:39], v10, s[68:71], s25 offen offset:3072 sc1
    v_cvt_pk_bf16_f32 v40, v120, v121
    v_cvt_pk_bf16_f32 v41, v122, v123
    v_cvt_pk_bf16_f32 v42, v124, v125
    buffer_store_dwordx4 v[40:43], v10, s[68:71], s35 offen offset:0 sc1
    v_mfma_f32_16x16x32_bf16 v[92:95], a[140:143], a[100:103], v[92:95]
    ds_read_b64_tr_b16 a[172:173], v189 offset:36864
    v_cvt_pk_bf16_f32 v44, v126, v127
    buffer_store_dwordx4 v[44:47], v10, s[68:71], s35 offen offset:1024 sc1
    buffer_load_dwordx4 a[16:19], v10, s[20:23], s15 offen offset:0 sc1
    buffer_load_dwordx4 a[20:23], v10, s[20:23], s15 offen offset:1024 sc1
    v_mfma_f32_16x16x32_bf16 v[88:91], a[140:143], a[96:99], v[88:91]
    ds_read_b64_tr_b16 a[174:175], v189 offset:38912
    buffer_load_dwordx4 a[24:27], v10, s[20:23], s15 offen offset:2048 sc1
    buffer_load_dwordx4 a[28:31], v10, s[20:23], s15 offen offset:3072 sc1
    s_add_u32 s15, s15, s34
    s_waitcnt vmcnt(14)
    s_barrier
    s_waitcnt lgkmcnt(4)
    v_mfma_f32_16x16x32_bf16 v[64:67], a[160:163], a[104:107], v[64:67]
    ds_read_b64_tr_b16 a[128:129], v186 offset:49152
    v_mfma_f32_16x16x32_bf16 v[68:71], a[160:163], a[108:111], v[68:71]
    ds_read_b64_tr_b16 a[130:131], v186 offset:51200
    buffer_load_dwordx4 v[160:163], v21, s[68:71], s30 offen offset:0 sc1
    v_mfma_f32_16x16x32_bf16 v[76:79], a[164:167], a[108:111], v[76:79]
    ds_read_b64_tr_b16 a[132:133], v187 offset:49152
    buffer_load_dwordx4 v[164:167], v21, s[68:71], s30 offen offset:64 sc1
    v_mfma_f32_16x16x32_bf16 v[72:75], a[164:167], a[104:107], v[72:75]
    ds_read_b64_tr_b16 a[134:135], v187 offset:51200
    buffer_load_dwordx4 v[168:171], v21, s[68:71], s42 offen offset:0 sc1
    s_waitcnt lgkmcnt(4)
    v_mfma_f32_16x16x32_bf16 v[80:83], a[168:171], a[104:107], v[80:83]
    ds_read_b64_tr_b16 a[136:137], v188 offset:49152
    buffer_load_dwordx4 v[172:175], v21, s[68:71], s42 offen offset:64 sc1
    v_mfma_f32_16x16x32_bf16 v[84:87], a[168:171], a[108:111], v[84:87]
    ds_read_b64_tr_b16 a[138:139], v188 offset:51200
    buffer_load_dwordx2 v[176:177], v22, s[68:71], s29 offen offset:0 sc1
    v_mfma_f32_16x16x32_bf16 v[92:95], a[172:175], a[108:111], v[92:95]
    ds_read_b64_tr_b16 a[140:141], v189 offset:49152
    buffer_load_dwordx2 v[178:179], v22, s[68:71], s29 offen offset:128 sc1
    v_mfma_f32_16x16x32_bf16 v[88:91], a[172:175], a[104:107], v[88:91]
    ds_read_b64_tr_b16 a[142:143], v189 offset:51200
    s_waitcnt lgkmcnt(4)
    v_mfma_f32_16x16x32_bf16 v[64:67], a[128:131], a[112:115], v[64:67]
    ds_read_b64_tr_b16 a[160:161], v186 offset:53248
    v_mfma_f32_16x16x32_bf16 v[68:71], a[128:131], a[116:119], v[68:71]
    ds_read_b64_tr_b16 a[162:163], v186 offset:55296
    v_mfma_f32_16x16x32_bf16 v[76:79], a[132:135], a[116:119], v[76:79]
    ds_read_b64_tr_b16 a[164:165], v187 offset:53248
    v_mfma_f32_16x16x32_bf16 v[72:75], a[132:135], a[112:115], v[72:75]
    ds_read_b64_tr_b16 a[166:167], v187 offset:55296
    s_waitcnt lgkmcnt(4)
    v_mfma_f32_16x16x32_bf16 v[80:83], a[136:139], a[112:115], v[80:83]
    ds_read_b64_tr_b16 a[168:169], v188 offset:53248
    v_mfma_f32_16x16x32_bf16 v[84:87], a[136:139], a[116:119], v[84:87]
    ds_read_b64_tr_b16 a[170:171], v188 offset:55296
    v_mfma_f32_16x16x32_bf16 v[92:95], a[140:143], a[116:119], v[92:95]
    ds_read_b64_tr_b16 a[172:173], v189 offset:53248
    v_mfma_f32_16x16x32_bf16 v[88:91], a[140:143], a[112:115], v[88:91]
    ds_read_b64_tr_b16 a[174:175], v189 offset:55296
    s_waitcnt vmcnt(16)
    s_barrier
    s_waitcnt lgkmcnt(4)
    v_mfma_f32_16x16x32_bf16 v[64:67], a[160:163], a[120:123], v[64:67]
    ds_read_b64_tr_b16 a[128:129], v182 offset:0
    v_mfma_f32_16x16x32_bf16 v[68:71], a[160:163], a[124:127], v[68:71]
    ds_read_b64_tr_b16 a[130:131], v182 offset:2048
    v_mfma_f32_16x16x32_bf16 v[76:79], a[164:167], a[124:127], v[76:79]
    ds_read_b64_tr_b16 a[132:133], v183 offset:0
    v_mfma_f32_16x16x32_bf16 v[72:75], a[164:167], a[120:123], v[72:75]
    ds_read_b64_tr_b16 a[134:135], v183 offset:2048
    s_waitcnt lgkmcnt(4)
    v_mfma_f32_16x16x32_bf16 v[80:83], a[168:171], a[120:123], v[80:83]
    ds_read_b64_tr_b16 a[136:137], v184 offset:0
    v_mfma_f32_16x16x32_bf16 v[84:87], a[168:171], a[124:127], v[84:87]
    ds_read_b64_tr_b16 a[138:139], v184 offset:2048
    v_mfma_f32_16x16x32_bf16 v[92:95], a[172:175], a[124:127], v[92:95]
    ds_read_b64_tr_b16 a[140:141], v185 offset:0
    v_mfma_f32_16x16x32_bf16 v[88:91], a[172:175], a[120:123], v[88:91]
    ds_read_b64_tr_b16 a[142:143], v185 offset:2048
    s_waitcnt lgkmcnt(4)
    v_mfma_f32_16x16x32_bf16 v[64:67], a[128:131], a[0:3], v[64:67]
    ds_read_b64_tr_b16 a[160:161], v182 offset:4096
    v_mfma_f32_16x16x32_bf16 v[68:71], a[128:131], a[4:7], v[68:71]
    ds_read_b64_tr_b16 a[162:163], v182 offset:6144
    v_mfma_f32_16x16x32_bf16 v[76:79], a[132:135], a[4:7], v[76:79]
    ds_read_b64_tr_b16 a[164:165], v183 offset:4096
    v_mfma_f32_16x16x32_bf16 v[72:75], a[132:135], a[0:3], v[72:75]
    ds_read_b64_tr_b16 a[166:167], v183 offset:6144
    s_waitcnt lgkmcnt(4)
    v_mfma_f32_16x16x32_bf16 v[80:83], a[136:139], a[0:3], v[80:83]
    ds_read_b64_tr_b16 a[168:169], v184 offset:4096
    v_mfma_f32_16x16x32_bf16 v[84:87], a[136:139], a[4:7], v[84:87]
    ds_read_b64_tr_b16 a[170:171], v184 offset:6144
    v_mfma_f32_16x16x32_bf16 v[92:95], a[140:143], a[4:7], v[92:95]
    ds_read_b64_tr_b16 a[172:173], v185 offset:4096
    v_mfma_f32_16x16x32_bf16 v[88:91], a[140:143], a[0:3], v[88:91]
    ds_read_b64_tr_b16 a[174:175], v185 offset:6144
    s_waitcnt vmcnt(6)
    s_barrier
    s_waitcnt lgkmcnt(4)
    v_mfma_f32_16x16x32_bf16 v[64:67], a[160:163], a[8:11], v[64:67]
    ds_read_b64_tr_b16 a[128:129], v182 offset:16384
    v_mfma_f32_16x16x32_bf16 v[68:71], a[160:163], a[12:15], v[68:71]
    ds_read_b64_tr_b16 a[130:131], v182 offset:18432
    v_mfma_f32_16x16x32_bf16 v[76:79], a[164:167], a[12:15], v[76:79]
    ds_read_b64_tr_b16 a[132:133], v183 offset:16384
    v_mfma_f32_16x16x32_bf16 v[72:75], a[164:167], a[8:11], v[72:75]
    ds_read_b64_tr_b16 a[134:135], v183 offset:18432
    s_waitcnt lgkmcnt(4)
    v_mfma_f32_16x16x32_bf16 v[80:83], a[168:171], a[8:11], v[80:83]
    ds_read_b64_tr_b16 a[136:137], v184 offset:16384
    v_mfma_f32_16x16x32_bf16 v[84:87], a[168:171], a[12:15], v[84:87]
    ds_read_b64_tr_b16 a[138:139], v184 offset:18432
    v_mfma_f32_16x16x32_bf16 v[92:95], a[172:175], a[12:15], v[92:95]
    ds_read_b64_tr_b16 a[140:141], v185 offset:16384
    v_mfma_f32_16x16x32_bf16 v[88:91], a[172:175], a[8:11], v[88:91]
    ds_read_b64_tr_b16 a[142:143], v185 offset:18432
    s_waitcnt lgkmcnt(4)
    v_mfma_f32_16x16x32_bf16 v[64:67], a[128:131], a[16:19], v[64:67]
    ds_read_b64_tr_b16 a[160:161], v182 offset:20480
    v_mfma_f32_16x16x32_bf16 v[68:71], a[128:131], a[20:23], v[68:71]
    ds_read_b64_tr_b16 a[162:163], v182 offset:22528
    v_mfma_f32_16x16x32_bf16 v[76:79], a[132:135], a[20:23], v[76:79]
    ds_read_b64_tr_b16 a[164:165], v183 offset:20480
    v_mfma_f32_16x16x32_bf16 v[72:75], a[132:135], a[16:19], v[72:75]
    ds_read_b64_tr_b16 a[166:167], v183 offset:22528
    s_waitcnt lgkmcnt(4)
    v_mfma_f32_16x16x32_bf16 v[80:83], a[136:139], a[16:19], v[80:83]
    ds_read_b64_tr_b16 a[168:169], v184 offset:20480
    v_mfma_f32_16x16x32_bf16 v[84:87], a[136:139], a[20:23], v[84:87]
    ds_read_b64_tr_b16 a[170:171], v184 offset:22528
    v_mfma_f32_16x16x32_bf16 v[92:95], a[140:143], a[20:23], v[92:95]
    ds_read_b64_tr_b16 a[172:173], v185 offset:20480
    v_mfma_f32_16x16x32_bf16 v[88:91], a[140:143], a[16:19], v[88:91]
    ds_read_b64_tr_b16 a[174:175], v185 offset:22528
    s_waitcnt lgkmcnt(4)
    v_mfma_f32_16x16x32_bf16 v[64:67], a[160:163], a[24:27], v[64:67]
    v_mfma_f32_16x16x32_bf16 v[68:71], a[160:163], a[28:31], v[68:71]
    buffer_load_dwordx4 v[128:131], v10, s[68:71], s26 offen offset:0 sc1
    v_mfma_f32_16x16x32_bf16 v[76:79], a[164:167], a[28:31], v[76:79]
    buffer_load_dwordx4 v[132:135], v10, s[68:71], s26 offen offset:1024 sc1
    v_mfma_f32_16x16x32_bf16 v[72:75], a[164:167], a[24:27], v[72:75]
    buffer_load_dwordx4 v[136:139], v10, s[68:71], s26 offen offset:2048 sc1
    s_waitcnt lgkmcnt(0)
    v_mfma_f32_16x16x32_bf16 v[80:83], a[168:171], a[24:27], v[80:83]
    buffer_load_dwordx4 v[140:143], v10, s[68:71], s26 offen offset:3072 sc1
    v_mfma_f32_16x16x32_bf16 v[84:87], a[168:171], a[28:31], v[84:87]
    buffer_load_dwordx4 v[144:147], v10, s[68:71], s36 offen offset:0 sc1
    v_mfma_f32_16x16x32_bf16 v[92:95], a[172:175], a[28:31], v[92:95]
    buffer_load_dwordx4 v[148:151], v10, s[68:71], s36 offen offset:1024 sc1
    v_mfma_f32_16x16x32_bf16 v[88:91], a[172:175], a[24:27], v[88:91]
    s_mov_b32 s76, 100000
    s_cmp_eq_u64 s[56:57], 0
    s_cbranch_scc1 Lpdone_53
Lpoll_52:
    buffer_load_dword v194, v212, s[68:71], 0 offen sc1
    s_waitcnt vmcnt(0)
    v_sub_u32 v194, v194, v213
    v_cmp_lt_u32 vcc, 3, v194
    s_sub_u32 s76, s76, 1
    s_cbranch_scc1 Lgo_54
    s_cbranch_vccnz Lpoll_52
Lgo_54:
    buffer_load_dwordx4 v[160:163], v21, s[68:71], s30 offen offset:0 sc1
    buffer_load_dwordx4 v[164:167], v21, s[68:71], s30 offen offset:64 sc1
    buffer_load_dwordx4 v[168:171], v21, s[68:71], s42 offen offset:0 sc1
    buffer_load_dwordx4 v[172:175], v21, s[68:71], s42 offen offset:64 sc1
    buffer_load_dwordx2 v[176:177], v22, s[68:71], s29 offen offset:0 sc1
    buffer_load_dwordx2 v[178:179], v22, s[68:71], s29 offen offset:128 sc1
Lpdone_53:
Lpp_55:
    s_waitcnt vmcnt(0)
    v_xor_b32 v131, v191, v131
    v_xor_b32 v135, v191, v135
    v_xor_b32 v139, v191, v139
    v_xor_b32 v143, v191, v143
    v_xor_b32 v147, v191, v147
    v_xor_b32 v151, v191, v151
    v_or3_b32 v195, v131, v135, v139
    v_or3_b32 v195, v195, v143, v147
    v_or_b32 v195, v195, v151
    v_cmp_ne_u32 vcc, 0, v195
    s_sub_u32 s76, s76, 1
    s_cbranch_scc1 Lpg_56
    s_cbranch_vccz Lpg_56
    s_sleep 6
    buffer_load_dwordx4 v[128:131], v10, s[68:71], s26 offen offset:0 sc1
    buffer_load_dwordx4 v[132:135], v10, s[68:71], s26 offen offset:1024 sc1
    buffer_load_dwordx4 v[136:139], v10, s[68:71], s26 offen offset:2048 sc1
    buffer_load_dwordx4 v[140:143], v10, s[68:71], s26 offen offset:3072 sc1
    buffer_load_dwordx4 v[144:147], v10, s[68:71], s36 offen offset:0 sc1
    buffer_load_dwordx4 v[148:151], v10, s[68:71], s36 offen offset:1024 sc1
    s_branch Lpp_55
Lpg_56:
    v_and_b32 v97, 0xffff0000, v128
    v_and_b32 v99, 0xffff0000, v129
    v_and_b32 v25, 0xffff0000, v160
    v_and_b32 v27, 0xffff0000, v161
    v_and_b32 v113, 0xffff0000, v138
    v_and_b32 v115, 0xffff0000, v140
    v_and_b32 v33, 0xffff0000, v164
    v_and_b32 v35, 0xffff0000, v165
    v_and_b32 v101, 0xffff0000, v130
    v_and_b32 v103, 0xffff0000, v132
    v_and_b32 v41, 0xffff0000, v168
    v_and_b32 v43, 0xffff0000, v169
    v_and_b32 v117, 0xffff0000, v141
    v_and_b32 v119, 0xffff0000, v142
    v_and_b32 v49, 0xffff0000, v172
    v_and_b32 v51, 0xffff0000, v173
    v_lshlrev_b32 v96, 16, v128
    v_lshlrev_b32 v98, 16, v129
    v_lshlrev_b32 v24, 16, v160
    v_lshlrev_b32 v26, 16, v161
    v_lshlrev_b32 v112, 16, v138
    v_lshlrev_b32 v114, 16, v140
    v_lshlrev_b32 v32, 16, v164
    v_lshlrev_b32 v34, 16, v165
    v_lshlrev_b32 v100, 16, v130
    v_lshlrev_b32 v102, 16, v132
    v_lshlrev_b32 v40, 16, v168
    v_lshlrev_b32 v42, 16, v169
    v_lshlrev_b32 v116, 16, v141
    v_lshlrev_b32 v118, 16, v142
    v_lshlrev_b32 v48, 16, v172
    v_lshlrev_b32 v50, 16, v173
    v_pk_add_f32 v[64:65], v[64:65], v[96:97]
    v_pk_add_f32 v[66:67], v[66:67], v[98:99]
    v_pk_mul_f32 v[24:25], v[24:25], v[176:177] op_sel_hi:[1,0]
    v_pk_mul_f32 v[26:27], v[26:27], v[176:177] op_sel_hi:[1,0]
    v_pk_add_f32 v[80:81], v[80:81], v[112:113]
    v_pk_add_f32 v[82:83], v[82:83], v[114:115]
    v_pk_mul_f32 v[32:33], v[32:33], v[176:177] op_sel_hi:[1,0]
    v_pk_mul_f32 v[34:35], v[34:35], v[176:177] op_sel_hi:[1,0]
    v_pk_add_f32 v[68:69], v[68:69], v[100:101]
    v_pk_add_f32 v[70:71], v[70:71], v[102:103]
    v_pk_mul_f32 v[40:41], v[40:41], v[178:179] op_sel_hi:[1,0]
    v_pk_mul_f32 v[42:43], v[42:43], v[178:179] op_sel_hi:[1,0]
    v_pk_add_f32 v[84:85], v[84:85], v[116:117]
    v_pk_add_f32 v[86:87], v[86:87], v[118:119]
    v_pk_mul_f32 v[48:49], v[48:49], v[178:179] op_sel_hi:[1,0]
    v_pk_mul_f32 v[50:51], v[50:51], v[178:179] op_sel_hi:[1,0]
    v_pk_fma_f32 v[24:25], v[64:65], v[176:177], v[24:25] op_sel:[0,1,0] op_sel_hi:[1,1,1]
    v_pk_fma_f32 v[26:27], v[66:67], v[176:177], v[26:27] op_sel:[0,1,0] op_sel_hi:[1,1,1]
    v_pk_fma_f32 v[32:33], v[80:81], v[176:177], v[32:33] op_sel:[0,1,0] op_sel_hi:[1,1,1]
    v_pk_fma_f32 v[34:35], v[82:83], v[176:177], v[34:35] op_sel:[0,1,0] op_sel_hi:[1,1,1]
    v_pk_fma_f32 v[40:41], v[68:69], v[178:179], v[40:41] op_sel:[0,1,0] op_sel_hi:[1,1,1]
    v_pk_fma_f32 v[42:43], v[70:71], v[178:179], v[42:43] op_sel:[0,1,0] op_sel_hi:[1,1,1]
    v_pk_fma_f32 v[48:49], v[84:85], v[178:179], v[48:49] op_sel:[0,1,0] op_sel_hi:[1,1,1]
    v_pk_fma_f32 v[50:51], v[86:87], v[178:179], v[50:51] op_sel:[0,1,0] op_sel_hi:[1,1,1]
    v_cvt_pk_bf16_f32 v28, v24, v25
    v_cvt_pk_bf16_f32 v29, v26, v27
    v_cvt_pk_bf16_f32 v36, v32, v33
    v_cvt_pk_bf16_f32 v37, v34, v35
    v_cvt_pk_bf16_f32 v44, v40, v41
    v_cvt_pk_bf16_f32 v45, v42, v43
    v_cvt_pk_bf16_f32 v52, v48, v49
    v_cvt_pk_bf16_f32 v53, v50, v51
    v_and_b32 v105, 0xffff0000, v133
    v_and_b32 v107, 0xffff0000, v134
    v_and_b32 v25, 0xffff0000, v162
    v_and_b32 v27, 0xffff0000, v163
    v_and_b32 v121, 0xffff0000, v144
    v_and_b32 v123, 0xffff0000, v145
    v_and_b32 v33, 0xffff0000, v166
    v_and_b32 v35, 0xffff0000, v167
    v_and_b32 v109, 0xffff0000, v136
    v_and_b32 v111, 0xffff0000, v137
    v_and_b32 v41, 0xffff0000, v170
    v_and_b32 v43, 0xffff0000, v171
    v_and_b32 v125, 0xffff0000, v146
    v_and_b32 v127, 0xffff0000, v148
    v_and_b32 v49, 0xffff0000, v174
    v_and_b32 v51, 0xffff0000, v175
    v_lshlrev_b32 v104, 16, v133
    v_lshlrev_b32 v106, 16, v134
    v_lshlrev_b32 v24, 16, v162
    v_lshlrev_b32 v26, 16, v163
    v_lshlrev_b32 v120, 16, v144
    v_lshlrev_b32 v122, 16, v145
    v_lshlrev_b32 v32, 16, v166
    v_lshlrev_b32 v34, 16, v167
    v_lshlrev_b32 v108, 16, v136
    v_lshlrev_b32 v110, 16, v137
    v_lshlrev_b32 v40, 16, v170
    v_lshlrev_b32 v42, 16, v171
    v_lshlrev_b32 v124, 16, v146
    v_lshlrev_b32 v126, 16, v148
    v_lshlrev_b32 v48, 16, v174
    v_lshlrev_b32 v50, 16, v175
    v_pk_add_f32 v[72:73], v[72:73], v[104:105]
    v_pk_add_f32 v[74:75], v[74:75], v[106:107]
    v_pk_mul_f32 v[24:25], v[24:25], v[176:177] op_sel_hi:[1,0]
    v_pk_mul_f32 v[26:27], v[26:27], v[176:177] op_sel_hi:[1,0]
    v_pk_add_f32 v[88:89], v[88:89], v[120:121]
    v_pk_add_f32 v[90:91], v[90:91], v[122:123]
    v_pk_mul_f32 v[32:33], v[32:33], v[176:177] op_sel_hi:[1,0]
    v_pk_mul_f32 v[34:35], v[34:35], v[176:177] op_sel_hi:[1,0]
    v_pk_add_f32 v[76:77], v[76:77], v[108:109]
    v_pk_add_f32 v[78:79], v[78:79], v[110:111]
    v_pk_mul_f32 v[40:41], v[40:41], v[178:179] op_sel_hi:[1,0]
    v_pk_mul_f32 v[42:43], v[42:43], v[178:179] op_sel_hi:[1,0]
    v_pk_add_f32 v[92:93], v[92:93], v[124:125]
    v_pk_add_f32 v[94:95], v[94:95], v[126:127]
    v_pk_mul_f32 v[48:49], v[48:49], v[178:179] op_sel_hi:[1,0]
    v_pk_mul_f32 v[50:51], v[50:51], v[178:179] op_sel_hi:[1,0]
    v_pk_fma_f32 v[24:25], v[72:73], v[176:177], v[24:25] op_sel:[0,1,0] op_sel_hi:[1,1,1]
    v_pk_fma_f32 v[26:27], v[74:75], v[176:177], v[26:27] op_sel:[0,1,0] op_sel_hi:[1,1,1]
    v_pk_fma_f32 v[32:33], v[88:89], v[176:177], v[32:33] op_sel:[0,1,0] op_sel_hi:[1,1,1]
    v_pk_fma_f32 v[34:35], v[90:91], v[176:177], v[34:35] op_sel:[0,1,0] op_sel_hi:[1,1,1]
    v_pk_fma_f32 v[40:41], v[76:77], v[178:179], v[40:41] op_sel:[0,1,0] op_sel_hi:[1,1,1]
    v_pk_fma_f32 v[42:43], v[78:79], v[178:179], v[42:43] op_sel:[0,1,0] op_sel_hi:[1,1,1]
    v_pk_fma_f32 v[48:49], v[92:93], v[178:179], v[48:49] op_sel:[0,1,0] op_sel_hi:[1,1,1]
    v_pk_fma_f32 v[50:51], v[94:95], v[178:179], v[50:51] op_sel:[0,1,0] op_sel_hi:[1,1,1]
    v_cvt_pk_bf16_f32 v30, v24, v25
    v_cvt_pk_bf16_f32 v31, v26, v27
    v_cvt_pk_bf16_f32 v38, v32, v33
    v_cvt_pk_bf16_f32 v39, v34, v35
    v_cvt_pk_bf16_f32 v46, v40, v41
    v_cvt_pk_bf16_f32 v47, v42, v43
    v_cvt_pk_bf16_f32 v54, v48, v49
    v_cvt_pk_bf16_f32 v55, v50, v51
    v_permlane16_swap_b32 v28, v30
    v_permlane16_swap_b32 v29, v31
    v_permlane16_swap_b32 v36, v38
    v_permlane16_swap_b32 v37, v39
    v_permlane16_swap_b32 v44, v46
    v_permlane16_swap_b32 v45, v47
    v_permlane16_swap_b32 v52, v54
    v_permlane16_swap_b32 v53, v55
    buffer_store_dwordx4 v[28:31], v20, s[8:11], s27 offen offset:0
    buffer_store_dwordx4 v[36:39], v20, s[8:11], s27 offen offset:64
    buffer_store_dwordx4 v[44:47], v20, s[8:11], s28 offen offset:0
    buffer_store_dwordx4 v[52:55], v20, s[8:11], s28 offen offset:64
    s_endpgm
Lcode_end:
.section .rodata,"a"
.p2align 6
.amdhsa_kernel gated_mix__spectral_gfnet__swiglu_ffn__prompt_kernel
  .amdhsa_next_free_vgpr 512
  .amdhsa_next_free_sgpr 102
  .amdhsa_accum_offset 256
  .amdhsa_group_segment_fixed_size 0
  .amdhsa_kernarg_size 88
  .amdhsa_user_sgpr_count 2
  .amdhsa_user_sgpr_kernarg_segment_ptr 1
  .amdhsa_system_sgpr_workgroup_id_x 1
.end_amdhsa_kernel
```
